```python
import torch

def _softmax(x, axis=-1):
    return torch.softmax(x, dim=axis)

def _gelu(x):
    return torch.nn.functional.gelu(x, approximate='tanh')

def _silu(x):
    return torch.nn.functional.silu(x)

def _sigmoid(x):
    return torch.sigmoid(x)

def _layernorm(x, axis=-1, eps=1e-05):
    m = x.mean(dim=axis, keepdim=True)
    v = x.var(dim=axis, keepdim=True, unbiased=False)
    return (x - m) / torch.sqrt(v + eps)

def _scatter_add(tgt, idx, src, axis=0):
    return tgt.clone().index_add_(axis, idx, src)

def _segment_sum(src, seg, n):
    out = torch.zeros((n,) + src.shape[1:], dtype=src.dtype)
    return out.index_add_(0, seg, src)

def _pad(x, pw):
    flat = tuple((v for pair in reversed(pw) for v in pair))
    return torch.nn.functional.pad(x, flat)
kernel_name = 'gated_mix__memory_aug_recurrent_mem_tr__dense_activation_gelu__prompt'

def setup_inputs():

    _w = lambda a: (lambda t: t.to(torch.bfloat16) if t.is_floating_point() else t)(torch.as_tensor(a))

    def _A_setup():
        B, S, Dm = (1, 2048, 576)
        H, Dh = (32, 128)
        M, seg = (8, 32)
        seg = min(seg, S)
        S = S // seg * seg
        return {'x': _w((lambda *s: torch.randn(*s, dtype=torch.bfloat16) * 0.05)(B, S, Dm)), 'mem0': _w((lambda *s: torch.randn(*s, dtype=torch.bfloat16) * 0.4)(B, M, Dm)), 'Wq': _w((lambda *s: torch.randn(*s, dtype=torch.bfloat16) * 6.4)(Dm, H, Dh) * Dm ** (-0.5)), 'Wk': _w((lambda *s: torch.randn(*s, dtype=torch.bfloat16) * 6.4)(Dm, H, Dh) * Dm ** (-0.5)), 'Wv': _w((lambda *s: torch.randn(*s, dtype=torch.bfloat16) * 0.4)(Dm, H, Dh) * Dm ** (-0.5)), 'Wo': _w((lambda *s: torch.randn(*s, dtype=torch.bfloat16) * 0.4)(H, Dh, Dm) * (H * Dh) ** (-0.5)), 'seg_len': seg}
    _A_in = _A_setup()

    def _B_setup():
        B, S, D, F = (1, 2048, 576, 4608)
        return {'x': _w((lambda *s: torch.randn(*s, dtype=torch.bfloat16) * 0.05)(B, S, D)), 'w1': _w((lambda *s: torch.randn(*s, dtype=torch.bfloat16) * 3.2)(D, F) * D ** (-0.5)), 'b1': _w((lambda *s: torch.randn(*s, dtype=torch.bfloat16) * 3.2)(F) * 0.01), 'w2': _w((lambda *s: torch.randn(*s, dtype=torch.bfloat16) * 0.2)(F, D) * F ** (-0.5)), 'b2': _w((lambda *s: torch.randn(*s, dtype=torch.bfloat16) * 0.4)(D) * 0.01)}
    _B_in = _B_setup()
    return {'A_x': _A_in['x'], 'A_mem0': _A_in['mem0'], 'A_Wq': _A_in['Wq'], 'A_Wk': _A_in['Wk'], 'A_Wv': _A_in['Wv'], 'A_Wo': _A_in['Wo'], 'A_seg_len': _A_in['seg_len'], 'B_x': _B_in['x'], 'B_w1': _B_in['w1'], 'B_b1': _B_in['b1'], 'B_w2': _B_in['w2'], 'B_b2': _B_in['b2'], 'gate_w': _w((lambda *s: torch.randn(*s, dtype=torch.bfloat16) * 0.05)(576) * 16.0)}

def reference(A_x, A_mem0, A_Wq, A_Wk, A_Wv, A_Wo, A_seg_len, B_x, B_w1, B_b1, B_w2, B_b2, gate_w):

    def _A_ref(x, mem0, Wq, Wk, Wv, Wo, seg_len):
        B, S, Dm = x.shape
        H, Dh = (Wq.shape[1], Wq.shape[2])
        M = mem0.shape[1]
        scale = Dh ** (-0.5)
        n_seg = S // seg_len
        L = M + seg_len
        idx = torch.arange(L)
        mask = (idx[:, None] < M) | (idx[:, None] >= idx[None, :])
        mem = mem0
        outs = []
        for s in range(n_seg):
            xs = x[:, s * seg_len:(s + 1) * seg_len, :].clone()
            h = torch.concatenate([mem, xs], axis=1)
            q = torch.einsum('btd,dhe->bhte', h, Wq)
            k = torch.einsum('btd,dhe->bhte', h, Wk)
            v = torch.einsum('btd,dhe->bhte', h, Wv)
            scores = torch.einsum('bhqe,bhke->bhqk', q, k) * scale
            scores = torch.where(mask[None, None], scores, -1000000000.0)
            p = _softmax(scores, axis=-1)
            o = torch.einsum('bhqk,bhke->bhqe', p, v)
            o = torch.einsum('bhte,hed->btd', o, Wo)
            mem = o[:, :M, :].clone()
            outs.append(o[:, M:, :])
        return torch.concatenate(outs, axis=1)

    def _B_ref(x, w1, b1, w2, b2):
        h = torch.einsum('bsd,df->bsf', x, w1) + b1
        h = _gelu(h)
        return torch.einsum('bsf,fd->bsd', h, w2) + b2
    x = A_x
    g = _sigmoid((x * gate_w).sum(-1, keepdims=True))
    a = _A_ref(x, A_mem0, A_Wq, A_Wk, A_Wv, A_Wo, A_seg_len)
    b = _B_ref(x, B_w1, B_b1, B_w2, B_b2)
    return g * a + (1 - g) * b
```

```asm
; @launch grid=(256,1,1) block=(256,1,1) lds=163840
.amdgcn_target "amdgcn-amd-amdhsa--gfx950"
.text
.globl gated_mix__memory_aug_recurrent_mem_tr__dense_activation_gelu__prompt_kernel
.p2align 8
.type gated_mix__memory_aug_recurrent_mem_tr__dense_activation_gelu__prompt_kernel,@function
gated_mix__memory_aug_recurrent_mem_tr__dense_activation_gelu__prompt_kernel:
    s_cmp_ge_u32 s2, 256
    s_cbranch_scc1 L_done
    s_load_dwordx2 s[8:9], s[0:1], 0
    s_load_dwordx2 s[12:13], s[0:1], 8
    s_load_dwordx2 s[16:17], s[0:1], 16
    s_load_dwordx2 s[20:21], s[0:1], 24
    s_load_dwordx2 s[24:25], s[0:1], 32
    s_load_dwordx2 s[28:29], s[0:1], 40
    s_load_dwordx2 s[32:33], s[0:1], 64
    s_load_dwordx2 s[36:37], s[0:1], 72
    s_load_dwordx2 s[40:41], s[0:1], 80
    s_load_dwordx2 s[44:45], s[0:1], 88
    s_load_dwordx2 s[48:49], s[0:1], 96
    s_load_dwordx2 s[52:53], s[0:1], 104
    s_load_dwordx2 s[56:57], s[0:1], 112
    s_load_dwordx2 s[60:61], s[0:1], 120
    s_mov_b32 s10, 0x240000
    s_mov_b32 s11, 0x20000
    s_mov_b32 s14, 0x2400
    s_mov_b32 s15, 0x20000
    s_mov_b32 s18, 0x480000
    s_mov_b32 s19, 0x20000
    s_mov_b32 s22, 0x480000
    s_mov_b32 s23, 0x20000
    s_mov_b32 s26, 0x480000
    s_mov_b32 s27, 0x20000
    s_mov_b32 s30, 0x480000
    s_mov_b32 s31, 0x20000
    s_mov_b32 s34, 0x510000
    s_mov_b32 s35, 0x20000
    s_mov_b32 s38, 0x2400
    s_mov_b32 s39, 0x20000
    s_mov_b32 s42, 0x510000
    s_mov_b32 s43, 0x20000
    s_mov_b32 s46, 0x480
    s_mov_b32 s47, 0x20000
    s_mov_b32 s50, 0x480
    s_mov_b32 s51, 0x20000
    s_mov_b32 s54, 0x240000
    s_mov_b32 s55, 0x20000
    s_mov_b32 s58, 0x100
    s_mov_b32 s59, 0x20000
    s_mov_b32 s62, 0x10000000
    s_mov_b32 s63, 0x20000
    s_waitcnt lgkmcnt(0)
    s_and_b32 s9, s9, 0xffff
    s_and_b32 s13, s13, 0xffff
    s_and_b32 s17, s17, 0xffff
    s_and_b32 s21, s21, 0xffff
    s_and_b32 s25, s25, 0xffff
    s_and_b32 s29, s29, 0xffff
    s_and_b32 s33, s33, 0xffff
    s_and_b32 s37, s37, 0xffff
    s_and_b32 s41, s41, 0xffff
    s_and_b32 s45, s45, 0xffff
    s_and_b32 s49, s49, 0xffff
    s_and_b32 s53, s53, 0xffff
    s_and_b32 s57, s57, 0xffff
    s_and_b32 s61, s61, 0xffff
    s_getreg_b32 s3, hwreg(HW_REG_XCC_ID)
    s_and_b32 s3, s3, 15
    v_lshrrev_b32 v1, 6, v0
    s_nop 0
    v_readfirstlane_b32 s65, v1
    v_mov_b32 v4, 0
    s_cmp_lg_u32 s65, 0
    s_cbranch_scc1 L_role_wait
    v_mov_b32 v1, 1
    s_lshl_b32 s4, s3, 2
    v_mov_b32 v2, s4
    s_mov_b64 exec, 1
    buffer_atomic_add v1, v2, s[56:59], 0 offen sc0
    s_waitcnt vmcnt(0)
    s_mov_b64 exec, -1
    v_readfirstlane_b32 s4, v1
    s_lshl_b32 s5, s3, 5
    s_add_u32 s5, s5, s4
    s_cmp_ge_u32 s3, 8
    s_cbranch_scc1 L_left
    s_cmp_lt_u32 s4, 32
    s_cbranch_scc1 L_role_pub
L_left:
    v_and_b32 v2, 15, v0
    v_lshlrev_b32 v2, 2, v2
    s_mov_b32 s6, 0
L_left_poll:
    buffer_load_dword v1, v2, s[56:59], 0 offen sc1
    s_waitcnt vmcnt(0)
    s_mov_b32 s5, 0
    v_readlane_b32 s4, v1, 0
    s_add_u32 s5, s5, s4
    v_readlane_b32 s4, v1, 1
    s_add_u32 s5, s5, s4
    v_readlane_b32 s4, v1, 2
    s_add_u32 s5, s5, s4
    v_readlane_b32 s4, v1, 3
    s_add_u32 s5, s5, s4
    v_readlane_b32 s4, v1, 4
    s_add_u32 s5, s5, s4
    v_readlane_b32 s4, v1, 5
    s_add_u32 s5, s5, s4
    v_readlane_b32 s4, v1, 6
    s_add_u32 s5, s5, s4
    v_readlane_b32 s4, v1, 7
    s_add_u32 s5, s5, s4
    v_readlane_b32 s4, v1, 8
    s_add_u32 s5, s5, s4
    v_readlane_b32 s4, v1, 9
    s_add_u32 s5, s5, s4
    v_readlane_b32 s4, v1, 10
    s_add_u32 s5, s5, s4
    v_readlane_b32 s4, v1, 11
    s_add_u32 s5, s5, s4
    v_readlane_b32 s4, v1, 12
    s_add_u32 s5, s5, s4
    v_readlane_b32 s4, v1, 13
    s_add_u32 s5, s5, s4
    v_readlane_b32 s4, v1, 14
    s_add_u32 s5, s5, s4
    v_readlane_b32 s4, v1, 15
    s_add_u32 s5, s5, s4
    s_cmp_ge_u32 s5, 256
    s_cbranch_scc1 L_left_go
    s_sleep 8
    s_add_u32 s6, s6, 1
    s_cmp_lt_u32 s6, 0x20000
    s_cbranch_scc1 L_left_poll
    s_mov_b32 s5, -1
    s_branch L_role_pub
L_left_go:
    v_mov_b32 v3, 1
    v_mov_b32 v2, 64
    s_mov_b64 exec, 1
    buffer_atomic_add v3, v2, s[56:59], 0 offen sc0
    s_waitcnt vmcnt(0)
    s_mov_b64 exec, -1
    v_readfirstlane_b32 s6, v3
    s_mov_b32 s5, 0
    v_readlane_b32 s4, v1, 0
    s_min_u32 s4, s4, 32
    s_add_u32 s7, s4, s6
    s_add_u32 s5, s7, 0
    s_cmp_lt_u32 s7, 32
    s_cbranch_scc1 L_role_pub
    s_sub_u32 s6, s7, 32
    v_readlane_b32 s4, v1, 1
    s_min_u32 s4, s4, 32
    s_add_u32 s7, s4, s6
    s_add_u32 s5, s7, 32
    s_cmp_lt_u32 s7, 32
    s_cbranch_scc1 L_role_pub
    s_sub_u32 s6, s7, 32
    v_readlane_b32 s4, v1, 2
    s_min_u32 s4, s4, 32
    s_add_u32 s7, s4, s6
    s_add_u32 s5, s7, 64
    s_cmp_lt_u32 s7, 32
    s_cbranch_scc1 L_role_pub
    s_sub_u32 s6, s7, 32
    v_readlane_b32 s4, v1, 3
    s_min_u32 s4, s4, 32
    s_add_u32 s7, s4, s6
    s_add_u32 s5, s7, 96
    s_cmp_lt_u32 s7, 32
    s_cbranch_scc1 L_role_pub
    s_sub_u32 s6, s7, 32
    v_readlane_b32 s4, v1, 4
    s_min_u32 s4, s4, 32
    s_add_u32 s7, s4, s6
    s_add_u32 s5, s7, 128
    s_cmp_lt_u32 s7, 32
    s_cbranch_scc1 L_role_pub
    s_sub_u32 s6, s7, 32
    v_readlane_b32 s4, v1, 5
    s_min_u32 s4, s4, 32
    s_add_u32 s7, s4, s6
    s_add_u32 s5, s7, 160
    s_cmp_lt_u32 s7, 32
    s_cbranch_scc1 L_role_pub
    s_sub_u32 s6, s7, 32
    v_readlane_b32 s4, v1, 6
    s_min_u32 s4, s4, 32
    s_add_u32 s7, s4, s6
    s_add_u32 s5, s7, 192
    s_cmp_lt_u32 s7, 32
    s_cbranch_scc1 L_role_pub
    s_sub_u32 s6, s7, 32
    v_readlane_b32 s4, v1, 7
    s_min_u32 s4, s4, 32
    s_add_u32 s7, s4, s6
    s_add_u32 s5, s7, 224
    s_cmp_lt_u32 s7, 32
    s_cbranch_scc1 L_role_pub
    s_sub_u32 s6, s7, 32
    s_mov_b32 s5, -1
L_role_pub:
    v_mov_b32 v1, s5
    ds_write_b32 v4, v1
    s_waitcnt lgkmcnt(0)
L_role_wait:
    s_barrier
    ds_read_b32 v1, v4
    s_waitcnt lgkmcnt(0)
    v_readfirstlane_b32 s64, v1
    s_barrier
    s_cmp_ge_u32 s64, 256
    s_cbranch_scc1 L_fail
    s_cmp_ge_u32 s64, 32
    s_cbranch_scc1 L_worker
    v_lshrrev_b32 v6, 6, v0
    s_nop 0
    v_readfirstlane_b32 s65, v6
    v_and_b32 v8, 63, v0
    v_and_b32 v9, 15, v8
    v_lshrrev_b32 v10, 4, v8
    v_lshlrev_b32 v0, 4, v8
    v_lshlrev_b32 v16, 13, v10
    v_lshl_add_u32 v16, v9, 4, v16
    s_lshl_b32 s67, s65, 17
    v_add_u32 v16, s67, v16
    v_lshrrev_b32 v21, 3, v8
    v_mul_u32_u24 v17, 1152, v21
    v_and_b32 v21, 7, v8
    v_lshl_add_u32 v17, v21, 4, v17
    s_mul_i32 s67, s65, 36864
    v_add_u32 v17, s67, v17
    s_lshl_b32 s85, s64, 8
    s_mul_i32 s82, s64, 147456
    s_lshl_b32 s83, s65, 12
    s_add_u32 m0, s83, 0x10000
    s_add_u32 s67, s85, 0
    buffer_load_dwordx4 v16, s[16:19], s67 offen nt lds
    s_add_u32 m0, s83, 0x10400
    s_add_u32 s67, s85, 32768
    buffer_load_dwordx4 v16, s[16:19], s67 offen nt lds
    s_add_u32 m0, s83, 0x10800
    s_add_u32 s67, s85, 65536
    buffer_load_dwordx4 v16, s[16:19], s67 offen nt lds
    s_add_u32 m0, s83, 0x10c00
    s_add_u32 s67, s85, 98304
    buffer_load_dwordx4 v16, s[16:19], s67 offen nt lds
    s_add_u32 m0, s83, 0x14000
    s_add_u32 s67, s85, 524288
    buffer_load_dwordx4 v16, s[16:19], s67 offen nt lds
    s_add_u32 m0, s83, 0x14400
    s_add_u32 s67, s85, 557056
    buffer_load_dwordx4 v16, s[16:19], s67 offen nt lds
    s_add_u32 m0, s83, 0x14800
    s_add_u32 s67, s85, 589824
    buffer_load_dwordx4 v16, s[16:19], s67 offen nt lds
    s_add_u32 m0, s83, 0x14c00
    s_add_u32 s67, s85, 622592
    buffer_load_dwordx4 v16, s[16:19], s67 offen nt lds
    s_add_u32 m0, s83, 0x18000
    s_add_u32 s67, s85, 1048576
    buffer_load_dwordx4 v16, s[16:19], s67 offen nt lds
    s_add_u32 m0, s83, 0x18400
    s_add_u32 s67, s85, 1081344
    buffer_load_dwordx4 v16, s[16:19], s67 offen nt lds
    s_add_u32 m0, s83, 0x18800
    s_add_u32 s67, s85, 1114112
    buffer_load_dwordx4 v16, s[16:19], s67 offen nt lds
    s_add_u32 m0, s83, 0x18c00
    s_add_u32 s67, s85, 1146880
    buffer_load_dwordx4 v16, s[16:19], s67 offen nt lds
    s_add_u32 m0, s83, 0x1c000
    s_add_u32 s67, s85, 1572864
    buffer_load_dwordx4 v16, s[16:19], s67 offen nt lds
    s_add_u32 m0, s83, 0x1c400
    s_add_u32 s67, s85, 1605632
    buffer_load_dwordx4 v16, s[16:19], s67 offen nt lds
    s_add_u32 m0, s83, 0x1c800
    s_add_u32 s67, s85, 1638400
    buffer_load_dwordx4 v16, s[16:19], s67 offen nt lds
    s_add_u32 m0, s83, 0x1cc00
    s_add_u32 s67, s85, 1671168
    buffer_load_dwordx4 v16, s[16:19], s67 offen nt lds
    s_add_u32 m0, s83, 0x20000
    s_add_u32 s67, s85, 2097152
    buffer_load_dwordx4 v16, s[16:19], s67 offen nt lds
    s_add_u32 m0, s83, 0x20400
    s_add_u32 s67, s85, 2129920
    buffer_load_dwordx4 v16, s[16:19], s67 offen nt lds
    s_add_u32 m0, s83, 0x20800
    s_add_u32 s67, s85, 2162688
    buffer_load_dwordx4 v16, s[16:19], s67 offen nt lds
    s_add_u32 m0, s83, 0x20c00
    s_add_u32 s67, s85, 2195456
    buffer_load_dwordx4 v16, s[16:19], s67 offen nt lds
    s_add_u32 m0, s83, 0x24000
    s_add_u32 s67, s85, 2621440
    buffer_load_dwordx4 v16, s[16:19], s67 offen nt lds
    s_add_u32 m0, s83, 0x24400
    s_add_u32 s67, s85, 2654208
    buffer_load_dwordx4 v16, s[16:19], s67 offen nt lds
    s_add_u32 m0, s83, 0x24800
    s_add_u32 s67, s85, 2686976
    buffer_load_dwordx4 v16, s[16:19], s67 offen nt lds
    s_add_u32 m0, s83, 0x24c00
    s_add_u32 s67, s85, 2719744
    buffer_load_dwordx4 v16, s[16:19], s67 offen nt lds
    s_add_u32 m0, s83, 0x0
    s_add_u32 s67, s85, 3145728
    buffer_load_dwordx4 v16, s[16:19], s67 offen nt lds
    s_add_u32 m0, s83, 0x400
    s_add_u32 s67, s85, 3178496
    buffer_load_dwordx4 v16, s[16:19], s67 offen nt lds
    s_add_u32 m0, s83, 0x800
    s_add_u32 s67, s85, 3211264
    buffer_load_dwordx4 v16, s[16:19], s67 offen nt lds
    s_add_u32 m0, s83, 0xc00
    s_add_u32 s67, s85, 3244032
    buffer_load_dwordx4 v16, s[16:19], s67 offen nt lds
    s_add_u32 m0, s83, 0x4000
    s_add_u32 s67, s85, 3670016
    buffer_load_dwordx4 v16, s[16:19], s67 offen nt lds
    s_add_u32 m0, s83, 0x4400
    s_add_u32 s67, s85, 3702784
    buffer_load_dwordx4 v16, s[16:19], s67 offen nt lds
    s_add_u32 m0, s83, 0x4800
    s_add_u32 s67, s85, 3735552
    buffer_load_dwordx4 v16, s[16:19], s67 offen nt lds
    s_add_u32 m0, s83, 0x4c00
    s_add_u32 s67, s85, 3768320
    buffer_load_dwordx4 v16, s[16:19], s67 offen nt lds
    s_add_u32 m0, s83, 0x8000
    s_add_u32 s67, s85, 4194304
    buffer_load_dwordx4 v16, s[16:19], s67 offen nt lds
    s_add_u32 m0, s83, 0x8400
    s_add_u32 s67, s85, 4227072
    buffer_load_dwordx4 v16, s[16:19], s67 offen nt lds
    s_add_u32 m0, s83, 0x8800
    s_add_u32 s67, s85, 4259840
    buffer_load_dwordx4 v16, s[16:19], s67 offen nt lds
    s_add_u32 m0, s83, 0x8c00
    s_add_u32 s67, s85, 4292608
    buffer_load_dwordx4 v16, s[16:19], s67 offen nt lds
    s_mov_b32 s76, 0x000f000f
    s_mov_b32 s77, 0x000f000f
    s_mov_b32 s92, 0x00ff00ff
    s_mov_b32 s93, 0x00ff00ff
    s_mov_b32 s78, 0xffff0000
    s_mov_b32 s79, 0xffff0000
    s_mov_b32 s80, 0x3db504f3
    s_mov_b32 s81, 0x3fb8aa3b
    v_lshrrev_b32 v21, 2, v9
    v_and_b32 v22, 3, v9
    v_lshl_add_u32 v23, v10, 3, v21
    v_lshlrev_b32 v18, 8, v23
    v_lshl_add_u32 v18, v22, 3, v18
    s_lshl_b32 s67, s65, 6
    v_add_u32 v18, s67, v18
    v_and_b32 v23, 1, v10
    v_lshlrev_b32 v19, 4, v23
    v_lshrrev_b32 v23, 1, v10
    v_lshl_add_u32 v19, v23, 3, v19
    v_lshrrev_b32 v23, 1, v21
    v_lshl_add_u32 v19, v23, 2, v19
    v_and_b32 v23, 1, v21
    v_add_u32 v19, v23, v19
    v_lshlrev_b32 v19, 7, v19
    v_lshl_add_u32 v19, v22, 3, v19
    s_lshl_b32 s67, s65, 5
    v_add_u32 v19, s67, v19
    s_lshl_b32 s67, s65, 12
    s_add_u32 s67, s67, 0x8000
    v_add_u32 v1, s67, v0
    v_bfe_u32 v28, v9, 1, 1
    v_and_b32 v29, 1, v9
    v_and_b32 v30, 1, v10
    v_lshrrev_b32 v31, 1, v10
    v_mov_b32 v24, 0x4444
    v_mov_b32 v25, 0xeeee
    v_cmp_eq_u32 vcc, 0, v28
    s_nop 1
    v_cndmask_b32 v2, v25, v24, vcc
    v_bfe_u32 v24, v9, 1, 2
    v_lshlrev_b32 v24, 2, v24
    v_lshl_add_u32 v24, v30, 1, v24
    v_add_u32 v24, v24, v29
    v_lshlrev_b32 v24, 4, v24
    v_lshl_add_u32 v24, v31, 8, v24
    s_lshl_b32 s67, s65, 9
    s_add_u32 s67, s67, 0x7000
    v_add_u32 v24, s67, v24
    v_lshl_or_b32 v2, v24, 16, v2
    v_lshlrev_b32 v24, 4, v9
    v_lshl_add_u32 v24, v10, 2, v24
    s_lshl_b32 s67, s65, 9
    s_add_u32 s67, s67, 0x0
    v_add_u32 v24, s67, v24
    v_lshl_add_u32 v25, v10, 2, v21
    v_lshlrev_b32 v25, 4, v25
    v_add_u32 v25, 0x0, v25
    v_and_b32 v26, 1, v22
    v_lshl_add_u32 v26, v26, 3, v25
    v_lshl_or_b32 v3, v26, 16, v24
    v_lshrrev_b32 v26, 1, v22
    v_lshl_add_u32 v26, v26, 3, v25
    v_add_u32 v7, 2048, v26
    v_lshlrev_b32 v24, 5, v29
    v_lshl_add_u32 v24, v30, 4, v24
    v_lshl_add_u32 v24, v28, 2, v24
    v_lshl_add_u32 v25, v31, 3, v24
    v_lshl_add_u32 v24, v31, 10, v24
    s_lshr_b32 s68, s64, 1
    s_lshl_b32 s68, s68, 6
    s_add_u32 s67, s68, 8192
    v_add_u32 v25, s67, v25
    s_and_b32 s69, s64, 1
    s_lshl_b32 s67, s69, 3
    s_add_u32 s68, s68, s67
    s_lshl_b32 s67, s65, 11
    s_add_u32 s68, s68, s67
    v_add_u32 v24, s68, v24
    v_lshl_or_b32 v4, v25, 16, v24
    s_mul_i32 s67, s64, 2048
    s_mul_i32 s68, s65, 65536
    s_add_u32 s68, s68, s67
    s_add_u32 s70, s68, 0x7000000
    s_add_u32 s71, s67, 0x7040000
    s_xor_b32 s99, s69, 1
    v_lshrrev_b32 v25, 3, v9
    v_lshl_add_u32 v24, v10, 1, v25
    v_mul_u32_u24 v24, 2048, v24
    v_and_b32 v25, 7, v9
    v_lshl_add_u32 v24, v25, 3, v24
    s_mul_i32 s67, s65, 16384
    s_lshl_b32 s68, s64, 6
    s_add_u32 s67, s67, s68
    v_add_u32 v5, s67, v24
    v_lshl_add_u32 v24, v22, 2, v21
    v_and_b32 v25, 1, v24
    v_lshlrev_b32 v25, 4, v25
    v_mov_b32 v26, 0x3f80
    v_lshlrev_b32 v25, v25, v26
    v_lshrrev_b32 v24, 1, v24
    v_cmp_eq_u32 vcc, 0, v24
    s_nop 1
    v_cndmask_b32 v32, 0, v25, vcc
    v_cmp_eq_u32 vcc, 1, v24
    s_nop 1
    v_cndmask_b32 v33, 0, v25, vcc
    v_cmp_eq_u32 vcc, 2, v24
    s_nop 1
    v_cndmask_b32 v34, 0, v25, vcc
    v_cmp_eq_u32 vcc, 3, v24
    s_nop 1
    v_cndmask_b32 v35, 0, v25, vcc
    v_lshl_add_u32 v24, v21, 1, v29
    v_mul_u32_u24 v27, 1152, v24
    v_lshl_add_u32 v27, v10, 5, v27
    v_lshl_add_u32 v27, v28, 2, v27
    v_mov_b32 v12, -1
    v_mov_b32 v13, -1
    v_mov_b32 v14, -1
    v_mov_b32 v15, -1
    s_lshl_b32 s67, s64, 2
    s_add_u32 s67, s67, s65
    s_lshr_b32 s68, s67, 1
    s_mul_i32 s68, s68, 6144
    s_and_b32 s69, s67, 1
    s_mul_i32 s69, s69, 0x80000
    s_add_u32 s68, s68, s69
    s_add_u32 s68, s68, 0x7000000
    buffer_store_dwordx4 v[12:15], v0, s[60:63], s68 offen offset:0 sc1
    buffer_store_dwordx4 v[12:15], v0, s[60:63], s68 offen offset:1024 sc1
    buffer_store_dwordx4 v[12:15], v0, s[60:63], s68 offen offset:2048 sc1
    buffer_store_dwordx4 v[12:15], v0, s[60:63], s68 offen offset:3072 sc1
    s_add_u32 s68, s68, 4096
    buffer_store_dwordx4 v[12:15], v0, s[60:63], s68 offen offset:0 sc1
    buffer_store_dwordx4 v[12:15], v0, s[60:63], s68 offen offset:1024 sc1
    s_sub_u32 s68, s67, 16
    s_cmp_ge_u32 s68, 48
    s_cbranch_scc1 Lag_1
    s_lshl_b32 s68, s67, 10
    s_add_u32 s68, s68, 0x7200000
    buffer_store_dwordx4 v[12:15], v0, s[60:63], s68 offen sc1
Lag_1:
    s_cmp_lg_u32 s65, 0
    s_cbranch_scc1 Lz_2
    s_lshl_b32 s68, s64, 7
    s_add_u32 s69, s68, 0x7410000
    v_mov_b32 v36, 0
    s_mov_b64 exec, 1
    buffer_store_dword v36, off, s[60:63], s69 sc1
    s_lshl_b32 s68, s68, 1
    s_add_u32 s69, s68, 0x7420000
    buffer_store_dword v36, off, s[60:63], s69 sc1
    buffer_store_dword v36, off, s[60:63], s69 offset:128 sc1
    s_mov_b64 exec, -1
Lz_2:
    s_cmp_ge_u32 s67, 9
    s_cbranch_scc1 Lm0_3
    s_lshl_b32 s68, s67, 7
    buffer_load_dword v36, v27, s[12:15], s68 offen offset:0
    buffer_load_dword v37, v27, s[12:15], s68 offen offset:8
    buffer_load_dword v38, v27, s[12:15], s68 offen offset:16
    buffer_load_dword v39, v27, s[12:15], s68 offen offset:24
Lm0_3:
    s_waitcnt vmcnt(32)
    s_barrier
    s_add_u32 m0, s83, 0xc000
    s_add_u32 s67, s82, 0
    buffer_load_dwordx4 v17, s[28:31], s67 offen nt lds
    s_add_u32 m0, s83, 0xc400
    s_add_u32 s67, s82, 9216
    buffer_load_dwordx4 v17, s[28:31], s67 offen nt lds
    s_add_u32 m0, s83, 0xc800
    s_add_u32 s67, s82, 18432
    buffer_load_dwordx4 v17, s[28:31], s67 offen nt lds
    s_add_u32 m0, s83, 0xcc00
    s_add_u32 s67, s82, 27648
    buffer_load_dwordx4 v17, s[28:31], s67 offen nt lds
    v_add_u32 v20, 0x10000, v18
    ds_read_b64_tr_b16 a[0:1], v20 offset:0
    ds_read_b64_tr_b16 a[2:3], v20 offset:1024
    ds_read_b64_tr_b16 a[4:5], v20 offset:8192
    ds_read_b64_tr_b16 a[6:7], v20 offset:9216
    ds_read_b64_tr_b16 a[8:9], v20 offset:32
    ds_read_b64_tr_b16 a[10:11], v20 offset:1056
    ds_read_b64_tr_b16 a[12:13], v20 offset:8224
    ds_read_b64_tr_b16 a[14:15], v20 offset:9248
    s_waitcnt lgkmcnt(0)
    s_waitcnt vmcnt(32)
    s_barrier
    s_add_u32 m0, s83, 0x10000
    s_add_u32 s67, s82, 128
    buffer_load_dwordx4 v17, s[28:31], s67 offen nt lds
    s_add_u32 m0, s83, 0x10400
    s_add_u32 s67, s82, 9344
    buffer_load_dwordx4 v17, s[28:31], s67 offen nt lds
    s_add_u32 m0, s83, 0x10800
    s_add_u32 s67, s82, 18560
    buffer_load_dwordx4 v17, s[28:31], s67 offen nt lds
    s_add_u32 m0, s83, 0x10c00
    s_add_u32 s67, s82, 27776
    buffer_load_dwordx4 v17, s[28:31], s67 offen nt lds
    v_add_u32 v20, 0x14000, v18
    ds_read_b64_tr_b16 a[16:17], v20 offset:0
    ds_read_b64_tr_b16 a[18:19], v20 offset:1024
    ds_read_b64_tr_b16 a[20:21], v20 offset:8192
    ds_read_b64_tr_b16 a[22:23], v20 offset:9216
    ds_read_b64_tr_b16 a[24:25], v20 offset:32
    ds_read_b64_tr_b16 a[26:27], v20 offset:1056
    ds_read_b64_tr_b16 a[28:29], v20 offset:8224
    ds_read_b64_tr_b16 a[30:31], v20 offset:9248
    s_waitcnt lgkmcnt(0)
    s_waitcnt vmcnt(32)
    s_barrier
    s_add_u32 m0, s83, 0x14000
    s_add_u32 s67, s82, 256
    buffer_load_dwordx4 v17, s[28:31], s67 offen nt lds
    s_add_u32 m0, s83, 0x14400
    s_add_u32 s67, s82, 9472
    buffer_load_dwordx4 v17, s[28:31], s67 offen nt lds
    s_add_u32 m0, s83, 0x14800
    s_add_u32 s67, s82, 18688
    buffer_load_dwordx4 v17, s[28:31], s67 offen nt lds
    s_add_u32 m0, s83, 0x14c00
    s_add_u32 s67, s82, 27904
    buffer_load_dwordx4 v17, s[28:31], s67 offen nt lds
    v_add_u32 v20, 0x18000, v18
    ds_read_b64_tr_b16 a[32:33], v20 offset:0
    ds_read_b64_tr_b16 a[34:35], v20 offset:1024
    ds_read_b64_tr_b16 a[36:37], v20 offset:8192
    ds_read_b64_tr_b16 a[38:39], v20 offset:9216
    ds_read_b64_tr_b16 a[40:41], v20 offset:32
    ds_read_b64_tr_b16 a[42:43], v20 offset:1056
    ds_read_b64_tr_b16 a[44:45], v20 offset:8224
    ds_read_b64_tr_b16 a[46:47], v20 offset:9248
    s_waitcnt lgkmcnt(0)
    s_waitcnt vmcnt(32)
    s_barrier
    s_add_u32 m0, s83, 0x18000
    s_add_u32 s67, s82, 384
    buffer_load_dwordx4 v17, s[28:31], s67 offen nt lds
    s_add_u32 m0, s83, 0x18400
    s_add_u32 s67, s82, 9600
    buffer_load_dwordx4 v17, s[28:31], s67 offen nt lds
    s_add_u32 m0, s83, 0x18800
    s_add_u32 s67, s82, 18816
    buffer_load_dwordx4 v17, s[28:31], s67 offen nt lds
    s_add_u32 m0, s83, 0x18c00
    s_add_u32 s67, s82, 28032
    buffer_load_dwordx4 v17, s[28:31], s67 offen nt lds
    v_add_u32 v20, 0x1c000, v18
    ds_read_b64_tr_b16 a[48:49], v20 offset:0
    ds_read_b64_tr_b16 a[50:51], v20 offset:1024
    ds_read_b64_tr_b16 a[52:53], v20 offset:8192
    ds_read_b64_tr_b16 a[54:55], v20 offset:9216
    ds_read_b64_tr_b16 a[56:57], v20 offset:32
    ds_read_b64_tr_b16 a[58:59], v20 offset:1056
    ds_read_b64_tr_b16 a[60:61], v20 offset:8224
    ds_read_b64_tr_b16 a[62:63], v20 offset:9248
    s_waitcnt lgkmcnt(0)
    s_waitcnt vmcnt(32)
    s_barrier
    s_add_u32 m0, s83, 0x1c000
    s_add_u32 s67, s82, 512
    buffer_load_dwordx4 v17, s[28:31], s67 offen nt lds
    s_add_u32 m0, s83, 0x1c400
    s_add_u32 s67, s82, 9728
    buffer_load_dwordx4 v17, s[28:31], s67 offen nt lds
    s_add_u32 m0, s83, 0x1c800
    s_add_u32 s67, s82, 18944
    buffer_load_dwordx4 v17, s[28:31], s67 offen nt lds
    s_add_u32 m0, s83, 0x1cc00
    s_add_u32 s67, s82, 28160
    buffer_load_dwordx4 v17, s[28:31], s67 offen nt lds
    v_add_u32 v20, 0x20000, v18
    ds_read_b64_tr_b16 a[64:65], v20 offset:0
    ds_read_b64_tr_b16 a[66:67], v20 offset:1024
    ds_read_b64_tr_b16 a[68:69], v20 offset:8192
    ds_read_b64_tr_b16 a[70:71], v20 offset:9216
    ds_read_b64_tr_b16 a[72:73], v20 offset:32
    ds_read_b64_tr_b16 a[74:75], v20 offset:1056
    ds_read_b64_tr_b16 a[76:77], v20 offset:8224
    ds_read_b64_tr_b16 a[78:79], v20 offset:9248
    s_waitcnt lgkmcnt(0)
    s_waitcnt vmcnt(32)
    s_barrier
    s_add_u32 m0, s83, 0x20000
    s_add_u32 s67, s82, 640
    buffer_load_dwordx4 v17, s[28:31], s67 offen nt lds
    s_add_u32 m0, s83, 0x20400
    s_add_u32 s67, s82, 9856
    buffer_load_dwordx4 v17, s[28:31], s67 offen nt lds
    s_add_u32 m0, s83, 0x20800
    s_add_u32 s67, s82, 19072
    buffer_load_dwordx4 v17, s[28:31], s67 offen nt lds
    s_add_u32 m0, s83, 0x20c00
    s_add_u32 s67, s82, 28288
    buffer_load_dwordx4 v17, s[28:31], s67 offen nt lds
    v_add_u32 v20, 0x24000, v18
    ds_read_b64_tr_b16 a[80:81], v20 offset:0
    ds_read_b64_tr_b16 a[82:83], v20 offset:1024
    ds_read_b64_tr_b16 a[84:85], v20 offset:8192
    ds_read_b64_tr_b16 a[86:87], v20 offset:9216
    ds_read_b64_tr_b16 a[88:89], v20 offset:32
    ds_read_b64_tr_b16 a[90:91], v20 offset:1056
    ds_read_b64_tr_b16 a[92:93], v20 offset:8224
    ds_read_b64_tr_b16 a[94:95], v20 offset:9248
    s_waitcnt lgkmcnt(0)
    s_waitcnt vmcnt(32)
    s_barrier
    s_add_u32 m0, s83, 0x24000
    s_add_u32 s67, s82, 768
    buffer_load_dwordx4 v17, s[28:31], s67 offen nt lds
    s_add_u32 m0, s83, 0x24400
    s_add_u32 s67, s82, 9984
    buffer_load_dwordx4 v17, s[28:31], s67 offen nt lds
    s_add_u32 m0, s83, 0x24800
    s_add_u32 s67, s82, 19200
    buffer_load_dwordx4 v17, s[28:31], s67 offen nt lds
    s_add_u32 m0, s83, 0x24c00
    s_add_u32 s67, s82, 28416
    buffer_load_dwordx4 v17, s[28:31], s67 offen nt lds
    v_add_u32 v20, 0x0, v18
    ds_read_b64_tr_b16 a[96:97], v20 offset:0
    ds_read_b64_tr_b16 a[98:99], v20 offset:1024
    ds_read_b64_tr_b16 a[100:101], v20 offset:8192
    ds_read_b64_tr_b16 a[102:103], v20 offset:9216
    ds_read_b64_tr_b16 a[104:105], v20 offset:32
    ds_read_b64_tr_b16 a[106:107], v20 offset:1056
    ds_read_b64_tr_b16 a[108:109], v20 offset:8224
    ds_read_b64_tr_b16 a[110:111], v20 offset:9248
    s_waitcnt lgkmcnt(0)
    s_waitcnt vmcnt(32)
    s_barrier
    s_add_u32 m0, s83, 0x0
    s_add_u32 s67, s82, 896
    buffer_load_dwordx4 v17, s[28:31], s67 offen nt lds
    s_add_u32 m0, s83, 0x400
    s_add_u32 s67, s82, 10112
    buffer_load_dwordx4 v17, s[28:31], s67 offen nt lds
    s_add_u32 m0, s83, 0x800
    s_add_u32 s67, s82, 19328
    buffer_load_dwordx4 v17, s[28:31], s67 offen nt lds
    s_add_u32 m0, s83, 0xc00
    s_add_u32 s67, s82, 28544
    buffer_load_dwordx4 v17, s[28:31], s67 offen nt lds
    v_add_u32 v20, 0x4000, v18
    ds_read_b64_tr_b16 a[112:113], v20 offset:0
    ds_read_b64_tr_b16 a[114:115], v20 offset:1024
    ds_read_b64_tr_b16 a[116:117], v20 offset:8192
    ds_read_b64_tr_b16 a[118:119], v20 offset:9216
    ds_read_b64_tr_b16 a[120:121], v20 offset:32
    ds_read_b64_tr_b16 a[122:123], v20 offset:1056
    ds_read_b64_tr_b16 a[124:125], v20 offset:8224
    ds_read_b64_tr_b16 a[126:127], v20 offset:9248
    s_waitcnt lgkmcnt(0)
    s_waitcnt vmcnt(32)
    s_barrier
    s_add_u32 m0, s83, 0x4000
    s_add_u32 s67, s82, 1024
    buffer_load_dwordx4 v17, s[28:31], s67 offen nt lds
    s_add_u32 m0, s83, 0x4400
    s_add_u32 s67, s82, 10240
    buffer_load_dwordx4 v17, s[28:31], s67 offen nt lds
    s_add_u32 m0, s83, 0x4800
    s_add_u32 s67, s82, 19456
    buffer_load_dwordx4 v17, s[28:31], s67 offen nt lds
    s_add_u32 m0, s83, 0x4c00
    s_add_u32 s67, s82, 28672
    buffer_load_dwordx4 v17, s[28:31], s67 offen nt lds
    v_add_u32 v20, 0x8000, v18
    ds_read_b64_tr_b16 a[128:129], v20 offset:0
    ds_read_b64_tr_b16 a[130:131], v20 offset:1024
    ds_read_b64_tr_b16 a[132:133], v20 offset:8192
    ds_read_b64_tr_b16 a[134:135], v20 offset:9216
    ds_read_b64_tr_b16 a[136:137], v20 offset:32
    ds_read_b64_tr_b16 a[138:139], v20 offset:1056
    ds_read_b64_tr_b16 a[140:141], v20 offset:8224
    ds_read_b64_tr_b16 a[142:143], v20 offset:9248
    s_waitcnt lgkmcnt(0)
    s_waitcnt vmcnt(32)
    s_barrier
    s_lshl_b32 s67, s64, 2
    s_add_u32 s67, s67, s65
    s_cmp_ge_u32 s67, 9
    s_cbranch_scc1 Lm1_4
    s_lshl_b32 s68, s67, 10
    s_add_u32 s68, s68, 0x7200000
    v_min_u32 v36, -3, v36
    v_min_u32 v37, -3, v37
    v_min_u32 v38, -3, v38
    v_min_u32 v39, -3, v39
    buffer_store_dwordx4 v[36:39], v0, s[60:63], s68 offen sc1
Lm1_4:
    s_add_u32 m0, s83, 0x8000
    s_add_u32 s67, s85, 0
    buffer_load_dwordx4 v16, s[20:23], s67 offen nt lds
    s_add_u32 m0, s83, 0x8400
    s_add_u32 s67, s85, 32768
    buffer_load_dwordx4 v16, s[20:23], s67 offen nt lds
    s_add_u32 m0, s83, 0x8800
    s_add_u32 s67, s85, 65536
    buffer_load_dwordx4 v16, s[20:23], s67 offen nt lds
    s_add_u32 m0, s83, 0x8c00
    s_add_u32 s67, s85, 98304
    buffer_load_dwordx4 v16, s[20:23], s67 offen nt lds
    v_add_u32 v20, 0xc000, v19
    ds_read_b64_tr_b16 v[96:97], v20 offset:0
    ds_read_b64_tr_b16 v[98:99], v20 offset:256
    ds_read_b64_tr_b16 v[100:101], v20 offset:4096
    ds_read_b64_tr_b16 v[102:103], v20 offset:4352
    ds_read_b64_tr_b16 v[104:105], v20 offset:8192
    ds_read_b64_tr_b16 v[106:107], v20 offset:8448
    ds_read_b64_tr_b16 v[108:109], v20 offset:12288
    ds_read_b64_tr_b16 v[110:111], v20 offset:12544
    s_waitcnt lgkmcnt(0)
    s_waitcnt vmcnt(32)
    s_barrier
    s_add_u32 m0, s83, 0xc000
    s_add_u32 s67, s85, 524288
    buffer_load_dwordx4 v16, s[20:23], s67 offen nt lds
    s_add_u32 m0, s83, 0xc400
    s_add_u32 s67, s85, 557056
    buffer_load_dwordx4 v16, s[20:23], s67 offen nt lds
    s_add_u32 m0, s83, 0xc800
    s_add_u32 s67, s85, 589824
    buffer_load_dwordx4 v16, s[20:23], s67 offen nt lds
    s_add_u32 m0, s83, 0xcc00
    s_add_u32 s67, s85, 622592
    buffer_load_dwordx4 v16, s[20:23], s67 offen nt lds
    v_add_u32 v20, 0x10000, v19
    ds_read_b64_tr_b16 v[112:113], v20 offset:0
    ds_read_b64_tr_b16 v[114:115], v20 offset:256
    ds_read_b64_tr_b16 v[116:117], v20 offset:4096
    ds_read_b64_tr_b16 v[118:119], v20 offset:4352
    ds_read_b64_tr_b16 v[120:121], v20 offset:8192
    ds_read_b64_tr_b16 v[122:123], v20 offset:8448
    ds_read_b64_tr_b16 v[124:125], v20 offset:12288
    ds_read_b64_tr_b16 v[126:127], v20 offset:12544
    s_waitcnt lgkmcnt(0)
    s_waitcnt vmcnt(32)
    s_barrier
    s_add_u32 m0, s83, 0x10000
    s_add_u32 s67, s85, 1048576
    buffer_load_dwordx4 v16, s[20:23], s67 offen nt lds
    s_add_u32 m0, s83, 0x10400
    s_add_u32 s67, s85, 1081344
    buffer_load_dwordx4 v16, s[20:23], s67 offen nt lds
    s_add_u32 m0, s83, 0x10800
    s_add_u32 s67, s85, 1114112
    buffer_load_dwordx4 v16, s[20:23], s67 offen nt lds
    s_add_u32 m0, s83, 0x10c00
    s_add_u32 s67, s85, 1146880
    buffer_load_dwordx4 v16, s[20:23], s67 offen nt lds
    v_add_u32 v20, 0x14000, v19
    ds_read_b64_tr_b16 v[128:129], v20 offset:0
    ds_read_b64_tr_b16 v[130:131], v20 offset:256
    ds_read_b64_tr_b16 v[132:133], v20 offset:4096
    ds_read_b64_tr_b16 v[134:135], v20 offset:4352
    ds_read_b64_tr_b16 v[136:137], v20 offset:8192
    ds_read_b64_tr_b16 v[138:139], v20 offset:8448
    ds_read_b64_tr_b16 v[140:141], v20 offset:12288
    ds_read_b64_tr_b16 v[142:143], v20 offset:12544
    s_waitcnt lgkmcnt(0)
    s_waitcnt vmcnt(32)
    s_barrier
    s_add_u32 m0, s83, 0x14000
    s_add_u32 s67, s85, 1572864
    buffer_load_dwordx4 v16, s[20:23], s67 offen nt lds
    s_add_u32 m0, s83, 0x14400
    s_add_u32 s67, s85, 1605632
    buffer_load_dwordx4 v16, s[20:23], s67 offen nt lds
    s_add_u32 m0, s83, 0x14800
    s_add_u32 s67, s85, 1638400
    buffer_load_dwordx4 v16, s[20:23], s67 offen nt lds
    s_add_u32 m0, s83, 0x14c00
    s_add_u32 s67, s85, 1671168
    buffer_load_dwordx4 v16, s[20:23], s67 offen nt lds
    v_add_u32 v20, 0x18000, v19
    ds_read_b64_tr_b16 v[144:145], v20 offset:0
    ds_read_b64_tr_b16 v[146:147], v20 offset:256
    ds_read_b64_tr_b16 v[148:149], v20 offset:4096
    ds_read_b64_tr_b16 v[150:151], v20 offset:4352
    ds_read_b64_tr_b16 v[152:153], v20 offset:8192
    ds_read_b64_tr_b16 v[154:155], v20 offset:8448
    ds_read_b64_tr_b16 v[156:157], v20 offset:12288
    ds_read_b64_tr_b16 v[158:159], v20 offset:12544
    s_waitcnt lgkmcnt(0)
    s_waitcnt vmcnt(32)
    s_barrier
    s_add_u32 m0, s83, 0x18000
    s_add_u32 s67, s85, 2097152
    buffer_load_dwordx4 v16, s[20:23], s67 offen nt lds
    s_add_u32 m0, s83, 0x18400
    s_add_u32 s67, s85, 2129920
    buffer_load_dwordx4 v16, s[20:23], s67 offen nt lds
    s_add_u32 m0, s83, 0x18800
    s_add_u32 s67, s85, 2162688
    buffer_load_dwordx4 v16, s[20:23], s67 offen nt lds
    s_add_u32 m0, s83, 0x18c00
    s_add_u32 s67, s85, 2195456
    buffer_load_dwordx4 v16, s[20:23], s67 offen nt lds
    v_add_u32 v20, 0x1c000, v19
    ds_read_b64_tr_b16 v[160:161], v20 offset:0
    ds_read_b64_tr_b16 v[162:163], v20 offset:256
    ds_read_b64_tr_b16 v[164:165], v20 offset:4096
    ds_read_b64_tr_b16 v[166:167], v20 offset:4352
    ds_read_b64_tr_b16 v[168:169], v20 offset:8192
    ds_read_b64_tr_b16 v[170:171], v20 offset:8448
    ds_read_b64_tr_b16 v[172:173], v20 offset:12288
    ds_read_b64_tr_b16 v[174:175], v20 offset:12544
    s_waitcnt lgkmcnt(0)
    s_waitcnt vmcnt(32)
    s_barrier
    s_add_u32 m0, s83, 0x1c000
    s_add_u32 s67, s85, 2621440
    buffer_load_dwordx4 v16, s[20:23], s67 offen nt lds
    s_add_u32 m0, s83, 0x1c400
    s_add_u32 s67, s85, 2654208
    buffer_load_dwordx4 v16, s[20:23], s67 offen nt lds
    s_add_u32 m0, s83, 0x1c800
    s_add_u32 s67, s85, 2686976
    buffer_load_dwordx4 v16, s[20:23], s67 offen nt lds
    s_add_u32 m0, s83, 0x1cc00
    s_add_u32 s67, s85, 2719744
    buffer_load_dwordx4 v16, s[20:23], s67 offen nt lds
    v_add_u32 v20, 0x20000, v19
    ds_read_b64_tr_b16 v[176:177], v20 offset:0
    ds_read_b64_tr_b16 v[178:179], v20 offset:256
    ds_read_b64_tr_b16 v[180:181], v20 offset:4096
    ds_read_b64_tr_b16 v[182:183], v20 offset:4352
    ds_read_b64_tr_b16 v[184:185], v20 offset:8192
    ds_read_b64_tr_b16 v[186:187], v20 offset:8448
    ds_read_b64_tr_b16 v[188:189], v20 offset:12288
    ds_read_b64_tr_b16 v[190:191], v20 offset:12544
    s_waitcnt lgkmcnt(0)
    s_waitcnt vmcnt(32)
    s_barrier
    s_add_u32 m0, s83, 0x20000
    s_add_u32 s67, s85, 3145728
    buffer_load_dwordx4 v16, s[20:23], s67 offen nt lds
    s_add_u32 m0, s83, 0x20400
    s_add_u32 s67, s85, 3178496
    buffer_load_dwordx4 v16, s[20:23], s67 offen nt lds
    s_add_u32 m0, s83, 0x20800
    s_add_u32 s67, s85, 3211264
    buffer_load_dwordx4 v16, s[20:23], s67 offen nt lds
    s_add_u32 m0, s83, 0x20c00
    s_add_u32 s67, s85, 3244032
    buffer_load_dwordx4 v16, s[20:23], s67 offen nt lds
    v_add_u32 v20, 0x24000, v19
    ds_read_b64_tr_b16 v[192:193], v20 offset:0
    ds_read_b64_tr_b16 v[194:195], v20 offset:256
    ds_read_b64_tr_b16 v[196:197], v20 offset:4096
    ds_read_b64_tr_b16 v[198:199], v20 offset:4352
    ds_read_b64_tr_b16 v[200:201], v20 offset:8192
    ds_read_b64_tr_b16 v[202:203], v20 offset:8448
    ds_read_b64_tr_b16 v[204:205], v20 offset:12288
    ds_read_b64_tr_b16 v[206:207], v20 offset:12544
    s_waitcnt lgkmcnt(0)
    s_waitcnt vmcnt(32)
    s_barrier
    s_add_u32 m0, s83, 0x24000
    s_add_u32 s67, s85, 3670016
    buffer_load_dwordx4 v16, s[20:23], s67 offen nt lds
    s_add_u32 m0, s83, 0x24400
    s_add_u32 s67, s85, 3702784
    buffer_load_dwordx4 v16, s[20:23], s67 offen nt lds
    s_add_u32 m0, s83, 0x24800
    s_add_u32 s67, s85, 3735552
    buffer_load_dwordx4 v16, s[20:23], s67 offen nt lds
    s_add_u32 m0, s83, 0x24c00
    s_add_u32 s67, s85, 3768320
    buffer_load_dwordx4 v16, s[20:23], s67 offen nt lds
    v_add_u32 v20, 0x0, v19
    ds_read_b64_tr_b16 v[208:209], v20 offset:0
    ds_read_b64_tr_b16 v[210:211], v20 offset:256
    ds_read_b64_tr_b16 v[212:213], v20 offset:4096
    ds_read_b64_tr_b16 v[214:215], v20 offset:4352
    ds_read_b64_tr_b16 v[216:217], v20 offset:8192
    ds_read_b64_tr_b16 v[218:219], v20 offset:8448
    ds_read_b64_tr_b16 v[220:221], v20 offset:12288
    ds_read_b64_tr_b16 v[222:223], v20 offset:12544
    s_waitcnt lgkmcnt(0)
    s_waitcnt vmcnt(32)
    s_barrier
    s_add_u32 m0, s83, 0x0
    s_add_u32 s67, s85, 4194304
    buffer_load_dwordx4 v16, s[20:23], s67 offen nt lds
    s_add_u32 m0, s83, 0x400
    s_add_u32 s67, s85, 4227072
    buffer_load_dwordx4 v16, s[20:23], s67 offen nt lds
    s_add_u32 m0, s83, 0x800
    s_add_u32 s67, s85, 4259840
    buffer_load_dwordx4 v16, s[20:23], s67 offen nt lds
    s_add_u32 m0, s83, 0xc00
    s_add_u32 s67, s85, 4292608
    buffer_load_dwordx4 v16, s[20:23], s67 offen nt lds
    v_add_u32 v20, 0x4000, v19
    ds_read_b64_tr_b16 v[224:225], v20 offset:0
    ds_read_b64_tr_b16 v[226:227], v20 offset:256
    ds_read_b64_tr_b16 v[228:229], v20 offset:4096
    ds_read_b64_tr_b16 v[230:231], v20 offset:4352
    ds_read_b64_tr_b16 v[232:233], v20 offset:8192
    ds_read_b64_tr_b16 v[234:235], v20 offset:8448
    ds_read_b64_tr_b16 v[236:237], v20 offset:12288
    ds_read_b64_tr_b16 v[238:239], v20 offset:12544
    s_waitcnt lgkmcnt(0)
    s_waitcnt vmcnt(32)
    s_barrier
    s_add_u32 m0, s83, 0x4000
    s_add_u32 s67, s85, 0
    buffer_load_dwordx4 v16, s[24:27], s67 offen nt lds
    s_add_u32 m0, s83, 0x4400
    s_add_u32 s67, s85, 32768
    buffer_load_dwordx4 v16, s[24:27], s67 offen nt lds
    s_add_u32 m0, s83, 0x4800
    s_add_u32 s67, s85, 65536
    buffer_load_dwordx4 v16, s[24:27], s67 offen nt lds
    s_add_u32 m0, s83, 0x4c00
    s_add_u32 s67, s85, 98304
    buffer_load_dwordx4 v16, s[24:27], s67 offen nt lds
    v_add_u32 v20, 0x8000, v18
    ds_read_b64_tr_b16 a[144:145], v20 offset:0
    ds_read_b64_tr_b16 a[146:147], v20 offset:1024
    ds_read_b64_tr_b16 a[148:149], v20 offset:8192
    ds_read_b64_tr_b16 a[150:151], v20 offset:9216
    ds_read_b64_tr_b16 a[152:153], v20 offset:32
    ds_read_b64_tr_b16 a[154:155], v20 offset:1056
    ds_read_b64_tr_b16 a[156:157], v20 offset:8224
    ds_read_b64_tr_b16 a[158:159], v20 offset:9248
    s_waitcnt lgkmcnt(0)
    s_waitcnt vmcnt(32)
    s_barrier
    s_cmp_lg_u32 s65, 0
    s_cbranch_scc1 Ltb0_5
    v_mov_b32 v12, 1
    s_mov_b64 exec, 1
    buffer_atomic_add v12, off, s[56:59], 0 offset:128
    s_mov_b64 exec, -1
Ltb0_5:
    s_getpc_b64 s[16:17]
L_pc0:
    s_add_u32 s16, s16, L_loopcode-L_pc0
    s_addc_u32 s17, s17, 0
    s_lshl_b32 s67, s65, 13
    v_lshlrev_b32 v12, 3, v0
    v_add_u32 v12, s67, v12
    global_load_dword v13, v12, s[16:17]
    s_add_u32 m0, s83, 0x8000
    s_add_u32 s67, s85, 524288
    buffer_load_dwordx4 v16, s[24:27], s67 offen nt lds
    s_add_u32 m0, s83, 0x8400
    s_add_u32 s67, s85, 557056
    buffer_load_dwordx4 v16, s[24:27], s67 offen nt lds
    s_add_u32 m0, s83, 0x8800
    s_add_u32 s67, s85, 589824
    buffer_load_dwordx4 v16, s[24:27], s67 offen nt lds
    s_add_u32 m0, s83, 0x8c00
    s_add_u32 s67, s85, 622592
    buffer_load_dwordx4 v16, s[24:27], s67 offen nt lds
    v_add_u32 v20, 0xc000, v18
    ds_read_b64_tr_b16 a[160:161], v20 offset:0
    ds_read_b64_tr_b16 a[162:163], v20 offset:1024
    ds_read_b64_tr_b16 a[164:165], v20 offset:8192
    ds_read_b64_tr_b16 a[166:167], v20 offset:9216
    ds_read_b64_tr_b16 a[168:169], v20 offset:32
    ds_read_b64_tr_b16 a[170:171], v20 offset:1056
    ds_read_b64_tr_b16 a[172:173], v20 offset:8224
    ds_read_b64_tr_b16 a[174:175], v20 offset:9248
    s_waitcnt lgkmcnt(0)
    s_waitcnt vmcnt(32)
    s_barrier
    s_add_u32 m0, s83, 0xc000
    s_add_u32 s67, s85, 1048576
    buffer_load_dwordx4 v16, s[24:27], s67 offen nt lds
    s_add_u32 m0, s83, 0xc400
    s_add_u32 s67, s85, 1081344
    buffer_load_dwordx4 v16, s[24:27], s67 offen nt lds
    s_add_u32 m0, s83, 0xc800
    s_add_u32 s67, s85, 1114112
    buffer_load_dwordx4 v16, s[24:27], s67 offen nt lds
    s_add_u32 m0, s83, 0xcc00
    s_add_u32 s67, s85, 1146880
    buffer_load_dwordx4 v16, s[24:27], s67 offen nt lds
    v_add_u32 v20, 0x10000, v18
    ds_read_b64_tr_b16 a[176:177], v20 offset:0
    ds_read_b64_tr_b16 a[178:179], v20 offset:1024
    ds_read_b64_tr_b16 a[180:181], v20 offset:8192
    ds_read_b64_tr_b16 a[182:183], v20 offset:9216
    ds_read_b64_tr_b16 a[184:185], v20 offset:32
    ds_read_b64_tr_b16 a[186:187], v20 offset:1056
    ds_read_b64_tr_b16 a[188:189], v20 offset:8224
    ds_read_b64_tr_b16 a[190:191], v20 offset:9248
    s_waitcnt lgkmcnt(0)
    s_waitcnt vmcnt(32)
    s_barrier
    s_add_u32 m0, s83, 0x10000
    s_add_u32 s67, s85, 1572864
    buffer_load_dwordx4 v16, s[24:27], s67 offen nt lds
    s_add_u32 m0, s83, 0x10400
    s_add_u32 s67, s85, 1605632
    buffer_load_dwordx4 v16, s[24:27], s67 offen nt lds
    s_add_u32 m0, s83, 0x10800
    s_add_u32 s67, s85, 1638400
    buffer_load_dwordx4 v16, s[24:27], s67 offen nt lds
    s_add_u32 m0, s83, 0x10c00
    s_add_u32 s67, s85, 1671168
    buffer_load_dwordx4 v16, s[24:27], s67 offen nt lds
    v_add_u32 v20, 0x14000, v18
    ds_read_b64_tr_b16 a[192:193], v20 offset:0
    ds_read_b64_tr_b16 a[194:195], v20 offset:1024
    ds_read_b64_tr_b16 a[196:197], v20 offset:8192
    ds_read_b64_tr_b16 a[198:199], v20 offset:9216
    ds_read_b64_tr_b16 a[200:201], v20 offset:32
    ds_read_b64_tr_b16 a[202:203], v20 offset:1056
    ds_read_b64_tr_b16 a[204:205], v20 offset:8224
    ds_read_b64_tr_b16 a[206:207], v20 offset:9248
    s_waitcnt lgkmcnt(0)
    s_waitcnt vmcnt(32)
    s_barrier
    s_add_u32 m0, s83, 0x14000
    s_add_u32 s67, s85, 2097152
    buffer_load_dwordx4 v16, s[24:27], s67 offen nt lds
    s_add_u32 m0, s83, 0x14400
    s_add_u32 s67, s85, 2129920
    buffer_load_dwordx4 v16, s[24:27], s67 offen nt lds
    s_add_u32 m0, s83, 0x14800
    s_add_u32 s67, s85, 2162688
    buffer_load_dwordx4 v16, s[24:27], s67 offen nt lds
    s_add_u32 m0, s83, 0x14c00
    s_add_u32 s67, s85, 2195456
    buffer_load_dwordx4 v16, s[24:27], s67 offen nt lds
    v_add_u32 v20, 0x18000, v18
    ds_read_b64_tr_b16 a[208:209], v20 offset:0
    ds_read_b64_tr_b16 a[210:211], v20 offset:1024
    ds_read_b64_tr_b16 a[212:213], v20 offset:8192
    ds_read_b64_tr_b16 a[214:215], v20 offset:9216
    ds_read_b64_tr_b16 a[216:217], v20 offset:32
    ds_read_b64_tr_b16 a[218:219], v20 offset:1056
    ds_read_b64_tr_b16 a[220:221], v20 offset:8224
    ds_read_b64_tr_b16 a[222:223], v20 offset:9248
    s_waitcnt lgkmcnt(0)
    s_waitcnt vmcnt(32)
    s_barrier
    s_add_u32 m0, s83, 0x18000
    s_add_u32 s67, s85, 2621440
    buffer_load_dwordx4 v16, s[24:27], s67 offen nt lds
    s_add_u32 m0, s83, 0x18400
    s_add_u32 s67, s85, 2654208
    buffer_load_dwordx4 v16, s[24:27], s67 offen nt lds
    s_add_u32 m0, s83, 0x18800
    s_add_u32 s67, s85, 2686976
    buffer_load_dwordx4 v16, s[24:27], s67 offen nt lds
    s_add_u32 m0, s83, 0x18c00
    s_add_u32 s67, s85, 2719744
    buffer_load_dwordx4 v16, s[24:27], s67 offen nt lds
    v_add_u32 v20, 0x1c000, v18
    ds_read_b64_tr_b16 a[224:225], v20 offset:0
    ds_read_b64_tr_b16 a[226:227], v20 offset:1024
    ds_read_b64_tr_b16 a[228:229], v20 offset:8192
    ds_read_b64_tr_b16 a[230:231], v20 offset:9216
    ds_read_b64_tr_b16 a[232:233], v20 offset:32
    ds_read_b64_tr_b16 a[234:235], v20 offset:1056
    ds_read_b64_tr_b16 a[236:237], v20 offset:8224
    ds_read_b64_tr_b16 a[238:239], v20 offset:9248
    s_waitcnt lgkmcnt(0)
    s_waitcnt vmcnt(32)
    s_barrier
    s_add_u32 m0, s83, 0x1c000
    s_add_u32 s67, s85, 3145728
    buffer_load_dwordx4 v16, s[24:27], s67 offen nt lds
    s_add_u32 m0, s83, 0x1c400
    s_add_u32 s67, s85, 3178496
    buffer_load_dwordx4 v16, s[24:27], s67 offen nt lds
    s_add_u32 m0, s83, 0x1c800
    s_add_u32 s67, s85, 3211264
    buffer_load_dwordx4 v16, s[24:27], s67 offen nt lds
    s_add_u32 m0, s83, 0x1cc00
    s_add_u32 s67, s85, 3244032
    buffer_load_dwordx4 v16, s[24:27], s67 offen nt lds
    v_add_u32 v20, 0x20000, v18
    ds_read_b64_tr_b16 a[240:241], v20 offset:0
    ds_read_b64_tr_b16 a[242:243], v20 offset:1024
    ds_read_b64_tr_b16 a[244:245], v20 offset:8192
    ds_read_b64_tr_b16 a[246:247], v20 offset:9216
    ds_read_b64_tr_b16 a[248:249], v20 offset:32
    ds_read_b64_tr_b16 a[250:251], v20 offset:1056
    ds_read_b64_tr_b16 a[252:253], v20 offset:8224
    ds_read_b64_tr_b16 a[254:255], v20 offset:9248
    s_waitcnt lgkmcnt(0)
    s_waitcnt vmcnt(32)
    s_barrier
    s_add_u32 m0, s83, 0x20000
    s_add_u32 s67, s85, 3670016
    buffer_load_dwordx4 v16, s[24:27], s67 offen nt lds
    s_add_u32 m0, s83, 0x20400
    s_add_u32 s67, s85, 3702784
    buffer_load_dwordx4 v16, s[24:27], s67 offen nt lds
    s_add_u32 m0, s83, 0x20800
    s_add_u32 s67, s85, 3735552
    buffer_load_dwordx4 v16, s[24:27], s67 offen nt lds
    s_add_u32 m0, s83, 0x20c00
    s_add_u32 s67, s85, 3768320
    buffer_load_dwordx4 v16, s[24:27], s67 offen nt lds
    v_add_u32 v20, 0x24000, v18
    ds_read_b64_tr_b16 v[64:65], v20 offset:0
    ds_read_b64_tr_b16 v[66:67], v20 offset:1024
    ds_read_b64_tr_b16 v[68:69], v20 offset:8192
    ds_read_b64_tr_b16 v[70:71], v20 offset:9216
    ds_read_b64_tr_b16 v[72:73], v20 offset:32
    ds_read_b64_tr_b16 v[74:75], v20 offset:1056
    ds_read_b64_tr_b16 v[76:77], v20 offset:8224
    ds_read_b64_tr_b16 v[78:79], v20 offset:9248
    s_waitcnt lgkmcnt(0)
    s_waitcnt vmcnt(32)
    s_barrier
    s_add_u32 m0, s83, 0x24000
    s_add_u32 s67, s85, 4194304
    buffer_load_dwordx4 v16, s[24:27], s67 offen nt lds
    s_add_u32 m0, s83, 0x24400
    s_add_u32 s67, s85, 4227072
    buffer_load_dwordx4 v16, s[24:27], s67 offen nt lds
    s_add_u32 m0, s83, 0x24800
    s_add_u32 s67, s85, 4259840
    buffer_load_dwordx4 v16, s[24:27], s67 offen nt lds
    s_add_u32 m0, s83, 0x24c00
    s_add_u32 s67, s85, 4292608
    buffer_load_dwordx4 v16, s[24:27], s67 offen nt lds
    v_add_u32 v20, 0x0, v18
    ds_read_b64_tr_b16 v[80:81], v20 offset:0
    ds_read_b64_tr_b16 v[82:83], v20 offset:1024
    ds_read_b64_tr_b16 v[84:85], v20 offset:8192
    ds_read_b64_tr_b16 v[86:87], v20 offset:9216
    ds_read_b64_tr_b16 v[88:89], v20 offset:32
    ds_read_b64_tr_b16 v[90:91], v20 offset:1056
    ds_read_b64_tr_b16 v[92:93], v20 offset:8224
    ds_read_b64_tr_b16 v[94:95], v20 offset:9248
    s_waitcnt lgkmcnt(0)
    s_waitcnt vmcnt(32)
    s_barrier
    v_add_u32 v20, 0x4000, v18
    ds_read_b64_tr_b16 v[240:241], v20 offset:0
    ds_read_b64_tr_b16 v[242:243], v20 offset:1024
    ds_read_b64_tr_b16 v[244:245], v20 offset:8192
    ds_read_b64_tr_b16 v[246:247], v20 offset:9216
    ds_read_b64_tr_b16 v[248:249], v20 offset:32
    ds_read_b64_tr_b16 v[250:251], v20 offset:1056
    ds_read_b64_tr_b16 v[252:253], v20 offset:8224
    ds_read_b64_tr_b16 v[254:255], v20 offset:9248
    s_waitcnt lgkmcnt(0)
    s_waitcnt vmcnt(28)
    s_barrier
    v_add_u32 v20, 0x8000, v18
    ds_read_b64_tr_b16 v[48:49], v20 offset:0
    ds_read_b64_tr_b16 v[50:51], v20 offset:1024
    ds_read_b64_tr_b16 v[52:53], v20 offset:8192
    ds_read_b64_tr_b16 v[54:55], v20 offset:9216
    ds_read_b64_tr_b16 v[56:57], v20 offset:32
    ds_read_b64_tr_b16 v[58:59], v20 offset:1056
    ds_read_b64_tr_b16 v[60:61], v20 offset:8224
    ds_read_b64_tr_b16 v[62:63], v20 offset:9248
    s_waitcnt lgkmcnt(0)
    s_barrier
    v_add_u32 v20, 0x0, v1
    ds_write_b128 v20, v[48:51] offset:0
    ds_write_b128 v20, v[52:55] offset:1024
    ds_write_b128 v20, v[56:59] offset:2048
    ds_write_b128 v20, v[60:63] offset:3072
    s_waitcnt vmcnt(24)
    s_barrier
    v_add_u32 v20, 0xc000, v18
    ds_read_b64_tr_b16 v[48:49], v20 offset:0
    ds_read_b64_tr_b16 v[50:51], v20 offset:1024
    ds_read_b64_tr_b16 v[52:53], v20 offset:8192
    ds_read_b64_tr_b16 v[54:55], v20 offset:9216
    ds_read_b64_tr_b16 v[56:57], v20 offset:32
    ds_read_b64_tr_b16 v[58:59], v20 offset:1056
    ds_read_b64_tr_b16 v[60:61], v20 offset:8224
    ds_read_b64_tr_b16 v[62:63], v20 offset:9248
    s_waitcnt lgkmcnt(0)
    s_barrier
    v_add_u32 v20, 0x4000, v1
    ds_write_b128 v20, v[48:51] offset:0
    ds_write_b128 v20, v[52:55] offset:1024
    ds_write_b128 v20, v[56:59] offset:2048
    ds_write_b128 v20, v[60:63] offset:3072
    s_waitcnt vmcnt(20)
    s_barrier
    v_add_u32 v20, 0x10000, v18
    ds_read_b64_tr_b16 v[48:49], v20 offset:0
    ds_read_b64_tr_b16 v[50:51], v20 offset:1024
    ds_read_b64_tr_b16 v[52:53], v20 offset:8192
    ds_read_b64_tr_b16 v[54:55], v20 offset:9216
    ds_read_b64_tr_b16 v[56:57], v20 offset:32
    ds_read_b64_tr_b16 v[58:59], v20 offset:1056
    ds_read_b64_tr_b16 v[60:61], v20 offset:8224
    ds_read_b64_tr_b16 v[62:63], v20 offset:9248
    s_waitcnt lgkmcnt(0)
    s_barrier
    v_add_u32 v20, 0x8000, v1
    ds_write_b128 v20, v[48:51] offset:0
    ds_write_b128 v20, v[52:55] offset:1024
    ds_write_b128 v20, v[56:59] offset:2048
    ds_write_b128 v20, v[60:63] offset:3072
    s_waitcnt vmcnt(16)
    s_barrier
    v_add_u32 v20, 0x14000, v18
    ds_read_b64_tr_b16 v[48:49], v20 offset:0
    ds_read_b64_tr_b16 v[50:51], v20 offset:1024
    ds_read_b64_tr_b16 v[52:53], v20 offset:8192
    ds_read_b64_tr_b16 v[54:55], v20 offset:9216
    ds_read_b64_tr_b16 v[56:57], v20 offset:32
    ds_read_b64_tr_b16 v[58:59], v20 offset:1056
    ds_read_b64_tr_b16 v[60:61], v20 offset:8224
    ds_read_b64_tr_b16 v[62:63], v20 offset:9248
    s_waitcnt lgkmcnt(0)
    s_barrier
    v_add_u32 v20, 0xc000, v1
    ds_write_b128 v20, v[48:51] offset:0
    ds_write_b128 v20, v[52:55] offset:1024
    ds_write_b128 v20, v[56:59] offset:2048
    ds_write_b128 v20, v[60:63] offset:3072
    s_waitcnt vmcnt(12)
    s_barrier
    v_add_u32 v20, 0x18000, v18
    ds_read_b64_tr_b16 v[48:49], v20 offset:0
    ds_read_b64_tr_b16 v[50:51], v20 offset:1024
    ds_read_b64_tr_b16 v[52:53], v20 offset:8192
    ds_read_b64_tr_b16 v[54:55], v20 offset:9216
    ds_read_b64_tr_b16 v[56:57], v20 offset:32
    ds_read_b64_tr_b16 v[58:59], v20 offset:1056
    ds_read_b64_tr_b16 v[60:61], v20 offset:8224
    ds_read_b64_tr_b16 v[62:63], v20 offset:9248
    s_waitcnt lgkmcnt(0)
    s_barrier
    v_add_u32 v20, 0x10000, v1
    ds_write_b128 v20, v[48:51] offset:0
    ds_write_b128 v20, v[52:55] offset:1024
    ds_write_b128 v20, v[56:59] offset:2048
    ds_write_b128 v20, v[60:63] offset:3072
    s_waitcnt vmcnt(8)
    s_barrier
    v_add_u32 v20, 0x1c000, v18
    ds_read_b64_tr_b16 v[48:49], v20 offset:0
    ds_read_b64_tr_b16 v[50:51], v20 offset:1024
    ds_read_b64_tr_b16 v[52:53], v20 offset:8192
    ds_read_b64_tr_b16 v[54:55], v20 offset:9216
    ds_read_b64_tr_b16 v[56:57], v20 offset:32
    ds_read_b64_tr_b16 v[58:59], v20 offset:1056
    ds_read_b64_tr_b16 v[60:61], v20 offset:8224
    ds_read_b64_tr_b16 v[62:63], v20 offset:9248
    s_waitcnt lgkmcnt(0)
    s_barrier
    v_add_u32 v20, 0x14000, v1
    ds_write_b128 v20, v[48:51] offset:0
    ds_write_b128 v20, v[52:55] offset:1024
    ds_write_b128 v20, v[56:59] offset:2048
    ds_write_b128 v20, v[60:63] offset:3072
    s_waitcnt vmcnt(4)
    s_barrier
    v_add_u32 v20, 0x20000, v18
    ds_read_b64_tr_b16 v[48:49], v20 offset:0
    ds_read_b64_tr_b16 v[50:51], v20 offset:1024
    ds_read_b64_tr_b16 v[52:53], v20 offset:8192
    ds_read_b64_tr_b16 v[54:55], v20 offset:9216
    ds_read_b64_tr_b16 v[56:57], v20 offset:32
    ds_read_b64_tr_b16 v[58:59], v20 offset:1056
    ds_read_b64_tr_b16 v[60:61], v20 offset:8224
    ds_read_b64_tr_b16 v[62:63], v20 offset:9248
    s_waitcnt lgkmcnt(0)
    s_barrier
    v_add_u32 v20, 0x18000, v1
    ds_write_b128 v20, v[48:51] offset:0
    ds_write_b128 v20, v[52:55] offset:1024
    ds_write_b128 v20, v[56:59] offset:2048
    ds_write_b128 v20, v[60:63] offset:3072
    s_waitcnt vmcnt(0)
    s_barrier
    v_add_u32 v20, 0x24000, v18
    ds_read_b64_tr_b16 v[48:49], v20 offset:0
    ds_read_b64_tr_b16 v[50:51], v20 offset:1024
    ds_read_b64_tr_b16 v[52:53], v20 offset:8192
    ds_read_b64_tr_b16 v[54:55], v20 offset:9216
    ds_read_b64_tr_b16 v[56:57], v20 offset:32
    ds_read_b64_tr_b16 v[58:59], v20 offset:1056
    ds_read_b64_tr_b16 v[60:61], v20 offset:8224
    ds_read_b64_tr_b16 v[62:63], v20 offset:9248
    s_waitcnt lgkmcnt(0)
    s_barrier
    v_add_u32 v20, 0x1c000, v1
    ds_write_b128 v20, v[48:51] offset:0
    ds_write_b128 v20, v[52:55] offset:1024
    ds_write_b128 v20, v[56:59] offset:2048
    ds_write_b128 v20, v[60:63] offset:3072
    s_lshl_b32 s98, s65, 11
    v_add_u32 v20, s98, v0
    ds_write_b128 v20, v[248:251] offset:12288
    ds_write_b128 v20, v[252:255] offset:13312
    v_and_b32 v20, 0xf0, v0
    ds_write_b128 v20, v[32:35] offset:31744
    s_mov_b32 s74, 0
    v_mov_b32 v9, 128
    v_mov_b32 v12, 0
L_tb0:
    buffer_load_dword v10, v9, s[56:59], 0 offen sc1
    s_waitcnt vmcnt(0)
    v_readfirstlane_b32 s67, v10
    s_add_u32 s74, s74, 1
    s_cmp_ge_u32 s74, 0x20000
    s_cbranch_scc1 L_fail
    s_cmp_lt_u32 s67, 32
    s_cbranch_scc1 L_tb0
    s_xor_b32 s67, s70, 0x80000
    buffer_load_dwordx4 v[16:19], v0, s[60:63], s70 offen sc1
    buffer_load_dwordx4 v[16:19], v0, s[60:63], s70 offen offset:1024 sc1
    buffer_load_dwordx4 v[16:19], v0, s[60:63], s67 offen sc1
    buffer_load_dwordx4 v[16:19], v0, s[60:63], s67 offen offset:1024 sc1
    s_xor_b32 s67, s71, 0x80000
    buffer_load_dwordx4 v[16:19], v0, s[60:63], s71 offen sc1
    buffer_load_dwordx4 v[16:19], v0, s[60:63], s71 offen offset:1024 sc1
    buffer_load_dwordx4 v[16:19], v0, s[60:63], s67 offen sc1
    buffer_load_dwordx4 v[16:19], v0, s[60:63], s67 offen offset:1024 sc1
    s_lshl_b32 s67, s64, 2
    s_add_u32 s67, s67, s65
    s_and_b32 s67, s67, 63
    s_lshl_b32 s67, s67, 10
    s_add_u32 s67, s67, 0x7200000
    buffer_load_dwordx4 v[16:19], v0, s[60:63], s67 offen sc1
    s_cmp_lg_u32 s65, 0
    s_cbranch_scc1 L_tbw
L_tb:
    buffer_load_dword v11, v9, s[56:59], 0 offen offset:4 sc1
    buffer_load_dword v13, v12, s[56:59], 0 offen sc1
    s_waitcnt vmcnt(0)
    v_readfirstlane_b32 s68, v11
    s_add_u32 s74, s74, 1
    s_cmp_ge_u32 s74, 0x20000
    s_cbranch_scc1 L_fail
    s_cmp_lt_u32 s68, 224
    s_cbranch_scc1 L_tb
    v_mov_b32 v9, 0x7d00
    ds_write_b32 v9, v13
L_tbw:
    s_waitcnt vmcnt(0) lgkmcnt(0)
    s_barrier
    v_mov_b32 v9, 0x7d00
    ds_read_b32 v10, v9
    s_waitcnt lgkmcnt(0)
    v_readfirstlane_b32 s85, v10
    v_mov_b64 v[8:9], 0
    v_mov_b64 v[10:11], 0
    v_mov_b64 v[12:13], 0
    v_mov_b64 v[14:15], 0
    v_mov_b64 v[16:17], 0
    v_mov_b64 v[18:19], 0
    v_mov_b64 v[20:21], 0
    v_mov_b64 v[22:23], 0
    v_mov_b64 v[24:25], 0
    v_mov_b64 v[26:27], 0
    v_mov_b64 v[28:29], 0
    v_mov_b64 v[30:31], 0
    v_add_u32 v6, s98, v0
    ds_read_b128 v[48:51], v6 offset:12288
    ds_read_b128 v[52:55], v6 offset:13312
    v_mov_b32 v40, -2
    v_mov_b32 v41, -2
    v_mov_b32 v42, -2
    v_mov_b32 v43, -2
    v_mov_b32 v44, -2
    v_mov_b32 v45, -2
    v_mov_b32 v46, -2
    v_mov_b32 v47, -2
    s_mov_b32 s3, 0x7000000
    s_mov_b32 s4, 0x7010000
    s_mov_b32 s5, 0x7020000
    s_mov_b32 s6, 0x7030000
    s_mov_b32 s7, 0x7040000
    s_mov_b32 s74, 0
    s_mov_b32 s66, 0
    s_lshl_b32 s67, s64, 14
    s_add_u32 s94, s67, s98
    s_add_u32 s95, s94, 8192
    s_lshl_b32 s68, s65, 12
    s_add_u32 s101, s67, s68
    s_add_u32 s101, s101, 0x80000
    s_add_u32 s96, s98, 0x1000
    s_add_u32 s97, s98, 0x5000
    s_lshl_b32 s68, s64, 7
    s_add_u32 s68, s68, 0x7410000
    s_cmp_eq_u32 s65, 3
    s_cselect_b32 s100, s68, 0x10000000
    s_lshl_b32 s67, s64, 11
    s_lshl_b32 s68, s65, 9
    s_add_u32 s67, s67, s68
    s_add_u32 s83, s67, 0x6400000
    s_add_u32 s84, s67, 0x6c00000
    s_mov_b32 s75, 0x7200000
    s_mov_b32 s72, 0x7200000
    s_lshl_b32 s90, s65, 11
    s_add_u32 s88, s90, 0x7200000
    s_add_u32 s67, s65, 6
    s_min_u32 s67, s67, 8
    s_lshl_b32 s91, s67, 10
    s_add_u32 s89, s91, 0x7200000
    s_mov_b32 s80, 0x3e0293ee
    s_cmp_lt_u32 s85, 32
    s_cbranch_scc1 L_slow
L_loopcode:
    s_cmp_eq_u32 s65, 1
    s_cbranch_scc1 Lwave_7
    s_cmp_eq_u32 s65, 2
    s_cbranch_scc1 Lwave_8
    s_cmp_eq_u32 s65, 3
    s_cbranch_scc1 Lwave_9
Lwave_6:
    s_branch Lagtop_10
.p2align 3
Lbar1_11:
    s_waitcnt lgkmcnt(0)
    s_barrier
    ds_read_b128 v[32:35], v0 offset:22528
    ds_read_b128 v[36:39], v0 offset:23552
    ds_read_b128 v[248:251], v1 offset:2048
    ds_read_b128 v[252:255], v1 offset:3072
    ds_read_b128 v[56:59], v1 offset:0
    ds_read_b128 v[60:63], v1 offset:1024
    s_waitcnt lgkmcnt(5)
    v_smfmac_f32_16x16x64_bf16 v[8:11], v[32:35], a[0:7], v2
    v_smfmac_f32_16x16x64_bf16 v[12:15], v[32:35], a[8:15], v2
    v_smfmac_f32_16x16x64_bf16 v[24:27], v[32:35], v[240:247], v2
    v_smfmac_f32_16x16x64_bf16 v[16:19], v[32:35], a[144:151], v2
    v_smfmac_f32_16x16x64_bf16 v[20:23], v[32:35], a[152:159], v2
    v_smfmac_f32_16x16x64_bf16 v[28:31], v[32:35], v[48:55], v2
    ds_read_b128 v[48:51], v1 offset:16384
    ds_read_b128 v[52:55], v1 offset:17408
    s_waitcnt lgkmcnt(2)
    v_smfmac_f32_16x16x64_bf16 v[8:11], v[36:39], a[16:23], v2
    s_waitcnt vmcnt(0)
    ds_read_b128 v[40:43], v0 offset:24576
    v_smfmac_f32_16x16x64_bf16 v[12:15], v[36:39], a[24:31], v2
    ds_read_b128 v[32:35], v0 offset:25600
    buffer_load_dwordx4 v[44:47], v0, s[60:63], s89 offen sc1
    v_smfmac_f32_16x16x64_bf16 v[24:27], v[36:39], v[56:63], v2
    ds_read_b128 v[56:59], v1 offset:18432
    ds_read_b128 v[60:63], v1 offset:19456
    v_smfmac_f32_16x16x64_bf16 v[16:19], v[36:39], a[160:167], v2
    s_mov_b32 m0, s96
    v_smfmac_f32_16x16x64_bf16 v[20:23], v[36:39], a[168:175], v2
    buffer_load_dwordx4 v0, s[60:63], s94 offen sc1 lds
    v_smfmac_f32_16x16x64_bf16 v[28:31], v[36:39], v[248:255], v2
    ds_read_b128 v[248:251], v1 offset:32768
    ds_read_b128 v[252:255], v1 offset:33792
    s_waitcnt lgkmcnt(5)
    v_smfmac_f32_16x16x64_bf16 v[8:11], v[40:43], a[32:39], v2
    ds_read_b128 v[36:39], v0 offset:26624
    v_smfmac_f32_16x16x64_bf16 v[12:15], v[40:43], a[40:47], v2
    buffer_load_dwordx4 v0, s[60:63], s94 offen offset:1024 sc1 lds
    v_smfmac_f32_16x16x64_bf16 v[24:27], v[40:43], v[48:55], v2
    ds_read_b128 v[48:51], v1 offset:34816
    ds_read_b128 v[52:55], v1 offset:35840
    v_smfmac_f32_16x16x64_bf16 v[16:19], v[40:43], a[176:183], v2
    v_smfmac_f32_16x16x64_bf16 v[20:23], v[40:43], a[184:191], v2
    s_waitcnt lgkmcnt(5)
    v_smfmac_f32_16x16x64_bf16 v[28:31], v[40:43], v[56:63], v2
    ds_read_b128 v[56:59], v1 offset:49152
    ds_read_b128 v[60:63], v1 offset:50176
    v_smfmac_f32_16x16x64_bf16 v[8:11], v[32:35], a[48:55], v2
    ds_read_b128 v[40:43], v0 offset:27648
    v_smfmac_f32_16x16x64_bf16 v[12:15], v[32:35], a[56:63], v2
    s_waitcnt lgkmcnt(5)
    v_smfmac_f32_16x16x64_bf16 v[24:27], v[32:35], v[248:255], v2
    ds_read_b128 v[248:251], v1 offset:51200
    ds_read_b128 v[252:255], v1 offset:52224
    v_smfmac_f32_16x16x64_bf16 v[16:19], v[32:35], a[192:199], v2
    s_waitcnt vmcnt(2)
    v_max3_u32 v6, v44, v45, v46
    v_smfmac_f32_16x16x64_bf16 v[20:23], v[32:35], a[200:207], v2
    v_add_u32 v1, 0x10000, v1
    s_waitcnt lgkmcnt(5)
    v_smfmac_f32_16x16x64_bf16 v[28:31], v[32:35], v[48:55], v2
    ds_read_b128 v[48:51], v1 offset:0
    ds_read_b128 v[52:55], v1 offset:1024
    v_smfmac_f32_16x16x64_bf16 v[8:11], v[36:39], a[64:71], v2
    v_max_u32 v6, v6, v47
    v_smfmac_f32_16x16x64_bf16 v[12:15], v[36:39], a[72:79], v2
    v_cmp_eq_u32 vcc, -1, v6
    s_waitcnt lgkmcnt(4)
    v_smfmac_f32_16x16x64_bf16 v[24:27], v[36:39], v[56:63], v2
    ds_read_b128 v[56:59], v1 offset:2048
    ds_read_b128 v[60:63], v1 offset:3072
    v_smfmac_f32_16x16x64_bf16 v[16:19], v[36:39], a[208:215], v2
    v_add_u32 v6, s91, v0
    s_cbranch_vccnz Lpr_12
Lpc_13:
    ds_write_b128 v6, v[44:47] offset:22528
    v_smfmac_f32_16x16x64_bf16 v[20:23], v[36:39], a[216:223], v2
    s_waitcnt lgkmcnt(5)
    v_smfmac_f32_16x16x64_bf16 v[28:31], v[36:39], v[248:255], v2
    ds_read_b128 v[248:251], v1 offset:16384
    ds_read_b128 v[252:255], v1 offset:17408
    v_smfmac_f32_16x16x64_bf16 v[8:11], v[40:43], a[80:87], v2
    s_mov_b32 m0, s97
    v_smfmac_f32_16x16x64_bf16 v[12:15], v[40:43], a[88:95], v2
    s_waitcnt lgkmcnt(2)
    s_waitcnt vmcnt(0)
    s_barrier
    ds_read_b128 v[32:35], v0 offset:28672
    ds_read_b128 v[36:39], v0 offset:29696
    v_smfmac_f32_16x16x64_bf16 v[24:27], v[40:43], v[48:55], v2
    ds_read_b128 v[48:51], v1 offset:18432
    ds_read_b128 v[52:55], v1 offset:19456
    s_cmp_eq_u32 s66, 30
    s_cbranch_scc1 Lkv_14
Lkvc_15:
    v_smfmac_f32_16x16x64_bf16 v[16:19], v[40:43], a[224:231], v2
    ds_read_b128 v[44:47], v0 offset:30720
    buffer_load_dwordx4 v0, s[60:63], s95 offen sc1 lds
    v_smfmac_f32_16x16x64_bf16 v[20:23], v[40:43], a[232:239], v2
    buffer_load_dwordx4 v0, s[60:63], s95 offen offset:1024 sc1 lds
    v_smfmac_f32_16x16x64_bf16 v[28:31], v[40:43], v[56:63], v2
    ds_read_b128 v[56:59], v1 offset:32768
    ds_read_b128 v[60:63], v1 offset:33792
    s_waitcnt lgkmcnt(6)
    v_smfmac_f32_16x16x64_bf16 v[8:11], v[32:35], a[96:103], v2
    s_mov_b32 m0, 0x7d00
    v_lshlrev_b32 v6, 2, v0
    v_smfmac_f32_16x16x64_bf16 v[12:15], v[32:35], a[104:111], v2
    v_smfmac_f32_16x16x64_bf16 v[16:19], v[32:35], a[240:247], v2
    s_waitcnt lgkmcnt(3)
    v_smfmac_f32_16x16x64_bf16 v[8:11], v[36:39], a[112:119], v2
    buffer_load_dword v6, s[60:63], s101 offen sc1 lds
    v_smfmac_f32_16x16x64_bf16 v[12:15], v[36:39], a[120:127], v2
    v_smfmac_f32_16x16x64_bf16 v[20:23], v[32:35], a[248:255], v2
    s_waitcnt lgkmcnt(0)
    v_smfmac_f32_16x16x64_bf16 v[8:11], v[44:47], a[128:135], v2
    v_smfmac_f32_16x16x64_bf16 v[12:15], v[44:47], a[136:143], v2
    v_and_b32 v6, 0xffff, v3
    v_smfmac_f32_16x16x64_bf16 v[24:27], v[32:35], v[248:255], v2
    ds_read_b128 v[248:251], v1 offset:34816
    ds_read_b128 v[252:255], v1 offset:35840
    v_smfmac_f32_16x16x64_bf16 v[16:19], v[36:39], v[64:71], v2
    v_add_f32 v8, v8, v10
    v_add_f32 v9, v9, v11
    v_smfmac_f32_16x16x64_bf16 v[20:23], v[36:39], v[72:79], v2
    v_add_f32 v12, v12, v14
    v_add_f32 v13, v13, v15
    v_smfmac_f32_16x16x64_bf16 v[28:31], v[32:35], v[48:55], v2
    ds_read_b128 v[48:51], v1 offset:49152
    ds_read_b128 v[52:55], v1 offset:50176
    v_cvt_pk_bf16_f32 v8, v8, v9
    v_smfmac_f32_16x16x64_bf16 v[16:19], v[44:47], v[80:87], v2
    v_cvt_pk_bf16_f32 v9, v12, v13
    ds_write2_b32 v6, v8, v9 offset0:0 offset1:64
    v_smfmac_f32_16x16x64_bf16 v[20:23], v[44:47], v[88:95], v2
    ds_read_b128 v[8:11], v1 offset:51200
    ds_read_b128 v[12:15], v1 offset:52224
    v_smfmac_f32_16x16x64_bf16 v[24:27], v[36:39], v[56:63], v2
    ds_read_b128 v[56:59], v0 offset:4096
    ds_read_b128 v[60:63], v0 offset:8192
    s_waitcnt lgkmcnt(7)
    v_smfmac_f32_16x16x64_bf16 v[28:31], v[36:39], v[248:255], v2
    v_add_f32 v16, v16, v18
    v_add_f32 v17, v17, v19
    v_add_f32 v20, v20, v22
    v_add_f32 v21, v21, v23
    v_cvt_pk_bf16_f32 v16, v16, v17
    v_cvt_pk_bf16_f32 v17, v20, v21
    v_add_u32 v18, 2048, v6
    ds_write2_b32 v18, v16, v17 offset0:0 offset1:64
    s_waitcnt lgkmcnt(6)
    v_smfmac_f32_16x16x64_bf16 v[24:27], v[44:47], v[48:55], v2
    ds_read_b128 v[248:251], v0 offset:5120
    ds_read_b128 v[252:255], v0 offset:9216
    v_lshrrev_b32 v3, 16, v3
    s_waitcnt lgkmcnt(5)
    v_smfmac_f32_16x16x64_bf16 v[28:31], v[44:47], v[8:15], v2
    v_lshrrev_b32 v18, 1, v0
    buffer_store_dwordx2 v[16:17], v18, s[60:63], s83 offen sc1
    s_nop 0
    v_add_f32 v24, v24, v26
    v_add_f32 v25, v25, v27
    s_waitcnt lgkmcnt(2)
    s_barrier
    ds_read_b64_tr_b16 v[32:33], v3 offset:0
    ds_read_b64_tr_b16 v[34:35], v3 offset:256
    ds_read_b64_tr_b16 v[40:41], v3 offset:512
    ds_read_b64_tr_b16 v[42:43], v3 offset:768
    v_add_f32 v28, v28, v30
    ds_read_b128 v[48:51], v0 offset:6144
    ds_read_b128 v[52:55], v0 offset:10240
    v_add_f32 v29, v29, v31
    ds_read_b64_tr_b16 v[36:37], v3 offset:1024
    ds_read_b64_tr_b16 v[38:39], v3 offset:1280
    v_cvt_pk_bf16_f32 v24, v24, v25
    s_waitcnt lgkmcnt(6)
    v_mfma_f32_16x16x32_bf16 v[16:19], v[56:59], v[32:35], 0
    ds_read_b64_tr_b16 v[44:45], v3 offset:1536
    ds_read_b64_tr_b16 v[46:47], v3 offset:1792
    v_mfma_f32_16x16x32_bf16 v[20:23], v[60:63], v[32:35], 0
    ds_read_b128 v[8:11], v0 offset:7168
    ds_read_b128 v[12:15], v0 offset:11264
    s_waitcnt lgkmcnt(8)
    v_mfma_f32_16x16x32_bf16 v[16:19], v[248:251], v[40:43], v[16:19]
    ds_read_b64_tr_b16 v[56:57], v7 offset:0
    ds_read_b64_tr_b16 v[58:59], v7 offset:256
    v_mfma_f32_16x16x32_bf16 v[20:23], v[252:255], v[40:43], v[20:23]
    ds_read_b64_tr_b16 v[60:61], v7 offset:512
    ds_read_b64_tr_b16 v[62:63], v7 offset:768
    s_waitcnt lgkmcnt(8)
    v_mfma_f32_16x16x32_bf16 v[16:19], v[48:51], v[36:39], v[16:19]
    ds_read_b64_tr_b16 v[248:249], v7 offset:1024
    ds_read_b64_tr_b16 v[250:251], v7 offset:1280
    v_mfma_f32_16x16x32_bf16 v[20:23], v[52:55], v[36:39], v[20:23]
    ds_read_b64_tr_b16 v[252:253], v7 offset:1536
    ds_read_b64_tr_b16 v[254:255], v7 offset:1792
    s_waitcnt lgkmcnt(8)
    v_mfma_f32_16x16x32_bf16 v[16:19], v[8:11], v[44:47], v[16:19]
    v_cvt_pk_bf16_f32 v25, v28, v29
    v_lshl_or_b32 v3, v3, 16, v6
    v_mfma_f32_16x16x32_bf16 v[20:23], v[12:15], v[44:47], v[20:23]
    v_add_u32 v6, s98, v0
    v_lshrrev_b32 v26, 1, v0
    s_waitcnt lgkmcnt(6)
    v_mfma_f32_16x16x32_bf16 v[28:31], v[56:59], v[32:35], 0
    buffer_store_dwordx2 v[24:25], v26, s[60:63], s84 offen sc1
    s_cmp_eq_u32 s66, 63
    s_waitcnt lgkmcnt(4)
    v_mfma_f32_16x16x32_bf16 v[28:31], v[60:63], v[40:43], v[28:31]
    s_cbranch_scc1 Llast_16
    s_waitcnt vmcnt(3)
    s_waitcnt lgkmcnt(2)
    v_mfma_f32_16x16x32_bf16 v[28:31], v[248:251], v[36:39], v[28:31]
    ds_read_b128 v[48:51], v6 offset:20480
    ds_read_b128 v[52:55], v6 offset:21504
    s_waitcnt lgkmcnt(2)
    v_mfma_f32_16x16x32_bf16 v[28:31], v[252:255], v[44:47], v[28:31]
    v_cndmask_b32 v8, v20, v16, s[92:93]
    v_cndmask_b32 v9, v21, v17, s[92:93]
    v_cndmask_b32 v10, v22, v18, s[92:93]
    v_cndmask_b32 v11, v23, v19, s[92:93]
    v_max3_f32 v12, v8, v9, v10
    v_mov_b64 v[20:21], -1
    v_max_f32 v12, v12, v11
    v_mov_b64 v[22:23], -1
    v_cndmask_b32 v16, v28, v30, s[78:79]
    v_cndmask_b32 v17, v29, v31, s[78:79]
    v_max3_f32 v12, v12, v16, v17
    s_xor_b32 s67, s70, 0x80000
    buffer_store_dwordx4 v[20:23], v0, s[60:63], s67 offen
    v_max_f32_dpp v13, v12, v12 row_ror:8 row_mask:0xf bank_mask:0xf
    v_max_f32_dpp v12, v12, v12 row_ror:8 row_mask:0xf bank_mask:0xf
    v_mov_b32 v40, 0x3f803f80
    v_mov_b32 v41, 0x3f803f80
    v_permlane16_swap_b32 v12, v13
    v_max_f32 v14, v12, v13
    v_max_f32 v12, v12, v13
    v_mov_b64 v[42:43], v[40:41]
    v_mov_b32 v37, 0
    v_permlane32_swap_b32 v12, v14
    v_max_f32 v12, v12, v14
    v_mul_f32 v12, s80, v12
    v_fma_f32 v8, v8, s80, -v12
    v_fma_f32 v9, v9, s80, -v12
    v_exp_f32 v8, v8
    v_exp_f32 v9, v9
    v_fma_f32 v10, v10, s80, -v12
    v_fma_f32 v11, v11, s80, -v12
    v_cvt_pk_bf16_f32 v32, v8, v9
    v_exp_f32 v10, v10
    v_exp_f32 v11, v11
    v_mov_b32_dpp v34, v32 row_ror:8 row_mask:0xf bank_mask:0xf
    v_cvt_pk_bf16_f32 v33, v10, v11
    v_fma_f32 v16, v16, s80, -v12
    v_fma_f32 v17, v17, s80, -v12
    v_mov_b32_dpp v35, v33 row_ror:8 row_mask:0xf bank_mask:0xf
    v_exp_f32 v16, v16
    s_waitcnt lgkmcnt(0)
    v_mfma_f32_16x16x32_bf16 v[56:59], v[40:43], v[32:35], 0
    v_exp_f32 v17, v17
    v_mfma_f32_16x16x32_bf16 v[248:251], v[48:51], v[32:35], 0
    v_mov_b32 v38, 0
    v_cvt_pk_bf16_f32 v36, v16, v17
    v_mfma_f32_16x16x32_bf16 v[252:255], v[52:55], v[32:35], 0
    v_cvt_pk_bf16_f32 v39, v16, v17
    v_lshrrev_b32 v6, 16, v2
    v_mfma_f32_16x16x16_bf16 v[56:59], v[40:41], v[36:37], v[56:59]
    v_mov_b64 v[8:9], 0
    v_mov_b64 v[10:11], 0
    v_mfma_f32_16x16x16_bf16 v[248:251], v[24:25], v[36:37], v[248:251]
    v_mov_b64 v[12:13], 0
    v_mov_b64 v[14:15], 0
    v_mfma_f32_16x16x16_bf16 v[252:255], v[24:25], v[38:39], v[252:255]
    buffer_store_dwordx4 v[20:23], v0, s[60:63], s67 offen offset:1024
    v_rcp_f32 v56, v56
    v_mov_b64 v[16:17], 0
    s_nop 0
    v_mul_f32 v248, v248, v56
    v_mul_f32 v249, v249, v56
    v_cvt_pk_bf16_f32 v44, v248, v249
    v_mul_f32 v250, v250, v56
    v_mul_f32 v251, v251, v56
    v_cvt_pk_bf16_f32 v45, v250, v251
    v_mul_f32 v252, v252, v56
    v_mul_f32 v253, v253, v56
    v_cvt_pk_bf16_f32 v46, v252, v253
    v_mul_f32 v254, v254, v56
    v_mul_f32 v255, v255, v56
    v_cvt_pk_bf16_f32 v47, v254, v255
    s_mov_b64 exec, s[92:93]
    ds_write_b128 v6, v[44:47]
    s_mov_b64 exec, -1
    v_mov_b64 v[18:19], 0
    v_mov_b64 v[20:21], 0
    v_mov_b64 v[22:23], 0
    v_mov_b64 v[24:25], 0
    v_mov_b64 v[26:27], 0
    v_and_b32 v6, 0xf0, v0
    v_mov_b32 v56, -2
    v_mov_b32 v57, -2
    v_mov_b64 v[58:59], v[56:57]
    v_mov_b64 v[60:61], v[56:57]
    v_mov_b64 v[62:63], v[56:57]
    s_waitcnt lgkmcnt(0)
    s_barrier
    ds_read_b128 v[44:47], v0 offset:28672
    ds_read_b128 v[48:51], v0 offset:29696
    ds_read_b128 v[248:251], v6 offset:31744
    v_mov_b64 v[28:29], 0
    v_mov_b64 v[30:31], 0
    v_mov_b64 v[32:33], 0
    v_mov_b64 v[34:35], 0
    v_mov_b64 v[36:37], 0
    v_mov_b64 v[38:39], 0
    v_mov_b64 v[40:41], 0
    v_mov_b64 v[42:43], 0
    s_waitcnt lgkmcnt(2)
    v_smfmac_f32_16x16x64_bf16 v[8:11], v[44:47], v[96:103], v2
    s_mov_b32 s72, s75
    v_subrev_u32 v1, 0x10000, v1
    v_smfmac_f32_16x16x64_bf16 v[12:15], v[44:47], v[112:119], v2
    s_add_u32 s75, s75, 16384
    v_and_b32 v6, 0xffff, v4
    v_smfmac_f32_16x16x64_bf16 v[16:19], v[44:47], v[128:135], v2
    s_and_b32 s75, s75, 0xfffeffff
    s_waitcnt lgkmcnt(1)
    v_smfmac_f32_16x16x64_bf16 v[8:11], v[48:51], v[104:111], v2
    s_add_u32 s88, s75, s90
    v_smfmac_f32_16x16x64_bf16 v[12:15], v[48:51], v[120:127], v2
    v_smfmac_f32_16x16x64_bf16 v[20:23], v[44:47], v[144:151], v2
    v_add_f32 v8, v8, v10
    v_smfmac_f32_16x16x64_bf16 v[16:19], v[48:51], v[136:143], v2
    v_add_f32 v9, v9, v11
    v_smfmac_f32_16x16x64_bf16 v[20:23], v[48:51], v[152:159], v2
    v_add_f32 v12, v12, v14
    v_smfmac_f32_16x16x64_bf16 v[24:27], v[44:47], v[160:167], v2
    v_add_f32 v13, v13, v15
    v_smfmac_f32_16x16x64_bf16 v[28:31], v[44:47], v[176:183], v2
    v_cvt_pk_bf16_f32 v8, v8, v9
    v_smfmac_f32_16x16x64_bf16 v[32:35], v[44:47], v[192:199], v2
    v_cvt_pk_bf16_f32 v9, v12, v13
    v_smfmac_f32_16x16x64_bf16 v[24:27], v[48:51], v[168:175], v2
    buffer_store_dwordx2 v[8:9], v5, s[60:63], s3 offen
    v_add_f32 v16, v16, v18
    v_smfmac_f32_16x16x64_bf16 v[28:31], v[48:51], v[184:191], v2
    v_add_f32 v17, v17, v19
    v_smfmac_f32_16x16x64_bf16 v[36:39], v[44:47], v[208:215], v2
    v_add_f32 v20, v20, v22
    v_smfmac_f32_16x16x64_bf16 v[40:43], v[44:47], v[224:231], v2
    v_add_f32 v21, v21, v23
    v_smfmac_f32_16x16x64_bf16 v[32:35], v[48:51], v[200:207], v2
    v_cvt_pk_bf16_f32 v16, v16, v17
    v_smfmac_f32_16x16x64_bf16 v[36:39], v[48:51], v[216:223], v2
    v_cvt_pk_bf16_f32 v17, v20, v21
    v_smfmac_f32_16x16x64_bf16 v[40:43], v[48:51], v[232:239], v2
    buffer_store_dwordx2 v[16:17], v5, s[60:63], s4 offen
    v_add_f32 v24, v24, v26
    v_add_f32 v25, v25, v27
    v_add_f32 v28, v28, v30
    v_add_f32 v29, v29, v31
    v_cvt_pk_bf16_f32 v24, v24, v25
    v_cvt_pk_bf16_f32 v25, v28, v29
    buffer_store_dwordx2 v[24:25], v5, s[60:63], s5 offen
    v_pk_add_f32 v[32:33], v[32:33], v[34:35]
    v_pk_add_f32 v[36:37], v[36:37], v[38:39]
    v_cvt_pk_bf16_f32 v32, v32, v33
    v_cvt_pk_bf16_f32 v33, v36, v37
    buffer_store_dwordx2 v[32:33], v5, s[60:63], s6 offen
    v_pk_add_f32 v[40:41], v[40:41], v[42:43]
    v_mov_b64 v[28:29], -1
    v_cvt_pk_bf16_f32 v40, v40, v41
    v_mov_b64 v[30:31], -1
    v_mov_b64 v[8:9], 0
    v_mov_b32_dpp v41, v40 row_ror:8 row_mask:0xf bank_mask:0xf
    s_mov_b64 exec, s[92:93]
    buffer_store_dwordx2 v[40:41], v5, s[60:63], s7 offen
    s_mov_b64 exec, -1
    buffer_load_dwordx4 v[56:59], v0, s[60:63], s70 offen sc1
    buffer_load_dwordx4 v[60:63], v0, s[60:63], s70 offen offset:1024 sc1
    s_waitcnt lgkmcnt(0)
Lpl_19:
    v_max3_u32 v252, v56, v57, v58
    v_max3_u32 v253, v59, v60, v61
    v_max3_u32 v252, v252, v62, v63
    v_max_u32 v252, v252, v253
    v_cmp_le_u32 vcc, -2, v252
    s_add_u32 s74, s74, 1
    s_cbranch_vccz Lrok_18
    v_max3_u32 v252, v56, v57, v58
    v_max3_u32 v253, v59, v60, v61
    v_max3_u32 v252, v252, v62, v63
    v_max_u32 v252, v252, v253
    v_cmp_le_u32 vcc, -2, v252
    s_nop 0
    s_cbranch_vccz Lrok_18
    v_max3_u32 v252, v56, v57, v58
    v_max3_u32 v253, v59, v60, v61
    v_max3_u32 v252, v252, v62, v63
    v_max_u32 v252, v252, v253
    v_cmp_le_u32 vcc, -2, v252
    s_cmp_lt_u32 s74, 0x100000
    s_cbranch_vccz Lrok_18
    buffer_load_dwordx4 v[56:59], v0, s[60:63], s70 offen sc1
    v_mov_b32 v254, 0
    buffer_load_dwordx4 v[60:63], v0, s[60:63], s70 offen offset:1024 sc1
    v_mov_b32 v254, 0
    s_cbranch_scc1 Lpl_19
    s_branch L_fail
Lrok_18:
    v_mfma_f32_16x16x32_bf16 v[252:255], v[248:251], v[56:59], 0
    v_mfma_f32_16x16x32_bf16 v[252:255], v[248:251], v[60:63], v[252:255]
    v_mov_b32 v40, -2
    v_mov_b32 v41, -2
    v_mov_b64 v[42:43], v[40:41]
    v_mov_b64 v[44:45], v[40:41]
    v_mov_b64 v[46:47], v[40:41]
    s_nop 2
    v_add_f32_dpp v254, v252, v252 row_ror:8 row_mask:0xf bank_mask:0xf
    v_add_f32_dpp v255, v253, v253 row_ror:8 row_mask:0xf bank_mask:0xf
    s_nop 0
    v_add_f32_dpp v252, v254, v254 row_ror:4 row_mask:0xf bank_mask:0xf
    v_add_f32_dpp v253, v255, v255 row_ror:4 row_mask:0xf bank_mask:0xf
    s_mov_b64 exec, s[76:77]
    v_cvt_pk_bf16_f32 v252, v252, v253
    buffer_store_dword v252, v6, s[60:63], s75 offen
    buffer_store_dword v28, v6, s[60:63], s72 offen
    s_mov_b64 exec, -1
    v_mov_b64 v[10:11], 0
    v_mov_b64 v[12:13], 0
    v_mov_b64 v[14:15], 0
    v_mov_b64 v[16:17], 0
    v_mov_b64 v[18:19], 0
    v_mov_b64 v[20:21], 0
    v_mov_b64 v[22:23], 0
    v_mov_b64 v[24:25], 0
    v_mov_b64 v[26:27], 0
    s_add_u32 s89, s75, s91
    s_add_u32 s94, s94, 0x80000
    s_add_u32 s95, s95, 0x80000
    s_add_u32 s101, s101, 0x80000
    s_add_u32 s83, s83, 0x10000
    s_add_u32 s84, s84, 0x10000
    v_xor_b32 v5, 0x80000, v5
    s_add_u32 s66, s66, 1
    s_xor_b32 s70, s70, 0x80000
    v_add_u32 v6, s98, v0
    ds_read_b128 v[48:51], v6 offset:12288
    ds_read_b128 v[52:55], v6 offset:13312
    v_mov_b64 v[28:29], 0
    v_mov_b64 v[30:31], 0
    buffer_load_dwordx4 v[40:43], v0, s[60:63], s88 offen sc1
    buffer_load_dwordx4 v[44:47], v0, s[60:63], s88 offen offset:1024 sc1
Lagp_17:
    v_add_u32 v6, s90, v0
Lpl_21:
    v_max3_u32 v252, v40, v41, v42
    v_max3_u32 v253, v43, v44, v45
    v_max3_u32 v252, v252, v46, v47
    v_max_u32 v252, v252, v253
    v_cmp_le_u32 vcc, -2, v252
    s_add_u32 s74, s74, 1
    s_cbranch_vccz LpAok_20
    v_max3_u32 v252, v40, v41, v42
    v_max3_u32 v253, v43, v44, v45
    v_max3_u32 v252, v252, v46, v47
    v_max_u32 v252, v252, v253
    v_cmp_le_u32 vcc, -2, v252
    s_nop 0
    s_cbranch_vccz LpAok_20
    v_max3_u32 v252, v40, v41, v42
    v_max3_u32 v253, v43, v44, v45
    v_max3_u32 v252, v252, v46, v47
    v_max_u32 v252, v252, v253
    v_cmp_le_u32 vcc, -2, v252
    s_cmp_lt_u32 s74, 0x100000
    s_cbranch_vccz LpAok_20
    buffer_load_dwordx4 v[40:43], v0, s[60:63], s88 offen sc1
    v_mov_b32 v254, 0
    buffer_load_dwordx4 v[44:47], v0, s[60:63], s88 offen offset:1024 sc1
    v_mov_b32 v254, 0
    s_cbranch_scc1 Lpl_21
    s_branch L_fail
LpAok_20:
    ds_write_b128 v6, v[40:43] offset:22528
    ds_write_b128 v6, v[44:47] offset:23552
    s_branch Lbar1_11
Lagtop_10:
    buffer_load_dwordx4 v[40:43], v0, s[60:63], s88 offen sc1
    buffer_load_dwordx4 v[44:47], v0, s[60:63], s88 offen offset:1024 sc1
    s_branch Lagp_17
Lpr_12:
    buffer_load_dwordx4 v[44:47], v0, s[60:63], s89 offen sc1
    s_add_u32 s74, s74, 1
    s_cmp_ge_u32 s74, 0x100000
    s_cbranch_scc1 L_fail
    s_waitcnt vmcnt(0)
    v_max3_u32 v6, v44, v45, v46
    v_max_u32 v6, v6, v47
    v_cmp_eq_u32 vcc, -1, v6
    v_add_u32 v6, s91, v0
    s_cbranch_vccnz Lpr_12
    s_branch Lpc_13
Lkv_14:
    buffer_load_dword v6, off, s[56:59], 0 offset:148 sc1
    s_add_u32 s74, s74, 1
    s_cmp_ge_u32 s74, 0x100000
    s_cbranch_scc1 L_fail
    s_waitcnt vmcnt(0)
    v_readfirstlane_b32 s67, v6
    s_cmp_lt_u32 s67, 224
    s_cbranch_scc1 Lkv_14
    s_branch Lkvc_15
Llast_16:
    s_waitcnt vmcnt(0)
    s_barrier
    s_branch L_cdone
Lwave_7:
    s_branch Lagtop_22
.p2align 3
Lbar1_23:
    s_waitcnt lgkmcnt(0)
    s_barrier
    ds_read_b128 v[32:35], v0 offset:22528
    ds_read_b128 v[36:39], v0 offset:23552
    ds_read_b128 v[248:251], v1 offset:2048
    ds_read_b128 v[252:255], v1 offset:3072
    ds_read_b128 v[56:59], v1 offset:0
    ds_read_b128 v[60:63], v1 offset:1024
    s_waitcnt lgkmcnt(5)
    v_smfmac_f32_16x16x64_bf16 v[8:11], v[32:35], a[0:7], v2
    v_smfmac_f32_16x16x64_bf16 v[12:15], v[32:35], a[8:15], v2
    v_smfmac_f32_16x16x64_bf16 v[24:27], v[32:35], v[240:247], v2
    v_smfmac_f32_16x16x64_bf16 v[16:19], v[32:35], a[144:151], v2
    v_smfmac_f32_16x16x64_bf16 v[20:23], v[32:35], a[152:159], v2
    v_smfmac_f32_16x16x64_bf16 v[28:31], v[32:35], v[48:55], v2
    ds_read_b128 v[48:51], v1 offset:16384
    ds_read_b128 v[52:55], v1 offset:17408
    s_waitcnt lgkmcnt(2)
    v_smfmac_f32_16x16x64_bf16 v[8:11], v[36:39], a[16:23], v2
    s_waitcnt vmcnt(0)
    ds_read_b128 v[40:43], v0 offset:24576
    v_smfmac_f32_16x16x64_bf16 v[12:15], v[36:39], a[24:31], v2
    ds_read_b128 v[32:35], v0 offset:25600
    buffer_load_dwordx4 v[44:47], v0, s[60:63], s89 offen sc1
    v_smfmac_f32_16x16x64_bf16 v[24:27], v[36:39], v[56:63], v2
    ds_read_b128 v[56:59], v1 offset:18432
    ds_read_b128 v[60:63], v1 offset:19456
    v_smfmac_f32_16x16x64_bf16 v[16:19], v[36:39], a[160:167], v2
    s_mov_b32 m0, s96
    v_smfmac_f32_16x16x64_bf16 v[20:23], v[36:39], a[168:175], v2
    buffer_load_dwordx4 v0, s[60:63], s94 offen sc1 lds
    v_smfmac_f32_16x16x64_bf16 v[28:31], v[36:39], v[248:255], v2
    ds_read_b128 v[248:251], v1 offset:32768
    ds_read_b128 v[252:255], v1 offset:33792
    s_waitcnt lgkmcnt(5)
    v_smfmac_f32_16x16x64_bf16 v[8:11], v[40:43], a[32:39], v2
    ds_read_b128 v[36:39], v0 offset:26624
    v_smfmac_f32_16x16x64_bf16 v[12:15], v[40:43], a[40:47], v2
    buffer_load_dwordx4 v0, s[60:63], s94 offen offset:1024 sc1 lds
    v_smfmac_f32_16x16x64_bf16 v[24:27], v[40:43], v[48:55], v2
    ds_read_b128 v[48:51], v1 offset:34816
    ds_read_b128 v[52:55], v1 offset:35840
    v_smfmac_f32_16x16x64_bf16 v[16:19], v[40:43], a[176:183], v2
    v_smfmac_f32_16x16x64_bf16 v[20:23], v[40:43], a[184:191], v2
    s_waitcnt lgkmcnt(5)
    v_smfmac_f32_16x16x64_bf16 v[28:31], v[40:43], v[56:63], v2
    ds_read_b128 v[56:59], v1 offset:49152
    ds_read_b128 v[60:63], v1 offset:50176
    v_smfmac_f32_16x16x64_bf16 v[8:11], v[32:35], a[48:55], v2
    ds_read_b128 v[40:43], v0 offset:27648
    v_smfmac_f32_16x16x64_bf16 v[12:15], v[32:35], a[56:63], v2
    s_waitcnt lgkmcnt(5)
    v_smfmac_f32_16x16x64_bf16 v[24:27], v[32:35], v[248:255], v2
    ds_read_b128 v[248:251], v1 offset:51200
    ds_read_b128 v[252:255], v1 offset:52224
    v_smfmac_f32_16x16x64_bf16 v[16:19], v[32:35], a[192:199], v2
    s_waitcnt vmcnt(2)
    v_max3_u32 v6, v44, v45, v46
    v_smfmac_f32_16x16x64_bf16 v[20:23], v[32:35], a[200:207], v2
    v_add_u32 v1, 0x10000, v1
    s_waitcnt lgkmcnt(5)
    v_smfmac_f32_16x16x64_bf16 v[28:31], v[32:35], v[48:55], v2
    ds_read_b128 v[48:51], v1 offset:0
    ds_read_b128 v[52:55], v1 offset:1024
    v_smfmac_f32_16x16x64_bf16 v[8:11], v[36:39], a[64:71], v2
    v_max_u32 v6, v6, v47
    v_smfmac_f32_16x16x64_bf16 v[12:15], v[36:39], a[72:79], v2
    v_cmp_eq_u32 vcc, -1, v6
    s_waitcnt lgkmcnt(4)
    v_smfmac_f32_16x16x64_bf16 v[24:27], v[36:39], v[56:63], v2
    ds_read_b128 v[56:59], v1 offset:2048
    ds_read_b128 v[60:63], v1 offset:3072
    v_smfmac_f32_16x16x64_bf16 v[16:19], v[36:39], a[208:215], v2
    v_add_u32 v6, s91, v0
    s_cbranch_vccnz Lpr_24
Lpc_25:
    ds_write_b128 v6, v[44:47] offset:22528
    v_smfmac_f32_16x16x64_bf16 v[20:23], v[36:39], a[216:223], v2
    s_waitcnt lgkmcnt(5)
    v_smfmac_f32_16x16x64_bf16 v[28:31], v[36:39], v[248:255], v2
    ds_read_b128 v[248:251], v1 offset:16384
    ds_read_b128 v[252:255], v1 offset:17408
    v_smfmac_f32_16x16x64_bf16 v[8:11], v[40:43], a[80:87], v2
    s_mov_b32 m0, s97
    v_smfmac_f32_16x16x64_bf16 v[12:15], v[40:43], a[88:95], v2
    s_waitcnt lgkmcnt(2)
    s_waitcnt vmcnt(0)
    s_barrier
    ds_read_b128 v[32:35], v0 offset:28672
    ds_read_b128 v[36:39], v0 offset:29696
    v_smfmac_f32_16x16x64_bf16 v[24:27], v[40:43], v[48:55], v2
    ds_read_b128 v[48:51], v1 offset:18432
    ds_read_b128 v[52:55], v1 offset:19456
    s_cmp_eq_u32 s66, 30
    s_cbranch_scc1 Lkv_26
Lkvc_27:
    v_smfmac_f32_16x16x64_bf16 v[16:19], v[40:43], a[224:231], v2
    ds_read_b128 v[44:47], v0 offset:30720
    buffer_load_dwordx4 v0, s[60:63], s95 offen sc1 lds
    v_smfmac_f32_16x16x64_bf16 v[20:23], v[40:43], a[232:239], v2
    buffer_load_dwordx4 v0, s[60:63], s95 offen offset:1024 sc1 lds
    v_smfmac_f32_16x16x64_bf16 v[28:31], v[40:43], v[56:63], v2
    ds_read_b128 v[56:59], v1 offset:32768
    ds_read_b128 v[60:63], v1 offset:33792
    s_waitcnt lgkmcnt(6)
    v_smfmac_f32_16x16x64_bf16 v[8:11], v[32:35], a[96:103], v2
    s_mov_b32 m0, 0x7d00
    v_lshlrev_b32 v6, 2, v0
    v_smfmac_f32_16x16x64_bf16 v[12:15], v[32:35], a[104:111], v2
    v_smfmac_f32_16x16x64_bf16 v[16:19], v[32:35], a[240:247], v2
    s_waitcnt lgkmcnt(3)
    v_smfmac_f32_16x16x64_bf16 v[8:11], v[36:39], a[112:119], v2
    buffer_load_dword v6, s[60:63], s101 offen sc1 lds
    v_smfmac_f32_16x16x64_bf16 v[12:15], v[36:39], a[120:127], v2
    v_smfmac_f32_16x16x64_bf16 v[20:23], v[32:35], a[248:255], v2
    s_waitcnt lgkmcnt(0)
    v_smfmac_f32_16x16x64_bf16 v[8:11], v[44:47], a[128:135], v2
    v_smfmac_f32_16x16x64_bf16 v[12:15], v[44:47], a[136:143], v2
    v_and_b32 v6, 0xffff, v3
    v_smfmac_f32_16x16x64_bf16 v[24:27], v[32:35], v[248:255], v2
    ds_read_b128 v[248:251], v1 offset:34816
    ds_read_b128 v[252:255], v1 offset:35840
    v_smfmac_f32_16x16x64_bf16 v[16:19], v[36:39], v[64:71], v2
    v_add_f32 v8, v8, v10
    v_add_f32 v9, v9, v11
    v_smfmac_f32_16x16x64_bf16 v[20:23], v[36:39], v[72:79], v2
    v_add_f32 v12, v12, v14
    v_add_f32 v13, v13, v15
    v_smfmac_f32_16x16x64_bf16 v[28:31], v[32:35], v[48:55], v2
    ds_read_b128 v[48:51], v1 offset:49152
    ds_read_b128 v[52:55], v1 offset:50176
    v_cvt_pk_bf16_f32 v8, v8, v9
    v_smfmac_f32_16x16x64_bf16 v[16:19], v[44:47], v[80:87], v2
    v_cvt_pk_bf16_f32 v9, v12, v13
    ds_write2_b32 v6, v8, v9 offset0:0 offset1:64
    v_smfmac_f32_16x16x64_bf16 v[20:23], v[44:47], v[88:95], v2
    ds_read_b128 v[8:11], v1 offset:51200
    ds_read_b128 v[12:15], v1 offset:52224
    v_smfmac_f32_16x16x64_bf16 v[24:27], v[36:39], v[56:63], v2
    ds_read_b128 v[56:59], v0 offset:4096
    ds_read_b128 v[60:63], v0 offset:8192
    s_waitcnt lgkmcnt(7)
    v_smfmac_f32_16x16x64_bf16 v[28:31], v[36:39], v[248:255], v2
    v_add_f32 v16, v16, v18
    v_add_f32 v17, v17, v19
    v_add_f32 v20, v20, v22
    v_add_f32 v21, v21, v23
    v_cvt_pk_bf16_f32 v16, v16, v17
    v_cvt_pk_bf16_f32 v17, v20, v21
    v_add_u32 v18, 2048, v6
    ds_write2_b32 v18, v16, v17 offset0:0 offset1:64
    s_waitcnt lgkmcnt(6)
    v_smfmac_f32_16x16x64_bf16 v[24:27], v[44:47], v[48:55], v2
    ds_read_b128 v[248:251], v0 offset:5120
    ds_read_b128 v[252:255], v0 offset:9216
    v_lshrrev_b32 v3, 16, v3
    s_waitcnt lgkmcnt(5)
    v_smfmac_f32_16x16x64_bf16 v[28:31], v[44:47], v[8:15], v2
    v_lshrrev_b32 v18, 1, v0
    buffer_store_dwordx2 v[16:17], v18, s[60:63], s83 offen sc1
    s_nop 0
    v_add_f32 v24, v24, v26
    v_add_f32 v25, v25, v27
    s_waitcnt lgkmcnt(2)
    s_barrier
    ds_read_b64_tr_b16 v[32:33], v3 offset:0
    ds_read_b64_tr_b16 v[34:35], v3 offset:256
    ds_read_b64_tr_b16 v[40:41], v3 offset:512
    ds_read_b64_tr_b16 v[42:43], v3 offset:768
    v_add_f32 v28, v28, v30
    ds_read_b128 v[48:51], v0 offset:6144
    ds_read_b128 v[52:55], v0 offset:10240
    v_add_f32 v29, v29, v31
    ds_read_b64_tr_b16 v[36:37], v3 offset:1024
    ds_read_b64_tr_b16 v[38:39], v3 offset:1280
    v_cvt_pk_bf16_f32 v24, v24, v25
    s_waitcnt lgkmcnt(6)
    v_mfma_f32_16x16x32_bf16 v[16:19], v[56:59], v[32:35], 0
    ds_read_b64_tr_b16 v[44:45], v3 offset:1536
    ds_read_b64_tr_b16 v[46:47], v3 offset:1792
    v_mfma_f32_16x16x32_bf16 v[20:23], v[60:63], v[32:35], 0
    ds_read_b128 v[8:11], v0 offset:7168
    ds_read_b128 v[12:15], v0 offset:11264
    s_waitcnt lgkmcnt(8)
    v_mfma_f32_16x16x32_bf16 v[16:19], v[248:251], v[40:43], v[16:19]
    ds_read_b64_tr_b16 v[56:57], v7 offset:0
    ds_read_b64_tr_b16 v[58:59], v7 offset:256
    v_mfma_f32_16x16x32_bf16 v[20:23], v[252:255], v[40:43], v[20:23]
    ds_read_b64_tr_b16 v[60:61], v7 offset:512
    ds_read_b64_tr_b16 v[62:63], v7 offset:768
    s_waitcnt lgkmcnt(8)
    v_mfma_f32_16x16x32_bf16 v[16:19], v[48:51], v[36:39], v[16:19]
    ds_read_b64_tr_b16 v[248:249], v7 offset:1024
    ds_read_b64_tr_b16 v[250:251], v7 offset:1280
    v_mfma_f32_16x16x32_bf16 v[20:23], v[52:55], v[36:39], v[20:23]
    ds_read_b64_tr_b16 v[252:253], v7 offset:1536
    ds_read_b64_tr_b16 v[254:255], v7 offset:1792
    s_waitcnt lgkmcnt(8)
    v_mfma_f32_16x16x32_bf16 v[16:19], v[8:11], v[44:47], v[16:19]
    v_cvt_pk_bf16_f32 v25, v28, v29
    v_lshl_or_b32 v3, v3, 16, v6
    v_mfma_f32_16x16x32_bf16 v[20:23], v[12:15], v[44:47], v[20:23]
    v_add_u32 v6, s98, v0
    v_lshrrev_b32 v26, 1, v0
    s_waitcnt lgkmcnt(6)
    v_mfma_f32_16x16x32_bf16 v[28:31], v[56:59], v[32:35], 0
    buffer_store_dwordx2 v[24:25], v26, s[60:63], s84 offen sc1
    s_cmp_eq_u32 s66, 63
    s_waitcnt lgkmcnt(4)
    v_mfma_f32_16x16x32_bf16 v[28:31], v[60:63], v[40:43], v[28:31]
    s_cbranch_scc1 Llast_28
    s_waitcnt vmcnt(3)
    s_waitcnt lgkmcnt(2)
    v_mfma_f32_16x16x32_bf16 v[28:31], v[248:251], v[36:39], v[28:31]
    ds_read_b128 v[48:51], v6 offset:20480
    ds_read_b128 v[52:55], v6 offset:21504
    s_waitcnt lgkmcnt(2)
    v_mfma_f32_16x16x32_bf16 v[28:31], v[252:255], v[44:47], v[28:31]
    v_cndmask_b32 v8, v20, v16, s[92:93]
    v_cndmask_b32 v9, v21, v17, s[92:93]
    v_cndmask_b32 v10, v22, v18, s[92:93]
    v_cndmask_b32 v11, v23, v19, s[92:93]
    v_max3_f32 v12, v8, v9, v10
    v_mov_b64 v[20:21], -1
    v_max_f32 v12, v12, v11
    v_mov_b64 v[22:23], -1
    v_cndmask_b32 v16, v28, v30, s[78:79]
    v_cndmask_b32 v17, v29, v31, s[78:79]
    v_max3_f32 v12, v12, v16, v17
    s_xor_b32 s67, s70, 0x80000
    buffer_store_dwordx4 v[20:23], v0, s[60:63], s67 offen
    v_max_f32_dpp v13, v12, v12 row_ror:8 row_mask:0xf bank_mask:0xf
    v_max_f32_dpp v12, v12, v12 row_ror:8 row_mask:0xf bank_mask:0xf
    v_mov_b32 v40, 0x3f803f80
    v_mov_b32 v41, 0x3f803f80
    v_permlane16_swap_b32 v12, v13
    v_max_f32 v14, v12, v13
    v_max_f32 v12, v12, v13
    v_mov_b64 v[42:43], v[40:41]
    v_mov_b32 v37, 0
    v_permlane32_swap_b32 v12, v14
    v_max_f32 v12, v12, v14
    v_mul_f32 v12, s80, v12
    v_fma_f32 v8, v8, s80, -v12
    v_fma_f32 v9, v9, s80, -v12
    v_exp_f32 v8, v8
    v_exp_f32 v9, v9
    v_fma_f32 v10, v10, s80, -v12
    v_fma_f32 v11, v11, s80, -v12
    v_cvt_pk_bf16_f32 v32, v8, v9
    v_exp_f32 v10, v10
    v_exp_f32 v11, v11
    v_mov_b32_dpp v34, v32 row_ror:8 row_mask:0xf bank_mask:0xf
    v_cvt_pk_bf16_f32 v33, v10, v11
    v_fma_f32 v16, v16, s80, -v12
    v_fma_f32 v17, v17, s80, -v12
    v_mov_b32_dpp v35, v33 row_ror:8 row_mask:0xf bank_mask:0xf
    v_exp_f32 v16, v16
    s_waitcnt lgkmcnt(0)
    v_mfma_f32_16x16x32_bf16 v[56:59], v[40:43], v[32:35], 0
    v_exp_f32 v17, v17
    v_mfma_f32_16x16x32_bf16 v[248:251], v[48:51], v[32:35], 0
    v_mov_b32 v38, 0
    v_cvt_pk_bf16_f32 v36, v16, v17
    v_mfma_f32_16x16x32_bf16 v[252:255], v[52:55], v[32:35], 0
    v_cvt_pk_bf16_f32 v39, v16, v17
    v_lshrrev_b32 v6, 16, v2
    v_mfma_f32_16x16x16_bf16 v[56:59], v[40:41], v[36:37], v[56:59]
    v_mov_b64 v[8:9], 0
    v_mov_b64 v[10:11], 0
    v_mfma_f32_16x16x16_bf16 v[248:251], v[24:25], v[36:37], v[248:251]
    v_mov_b64 v[12:13], 0
    v_mov_b64 v[14:15], 0
    v_mfma_f32_16x16x16_bf16 v[252:255], v[24:25], v[38:39], v[252:255]
    buffer_store_dwordx4 v[20:23], v0, s[60:63], s67 offen offset:1024
    v_rcp_f32 v56, v56
    v_mov_b64 v[16:17], 0
    s_nop 0
    v_mul_f32 v248, v248, v56
    v_mul_f32 v249, v249, v56
    v_cvt_pk_bf16_f32 v44, v248, v249
    v_mul_f32 v250, v250, v56
    v_mul_f32 v251, v251, v56
    v_cvt_pk_bf16_f32 v45, v250, v251
    v_mul_f32 v252, v252, v56
    v_mul_f32 v253, v253, v56
    v_cvt_pk_bf16_f32 v46, v252, v253
    v_mul_f32 v254, v254, v56
    v_mul_f32 v255, v255, v56
    v_cvt_pk_bf16_f32 v47, v254, v255
    s_mov_b64 exec, s[92:93]
    ds_write_b128 v6, v[44:47]
    s_mov_b64 exec, -1
    v_mov_b64 v[18:19], 0
    v_mov_b64 v[20:21], 0
    v_mov_b64 v[22:23], 0
    v_mov_b64 v[24:25], 0
    v_mov_b64 v[26:27], 0
    v_and_b32 v6, 0xf0, v0
    v_mov_b32 v56, -2
    v_mov_b32 v57, -2
    v_mov_b64 v[58:59], v[56:57]
    v_mov_b64 v[60:61], v[56:57]
    v_mov_b64 v[62:63], v[56:57]
    s_waitcnt lgkmcnt(0)
    s_barrier
    ds_read_b128 v[44:47], v0 offset:28672
    ds_read_b128 v[48:51], v0 offset:29696
    ds_read_b128 v[248:251], v6 offset:31744
    v_mov_b64 v[28:29], 0
    v_mov_b64 v[30:31], 0
    v_mov_b64 v[32:33], 0
    v_mov_b64 v[34:35], 0
    v_mov_b64 v[36:37], 0
    v_mov_b64 v[38:39], 0
    v_mov_b64 v[40:41], 0
    v_mov_b64 v[42:43], 0
    s_waitcnt lgkmcnt(2)
    v_smfmac_f32_16x16x64_bf16 v[8:11], v[44:47], v[96:103], v2
    s_mov_b32 s72, s75
    v_subrev_u32 v1, 0x10000, v1
    v_smfmac_f32_16x16x64_bf16 v[12:15], v[44:47], v[112:119], v2
    s_add_u32 s75, s75, 16384
    v_and_b32 v6, 0xffff, v4
    v_smfmac_f32_16x16x64_bf16 v[16:19], v[44:47], v[128:135], v2
    s_and_b32 s75, s75, 0xfffeffff
    s_waitcnt lgkmcnt(1)
    v_smfmac_f32_16x16x64_bf16 v[8:11], v[48:51], v[104:111], v2
    s_add_u32 s88, s75, s90
    v_smfmac_f32_16x16x64_bf16 v[12:15], v[48:51], v[120:127], v2
    v_smfmac_f32_16x16x64_bf16 v[20:23], v[44:47], v[144:151], v2
    v_add_f32 v8, v8, v10
    v_smfmac_f32_16x16x64_bf16 v[16:19], v[48:51], v[136:143], v2
    v_add_f32 v9, v9, v11
    v_smfmac_f32_16x16x64_bf16 v[20:23], v[48:51], v[152:159], v2
    v_add_f32 v12, v12, v14
    v_smfmac_f32_16x16x64_bf16 v[24:27], v[44:47], v[160:167], v2
    v_add_f32 v13, v13, v15
    v_smfmac_f32_16x16x64_bf16 v[28:31], v[44:47], v[176:183], v2
    v_cvt_pk_bf16_f32 v8, v8, v9
    v_smfmac_f32_16x16x64_bf16 v[32:35], v[44:47], v[192:199], v2
    v_cvt_pk_bf16_f32 v9, v12, v13
    v_smfmac_f32_16x16x64_bf16 v[24:27], v[48:51], v[168:175], v2
    buffer_store_dwordx2 v[8:9], v5, s[60:63], s3 offen
    v_add_f32 v16, v16, v18
    v_smfmac_f32_16x16x64_bf16 v[28:31], v[48:51], v[184:191], v2
    v_add_f32 v17, v17, v19
    v_smfmac_f32_16x16x64_bf16 v[36:39], v[44:47], v[208:215], v2
    v_add_f32 v20, v20, v22
    v_smfmac_f32_16x16x64_bf16 v[40:43], v[44:47], v[224:231], v2
    v_add_f32 v21, v21, v23
    v_smfmac_f32_16x16x64_bf16 v[32:35], v[48:51], v[200:207], v2
    v_cvt_pk_bf16_f32 v16, v16, v17
    v_smfmac_f32_16x16x64_bf16 v[36:39], v[48:51], v[216:223], v2
    v_cvt_pk_bf16_f32 v17, v20, v21
    v_smfmac_f32_16x16x64_bf16 v[40:43], v[48:51], v[232:239], v2
    buffer_store_dwordx2 v[16:17], v5, s[60:63], s4 offen
    v_add_f32 v24, v24, v26
    v_add_f32 v25, v25, v27
    v_add_f32 v28, v28, v30
    v_add_f32 v29, v29, v31
    v_cvt_pk_bf16_f32 v24, v24, v25
    v_cvt_pk_bf16_f32 v25, v28, v29
    buffer_store_dwordx2 v[24:25], v5, s[60:63], s5 offen
    v_pk_add_f32 v[32:33], v[32:33], v[34:35]
    v_pk_add_f32 v[36:37], v[36:37], v[38:39]
    v_cvt_pk_bf16_f32 v32, v32, v33
    v_cvt_pk_bf16_f32 v33, v36, v37
    buffer_store_dwordx2 v[32:33], v5, s[60:63], s6 offen
    v_pk_add_f32 v[40:41], v[40:41], v[42:43]
    v_mov_b64 v[28:29], -1
    v_cvt_pk_bf16_f32 v40, v40, v41
    v_mov_b64 v[30:31], -1
    v_mov_b64 v[8:9], 0
    v_mov_b32_dpp v41, v40 row_ror:8 row_mask:0xf bank_mask:0xf
    s_mov_b64 exec, s[92:93]
    buffer_store_dwordx2 v[40:41], v5, s[60:63], s7 offen
    s_mov_b64 exec, -1
    s_waitcnt lgkmcnt(0)
    v_mov_b64 v[10:11], 0
    v_mov_b64 v[12:13], 0
    v_mov_b64 v[14:15], 0
    v_mov_b64 v[16:17], 0
    v_mov_b64 v[18:19], 0
    buffer_load_dwordx4 v[56:59], v0, s[60:63], s70 offen sc1
    buffer_load_dwordx4 v[60:63], v0, s[60:63], s70 offen offset:1024 sc1
Lpl_31:
    v_max3_u32 v252, v56, v57, v58
    v_max3_u32 v253, v59, v60, v61
    v_max3_u32 v252, v252, v62, v63
    v_max_u32 v252, v252, v253
    v_cmp_le_u32 vcc, -2, v252
    s_add_u32 s74, s74, 1
    s_cbranch_vccz Lrok_30
    v_max3_u32 v252, v56, v57, v58
    v_max3_u32 v253, v59, v60, v61
    v_max3_u32 v252, v252, v62, v63
    v_max_u32 v252, v252, v253
    v_cmp_le_u32 vcc, -2, v252
    s_nop 0
    s_cbranch_vccz Lrok_30
    v_max3_u32 v252, v56, v57, v58
    v_max3_u32 v253, v59, v60, v61
    v_max3_u32 v252, v252, v62, v63
    v_max_u32 v252, v252, v253
    v_cmp_le_u32 vcc, -2, v252
    s_cmp_lt_u32 s74, 0x100000
    s_cbranch_vccz Lrok_30
    buffer_load_dwordx4 v[56:59], v0, s[60:63], s70 offen sc1
    v_mov_b32 v254, 0
    buffer_load_dwordx4 v[60:63], v0, s[60:63], s70 offen offset:1024 sc1
    v_mov_b32 v254, 0
    s_cbranch_scc1 Lpl_31
    s_branch L_fail
Lrok_30:
    v_mfma_f32_16x16x32_bf16 v[252:255], v[248:251], v[56:59], 0
    v_mfma_f32_16x16x32_bf16 v[252:255], v[248:251], v[60:63], v[252:255]
    v_mov_b32 v40, -2
    v_mov_b32 v41, -2
    v_mov_b64 v[42:43], v[40:41]
    v_mov_b64 v[44:45], v[40:41]
    v_mov_b64 v[46:47], v[40:41]
    s_nop 2
    v_add_f32_dpp v254, v252, v252 row_ror:8 row_mask:0xf bank_mask:0xf
    v_add_f32_dpp v255, v253, v253 row_ror:8 row_mask:0xf bank_mask:0xf
    s_nop 0
    v_add_f32_dpp v252, v254, v254 row_ror:4 row_mask:0xf bank_mask:0xf
    v_add_f32_dpp v253, v255, v255 row_ror:4 row_mask:0xf bank_mask:0xf
    s_mov_b64 exec, s[76:77]
    v_cvt_pk_bf16_f32 v252, v252, v253
    buffer_store_dword v252, v6, s[60:63], s75 offen
    buffer_store_dword v28, v6, s[60:63], s72 offen
    s_mov_b64 exec, -1
    v_mov_b64 v[20:21], 0
    v_mov_b64 v[22:23], 0
    v_mov_b64 v[24:25], 0
    v_mov_b64 v[26:27], 0
    s_add_u32 s89, s75, s91
    s_add_u32 s94, s94, 0x80000
    s_add_u32 s95, s95, 0x80000
    s_add_u32 s101, s101, 0x80000
    s_add_u32 s83, s83, 0x10000
    s_add_u32 s84, s84, 0x10000
    v_xor_b32 v5, 0x80000, v5
    s_add_u32 s66, s66, 1
    s_xor_b32 s70, s70, 0x80000
    v_add_u32 v6, s98, v0
    ds_read_b128 v[48:51], v6 offset:12288
    ds_read_b128 v[52:55], v6 offset:13312
    v_mov_b64 v[28:29], 0
    v_mov_b64 v[30:31], 0
    buffer_load_dwordx4 v[40:43], v0, s[60:63], s88 offen sc1
    buffer_load_dwordx4 v[44:47], v0, s[60:63], s88 offen offset:1024 sc1
Lagp_29:
    v_add_u32 v6, s90, v0
Lpl_33:
    v_max3_u32 v252, v40, v41, v42
    v_max3_u32 v253, v43, v44, v45
    v_max3_u32 v252, v252, v46, v47
    v_max_u32 v252, v252, v253
    v_cmp_le_u32 vcc, -2, v252
    s_add_u32 s74, s74, 1
    s_cbranch_vccz LpAok_32
    v_max3_u32 v252, v40, v41, v42
    v_max3_u32 v253, v43, v44, v45
    v_max3_u32 v252, v252, v46, v47
    v_max_u32 v252, v252, v253
    v_cmp_le_u32 vcc, -2, v252
    s_nop 0
    s_cbranch_vccz LpAok_32
    v_max3_u32 v252, v40, v41, v42
    v_max3_u32 v253, v43, v44, v45
    v_max3_u32 v252, v252, v46, v47
    v_max_u32 v252, v252, v253
    v_cmp_le_u32 vcc, -2, v252
    s_cmp_lt_u32 s74, 0x100000
    s_cbranch_vccz LpAok_32
    buffer_load_dwordx4 v[40:43], v0, s[60:63], s88 offen sc1
    v_mov_b32 v254, 0
    buffer_load_dwordx4 v[44:47], v0, s[60:63], s88 offen offset:1024 sc1
    v_mov_b32 v254, 0
    s_cbranch_scc1 Lpl_33
    s_branch L_fail
LpAok_32:
    ds_write_b128 v6, v[40:43] offset:22528
    ds_write_b128 v6, v[44:47] offset:23552
    s_branch Lbar1_23
Lagtop_22:
    buffer_load_dwordx4 v[40:43], v0, s[60:63], s88 offen sc1
    buffer_load_dwordx4 v[44:47], v0, s[60:63], s88 offen offset:1024 sc1
    s_branch Lagp_29
Lpr_24:
    buffer_load_dwordx4 v[44:47], v0, s[60:63], s89 offen sc1
    s_add_u32 s74, s74, 1
    s_cmp_ge_u32 s74, 0x100000
    s_cbranch_scc1 L_fail
    s_waitcnt vmcnt(0)
    v_max3_u32 v6, v44, v45, v46
    v_max_u32 v6, v6, v47
    v_cmp_eq_u32 vcc, -1, v6
    v_add_u32 v6, s91, v0
    s_cbranch_vccnz Lpr_24
    s_branch Lpc_25
Lkv_26:
    buffer_load_dword v6, off, s[56:59], 0 offset:148 sc1
    s_add_u32 s74, s74, 1
    s_cmp_ge_u32 s74, 0x100000
    s_cbranch_scc1 L_fail
    s_waitcnt vmcnt(0)
    v_readfirstlane_b32 s67, v6
    s_cmp_lt_u32 s67, 224
    s_cbranch_scc1 Lkv_26
    s_branch Lkvc_27
Llast_28:
    s_waitcnt vmcnt(0)
    s_barrier
    s_branch L_cdone
Lwave_8:
    s_branch Lagtop_34
.p2align 3
Lbar1_35:
    s_waitcnt lgkmcnt(0)
    s_barrier
    ds_read_b128 v[32:35], v0 offset:22528
    ds_read_b128 v[36:39], v0 offset:23552
    ds_read_b128 v[248:251], v1 offset:2048
    ds_read_b128 v[252:255], v1 offset:3072
    ds_read_b128 v[56:59], v1 offset:0
    ds_read_b128 v[60:63], v1 offset:1024
    s_waitcnt lgkmcnt(5)
    v_smfmac_f32_16x16x64_bf16 v[8:11], v[32:35], a[0:7], v2
    v_smfmac_f32_16x16x64_bf16 v[12:15], v[32:35], a[8:15], v2
    v_smfmac_f32_16x16x64_bf16 v[24:27], v[32:35], v[240:247], v2
    v_smfmac_f32_16x16x64_bf16 v[16:19], v[32:35], a[144:151], v2
    v_smfmac_f32_16x16x64_bf16 v[20:23], v[32:35], a[152:159], v2
    v_smfmac_f32_16x16x64_bf16 v[28:31], v[32:35], v[48:55], v2
    ds_read_b128 v[48:51], v1 offset:16384
    ds_read_b128 v[52:55], v1 offset:17408
    s_waitcnt lgkmcnt(2)
    v_smfmac_f32_16x16x64_bf16 v[8:11], v[36:39], a[16:23], v2
    s_waitcnt vmcnt(0)
    ds_read_b128 v[40:43], v0 offset:24576
    v_smfmac_f32_16x16x64_bf16 v[12:15], v[36:39], a[24:31], v2
    ds_read_b128 v[32:35], v0 offset:25600
    buffer_load_dwordx4 v[44:47], v0, s[60:63], s89 offen sc1
    v_smfmac_f32_16x16x64_bf16 v[24:27], v[36:39], v[56:63], v2
    ds_read_b128 v[56:59], v1 offset:18432
    ds_read_b128 v[60:63], v1 offset:19456
    v_smfmac_f32_16x16x64_bf16 v[16:19], v[36:39], a[160:167], v2
    s_mov_b32 m0, s96
    v_smfmac_f32_16x16x64_bf16 v[20:23], v[36:39], a[168:175], v2
    buffer_load_dwordx4 v0, s[60:63], s94 offen sc1 lds
    v_smfmac_f32_16x16x64_bf16 v[28:31], v[36:39], v[248:255], v2
    ds_read_b128 v[248:251], v1 offset:32768
    ds_read_b128 v[252:255], v1 offset:33792
    s_waitcnt lgkmcnt(5)
    v_smfmac_f32_16x16x64_bf16 v[8:11], v[40:43], a[32:39], v2
    ds_read_b128 v[36:39], v0 offset:26624
    v_smfmac_f32_16x16x64_bf16 v[12:15], v[40:43], a[40:47], v2
    buffer_load_dwordx4 v0, s[60:63], s94 offen offset:1024 sc1 lds
    v_smfmac_f32_16x16x64_bf16 v[24:27], v[40:43], v[48:55], v2
    ds_read_b128 v[48:51], v1 offset:34816
    ds_read_b128 v[52:55], v1 offset:35840
    v_smfmac_f32_16x16x64_bf16 v[16:19], v[40:43], a[176:183], v2
    v_smfmac_f32_16x16x64_bf16 v[20:23], v[40:43], a[184:191], v2
    s_waitcnt lgkmcnt(5)
    v_smfmac_f32_16x16x64_bf16 v[28:31], v[40:43], v[56:63], v2
    ds_read_b128 v[56:59], v1 offset:49152
    ds_read_b128 v[60:63], v1 offset:50176
    v_smfmac_f32_16x16x64_bf16 v[8:11], v[32:35], a[48:55], v2
    ds_read_b128 v[40:43], v0 offset:27648
    v_smfmac_f32_16x16x64_bf16 v[12:15], v[32:35], a[56:63], v2
    s_waitcnt lgkmcnt(5)
    v_smfmac_f32_16x16x64_bf16 v[24:27], v[32:35], v[248:255], v2
    ds_read_b128 v[248:251], v1 offset:51200
    ds_read_b128 v[252:255], v1 offset:52224
    v_smfmac_f32_16x16x64_bf16 v[16:19], v[32:35], a[192:199], v2
    s_waitcnt vmcnt(2)
    v_max3_u32 v6, v44, v45, v46
    v_smfmac_f32_16x16x64_bf16 v[20:23], v[32:35], a[200:207], v2
    v_add_u32 v1, 0x10000, v1
    s_waitcnt lgkmcnt(5)
    v_smfmac_f32_16x16x64_bf16 v[28:31], v[32:35], v[48:55], v2
    ds_read_b128 v[48:51], v1 offset:0
    ds_read_b128 v[52:55], v1 offset:1024
    v_smfmac_f32_16x16x64_bf16 v[8:11], v[36:39], a[64:71], v2
    v_max_u32 v6, v6, v47
    v_smfmac_f32_16x16x64_bf16 v[12:15], v[36:39], a[72:79], v2
    v_cmp_eq_u32 vcc, -1, v6
    s_waitcnt lgkmcnt(4)
    v_smfmac_f32_16x16x64_bf16 v[24:27], v[36:39], v[56:63], v2
    ds_read_b128 v[56:59], v1 offset:2048
    ds_read_b128 v[60:63], v1 offset:3072
    v_smfmac_f32_16x16x64_bf16 v[16:19], v[36:39], a[208:215], v2
    v_add_u32 v6, s91, v0
    s_cbranch_vccnz Lpr_36
Lpc_37:
    ds_write_b128 v6, v[44:47] offset:22528
    v_smfmac_f32_16x16x64_bf16 v[20:23], v[36:39], a[216:223], v2
    s_waitcnt lgkmcnt(5)
    v_smfmac_f32_16x16x64_bf16 v[28:31], v[36:39], v[248:255], v2
    ds_read_b128 v[248:251], v1 offset:16384
    ds_read_b128 v[252:255], v1 offset:17408
    v_smfmac_f32_16x16x64_bf16 v[8:11], v[40:43], a[80:87], v2
    s_mov_b32 m0, s97
    v_smfmac_f32_16x16x64_bf16 v[12:15], v[40:43], a[88:95], v2
    s_waitcnt lgkmcnt(2)
    s_waitcnt vmcnt(0)
    s_barrier
    ds_read_b128 v[32:35], v0 offset:28672
    ds_read_b128 v[36:39], v0 offset:29696
    v_smfmac_f32_16x16x64_bf16 v[24:27], v[40:43], v[48:55], v2
    ds_read_b128 v[48:51], v1 offset:18432
    ds_read_b128 v[52:55], v1 offset:19456
    s_cmp_eq_u32 s66, 30
    s_cbranch_scc1 Lkv_38
Lkvc_39:
    v_smfmac_f32_16x16x64_bf16 v[16:19], v[40:43], a[224:231], v2
    ds_read_b128 v[44:47], v0 offset:30720
    buffer_load_dwordx4 v0, s[60:63], s95 offen sc1 lds
    v_smfmac_f32_16x16x64_bf16 v[20:23], v[40:43], a[232:239], v2
    buffer_load_dwordx4 v0, s[60:63], s95 offen offset:1024 sc1 lds
    v_smfmac_f32_16x16x64_bf16 v[28:31], v[40:43], v[56:63], v2
    ds_read_b128 v[56:59], v1 offset:32768
    ds_read_b128 v[60:63], v1 offset:33792
    s_waitcnt lgkmcnt(6)
    v_smfmac_f32_16x16x64_bf16 v[8:11], v[32:35], a[96:103], v2
    s_mov_b32 m0, 0x7d00
    v_lshlrev_b32 v6, 2, v0
    v_smfmac_f32_16x16x64_bf16 v[12:15], v[32:35], a[104:111], v2
    v_smfmac_f32_16x16x64_bf16 v[16:19], v[32:35], a[240:247], v2
    s_waitcnt lgkmcnt(3)
    v_smfmac_f32_16x16x64_bf16 v[8:11], v[36:39], a[112:119], v2
    buffer_load_dword v6, s[60:63], s101 offen sc1 lds
    v_smfmac_f32_16x16x64_bf16 v[12:15], v[36:39], a[120:127], v2
    v_smfmac_f32_16x16x64_bf16 v[20:23], v[32:35], a[248:255], v2
    s_waitcnt lgkmcnt(0)
    v_smfmac_f32_16x16x64_bf16 v[8:11], v[44:47], a[128:135], v2
    v_smfmac_f32_16x16x64_bf16 v[12:15], v[44:47], a[136:143], v2
    v_and_b32 v6, 0xffff, v3
    v_smfmac_f32_16x16x64_bf16 v[24:27], v[32:35], v[248:255], v2
    ds_read_b128 v[248:251], v1 offset:34816
    ds_read_b128 v[252:255], v1 offset:35840
    v_smfmac_f32_16x16x64_bf16 v[16:19], v[36:39], v[64:71], v2
    v_add_f32 v8, v8, v10
    v_add_f32 v9, v9, v11
    v_smfmac_f32_16x16x64_bf16 v[20:23], v[36:39], v[72:79], v2
    v_add_f32 v12, v12, v14
    v_add_f32 v13, v13, v15
    v_smfmac_f32_16x16x64_bf16 v[28:31], v[32:35], v[48:55], v2
    ds_read_b128 v[48:51], v1 offset:49152
    ds_read_b128 v[52:55], v1 offset:50176
    v_cvt_pk_bf16_f32 v8, v8, v9
    v_smfmac_f32_16x16x64_bf16 v[16:19], v[44:47], v[80:87], v2
    v_cvt_pk_bf16_f32 v9, v12, v13
    ds_write2_b32 v6, v8, v9 offset0:0 offset1:64
    v_smfmac_f32_16x16x64_bf16 v[20:23], v[44:47], v[88:95], v2
    ds_read_b128 v[8:11], v1 offset:51200
    ds_read_b128 v[12:15], v1 offset:52224
    v_smfmac_f32_16x16x64_bf16 v[24:27], v[36:39], v[56:63], v2
    ds_read_b128 v[56:59], v0 offset:4096
    ds_read_b128 v[60:63], v0 offset:8192
    s_waitcnt lgkmcnt(7)
    v_smfmac_f32_16x16x64_bf16 v[28:31], v[36:39], v[248:255], v2
    v_add_f32 v16, v16, v18
    v_add_f32 v17, v17, v19
    v_add_f32 v20, v20, v22
    v_add_f32 v21, v21, v23
    v_cvt_pk_bf16_f32 v16, v16, v17
    v_cvt_pk_bf16_f32 v17, v20, v21
    v_add_u32 v18, 2048, v6
    ds_write2_b32 v18, v16, v17 offset0:0 offset1:64
    s_waitcnt lgkmcnt(6)
    v_smfmac_f32_16x16x64_bf16 v[24:27], v[44:47], v[48:55], v2
    ds_read_b128 v[248:251], v0 offset:5120
    ds_read_b128 v[252:255], v0 offset:9216
    v_lshrrev_b32 v3, 16, v3
    s_waitcnt lgkmcnt(5)
    v_smfmac_f32_16x16x64_bf16 v[28:31], v[44:47], v[8:15], v2
    v_lshrrev_b32 v18, 1, v0
    buffer_store_dwordx2 v[16:17], v18, s[60:63], s83 offen sc1
    s_nop 0
    v_add_f32 v24, v24, v26
    v_add_f32 v25, v25, v27
    s_waitcnt lgkmcnt(2)
    s_barrier
    ds_read_b64_tr_b16 v[32:33], v3 offset:0
    ds_read_b64_tr_b16 v[34:35], v3 offset:256
    ds_read_b64_tr_b16 v[40:41], v3 offset:512
    ds_read_b64_tr_b16 v[42:43], v3 offset:768
    v_add_f32 v28, v28, v30
    ds_read_b128 v[48:51], v0 offset:6144
    ds_read_b128 v[52:55], v0 offset:10240
    v_add_f32 v29, v29, v31
    ds_read_b64_tr_b16 v[36:37], v3 offset:1024
    ds_read_b64_tr_b16 v[38:39], v3 offset:1280
    v_cvt_pk_bf16_f32 v24, v24, v25
    s_waitcnt lgkmcnt(6)
    v_mfma_f32_16x16x32_bf16 v[16:19], v[56:59], v[32:35], 0
    ds_read_b64_tr_b16 v[44:45], v3 offset:1536
    ds_read_b64_tr_b16 v[46:47], v3 offset:1792
    v_mfma_f32_16x16x32_bf16 v[20:23], v[60:63], v[32:35], 0
    ds_read_b128 v[8:11], v0 offset:7168
    ds_read_b128 v[12:15], v0 offset:11264
    s_waitcnt lgkmcnt(8)
    v_mfma_f32_16x16x32_bf16 v[16:19], v[248:251], v[40:43], v[16:19]
    ds_read_b64_tr_b16 v[56:57], v7 offset:0
    ds_read_b64_tr_b16 v[58:59], v7 offset:256
    v_mfma_f32_16x16x32_bf16 v[20:23], v[252:255], v[40:43], v[20:23]
    ds_read_b64_tr_b16 v[60:61], v7 offset:512
    ds_read_b64_tr_b16 v[62:63], v7 offset:768
    s_waitcnt lgkmcnt(8)
    v_mfma_f32_16x16x32_bf16 v[16:19], v[48:51], v[36:39], v[16:19]
    ds_read_b64_tr_b16 v[248:249], v7 offset:1024
    ds_read_b64_tr_b16 v[250:251], v7 offset:1280
    v_mfma_f32_16x16x32_bf16 v[20:23], v[52:55], v[36:39], v[20:23]
    ds_read_b64_tr_b16 v[252:253], v7 offset:1536
    ds_read_b64_tr_b16 v[254:255], v7 offset:1792
    s_waitcnt lgkmcnt(8)
    v_mfma_f32_16x16x32_bf16 v[16:19], v[8:11], v[44:47], v[16:19]
    v_cvt_pk_bf16_f32 v25, v28, v29
    v_lshl_or_b32 v3, v3, 16, v6
    v_mfma_f32_16x16x32_bf16 v[20:23], v[12:15], v[44:47], v[20:23]
    v_add_u32 v6, s98, v0
    v_lshrrev_b32 v26, 1, v0
    s_waitcnt lgkmcnt(6)
    v_mfma_f32_16x16x32_bf16 v[28:31], v[56:59], v[32:35], 0
    buffer_store_dwordx2 v[24:25], v26, s[60:63], s84 offen sc1
    s_cmp_eq_u32 s66, 63
    s_waitcnt lgkmcnt(4)
    v_mfma_f32_16x16x32_bf16 v[28:31], v[60:63], v[40:43], v[28:31]
    s_cbranch_scc1 Llast_40
    s_waitcnt vmcnt(3)
    s_waitcnt lgkmcnt(2)
    v_mfma_f32_16x16x32_bf16 v[28:31], v[248:251], v[36:39], v[28:31]
    ds_read_b128 v[48:51], v6 offset:20480
    ds_read_b128 v[52:55], v6 offset:21504
    s_waitcnt lgkmcnt(2)
    v_mfma_f32_16x16x32_bf16 v[28:31], v[252:255], v[44:47], v[28:31]
    v_cndmask_b32 v8, v20, v16, s[92:93]
    v_cndmask_b32 v9, v21, v17, s[92:93]
    v_cndmask_b32 v10, v22, v18, s[92:93]
    v_cndmask_b32 v11, v23, v19, s[92:93]
    v_max3_f32 v12, v8, v9, v10
    v_mov_b64 v[20:21], -1
    v_max_f32 v12, v12, v11
    v_mov_b64 v[22:23], -1
    v_cndmask_b32 v16, v28, v30, s[78:79]
    v_cndmask_b32 v17, v29, v31, s[78:79]
    v_max3_f32 v12, v12, v16, v17
    s_xor_b32 s67, s70, 0x80000
    buffer_store_dwordx4 v[20:23], v0, s[60:63], s67 offen
    v_max_f32_dpp v13, v12, v12 row_ror:8 row_mask:0xf bank_mask:0xf
    v_max_f32_dpp v12, v12, v12 row_ror:8 row_mask:0xf bank_mask:0xf
    v_mov_b32 v40, 0x3f803f80
    v_mov_b32 v41, 0x3f803f80
    v_permlane16_swap_b32 v12, v13
    v_max_f32 v14, v12, v13
    v_max_f32 v12, v12, v13
    v_mov_b64 v[42:43], v[40:41]
    v_mov_b32 v37, 0
    v_permlane32_swap_b32 v12, v14
    v_max_f32 v12, v12, v14
    v_mul_f32 v12, s80, v12
    v_fma_f32 v8, v8, s80, -v12
    v_fma_f32 v9, v9, s80, -v12
    v_exp_f32 v8, v8
    v_exp_f32 v9, v9
    v_fma_f32 v10, v10, s80, -v12
    v_fma_f32 v11, v11, s80, -v12
    v_cvt_pk_bf16_f32 v32, v8, v9
    v_exp_f32 v10, v10
    v_exp_f32 v11, v11
    v_mov_b32_dpp v34, v32 row_ror:8 row_mask:0xf bank_mask:0xf
    v_cvt_pk_bf16_f32 v33, v10, v11
    v_fma_f32 v16, v16, s80, -v12
    v_fma_f32 v17, v17, s80, -v12
    v_mov_b32_dpp v35, v33 row_ror:8 row_mask:0xf bank_mask:0xf
    v_exp_f32 v16, v16
    s_waitcnt lgkmcnt(0)
    v_mfma_f32_16x16x32_bf16 v[56:59], v[40:43], v[32:35], 0
    v_exp_f32 v17, v17
    v_mfma_f32_16x16x32_bf16 v[248:251], v[48:51], v[32:35], 0
    v_mov_b32 v38, 0
    v_cvt_pk_bf16_f32 v36, v16, v17
    v_mfma_f32_16x16x32_bf16 v[252:255], v[52:55], v[32:35], 0
    v_cvt_pk_bf16_f32 v39, v16, v17
    v_lshrrev_b32 v6, 16, v2
    v_mfma_f32_16x16x16_bf16 v[56:59], v[40:41], v[36:37], v[56:59]
    v_mov_b64 v[8:9], 0
    v_mov_b64 v[10:11], 0
    v_mfma_f32_16x16x16_bf16 v[248:251], v[24:25], v[36:37], v[248:251]
    v_mov_b64 v[12:13], 0
    v_mov_b64 v[14:15], 0
    v_mfma_f32_16x16x16_bf16 v[252:255], v[24:25], v[38:39], v[252:255]
    buffer_store_dwordx4 v[20:23], v0, s[60:63], s67 offen offset:1024
    v_rcp_f32 v56, v56
    v_mov_b64 v[16:17], 0
    s_nop 0
    v_mul_f32 v248, v248, v56
    v_mul_f32 v249, v249, v56
    v_cvt_pk_bf16_f32 v44, v248, v249
    v_mul_f32 v250, v250, v56
    v_mul_f32 v251, v251, v56
    v_cvt_pk_bf16_f32 v45, v250, v251
    v_mul_f32 v252, v252, v56
    v_mul_f32 v253, v253, v56
    v_cvt_pk_bf16_f32 v46, v252, v253
    v_mul_f32 v254, v254, v56
    v_mul_f32 v255, v255, v56
    v_cvt_pk_bf16_f32 v47, v254, v255
    s_mov_b64 exec, s[92:93]
    ds_write_b128 v6, v[44:47]
    s_mov_b64 exec, -1
    v_mov_b64 v[18:19], 0
    v_mov_b64 v[20:21], 0
    v_mov_b64 v[22:23], 0
    v_mov_b64 v[24:25], 0
    v_mov_b64 v[26:27], 0
    v_and_b32 v6, 0xf0, v0
    v_mov_b32 v56, -2
    v_mov_b32 v57, -2
    v_mov_b64 v[58:59], v[56:57]
    v_mov_b64 v[60:61], v[56:57]
    v_mov_b64 v[62:63], v[56:57]
    s_waitcnt lgkmcnt(0)
    s_barrier
    ds_read_b128 v[44:47], v0 offset:28672
    ds_read_b128 v[48:51], v0 offset:29696
    ds_read_b128 v[248:251], v6 offset:31744
    v_mov_b64 v[28:29], 0
    v_mov_b64 v[30:31], 0
    v_mov_b64 v[32:33], 0
    v_mov_b64 v[34:35], 0
    v_mov_b64 v[36:37], 0
    v_mov_b64 v[38:39], 0
    v_mov_b64 v[40:41], 0
    v_mov_b64 v[42:43], 0
    s_waitcnt lgkmcnt(2)
    v_smfmac_f32_16x16x64_bf16 v[8:11], v[44:47], v[96:103], v2
    s_mov_b32 s72, s75
    v_subrev_u32 v1, 0x10000, v1
    v_smfmac_f32_16x16x64_bf16 v[12:15], v[44:47], v[112:119], v2
    s_add_u32 s75, s75, 16384
    v_and_b32 v6, 0xffff, v4
    v_smfmac_f32_16x16x64_bf16 v[16:19], v[44:47], v[128:135], v2
    s_and_b32 s75, s75, 0xfffeffff
    s_waitcnt lgkmcnt(1)
    v_smfmac_f32_16x16x64_bf16 v[8:11], v[48:51], v[104:111], v2
    s_add_u32 s88, s75, s90
    v_smfmac_f32_16x16x64_bf16 v[12:15], v[48:51], v[120:127], v2
    v_smfmac_f32_16x16x64_bf16 v[20:23], v[44:47], v[144:151], v2
    v_add_f32 v8, v8, v10
    v_smfmac_f32_16x16x64_bf16 v[16:19], v[48:51], v[136:143], v2
    v_add_f32 v9, v9, v11
    v_smfmac_f32_16x16x64_bf16 v[20:23], v[48:51], v[152:159], v2
    v_add_f32 v12, v12, v14
    v_smfmac_f32_16x16x64_bf16 v[24:27], v[44:47], v[160:167], v2
    v_add_f32 v13, v13, v15
    v_smfmac_f32_16x16x64_bf16 v[28:31], v[44:47], v[176:183], v2
    v_cvt_pk_bf16_f32 v8, v8, v9
    v_smfmac_f32_16x16x64_bf16 v[32:35], v[44:47], v[192:199], v2
    v_cvt_pk_bf16_f32 v9, v12, v13
    v_smfmac_f32_16x16x64_bf16 v[24:27], v[48:51], v[168:175], v2
    buffer_store_dwordx2 v[8:9], v5, s[60:63], s3 offen
    v_add_f32 v16, v16, v18
    v_smfmac_f32_16x16x64_bf16 v[28:31], v[48:51], v[184:191], v2
    v_add_f32 v17, v17, v19
    v_smfmac_f32_16x16x64_bf16 v[36:39], v[44:47], v[208:215], v2
    v_add_f32 v20, v20, v22
    v_smfmac_f32_16x16x64_bf16 v[40:43], v[44:47], v[224:231], v2
    v_add_f32 v21, v21, v23
    v_smfmac_f32_16x16x64_bf16 v[32:35], v[48:51], v[200:207], v2
    v_cvt_pk_bf16_f32 v16, v16, v17
    v_smfmac_f32_16x16x64_bf16 v[36:39], v[48:51], v[216:223], v2
    v_cvt_pk_bf16_f32 v17, v20, v21
    v_smfmac_f32_16x16x64_bf16 v[40:43], v[48:51], v[232:239], v2
    buffer_store_dwordx2 v[16:17], v5, s[60:63], s4 offen
    v_add_f32 v24, v24, v26
    v_add_f32 v25, v25, v27
    v_add_f32 v28, v28, v30
    v_add_f32 v29, v29, v31
    v_cvt_pk_bf16_f32 v24, v24, v25
    v_cvt_pk_bf16_f32 v25, v28, v29
    buffer_store_dwordx2 v[24:25], v5, s[60:63], s5 offen
    v_pk_add_f32 v[32:33], v[32:33], v[34:35]
    v_pk_add_f32 v[36:37], v[36:37], v[38:39]
    v_cvt_pk_bf16_f32 v32, v32, v33
    v_cvt_pk_bf16_f32 v33, v36, v37
    buffer_store_dwordx2 v[32:33], v5, s[60:63], s6 offen
    v_pk_add_f32 v[40:41], v[40:41], v[42:43]
    v_mov_b64 v[28:29], -1
    v_cvt_pk_bf16_f32 v40, v40, v41
    v_mov_b64 v[30:31], -1
    v_mov_b64 v[8:9], 0
    v_mov_b32_dpp v41, v40 row_ror:8 row_mask:0xf bank_mask:0xf
    s_mov_b64 exec, s[92:93]
    buffer_store_dwordx2 v[40:41], v5, s[60:63], s7 offen
    s_mov_b64 exec, -1
    s_waitcnt lgkmcnt(0)
    v_mov_b64 v[10:11], 0
    v_mov_b64 v[12:13], 0
    v_mov_b64 v[14:15], 0
    v_mov_b64 v[16:17], 0
    v_mov_b64 v[18:19], 0
    v_mov_b64 v[20:21], 0
    v_mov_b64 v[22:23], 0
    v_mov_b64 v[24:25], 0
    v_mov_b64 v[26:27], 0
    s_add_u32 s89, s75, s91
    s_add_u32 s94, s94, 0x80000
    s_add_u32 s95, s95, 0x80000
    buffer_load_dwordx4 v[56:59], v0, s[60:63], s70 offen sc1
    buffer_load_dwordx4 v[60:63], v0, s[60:63], s70 offen offset:1024 sc1
Lpl_43:
    v_max3_u32 v252, v56, v57, v58
    v_max3_u32 v253, v59, v60, v61
    v_max3_u32 v252, v252, v62, v63
    v_max_u32 v252, v252, v253
    v_cmp_le_u32 vcc, -2, v252
    s_add_u32 s74, s74, 1
    s_cbranch_vccz Lrok_42
    v_max3_u32 v252, v56, v57, v58
    v_max3_u32 v253, v59, v60, v61
    v_max3_u32 v252, v252, v62, v63
    v_max_u32 v252, v252, v253
    v_cmp_le_u32 vcc, -2, v252
    s_nop 0
    s_cbranch_vccz Lrok_42
    v_max3_u32 v252, v56, v57, v58
    v_max3_u32 v253, v59, v60, v61
    v_max3_u32 v252, v252, v62, v63
    v_max_u32 v252, v252, v253
    v_cmp_le_u32 vcc, -2, v252
    s_cmp_lt_u32 s74, 0x100000
    s_cbranch_vccz Lrok_42
    buffer_load_dwordx4 v[56:59], v0, s[60:63], s70 offen sc1
    v_mov_b32 v254, 0
    buffer_load_dwordx4 v[60:63], v0, s[60:63], s70 offen offset:1024 sc1
    v_mov_b32 v254, 0
    s_cbranch_scc1 Lpl_43
    s_branch L_fail
Lrok_42:
    v_mfma_f32_16x16x32_bf16 v[252:255], v[248:251], v[56:59], 0
    v_mfma_f32_16x16x32_bf16 v[252:255], v[248:251], v[60:63], v[252:255]
    v_mov_b32 v40, -2
    v_mov_b32 v41, -2
    v_mov_b64 v[42:43], v[40:41]
    v_mov_b64 v[44:45], v[40:41]
    v_mov_b64 v[46:47], v[40:41]
    s_nop 2
    v_add_f32_dpp v254, v252, v252 row_ror:8 row_mask:0xf bank_mask:0xf
    v_add_f32_dpp v255, v253, v253 row_ror:8 row_mask:0xf bank_mask:0xf
    s_nop 0
    v_add_f32_dpp v252, v254, v254 row_ror:4 row_mask:0xf bank_mask:0xf
    v_add_f32_dpp v253, v255, v255 row_ror:4 row_mask:0xf bank_mask:0xf
    s_mov_b64 exec, s[76:77]
    v_cvt_pk_bf16_f32 v252, v252, v253
    buffer_store_dword v252, v6, s[60:63], s75 offen
    buffer_store_dword v28, v6, s[60:63], s72 offen
    s_mov_b64 exec, -1
    s_add_u32 s101, s101, 0x80000
    s_add_u32 s83, s83, 0x10000
    s_add_u32 s84, s84, 0x10000
    v_xor_b32 v5, 0x80000, v5
    s_add_u32 s66, s66, 1
    s_xor_b32 s70, s70, 0x80000
    v_add_u32 v6, s98, v0
    ds_read_b128 v[48:51], v6 offset:12288
    ds_read_b128 v[52:55], v6 offset:13312
    v_mov_b64 v[28:29], 0
    v_mov_b64 v[30:31], 0
    buffer_load_dwordx4 v[40:43], v0, s[60:63], s88 offen sc1
    buffer_load_dwordx4 v[44:47], v0, s[60:63], s88 offen offset:1024 sc1
Lagp_41:
    v_add_u32 v6, s90, v0
Lpl_45:
    v_max3_u32 v252, v40, v41, v42
    v_max3_u32 v253, v43, v44, v45
    v_max3_u32 v252, v252, v46, v47
    v_max_u32 v252, v252, v253
    v_cmp_le_u32 vcc, -2, v252
    s_add_u32 s74, s74, 1
    s_cbranch_vccz LpAok_44
    v_max3_u32 v252, v40, v41, v42
    v_max3_u32 v253, v43, v44, v45
    v_max3_u32 v252, v252, v46, v47
    v_max_u32 v252, v252, v253
    v_cmp_le_u32 vcc, -2, v252
    s_nop 0
    s_cbranch_vccz LpAok_44
    v_max3_u32 v252, v40, v41, v42
    v_max3_u32 v253, v43, v44, v45
    v_max3_u32 v252, v252, v46, v47
    v_max_u32 v252, v252, v253
    v_cmp_le_u32 vcc, -2, v252
    s_cmp_lt_u32 s74, 0x100000
    s_cbranch_vccz LpAok_44
    buffer_load_dwordx4 v[40:43], v0, s[60:63], s88 offen sc1
    v_mov_b32 v254, 0
    buffer_load_dwordx4 v[44:47], v0, s[60:63], s88 offen offset:1024 sc1
    v_mov_b32 v254, 0
    s_cbranch_scc1 Lpl_45
    s_branch L_fail
LpAok_44:
    ds_write_b128 v6, v[40:43] offset:22528
    ds_write_b128 v6, v[44:47] offset:23552
    s_branch Lbar1_35
Lagtop_34:
    buffer_load_dwordx4 v[40:43], v0, s[60:63], s88 offen sc1
    buffer_load_dwordx4 v[44:47], v0, s[60:63], s88 offen offset:1024 sc1
    s_branch Lagp_41
Lpr_36:
    buffer_load_dwordx4 v[44:47], v0, s[60:63], s89 offen sc1
    s_add_u32 s74, s74, 1
    s_cmp_ge_u32 s74, 0x100000
    s_cbranch_scc1 L_fail
    s_waitcnt vmcnt(0)
    v_max3_u32 v6, v44, v45, v46
    v_max_u32 v6, v6, v47
    v_cmp_eq_u32 vcc, -1, v6
    v_add_u32 v6, s91, v0
    s_cbranch_vccnz Lpr_36
    s_branch Lpc_37
Lkv_38:
    buffer_load_dword v6, off, s[56:59], 0 offset:148 sc1
    s_add_u32 s74, s74, 1
    s_cmp_ge_u32 s74, 0x100000
    s_cbranch_scc1 L_fail
    s_waitcnt vmcnt(0)
    v_readfirstlane_b32 s67, v6
    s_cmp_lt_u32 s67, 224
    s_cbranch_scc1 Lkv_38
    s_branch Lkvc_39
Llast_40:
    s_waitcnt vmcnt(0)
    s_barrier
    s_branch L_cdone
Lwave_9:
.p2align 3
Lbar1_47:
    s_waitcnt lgkmcnt(0)
    s_barrier
    ds_read_b128 v[32:35], v0 offset:22528
    ds_read_b128 v[36:39], v0 offset:23552
    ds_read_b128 v[248:251], v1 offset:2048
    ds_read_b128 v[252:255], v1 offset:3072
    ds_read_b128 v[56:59], v1 offset:0
    ds_read_b128 v[60:63], v1 offset:1024
    s_waitcnt lgkmcnt(5)
    v_smfmac_f32_16x16x64_bf16 v[8:11], v[32:35], a[0:7], v2
    v_smfmac_f32_16x16x64_bf16 v[12:15], v[32:35], a[8:15], v2
    v_smfmac_f32_16x16x64_bf16 v[24:27], v[32:35], v[240:247], v2
    v_smfmac_f32_16x16x64_bf16 v[16:19], v[32:35], a[144:151], v2
    v_smfmac_f32_16x16x64_bf16 v[20:23], v[32:35], a[152:159], v2
    v_smfmac_f32_16x16x64_bf16 v[28:31], v[32:35], v[48:55], v2
    ds_read_b128 v[48:51], v1 offset:16384
    ds_read_b128 v[52:55], v1 offset:17408
    s_waitcnt lgkmcnt(2)
    v_smfmac_f32_16x16x64_bf16 v[8:11], v[36:39], a[16:23], v2
    s_waitcnt vmcnt(0)
    ds_read_b128 v[40:43], v0 offset:24576
    v_smfmac_f32_16x16x64_bf16 v[12:15], v[36:39], a[24:31], v2
    ds_read_b128 v[32:35], v0 offset:25600
    buffer_load_dwordx4 v[44:47], v0, s[60:63], s89 offen sc1
    v_smfmac_f32_16x16x64_bf16 v[24:27], v[36:39], v[56:63], v2
    ds_read_b128 v[56:59], v1 offset:18432
    ds_read_b128 v[60:63], v1 offset:19456
    v_smfmac_f32_16x16x64_bf16 v[16:19], v[36:39], a[160:167], v2
    s_mov_b32 m0, s96
    v_smfmac_f32_16x16x64_bf16 v[20:23], v[36:39], a[168:175], v2
    buffer_load_dwordx4 v0, s[60:63], s94 offen sc1 lds
    v_smfmac_f32_16x16x64_bf16 v[28:31], v[36:39], v[248:255], v2
    ds_read_b128 v[248:251], v1 offset:32768
    ds_read_b128 v[252:255], v1 offset:33792
    s_waitcnt lgkmcnt(5)
    v_smfmac_f32_16x16x64_bf16 v[8:11], v[40:43], a[32:39], v2
    ds_read_b128 v[36:39], v0 offset:26624
    v_smfmac_f32_16x16x64_bf16 v[12:15], v[40:43], a[40:47], v2
    buffer_load_dwordx4 v0, s[60:63], s94 offen offset:1024 sc1 lds
    v_smfmac_f32_16x16x64_bf16 v[24:27], v[40:43], v[48:55], v2
    ds_read_b128 v[48:51], v1 offset:34816
    ds_read_b128 v[52:55], v1 offset:35840
    v_smfmac_f32_16x16x64_bf16 v[16:19], v[40:43], a[176:183], v2
    v_smfmac_f32_16x16x64_bf16 v[20:23], v[40:43], a[184:191], v2
    s_waitcnt lgkmcnt(5)
    v_smfmac_f32_16x16x64_bf16 v[28:31], v[40:43], v[56:63], v2
    ds_read_b128 v[56:59], v1 offset:49152
    ds_read_b128 v[60:63], v1 offset:50176
    v_smfmac_f32_16x16x64_bf16 v[8:11], v[32:35], a[48:55], v2
    ds_read_b128 v[40:43], v0 offset:27648
    v_smfmac_f32_16x16x64_bf16 v[12:15], v[32:35], a[56:63], v2
    s_waitcnt lgkmcnt(5)
    v_smfmac_f32_16x16x64_bf16 v[24:27], v[32:35], v[248:255], v2
    ds_read_b128 v[248:251], v1 offset:51200
    ds_read_b128 v[252:255], v1 offset:52224
    v_smfmac_f32_16x16x64_bf16 v[16:19], v[32:35], a[192:199], v2
    s_waitcnt vmcnt(2)
    v_max3_u32 v6, v44, v45, v46
    v_smfmac_f32_16x16x64_bf16 v[20:23], v[32:35], a[200:207], v2
    v_add_u32 v1, 0x10000, v1
    s_waitcnt lgkmcnt(5)
    v_smfmac_f32_16x16x64_bf16 v[28:31], v[32:35], v[48:55], v2
    ds_read_b128 v[48:51], v1 offset:0
    ds_read_b128 v[52:55], v1 offset:1024
    v_smfmac_f32_16x16x64_bf16 v[8:11], v[36:39], a[64:71], v2
    v_max_u32 v6, v6, v47
    v_smfmac_f32_16x16x64_bf16 v[12:15], v[36:39], a[72:79], v2
    v_cmp_eq_u32 vcc, -1, v6
    s_waitcnt lgkmcnt(4)
    v_smfmac_f32_16x16x64_bf16 v[24:27], v[36:39], v[56:63], v2
    ds_read_b128 v[56:59], v1 offset:2048
    ds_read_b128 v[60:63], v1 offset:3072
    v_smfmac_f32_16x16x64_bf16 v[16:19], v[36:39], a[208:215], v2
    v_add_u32 v6, s91, v0
    s_cbranch_vccnz Lpr_48
Lpc_49:
    ds_write_b128 v6, v[44:47] offset:22528
    v_smfmac_f32_16x16x64_bf16 v[20:23], v[36:39], a[216:223], v2
    s_waitcnt lgkmcnt(5)
    v_smfmac_f32_16x16x64_bf16 v[28:31], v[36:39], v[248:255], v2
    ds_read_b128 v[248:251], v1 offset:16384
    ds_read_b128 v[252:255], v1 offset:17408
    v_smfmac_f32_16x16x64_bf16 v[8:11], v[40:43], a[80:87], v2
    s_mov_b32 m0, s97
    v_smfmac_f32_16x16x64_bf16 v[12:15], v[40:43], a[88:95], v2
    s_waitcnt lgkmcnt(2)
    s_waitcnt vmcnt(0)
    s_barrier
    ds_read_b128 v[32:35], v0 offset:28672
    ds_read_b128 v[36:39], v0 offset:29696
    v_smfmac_f32_16x16x64_bf16 v[24:27], v[40:43], v[48:55], v2
    ds_read_b128 v[48:51], v1 offset:18432
    ds_read_b128 v[52:55], v1 offset:19456
    s_cmp_eq_u32 s66, 30
    s_cbranch_scc1 Lkv_50
Lkvc_51:
    v_smfmac_f32_16x16x64_bf16 v[16:19], v[40:43], a[224:231], v2
    ds_read_b128 v[44:47], v0 offset:30720
    buffer_load_dwordx4 v0, s[60:63], s95 offen sc1 lds
    v_smfmac_f32_16x16x64_bf16 v[20:23], v[40:43], a[232:239], v2
    buffer_load_dwordx4 v0, s[60:63], s95 offen offset:1024 sc1 lds
    v_smfmac_f32_16x16x64_bf16 v[28:31], v[40:43], v[56:63], v2
    ds_read_b128 v[56:59], v1 offset:32768
    ds_read_b128 v[60:63], v1 offset:33792
    s_waitcnt lgkmcnt(6)
    v_smfmac_f32_16x16x64_bf16 v[8:11], v[32:35], a[96:103], v2
    s_mov_b32 m0, 0x7d00
    v_lshlrev_b32 v6, 2, v0
    v_smfmac_f32_16x16x64_bf16 v[12:15], v[32:35], a[104:111], v2
    v_smfmac_f32_16x16x64_bf16 v[16:19], v[32:35], a[240:247], v2
    s_waitcnt lgkmcnt(3)
    v_smfmac_f32_16x16x64_bf16 v[8:11], v[36:39], a[112:119], v2
    buffer_load_dword v6, s[60:63], s101 offen sc1 lds
    v_smfmac_f32_16x16x64_bf16 v[12:15], v[36:39], a[120:127], v2
    v_smfmac_f32_16x16x64_bf16 v[20:23], v[32:35], a[248:255], v2
    v_mov_b32 v6, s66
    s_mov_b64 exec, 1
    buffer_store_dword v6, off, s[60:63], s100 sc1
    s_mov_b64 exec, -1
    s_waitcnt lgkmcnt(0)
    v_smfmac_f32_16x16x64_bf16 v[8:11], v[44:47], a[128:135], v2
    v_smfmac_f32_16x16x64_bf16 v[12:15], v[44:47], a[136:143], v2
    v_and_b32 v6, 0xffff, v3
    v_smfmac_f32_16x16x64_bf16 v[24:27], v[32:35], v[248:255], v2
    ds_read_b128 v[248:251], v1 offset:34816
    ds_read_b128 v[252:255], v1 offset:35840
    v_smfmac_f32_16x16x64_bf16 v[16:19], v[36:39], v[64:71], v2
    v_add_f32 v8, v8, v10
    v_add_f32 v9, v9, v11
    v_smfmac_f32_16x16x64_bf16 v[20:23], v[36:39], v[72:79], v2
    v_add_f32 v12, v12, v14
    v_add_f32 v13, v13, v15
    v_smfmac_f32_16x16x64_bf16 v[28:31], v[32:35], v[48:55], v2
    ds_read_b128 v[48:51], v1 offset:49152
    ds_read_b128 v[52:55], v1 offset:50176
    v_cvt_pk_bf16_f32 v8, v8, v9
    v_smfmac_f32_16x16x64_bf16 v[16:19], v[44:47], v[80:87], v2
    v_cvt_pk_bf16_f32 v9, v12, v13
    ds_write2_b32 v6, v8, v9 offset0:0 offset1:64
    v_smfmac_f32_16x16x64_bf16 v[20:23], v[44:47], v[88:95], v2
    ds_read_b128 v[8:11], v1 offset:51200
    ds_read_b128 v[12:15], v1 offset:52224
    v_smfmac_f32_16x16x64_bf16 v[24:27], v[36:39], v[56:63], v2
    ds_read_b128 v[56:59], v0 offset:4096
    ds_read_b128 v[60:63], v0 offset:8192
    s_waitcnt lgkmcnt(7)
    v_smfmac_f32_16x16x64_bf16 v[28:31], v[36:39], v[248:255], v2
    v_add_f32 v16, v16, v18
    v_add_f32 v17, v17, v19
    v_add_f32 v20, v20, v22
    v_add_f32 v21, v21, v23
    v_cvt_pk_bf16_f32 v16, v16, v17
    v_cvt_pk_bf16_f32 v17, v20, v21
    v_add_u32 v18, 2048, v6
    ds_write2_b32 v18, v16, v17 offset0:0 offset1:64
    s_waitcnt lgkmcnt(6)
    v_smfmac_f32_16x16x64_bf16 v[24:27], v[44:47], v[48:55], v2
    ds_read_b128 v[248:251], v0 offset:5120
    ds_read_b128 v[252:255], v0 offset:9216
    v_lshrrev_b32 v3, 16, v3
    s_waitcnt lgkmcnt(5)
    v_smfmac_f32_16x16x64_bf16 v[28:31], v[44:47], v[8:15], v2
    v_lshrrev_b32 v18, 1, v0
    buffer_store_dwordx2 v[16:17], v18, s[60:63], s83 offen sc1
    s_nop 0
    v_add_f32 v24, v24, v26
    v_add_f32 v25, v25, v27
    s_waitcnt lgkmcnt(2)
    s_barrier
    ds_read_b64_tr_b16 v[32:33], v3 offset:0
    ds_read_b64_tr_b16 v[34:35], v3 offset:256
    ds_read_b64_tr_b16 v[40:41], v3 offset:512
    ds_read_b64_tr_b16 v[42:43], v3 offset:768
    v_add_f32 v28, v28, v30
    ds_read_b128 v[48:51], v0 offset:6144
    ds_read_b128 v[52:55], v0 offset:10240
    v_add_f32 v29, v29, v31
    ds_read_b64_tr_b16 v[36:37], v3 offset:1024
    ds_read_b64_tr_b16 v[38:39], v3 offset:1280
    v_cvt_pk_bf16_f32 v24, v24, v25
    s_waitcnt lgkmcnt(6)
    v_mfma_f32_16x16x32_bf16 v[16:19], v[56:59], v[32:35], 0
    ds_read_b64_tr_b16 v[44:45], v3 offset:1536
    ds_read_b64_tr_b16 v[46:47], v3 offset:1792
    v_mfma_f32_16x16x32_bf16 v[20:23], v[60:63], v[32:35], 0
    ds_read_b128 v[8:11], v0 offset:7168
    ds_read_b128 v[12:15], v0 offset:11264
    s_waitcnt lgkmcnt(8)
    v_mfma_f32_16x16x32_bf16 v[16:19], v[248:251], v[40:43], v[16:19]
    ds_read_b64_tr_b16 v[56:57], v7 offset:0
    ds_read_b64_tr_b16 v[58:59], v7 offset:256
    v_mfma_f32_16x16x32_bf16 v[20:23], v[252:255], v[40:43], v[20:23]
    ds_read_b64_tr_b16 v[60:61], v7 offset:512
    ds_read_b64_tr_b16 v[62:63], v7 offset:768
    s_waitcnt lgkmcnt(8)
    v_mfma_f32_16x16x32_bf16 v[16:19], v[48:51], v[36:39], v[16:19]
    ds_read_b64_tr_b16 v[248:249], v7 offset:1024
    ds_read_b64_tr_b16 v[250:251], v7 offset:1280
    v_mfma_f32_16x16x32_bf16 v[20:23], v[52:55], v[36:39], v[20:23]
    ds_read_b64_tr_b16 v[252:253], v7 offset:1536
    ds_read_b64_tr_b16 v[254:255], v7 offset:1792
    s_waitcnt lgkmcnt(8)
    v_mfma_f32_16x16x32_bf16 v[16:19], v[8:11], v[44:47], v[16:19]
    v_cvt_pk_bf16_f32 v25, v28, v29
    v_lshl_or_b32 v3, v3, 16, v6
    v_mfma_f32_16x16x32_bf16 v[20:23], v[12:15], v[44:47], v[20:23]
    v_add_u32 v6, s98, v0
    v_lshrrev_b32 v26, 1, v0
    s_waitcnt lgkmcnt(6)
    v_mfma_f32_16x16x32_bf16 v[28:31], v[56:59], v[32:35], 0
    buffer_store_dwordx2 v[24:25], v26, s[60:63], s84 offen sc1
    s_cmp_eq_u32 s66, 63
    s_waitcnt lgkmcnt(4)
    v_mfma_f32_16x16x32_bf16 v[28:31], v[60:63], v[40:43], v[28:31]
    s_cbranch_scc1 Llast_52
    s_waitcnt vmcnt(4)
    s_waitcnt lgkmcnt(2)
    v_mfma_f32_16x16x32_bf16 v[28:31], v[248:251], v[36:39], v[28:31]
    ds_read_b128 v[48:51], v6 offset:20480
    ds_read_b128 v[52:55], v6 offset:21504
    s_waitcnt lgkmcnt(2)
    v_mfma_f32_16x16x32_bf16 v[28:31], v[252:255], v[44:47], v[28:31]
    v_cndmask_b32 v8, v20, v16, s[92:93]
    v_cndmask_b32 v9, v21, v17, s[92:93]
    v_cndmask_b32 v10, v22, v18, s[92:93]
    v_cndmask_b32 v11, v23, v19, s[92:93]
    v_max3_f32 v12, v8, v9, v10
    v_mov_b64 v[20:21], -1
    v_max_f32 v12, v12, v11
    v_mov_b64 v[22:23], -1
    v_cndmask_b32 v16, v28, v30, s[78:79]
    v_cndmask_b32 v17, v29, v31, s[78:79]
    v_max3_f32 v12, v12, v16, v17
    s_xor_b32 s67, s70, 0x80000
    buffer_store_dwordx4 v[20:23], v0, s[60:63], s67 offen
    v_max_f32_dpp v13, v12, v12 row_ror:8 row_mask:0xf bank_mask:0xf
    v_max_f32_dpp v12, v12, v12 row_ror:8 row_mask:0xf bank_mask:0xf
    v_mov_b32 v40, 0x3f803f80
    v_mov_b32 v41, 0x3f803f80
    v_permlane16_swap_b32 v12, v13
    v_max_f32 v14, v12, v13
    v_max_f32 v12, v12, v13
    v_mov_b64 v[42:43], v[40:41]
    v_mov_b32 v37, 0
    v_permlane32_swap_b32 v12, v14
    v_max_f32 v12, v12, v14
    v_mul_f32 v12, s80, v12
    v_fma_f32 v8, v8, s80, -v12
    v_fma_f32 v9, v9, s80, -v12
    v_exp_f32 v8, v8
    v_exp_f32 v9, v9
    v_fma_f32 v10, v10, s80, -v12
    v_fma_f32 v11, v11, s80, -v12
    v_cvt_pk_bf16_f32 v32, v8, v9
    v_exp_f32 v10, v10
    v_exp_f32 v11, v11
    v_mov_b32_dpp v34, v32 row_ror:8 row_mask:0xf bank_mask:0xf
    v_cvt_pk_bf16_f32 v33, v10, v11
    v_fma_f32 v16, v16, s80, -v12
    v_fma_f32 v17, v17, s80, -v12
    v_mov_b32_dpp v35, v33 row_ror:8 row_mask:0xf bank_mask:0xf
    v_exp_f32 v16, v16
    s_waitcnt lgkmcnt(0)
    v_mfma_f32_16x16x32_bf16 v[56:59], v[40:43], v[32:35], 0
    v_exp_f32 v17, v17
    v_mfma_f32_16x16x32_bf16 v[248:251], v[48:51], v[32:35], 0
    v_mov_b32 v38, 0
    v_cvt_pk_bf16_f32 v36, v16, v17
    v_mfma_f32_16x16x32_bf16 v[252:255], v[52:55], v[32:35], 0
    v_cvt_pk_bf16_f32 v39, v16, v17
    v_lshrrev_b32 v6, 16, v2
    v_mfma_f32_16x16x16_bf16 v[56:59], v[40:41], v[36:37], v[56:59]
    v_mov_b64 v[8:9], 0
    v_mov_b64 v[10:11], 0
    v_mfma_f32_16x16x16_bf16 v[248:251], v[24:25], v[36:37], v[248:251]
    v_mov_b64 v[12:13], 0
    v_mov_b64 v[14:15], 0
    v_mfma_f32_16x16x16_bf16 v[252:255], v[24:25], v[38:39], v[252:255]
    buffer_store_dwordx4 v[20:23], v0, s[60:63], s67 offen offset:1024
    v_rcp_f32 v56, v56
    v_mov_b64 v[16:17], 0
    s_nop 0
    v_mul_f32 v248, v248, v56
    v_mul_f32 v249, v249, v56
    v_cvt_pk_bf16_f32 v44, v248, v249
    v_mul_f32 v250, v250, v56
    v_mul_f32 v251, v251, v56
    v_cvt_pk_bf16_f32 v45, v250, v251
    v_mul_f32 v252, v252, v56
    v_mul_f32 v253, v253, v56
    v_cvt_pk_bf16_f32 v46, v252, v253
    v_mul_f32 v254, v254, v56
    v_mul_f32 v255, v255, v56
    v_cvt_pk_bf16_f32 v47, v254, v255
    s_mov_b64 exec, s[92:93]
    ds_write_b128 v6, v[44:47]
    s_mov_b64 exec, -1
    v_mov_b64 v[18:19], 0
    v_mov_b64 v[20:21], 0
    v_mov_b64 v[22:23], 0
    v_mov_b64 v[24:25], 0
    v_mov_b64 v[26:27], 0
    v_and_b32 v6, 0xf0, v0
    v_mov_b32 v56, -2
    v_mov_b32 v57, -2
    v_mov_b64 v[58:59], v[56:57]
    v_mov_b64 v[60:61], v[56:57]
    v_mov_b64 v[62:63], v[56:57]
    s_waitcnt lgkmcnt(0)
    s_barrier
    ds_read_b128 v[44:47], v0 offset:28672
    ds_read_b128 v[48:51], v0 offset:29696
    ds_read_b128 v[248:251], v6 offset:31744
    v_mov_b64 v[28:29], 0
    v_mov_b64 v[30:31], 0
    v_mov_b64 v[32:33], 0
    v_mov_b64 v[34:35], 0
    v_mov_b64 v[36:37], 0
    v_mov_b64 v[38:39], 0
    v_mov_b64 v[40:41], 0
    v_mov_b64 v[42:43], 0
    s_waitcnt lgkmcnt(2)
    v_smfmac_f32_16x16x64_bf16 v[8:11], v[44:47], v[96:103], v2
    s_mov_b32 s72, s75
    v_subrev_u32 v1, 0x10000, v1
    v_smfmac_f32_16x16x64_bf16 v[12:15], v[44:47], v[112:119], v2
    s_add_u32 s75, s75, 16384
    v_and_b32 v6, 0xffff, v4
    v_smfmac_f32_16x16x64_bf16 v[16:19], v[44:47], v[128:135], v2
    s_and_b32 s75, s75, 0xfffeffff
    s_waitcnt lgkmcnt(1)
    v_smfmac_f32_16x16x64_bf16 v[8:11], v[48:51], v[104:111], v2
    s_add_u32 s88, s75, s90
    v_smfmac_f32_16x16x64_bf16 v[12:15], v[48:51], v[120:127], v2
    v_smfmac_f32_16x16x64_bf16 v[20:23], v[44:47], v[144:151], v2
    v_add_f32 v8, v8, v10
    v_smfmac_f32_16x16x64_bf16 v[16:19], v[48:51], v[136:143], v2
    v_add_f32 v9, v9, v11
    v_smfmac_f32_16x16x64_bf16 v[20:23], v[48:51], v[152:159], v2
    v_add_f32 v12, v12, v14
    v_smfmac_f32_16x16x64_bf16 v[24:27], v[44:47], v[160:167], v2
    v_add_f32 v13, v13, v15
    v_smfmac_f32_16x16x64_bf16 v[28:31], v[44:47], v[176:183], v2
    v_cvt_pk_bf16_f32 v8, v8, v9
    v_smfmac_f32_16x16x64_bf16 v[32:35], v[44:47], v[192:199], v2
    v_cvt_pk_bf16_f32 v9, v12, v13
    v_smfmac_f32_16x16x64_bf16 v[24:27], v[48:51], v[168:175], v2
    buffer_store_dwordx2 v[8:9], v5, s[60:63], s3 offen
    v_add_f32 v16, v16, v18
    v_smfmac_f32_16x16x64_bf16 v[28:31], v[48:51], v[184:191], v2
    v_add_f32 v17, v17, v19
    v_smfmac_f32_16x16x64_bf16 v[36:39], v[44:47], v[208:215], v2
    v_add_f32 v20, v20, v22
    v_smfmac_f32_16x16x64_bf16 v[40:43], v[44:47], v[224:231], v2
    v_add_f32 v21, v21, v23
    v_smfmac_f32_16x16x64_bf16 v[32:35], v[48:51], v[200:207], v2
    v_cvt_pk_bf16_f32 v16, v16, v17
    v_smfmac_f32_16x16x64_bf16 v[36:39], v[48:51], v[216:223], v2
    v_cvt_pk_bf16_f32 v17, v20, v21
    v_smfmac_f32_16x16x64_bf16 v[40:43], v[48:51], v[232:239], v2
    buffer_store_dwordx2 v[16:17], v5, s[60:63], s4 offen
    v_add_f32 v24, v24, v26
    v_add_f32 v25, v25, v27
    v_add_f32 v28, v28, v30
    v_add_f32 v29, v29, v31
    v_cvt_pk_bf16_f32 v24, v24, v25
    v_cvt_pk_bf16_f32 v25, v28, v29
    buffer_store_dwordx2 v[24:25], v5, s[60:63], s5 offen
    v_pk_add_f32 v[32:33], v[32:33], v[34:35]
    v_pk_add_f32 v[36:37], v[36:37], v[38:39]
    v_cvt_pk_bf16_f32 v32, v32, v33
    v_cvt_pk_bf16_f32 v33, v36, v37
    buffer_store_dwordx2 v[32:33], v5, s[60:63], s6 offen
    v_pk_add_f32 v[40:41], v[40:41], v[42:43]
    v_mov_b64 v[28:29], -1
    v_cvt_pk_bf16_f32 v40, v40, v41
    v_mov_b64 v[30:31], -1
    v_mov_b64 v[8:9], 0
    v_mov_b32_dpp v41, v40 row_ror:8 row_mask:0xf bank_mask:0xf
    s_mov_b64 exec, s[92:93]
    buffer_store_dwordx2 v[40:41], v5, s[60:63], s7 offen
    s_mov_b64 exec, -1
    s_waitcnt lgkmcnt(0)
    v_mov_b32 v40, -2
    v_mov_b32 v41, -2
    v_mov_b64 v[42:43], v[40:41]
    v_mov_b64 v[44:45], v[40:41]
    v_mov_b64 v[46:47], v[40:41]
    v_mov_b64 v[10:11], 0
    v_mov_b64 v[12:13], 0
    v_mov_b64 v[14:15], 0
    v_mov_b64 v[16:17], 0
    v_mov_b64 v[18:19], 0
    v_mov_b64 v[20:21], 0
    v_mov_b64 v[22:23], 0
    v_mov_b64 v[24:25], 0
    v_mov_b64 v[26:27], 0
    s_add_u32 s89, s75, s91
    s_add_u32 s94, s94, 0x80000
    s_add_u32 s95, s95, 0x80000
    s_add_u32 s101, s101, 0x80000
    s_add_u32 s83, s83, 0x10000
    s_add_u32 s84, s84, 0x10000
    v_xor_b32 v5, 0x80000, v5
    s_add_u32 s66, s66, 1
    s_cmp_eq_u32 s99, 0
    s_cbranch_scc1 Lnj2_54
    s_xor_b32 s67, s71, 0x80000
    buffer_store_dwordx4 v[28:31], v0, s[60:63], s67 offen
    buffer_store_dwordx4 v[28:31], v0, s[60:63], s67 offen offset:1024
    buffer_load_dwordx4 v[56:59], v0, s[60:63], s70 offen sc1
    buffer_load_dwordx4 v[60:63], v0, s[60:63], s70 offen offset:1024 sc1
    buffer_load_dwordx4 v[40:43], v0, s[60:63], s71 offen sc1
    buffer_load_dwordx4 v[44:47], v0, s[60:63], s71 offen offset:1024 sc1
Lpl_56:
    v_max3_u32 v252, v56, v57, v58
    v_max3_u32 v253, v59, v60, v61
    v_max3_u32 v252, v252, v62, v63
    v_max_u32 v252, v252, v253
    v_cmp_le_u32 vcc, -2, v252
    s_add_u32 s74, s74, 1
    s_cbranch_vccz Lrok_55
    v_max3_u32 v252, v56, v57, v58
    v_max3_u32 v253, v59, v60, v61
    v_max3_u32 v252, v252, v62, v63
    v_max_u32 v252, v252, v253
    v_cmp_le_u32 vcc, -2, v252
    s_nop 0
    s_cbranch_vccz Lrok_55
    v_max3_u32 v252, v56, v57, v58
    v_max3_u32 v253, v59, v60, v61
    v_max3_u32 v252, v252, v62, v63
    v_max_u32 v252, v252, v253
    v_cmp_le_u32 vcc, -2, v252
    s_cmp_lt_u32 s74, 0x100000
    s_cbranch_vccz Lrok_55
    buffer_load_dwordx4 v[56:59], v0, s[60:63], s70 offen sc1
    v_mov_b32 v254, 0
    buffer_load_dwordx4 v[60:63], v0, s[60:63], s70 offen offset:1024 sc1
    v_mov_b32 v254, 0
    s_cbranch_scc1 Lpl_56
    s_branch L_fail
Lrok_55:
    v_mfma_f32_16x16x32_bf16 v[252:255], v[248:251], v[56:59], 0
    v_mfma_f32_16x16x32_bf16 v[252:255], v[248:251], v[60:63], v[252:255]
    s_nop 7
    v_add_f32_dpp v254, v252, v252 row_ror:8 row_mask:0xf bank_mask:0xf
    v_add_f32_dpp v255, v253, v253 row_ror:8 row_mask:0xf bank_mask:0xf
    s_nop 0
    v_add_f32_dpp v252, v254, v254 row_ror:4 row_mask:0xf bank_mask:0xf
    v_add_f32_dpp v253, v255, v255 row_ror:4 row_mask:0xf bank_mask:0xf
    s_mov_b64 exec, s[76:77]
    v_cvt_pk_bf16_f32 v252, v252, v253
    buffer_store_dword v252, v6, s[60:63], s75 offen
    buffer_store_dword v28, v6, s[60:63], s72 offen
    s_mov_b64 exec, -1
    v_lshrrev_b32 v6, 16, v4
Lpl_58:
    v_max3_u32 v252, v40, v41, v42
    v_max3_u32 v253, v43, v44, v45
    v_max3_u32 v252, v252, v46, v47
    v_max_u32 v252, v252, v253
    v_cmp_le_u32 vcc, -2, v252
    s_add_u32 s74, s74, 1
    s_cbranch_vccz Lrok_57
    v_max3_u32 v252, v40, v41, v42
    v_max3_u32 v253, v43, v44, v45
    v_max3_u32 v252, v252, v46, v47
    v_max_u32 v252, v252, v253
    v_cmp_le_u32 vcc, -2, v252
    s_nop 0
    s_cbranch_vccz Lrok_57
    v_max3_u32 v252, v40, v41, v42
    v_max3_u32 v253, v43, v44, v45
    v_max3_u32 v252, v252, v46, v47
    v_max_u32 v252, v252, v253
    v_cmp_le_u32 vcc, -2, v252
    s_cmp_lt_u32 s74, 0x100000
    s_cbranch_vccz Lrok_57
    buffer_load_dwordx4 v[40:43], v0, s[60:63], s71 offen sc1
    v_mov_b32 v254, 0
    buffer_load_dwordx4 v[44:47], v0, s[60:63], s71 offen offset:1024 sc1
    v_mov_b32 v254, 0
    s_cbranch_scc1 Lpl_58
    s_branch L_fail
Lrok_57:
    v_mfma_f32_16x16x32_bf16 v[252:255], v[248:251], v[40:43], 0
    v_mfma_f32_16x16x32_bf16 v[252:255], v[248:251], v[44:47], v[252:255]
    s_nop 7
    v_add_f32_dpp v254, v252, v252 row_ror:8 row_mask:0xf bank_mask:0xf
    v_add_f32_dpp v255, v253, v253 row_ror:8 row_mask:0xf bank_mask:0xf
    s_nop 0
    v_add_f32_dpp v252, v254, v254 row_ror:4 row_mask:0xf bank_mask:0xf
    v_add_f32_dpp v253, v255, v255 row_ror:4 row_mask:0xf bank_mask:0xf
    s_mov_b64 exec, s[76:77]
    v_cvt_pk_bf16_f32 v252, v252, v253
    buffer_store_dword v252, v6, s[60:63], s75 offen
    buffer_store_dword v28, v6, s[60:63], s72 offen
    s_mov_b64 exec, -1
    s_xor_b32 s71, s71, 0x80000
    s_xor_b32 s70, s70, 0x80000
    v_add_u32 v6, s98, v0
    ds_read_b128 v[48:51], v6 offset:12288
    ds_read_b128 v[52:55], v6 offset:13312
    v_mov_b64 v[28:29], 0
    v_mov_b64 v[30:31], 0
    s_waitcnt vmcnt(2)
    s_branch Lbar1_47
Lnj2_54:
    buffer_load_dwordx4 v[56:59], v0, s[60:63], s70 offen sc1
    buffer_load_dwordx4 v[60:63], v0, s[60:63], s70 offen offset:1024 sc1
Lpl_60:
    v_max3_u32 v252, v56, v57, v58
    v_max3_u32 v253, v59, v60, v61
    v_max3_u32 v252, v252, v62, v63
    v_max_u32 v252, v252, v253
    v_cmp_le_u32 vcc, -2, v252
    s_add_u32 s74, s74, 1
    s_cbranch_vccz Lrok_59
    v_max3_u32 v252, v56, v57, v58
    v_max3_u32 v253, v59, v60, v61
    v_max3_u32 v252, v252, v62, v63
    v_max_u32 v252, v252, v253
    v_cmp_le_u32 vcc, -2, v252
    s_nop 0
    s_cbranch_vccz Lrok_59
    v_max3_u32 v252, v56, v57, v58
    v_max3_u32 v253, v59, v60, v61
    v_max3_u32 v252, v252, v62, v63
    v_max_u32 v252, v252, v253
    v_cmp_le_u32 vcc, -2, v252
    s_cmp_lt_u32 s74, 0x100000
    s_cbranch_vccz Lrok_59
    buffer_load_dwordx4 v[56:59], v0, s[60:63], s70 offen sc1
    v_mov_b32 v254, 0
    buffer_load_dwordx4 v[60:63], v0, s[60:63], s70 offen offset:1024 sc1
    v_mov_b32 v254, 0
    s_cbranch_scc1 Lpl_60
    s_branch L_fail
Lrok_59:
    v_mfma_f32_16x16x32_bf16 v[252:255], v[248:251], v[56:59], 0
    v_mfma_f32_16x16x32_bf16 v[252:255], v[248:251], v[60:63], v[252:255]
    s_nop 7
    v_add_f32_dpp v254, v252, v252 row_ror:8 row_mask:0xf bank_mask:0xf
    v_add_f32_dpp v255, v253, v253 row_ror:8 row_mask:0xf bank_mask:0xf
    s_nop 0
    v_add_f32_dpp v252, v254, v254 row_ror:4 row_mask:0xf bank_mask:0xf
    v_add_f32_dpp v253, v255, v255 row_ror:4 row_mask:0xf bank_mask:0xf
    s_mov_b64 exec, s[76:77]
    v_cvt_pk_bf16_f32 v252, v252, v253
    buffer_store_dword v252, v6, s[60:63], s75 offen
    buffer_store_dword v28, v6, s[60:63], s72 offen
    s_mov_b64 exec, -1
    s_xor_b32 s70, s70, 0x80000
    v_add_u32 v6, s98, v0
    ds_read_b128 v[48:51], v6 offset:12288
    ds_read_b128 v[52:55], v6 offset:13312
    v_mov_b64 v[28:29], 0
    v_mov_b64 v[30:31], 0
    s_waitcnt vmcnt(0)
    s_branch Lbar1_47
Lpr_48:
    buffer_load_dwordx4 v[44:47], v0, s[60:63], s89 offen sc1
    s_add_u32 s74, s74, 1
    s_cmp_ge_u32 s74, 0x100000
    s_cbranch_scc1 L_fail
    s_waitcnt vmcnt(0)
    v_max3_u32 v6, v44, v45, v46
    v_max_u32 v6, v6, v47
    v_cmp_eq_u32 vcc, -1, v6
    v_add_u32 v6, s91, v0
    s_cbranch_vccnz Lpr_48
    s_branch Lpc_49
Lkv_50:
    buffer_load_dword v6, off, s[56:59], 0 offset:148 sc1
    s_add_u32 s74, s74, 1
    s_cmp_ge_u32 s74, 0x100000
    s_cbranch_scc1 L_fail
    s_waitcnt vmcnt(0)
    v_readfirstlane_b32 s67, v6
    s_cmp_lt_u32 s67, 224
    s_cbranch_scc1 Lkv_50
    s_branch Lkvc_51
Llast_52:
    s_waitcnt vmcnt(0)
    s_barrier
    v_mov_b32 v60, 64
    s_mov_b64 exec, 1
    buffer_store_dword v60, off, s[60:63], s100 sc1
    s_mov_b64 exec, -1
    s_branch L_cdone
L_cdone:
    s_branch L_done
L_slow:
    s_cmp_eq_u32 s65, 1
    s_cbranch_scc1 Lwave_62
    s_cmp_eq_u32 s65, 2
    s_cbranch_scc1 Lwave_63
    s_cmp_eq_u32 s65, 3
    s_cbranch_scc1 Lwave_64
Lwave_61:
    s_branch Lagtop_65
.p2align 3
Lbar1_66:
    s_waitcnt lgkmcnt(0)
    s_barrier
    ds_read_b128 v[32:35], v0 offset:22528
    ds_read_b128 v[36:39], v0 offset:23552
    ds_read_b128 v[248:251], v1 offset:2048
    ds_read_b128 v[252:255], v1 offset:3072
    ds_read_b128 v[56:59], v1 offset:0
    ds_read_b128 v[60:63], v1 offset:1024
    s_waitcnt lgkmcnt(5)
    v_smfmac_f32_16x16x64_bf16 v[8:11], v[32:35], a[0:7], v2
    v_smfmac_f32_16x16x64_bf16 v[12:15], v[32:35], a[8:15], v2
    v_smfmac_f32_16x16x64_bf16 v[24:27], v[32:35], v[240:247], v2
    v_smfmac_f32_16x16x64_bf16 v[16:19], v[32:35], a[144:151], v2
    v_smfmac_f32_16x16x64_bf16 v[20:23], v[32:35], a[152:159], v2
    v_smfmac_f32_16x16x64_bf16 v[28:31], v[32:35], v[48:55], v2
    ds_read_b128 v[48:51], v1 offset:16384
    ds_read_b128 v[52:55], v1 offset:17408
    s_waitcnt lgkmcnt(2)
    v_smfmac_f32_16x16x64_bf16 v[8:11], v[36:39], a[16:23], v2
    s_waitcnt vmcnt(0)
    ds_read_b128 v[40:43], v0 offset:24576
    v_smfmac_f32_16x16x64_bf16 v[12:15], v[36:39], a[24:31], v2
    ds_read_b128 v[32:35], v0 offset:25600
    buffer_load_dwordx4 v[44:47], v0, s[60:63], s89 offen sc1
    v_smfmac_f32_16x16x64_bf16 v[24:27], v[36:39], v[56:63], v2
    ds_read_b128 v[56:59], v1 offset:18432
    ds_read_b128 v[60:63], v1 offset:19456
    v_smfmac_f32_16x16x64_bf16 v[16:19], v[36:39], a[160:167], v2
    s_mov_b32 m0, s96
    v_smfmac_f32_16x16x64_bf16 v[20:23], v[36:39], a[168:175], v2
    buffer_load_dwordx4 v0, s[60:63], s94 offen sc1 lds
    v_smfmac_f32_16x16x64_bf16 v[28:31], v[36:39], v[248:255], v2
    ds_read_b128 v[248:251], v1 offset:32768
    ds_read_b128 v[252:255], v1 offset:33792
    s_waitcnt lgkmcnt(5)
    v_smfmac_f32_16x16x64_bf16 v[8:11], v[40:43], a[32:39], v2
    ds_read_b128 v[36:39], v0 offset:26624
    v_smfmac_f32_16x16x64_bf16 v[12:15], v[40:43], a[40:47], v2
    buffer_load_dwordx4 v0, s[60:63], s94 offen offset:1024 sc1 lds
    v_smfmac_f32_16x16x64_bf16 v[24:27], v[40:43], v[48:55], v2
    ds_read_b128 v[48:51], v1 offset:34816
    ds_read_b128 v[52:55], v1 offset:35840
    v_smfmac_f32_16x16x64_bf16 v[16:19], v[40:43], a[176:183], v2
    v_smfmac_f32_16x16x64_bf16 v[20:23], v[40:43], a[184:191], v2
    s_waitcnt lgkmcnt(5)
    v_smfmac_f32_16x16x64_bf16 v[28:31], v[40:43], v[56:63], v2
    ds_read_b128 v[56:59], v1 offset:49152
    ds_read_b128 v[60:63], v1 offset:50176
    v_smfmac_f32_16x16x64_bf16 v[8:11], v[32:35], a[48:55], v2
    ds_read_b128 v[40:43], v0 offset:27648
    v_smfmac_f32_16x16x64_bf16 v[12:15], v[32:35], a[56:63], v2
    s_waitcnt lgkmcnt(5)
    v_smfmac_f32_16x16x64_bf16 v[24:27], v[32:35], v[248:255], v2
    ds_read_b128 v[248:251], v1 offset:51200
    ds_read_b128 v[252:255], v1 offset:52224
    v_smfmac_f32_16x16x64_bf16 v[16:19], v[32:35], a[192:199], v2
    s_waitcnt vmcnt(2)
    v_max3_u32 v6, v44, v45, v46
    v_smfmac_f32_16x16x64_bf16 v[20:23], v[32:35], a[200:207], v2
    v_add_u32 v1, 0x10000, v1
    s_waitcnt lgkmcnt(5)
    v_smfmac_f32_16x16x64_bf16 v[28:31], v[32:35], v[48:55], v2
    ds_read_b128 v[48:51], v1 offset:0
    ds_read_b128 v[52:55], v1 offset:1024
    v_smfmac_f32_16x16x64_bf16 v[8:11], v[36:39], a[64:71], v2
    v_max_u32 v6, v6, v47
    v_smfmac_f32_16x16x64_bf16 v[12:15], v[36:39], a[72:79], v2
    v_cmp_eq_u32 vcc, -1, v6
    s_waitcnt lgkmcnt(4)
    v_smfmac_f32_16x16x64_bf16 v[24:27], v[36:39], v[56:63], v2
    ds_read_b128 v[56:59], v1 offset:2048
    ds_read_b128 v[60:63], v1 offset:3072
    v_smfmac_f32_16x16x64_bf16 v[16:19], v[36:39], a[208:215], v2
    v_add_u32 v6, s91, v0
    s_cbranch_vccnz Lpr_67
Lpc_68:
    ds_write_b128 v6, v[44:47] offset:22528
    v_smfmac_f32_16x16x64_bf16 v[20:23], v[36:39], a[216:223], v2
    s_waitcnt lgkmcnt(5)
    v_smfmac_f32_16x16x64_bf16 v[28:31], v[36:39], v[248:255], v2
    ds_read_b128 v[248:251], v1 offset:16384
    ds_read_b128 v[252:255], v1 offset:17408
    v_smfmac_f32_16x16x64_bf16 v[8:11], v[40:43], a[80:87], v2
    s_mov_b32 m0, s97
    v_smfmac_f32_16x16x64_bf16 v[12:15], v[40:43], a[88:95], v2
    s_waitcnt lgkmcnt(2)
    s_waitcnt vmcnt(0)
    s_barrier
    ds_read_b128 v[32:35], v0 offset:28672
    ds_read_b128 v[36:39], v0 offset:29696
    v_smfmac_f32_16x16x64_bf16 v[24:27], v[40:43], v[48:55], v2
    ds_read_b128 v[48:51], v1 offset:18432
    ds_read_b128 v[52:55], v1 offset:19456
    s_cmp_eq_u32 s66, 30
    s_cbranch_scc1 Lkv_69
Lkvc_70:
    v_smfmac_f32_16x16x64_bf16 v[16:19], v[40:43], a[224:231], v2
    ds_read_b128 v[44:47], v0 offset:30720
    buffer_load_dwordx4 v0, s[60:63], s95 offen sc1 lds
    v_smfmac_f32_16x16x64_bf16 v[20:23], v[40:43], a[232:239], v2
    buffer_load_dwordx4 v0, s[60:63], s95 offen offset:1024 sc1 lds
    v_smfmac_f32_16x16x64_bf16 v[28:31], v[40:43], v[56:63], v2
    ds_read_b128 v[56:59], v1 offset:32768
    ds_read_b128 v[60:63], v1 offset:33792
    s_waitcnt lgkmcnt(6)
    v_smfmac_f32_16x16x64_bf16 v[8:11], v[32:35], a[96:103], v2
    s_mov_b32 m0, 0x7d00
    v_lshlrev_b32 v6, 2, v0
    v_smfmac_f32_16x16x64_bf16 v[12:15], v[32:35], a[104:111], v2
    v_smfmac_f32_16x16x64_bf16 v[16:19], v[32:35], a[240:247], v2
    s_waitcnt lgkmcnt(3)
    v_smfmac_f32_16x16x64_bf16 v[8:11], v[36:39], a[112:119], v2
    buffer_load_dword v6, s[60:63], s101 offen sc1 lds
    v_smfmac_f32_16x16x64_bf16 v[12:15], v[36:39], a[120:127], v2
    v_smfmac_f32_16x16x64_bf16 v[20:23], v[32:35], a[248:255], v2
    s_waitcnt lgkmcnt(0)
    v_smfmac_f32_16x16x64_bf16 v[8:11], v[44:47], a[128:135], v2
    v_smfmac_f32_16x16x64_bf16 v[12:15], v[44:47], a[136:143], v2
    v_and_b32 v6, 0xffff, v3
    v_smfmac_f32_16x16x64_bf16 v[24:27], v[32:35], v[248:255], v2
    ds_read_b128 v[248:251], v1 offset:34816
    ds_read_b128 v[252:255], v1 offset:35840
    v_smfmac_f32_16x16x64_bf16 v[16:19], v[36:39], v[64:71], v2
    v_add_f32 v8, v8, v10
    v_add_f32 v9, v9, v11
    v_smfmac_f32_16x16x64_bf16 v[20:23], v[36:39], v[72:79], v2
    v_add_f32 v12, v12, v14
    v_add_f32 v13, v13, v15
    v_smfmac_f32_16x16x64_bf16 v[28:31], v[32:35], v[48:55], v2
    ds_read_b128 v[48:51], v1 offset:49152
    ds_read_b128 v[52:55], v1 offset:50176
    v_cvt_pk_bf16_f32 v8, v8, v9
    v_smfmac_f32_16x16x64_bf16 v[16:19], v[44:47], v[80:87], v2
    v_cvt_pk_bf16_f32 v9, v12, v13
    ds_write2_b32 v6, v8, v9 offset0:0 offset1:64
    v_smfmac_f32_16x16x64_bf16 v[20:23], v[44:47], v[88:95], v2
    ds_read_b128 v[8:11], v1 offset:51200
    ds_read_b128 v[12:15], v1 offset:52224
    v_smfmac_f32_16x16x64_bf16 v[24:27], v[36:39], v[56:63], v2
    ds_read_b128 v[56:59], v0 offset:4096
    ds_read_b128 v[60:63], v0 offset:8192
    s_waitcnt lgkmcnt(7)
    v_smfmac_f32_16x16x64_bf16 v[28:31], v[36:39], v[248:255], v2
    v_add_f32 v16, v16, v18
    v_add_f32 v17, v17, v19
    v_add_f32 v20, v20, v22
    v_add_f32 v21, v21, v23
    v_cvt_pk_bf16_f32 v16, v16, v17
    v_cvt_pk_bf16_f32 v17, v20, v21
    v_add_u32 v18, 2048, v6
    ds_write2_b32 v18, v16, v17 offset0:0 offset1:64
    s_waitcnt lgkmcnt(6)
    v_smfmac_f32_16x16x64_bf16 v[24:27], v[44:47], v[48:55], v2
    ds_read_b128 v[248:251], v0 offset:5120
    ds_read_b128 v[252:255], v0 offset:9216
    v_lshrrev_b32 v3, 16, v3
    s_waitcnt lgkmcnt(5)
    v_smfmac_f32_16x16x64_bf16 v[28:31], v[44:47], v[8:15], v2
    v_lshrrev_b32 v18, 1, v0
    buffer_store_dwordx2 v[16:17], v18, s[60:63], s83 offen sc1
    s_nop 0
    v_add_f32 v24, v24, v26
    v_add_f32 v25, v25, v27
    s_waitcnt lgkmcnt(2)
    s_barrier
    ds_read_b64_tr_b16 v[32:33], v3 offset:0
    ds_read_b64_tr_b16 v[34:35], v3 offset:256
    ds_read_b64_tr_b16 v[40:41], v3 offset:512
    ds_read_b64_tr_b16 v[42:43], v3 offset:768
    v_add_f32 v28, v28, v30
    ds_read_b128 v[48:51], v0 offset:6144
    ds_read_b128 v[52:55], v0 offset:10240
    v_add_f32 v29, v29, v31
    ds_read_b64_tr_b16 v[36:37], v3 offset:1024
    ds_read_b64_tr_b16 v[38:39], v3 offset:1280
    v_cvt_pk_bf16_f32 v24, v24, v25
    s_waitcnt lgkmcnt(6)
    v_mfma_f32_16x16x32_bf16 v[16:19], v[56:59], v[32:35], 0
    ds_read_b64_tr_b16 v[44:45], v3 offset:1536
    ds_read_b64_tr_b16 v[46:47], v3 offset:1792
    v_mfma_f32_16x16x32_bf16 v[20:23], v[60:63], v[32:35], 0
    ds_read_b128 v[8:11], v0 offset:7168
    ds_read_b128 v[12:15], v0 offset:11264
    s_waitcnt lgkmcnt(8)
    v_mfma_f32_16x16x32_bf16 v[16:19], v[248:251], v[40:43], v[16:19]
    ds_read_b64_tr_b16 v[56:57], v7 offset:0
    ds_read_b64_tr_b16 v[58:59], v7 offset:256
    v_mfma_f32_16x16x32_bf16 v[20:23], v[252:255], v[40:43], v[20:23]
    ds_read_b64_tr_b16 v[60:61], v7 offset:512
    ds_read_b64_tr_b16 v[62:63], v7 offset:768
    s_waitcnt lgkmcnt(8)
    v_mfma_f32_16x16x32_bf16 v[16:19], v[48:51], v[36:39], v[16:19]
    ds_read_b64_tr_b16 v[248:249], v7 offset:1024
    ds_read_b64_tr_b16 v[250:251], v7 offset:1280
    v_mfma_f32_16x16x32_bf16 v[20:23], v[52:55], v[36:39], v[20:23]
    ds_read_b64_tr_b16 v[252:253], v7 offset:1536
    ds_read_b64_tr_b16 v[254:255], v7 offset:1792
    s_waitcnt lgkmcnt(8)
    v_mfma_f32_16x16x32_bf16 v[16:19], v[8:11], v[44:47], v[16:19]
    v_cvt_pk_bf16_f32 v25, v28, v29
    v_lshl_or_b32 v3, v3, 16, v6
    v_mfma_f32_16x16x32_bf16 v[20:23], v[12:15], v[44:47], v[20:23]
    v_add_u32 v6, s98, v0
    v_lshrrev_b32 v26, 1, v0
    s_waitcnt lgkmcnt(6)
    v_mfma_f32_16x16x32_bf16 v[28:31], v[56:59], v[32:35], 0
    buffer_store_dwordx2 v[24:25], v26, s[60:63], s84 offen sc1
    s_cmp_eq_u32 s66, 63
    s_waitcnt lgkmcnt(4)
    v_mfma_f32_16x16x32_bf16 v[28:31], v[60:63], v[40:43], v[28:31]
    s_cbranch_scc1 Llast_71
    s_waitcnt vmcnt(3)
    s_waitcnt lgkmcnt(2)
    v_mfma_f32_16x16x32_bf16 v[28:31], v[248:251], v[36:39], v[28:31]
    ds_read_b128 v[48:51], v6 offset:20480
    ds_read_b128 v[52:55], v6 offset:21504
    s_waitcnt lgkmcnt(2)
    v_mfma_f32_16x16x32_bf16 v[28:31], v[252:255], v[44:47], v[28:31]
    v_cndmask_b32 v8, v20, v16, s[92:93]
    v_cndmask_b32 v9, v21, v17, s[92:93]
    v_cndmask_b32 v10, v22, v18, s[92:93]
    v_cndmask_b32 v11, v23, v19, s[92:93]
    v_max3_f32 v12, v8, v9, v10
    v_mov_b64 v[20:21], -1
    v_max_f32 v12, v12, v11
    v_mov_b64 v[22:23], -1
    v_cndmask_b32 v16, v28, v30, s[78:79]
    v_cndmask_b32 v17, v29, v31, s[78:79]
    v_max3_f32 v12, v12, v16, v17
    s_xor_b32 s67, s70, 0x80000
    buffer_store_dwordx4 v[20:23], v0, s[60:63], s67 offen sc1
    v_max_f32_dpp v13, v12, v12 row_ror:8 row_mask:0xf bank_mask:0xf
    v_max_f32_dpp v12, v12, v12 row_ror:8 row_mask:0xf bank_mask:0xf
    v_mov_b32 v40, 0x3f803f80
    v_mov_b32 v41, 0x3f803f80
    v_permlane16_swap_b32 v12, v13
    v_max_f32 v14, v12, v13
    v_max_f32 v12, v12, v13
    v_mov_b64 v[42:43], v[40:41]
    v_mov_b32 v37, 0
    v_permlane32_swap_b32 v12, v14
    v_max_f32 v12, v12, v14
    v_mul_f32 v12, s80, v12
    v_fma_f32 v8, v8, s80, -v12
    v_fma_f32 v9, v9, s80, -v12
    v_exp_f32 v8, v8
    v_exp_f32 v9, v9
    v_fma_f32 v10, v10, s80, -v12
    v_fma_f32 v11, v11, s80, -v12
    v_cvt_pk_bf16_f32 v32, v8, v9
    v_exp_f32 v10, v10
    v_exp_f32 v11, v11
    v_mov_b32_dpp v34, v32 row_ror:8 row_mask:0xf bank_mask:0xf
    v_cvt_pk_bf16_f32 v33, v10, v11
    v_fma_f32 v16, v16, s80, -v12
    v_fma_f32 v17, v17, s80, -v12
    v_mov_b32_dpp v35, v33 row_ror:8 row_mask:0xf bank_mask:0xf
    v_exp_f32 v16, v16
    s_waitcnt lgkmcnt(0)
    v_mfma_f32_16x16x32_bf16 v[56:59], v[40:43], v[32:35], 0
    v_exp_f32 v17, v17
    v_mfma_f32_16x16x32_bf16 v[248:251], v[48:51], v[32:35], 0
    v_mov_b32 v38, 0
    v_cvt_pk_bf16_f32 v36, v16, v17
    v_mfma_f32_16x16x32_bf16 v[252:255], v[52:55], v[32:35], 0
    v_cvt_pk_bf16_f32 v39, v16, v17
    v_lshrrev_b32 v6, 16, v2
    v_mfma_f32_16x16x16_bf16 v[56:59], v[40:41], v[36:37], v[56:59]
    v_mov_b64 v[8:9], 0
    v_mov_b64 v[10:11], 0
    v_mfma_f32_16x16x16_bf16 v[248:251], v[24:25], v[36:37], v[248:251]
    v_mov_b64 v[12:13], 0
    v_mov_b64 v[14:15], 0
    v_mfma_f32_16x16x16_bf16 v[252:255], v[24:25], v[38:39], v[252:255]
    buffer_store_dwordx4 v[20:23], v0, s[60:63], s67 offen offset:1024 sc1
    v_rcp_f32 v56, v56
    v_mov_b64 v[16:17], 0
    s_nop 0
    v_mul_f32 v248, v248, v56
    v_mul_f32 v249, v249, v56
    v_cvt_pk_bf16_f32 v44, v248, v249
    v_mul_f32 v250, v250, v56
    v_mul_f32 v251, v251, v56
    v_cvt_pk_bf16_f32 v45, v250, v251
    v_mul_f32 v252, v252, v56
    v_mul_f32 v253, v253, v56
    v_cvt_pk_bf16_f32 v46, v252, v253
    v_mul_f32 v254, v254, v56
    v_mul_f32 v255, v255, v56
    v_cvt_pk_bf16_f32 v47, v254, v255
    s_mov_b64 exec, s[92:93]
    ds_write_b128 v6, v[44:47]
    s_mov_b64 exec, -1
    v_mov_b64 v[18:19], 0
    v_mov_b64 v[20:21], 0
    v_mov_b64 v[22:23], 0
    v_mov_b64 v[24:25], 0
    v_mov_b64 v[26:27], 0
    v_and_b32 v6, 0xf0, v0
    v_mov_b32 v56, -2
    v_mov_b32 v57, -2
    v_mov_b64 v[58:59], v[56:57]
    v_mov_b64 v[60:61], v[56:57]
    v_mov_b64 v[62:63], v[56:57]
    s_waitcnt lgkmcnt(0)
    s_barrier
    ds_read_b128 v[44:47], v0 offset:28672
    ds_read_b128 v[48:51], v0 offset:29696
    ds_read_b128 v[248:251], v6 offset:31744
    v_mov_b64 v[28:29], 0
    v_mov_b64 v[30:31], 0
    v_mov_b64 v[32:33], 0
    v_mov_b64 v[34:35], 0
    v_mov_b64 v[36:37], 0
    v_mov_b64 v[38:39], 0
    v_mov_b64 v[40:41], 0
    v_mov_b64 v[42:43], 0
    s_waitcnt lgkmcnt(2)
    v_smfmac_f32_16x16x64_bf16 v[8:11], v[44:47], v[96:103], v2
    s_mov_b32 s72, s75
    v_subrev_u32 v1, 0x10000, v1
    v_smfmac_f32_16x16x64_bf16 v[12:15], v[44:47], v[112:119], v2
    s_add_u32 s75, s75, 16384
    v_and_b32 v6, 0xffff, v4
    v_smfmac_f32_16x16x64_bf16 v[16:19], v[44:47], v[128:135], v2
    s_and_b32 s75, s75, 0xfffeffff
    s_waitcnt lgkmcnt(1)
    v_smfmac_f32_16x16x64_bf16 v[8:11], v[48:51], v[104:111], v2
    s_add_u32 s88, s75, s90
    v_smfmac_f32_16x16x64_bf16 v[12:15], v[48:51], v[120:127], v2
    v_smfmac_f32_16x16x64_bf16 v[20:23], v[44:47], v[144:151], v2
    v_add_f32 v8, v8, v10
    v_smfmac_f32_16x16x64_bf16 v[16:19], v[48:51], v[136:143], v2
    v_add_f32 v9, v9, v11
    v_smfmac_f32_16x16x64_bf16 v[20:23], v[48:51], v[152:159], v2
    v_add_f32 v12, v12, v14
    v_smfmac_f32_16x16x64_bf16 v[24:27], v[44:47], v[160:167], v2
    v_add_f32 v13, v13, v15
    v_smfmac_f32_16x16x64_bf16 v[28:31], v[44:47], v[176:183], v2
    v_cvt_pk_bf16_f32 v8, v8, v9
    v_smfmac_f32_16x16x64_bf16 v[32:35], v[44:47], v[192:199], v2
    v_cvt_pk_bf16_f32 v9, v12, v13
    v_smfmac_f32_16x16x64_bf16 v[24:27], v[48:51], v[168:175], v2
    buffer_store_dwordx2 v[8:9], v5, s[60:63], s3 offen sc1
    v_add_f32 v16, v16, v18
    v_smfmac_f32_16x16x64_bf16 v[28:31], v[48:51], v[184:191], v2
    v_add_f32 v17, v17, v19
    v_smfmac_f32_16x16x64_bf16 v[36:39], v[44:47], v[208:215], v2
    v_add_f32 v20, v20, v22
    v_smfmac_f32_16x16x64_bf16 v[40:43], v[44:47], v[224:231], v2
    v_add_f32 v21, v21, v23
    v_smfmac_f32_16x16x64_bf16 v[32:35], v[48:51], v[200:207], v2
    v_cvt_pk_bf16_f32 v16, v16, v17
    v_smfmac_f32_16x16x64_bf16 v[36:39], v[48:51], v[216:223], v2
    v_cvt_pk_bf16_f32 v17, v20, v21
    v_smfmac_f32_16x16x64_bf16 v[40:43], v[48:51], v[232:239], v2
    buffer_store_dwordx2 v[16:17], v5, s[60:63], s4 offen sc1
    v_add_f32 v24, v24, v26
    v_add_f32 v25, v25, v27
    v_add_f32 v28, v28, v30
    v_add_f32 v29, v29, v31
    v_cvt_pk_bf16_f32 v24, v24, v25
    v_cvt_pk_bf16_f32 v25, v28, v29
    buffer_store_dwordx2 v[24:25], v5, s[60:63], s5 offen sc1
    v_pk_add_f32 v[32:33], v[32:33], v[34:35]
    v_pk_add_f32 v[36:37], v[36:37], v[38:39]
    v_cvt_pk_bf16_f32 v32, v32, v33
    v_cvt_pk_bf16_f32 v33, v36, v37
    buffer_store_dwordx2 v[32:33], v5, s[60:63], s6 offen sc1
    v_pk_add_f32 v[40:41], v[40:41], v[42:43]
    v_mov_b64 v[28:29], -1
    v_cvt_pk_bf16_f32 v40, v40, v41
    v_mov_b64 v[30:31], -1
    v_mov_b64 v[8:9], 0
    v_mov_b32_dpp v41, v40 row_ror:8 row_mask:0xf bank_mask:0xf
    s_mov_b64 exec, s[92:93]
    buffer_store_dwordx2 v[40:41], v5, s[60:63], s7 offen sc1
    s_mov_b64 exec, -1
    buffer_load_dwordx4 v[56:59], v0, s[60:63], s70 offen sc1
    buffer_load_dwordx4 v[60:63], v0, s[60:63], s70 offen offset:1024 sc1
    s_waitcnt lgkmcnt(0)
Lpl_74:
    v_max3_u32 v252, v56, v57, v58
    v_max3_u32 v253, v59, v60, v61
    v_max3_u32 v252, v252, v62, v63
    v_max_u32 v252, v252, v253
    v_cmp_le_u32 vcc, -2, v252
    s_add_u32 s74, s74, 1
    s_cbranch_vccz Lrok_73
    v_max3_u32 v252, v56, v57, v58
    v_max3_u32 v253, v59, v60, v61
    v_max3_u32 v252, v252, v62, v63
    v_max_u32 v252, v252, v253
    v_cmp_le_u32 vcc, -2, v252
    s_nop 0
    s_cbranch_vccz Lrok_73
    v_max3_u32 v252, v56, v57, v58
    v_max3_u32 v253, v59, v60, v61
    v_max3_u32 v252, v252, v62, v63
    v_max_u32 v252, v252, v253
    v_cmp_le_u32 vcc, -2, v252
    s_cmp_lt_u32 s74, 0x100000
    s_cbranch_vccz Lrok_73
    buffer_load_dwordx4 v[56:59], v0, s[60:63], s70 offen sc1
    v_mov_b32 v254, 0
    buffer_load_dwordx4 v[60:63], v0, s[60:63], s70 offen offset:1024 sc1
    v_mov_b32 v254, 0
    s_cbranch_scc1 Lpl_74
    s_branch L_fail
Lrok_73:
    v_mfma_f32_16x16x32_bf16 v[252:255], v[248:251], v[56:59], 0
    v_mfma_f32_16x16x32_bf16 v[252:255], v[248:251], v[60:63], v[252:255]
    v_mov_b32 v40, -2
    v_mov_b32 v41, -2
    v_mov_b64 v[42:43], v[40:41]
    v_mov_b64 v[44:45], v[40:41]
    v_mov_b64 v[46:47], v[40:41]
    s_nop 2
    v_add_f32_dpp v254, v252, v252 row_ror:8 row_mask:0xf bank_mask:0xf
    v_add_f32_dpp v255, v253, v253 row_ror:8 row_mask:0xf bank_mask:0xf
    s_nop 0
    v_add_f32_dpp v252, v254, v254 row_ror:4 row_mask:0xf bank_mask:0xf
    v_add_f32_dpp v253, v255, v255 row_ror:4 row_mask:0xf bank_mask:0xf
    s_mov_b64 exec, s[76:77]
    v_cvt_pk_bf16_f32 v252, v252, v253
    buffer_store_dword v252, v6, s[60:63], s75 offen sc1
    buffer_store_dword v28, v6, s[60:63], s72 offen sc1
    s_mov_b64 exec, -1
    v_mov_b64 v[10:11], 0
    v_mov_b64 v[12:13], 0
    v_mov_b64 v[14:15], 0
    v_mov_b64 v[16:17], 0
    v_mov_b64 v[18:19], 0
    v_mov_b64 v[20:21], 0
    v_mov_b64 v[22:23], 0
    v_mov_b64 v[24:25], 0
    v_mov_b64 v[26:27], 0
    s_add_u32 s89, s75, s91
    s_add_u32 s94, s94, 0x80000
    s_add_u32 s95, s95, 0x80000
    s_add_u32 s101, s101, 0x80000
    s_add_u32 s83, s83, 0x10000
    s_add_u32 s84, s84, 0x10000
    v_xor_b32 v5, 0x80000, v5
    s_add_u32 s66, s66, 1
    s_xor_b32 s70, s70, 0x80000
    v_add_u32 v6, s98, v0
    ds_read_b128 v[48:51], v6 offset:12288
    ds_read_b128 v[52:55], v6 offset:13312
    v_mov_b64 v[28:29], 0
    v_mov_b64 v[30:31], 0
    buffer_load_dwordx4 v[40:43], v0, s[60:63], s88 offen sc1
    buffer_load_dwordx4 v[44:47], v0, s[60:63], s88 offen offset:1024 sc1
Lagp_72:
    v_add_u32 v6, s90, v0
Lpl_76:
    v_max3_u32 v252, v40, v41, v42
    v_max3_u32 v253, v43, v44, v45
    v_max3_u32 v252, v252, v46, v47
    v_max_u32 v252, v252, v253
    v_cmp_le_u32 vcc, -2, v252
    s_add_u32 s74, s74, 1
    s_cbranch_vccz LpAok_75
    v_max3_u32 v252, v40, v41, v42
    v_max3_u32 v253, v43, v44, v45
    v_max3_u32 v252, v252, v46, v47
    v_max_u32 v252, v252, v253
    v_cmp_le_u32 vcc, -2, v252
    s_nop 0
    s_cbranch_vccz LpAok_75
    v_max3_u32 v252, v40, v41, v42
    v_max3_u32 v253, v43, v44, v45
    v_max3_u32 v252, v252, v46, v47
    v_max_u32 v252, v252, v253
    v_cmp_le_u32 vcc, -2, v252
    s_cmp_lt_u32 s74, 0x100000
    s_cbranch_vccz LpAok_75
    buffer_load_dwordx4 v[40:43], v0, s[60:63], s88 offen sc1
    v_mov_b32 v254, 0
    buffer_load_dwordx4 v[44:47], v0, s[60:63], s88 offen offset:1024 sc1
    v_mov_b32 v254, 0
    s_cbranch_scc1 Lpl_76
    s_branch L_fail
LpAok_75:
    ds_write_b128 v6, v[40:43] offset:22528
    ds_write_b128 v6, v[44:47] offset:23552
    s_branch Lbar1_66
Lagtop_65:
    buffer_load_dwordx4 v[40:43], v0, s[60:63], s88 offen sc1
    buffer_load_dwordx4 v[44:47], v0, s[60:63], s88 offen offset:1024 sc1
    s_branch Lagp_72
Lpr_67:
    buffer_load_dwordx4 v[44:47], v0, s[60:63], s89 offen sc1
    s_add_u32 s74, s74, 1
    s_cmp_ge_u32 s74, 0x100000
    s_cbranch_scc1 L_fail
    s_waitcnt vmcnt(0)
    v_max3_u32 v6, v44, v45, v46
    v_max_u32 v6, v6, v47
    v_cmp_eq_u32 vcc, -1, v6
    v_add_u32 v6, s91, v0
    s_cbranch_vccnz Lpr_67
    s_branch Lpc_68
Lkv_69:
    buffer_load_dword v6, off, s[56:59], 0 offset:148 sc1
    s_add_u32 s74, s74, 1
    s_cmp_ge_u32 s74, 0x100000
    s_cbranch_scc1 L_fail
    s_waitcnt vmcnt(0)
    v_readfirstlane_b32 s67, v6
    s_cmp_lt_u32 s67, 224
    s_cbranch_scc1 Lkv_69
    s_branch Lkvc_70
Llast_71:
    s_waitcnt vmcnt(0)
    s_barrier
    s_branch L_done
Lwave_62:
    s_branch Lagtop_77
.p2align 3
Lbar1_78:
    s_waitcnt lgkmcnt(0)
    s_barrier
    ds_read_b128 v[32:35], v0 offset:22528
    ds_read_b128 v[36:39], v0 offset:23552
    ds_read_b128 v[248:251], v1 offset:2048
    ds_read_b128 v[252:255], v1 offset:3072
    ds_read_b128 v[56:59], v1 offset:0
    ds_read_b128 v[60:63], v1 offset:1024
    s_waitcnt lgkmcnt(5)
    v_smfmac_f32_16x16x64_bf16 v[8:11], v[32:35], a[0:7], v2
    v_smfmac_f32_16x16x64_bf16 v[12:15], v[32:35], a[8:15], v2
    v_smfmac_f32_16x16x64_bf16 v[24:27], v[32:35], v[240:247], v2
    v_smfmac_f32_16x16x64_bf16 v[16:19], v[32:35], a[144:151], v2
    v_smfmac_f32_16x16x64_bf16 v[20:23], v[32:35], a[152:159], v2
    v_smfmac_f32_16x16x64_bf16 v[28:31], v[32:35], v[48:55], v2
    ds_read_b128 v[48:51], v1 offset:16384
    ds_read_b128 v[52:55], v1 offset:17408
    s_waitcnt lgkmcnt(2)
    v_smfmac_f32_16x16x64_bf16 v[8:11], v[36:39], a[16:23], v2
    s_waitcnt vmcnt(0)
    ds_read_b128 v[40:43], v0 offset:24576
    v_smfmac_f32_16x16x64_bf16 v[12:15], v[36:39], a[24:31], v2
    ds_read_b128 v[32:35], v0 offset:25600
    buffer_load_dwordx4 v[44:47], v0, s[60:63], s89 offen sc1
    v_smfmac_f32_16x16x64_bf16 v[24:27], v[36:39], v[56:63], v2
    ds_read_b128 v[56:59], v1 offset:18432
    ds_read_b128 v[60:63], v1 offset:19456
    v_smfmac_f32_16x16x64_bf16 v[16:19], v[36:39], a[160:167], v2
    s_mov_b32 m0, s96
    v_smfmac_f32_16x16x64_bf16 v[20:23], v[36:39], a[168:175], v2
    buffer_load_dwordx4 v0, s[60:63], s94 offen sc1 lds
    v_smfmac_f32_16x16x64_bf16 v[28:31], v[36:39], v[248:255], v2
    ds_read_b128 v[248:251], v1 offset:32768
    ds_read_b128 v[252:255], v1 offset:33792
    s_waitcnt lgkmcnt(5)
    v_smfmac_f32_16x16x64_bf16 v[8:11], v[40:43], a[32:39], v2
    ds_read_b128 v[36:39], v0 offset:26624
    v_smfmac_f32_16x16x64_bf16 v[12:15], v[40:43], a[40:47], v2
    buffer_load_dwordx4 v0, s[60:63], s94 offen offset:1024 sc1 lds
    v_smfmac_f32_16x16x64_bf16 v[24:27], v[40:43], v[48:55], v2
    ds_read_b128 v[48:51], v1 offset:34816
    ds_read_b128 v[52:55], v1 offset:35840
    v_smfmac_f32_16x16x64_bf16 v[16:19], v[40:43], a[176:183], v2
    v_smfmac_f32_16x16x64_bf16 v[20:23], v[40:43], a[184:191], v2
    s_waitcnt lgkmcnt(5)
    v_smfmac_f32_16x16x64_bf16 v[28:31], v[40:43], v[56:63], v2
    ds_read_b128 v[56:59], v1 offset:49152
    ds_read_b128 v[60:63], v1 offset:50176
    v_smfmac_f32_16x16x64_bf16 v[8:11], v[32:35], a[48:55], v2
    ds_read_b128 v[40:43], v0 offset:27648
    v_smfmac_f32_16x16x64_bf16 v[12:15], v[32:35], a[56:63], v2
    s_waitcnt lgkmcnt(5)
    v_smfmac_f32_16x16x64_bf16 v[24:27], v[32:35], v[248:255], v2
    ds_read_b128 v[248:251], v1 offset:51200
    ds_read_b128 v[252:255], v1 offset:52224
    v_smfmac_f32_16x16x64_bf16 v[16:19], v[32:35], a[192:199], v2
    s_waitcnt vmcnt(2)
    v_max3_u32 v6, v44, v45, v46
    v_smfmac_f32_16x16x64_bf16 v[20:23], v[32:35], a[200:207], v2
    v_add_u32 v1, 0x10000, v1
    s_waitcnt lgkmcnt(5)
    v_smfmac_f32_16x16x64_bf16 v[28:31], v[32:35], v[48:55], v2
    ds_read_b128 v[48:51], v1 offset:0
    ds_read_b128 v[52:55], v1 offset:1024
    v_smfmac_f32_16x16x64_bf16 v[8:11], v[36:39], a[64:71], v2
    v_max_u32 v6, v6, v47
    v_smfmac_f32_16x16x64_bf16 v[12:15], v[36:39], a[72:79], v2
    v_cmp_eq_u32 vcc, -1, v6
    s_waitcnt lgkmcnt(4)
    v_smfmac_f32_16x16x64_bf16 v[24:27], v[36:39], v[56:63], v2
    ds_read_b128 v[56:59], v1 offset:2048
    ds_read_b128 v[60:63], v1 offset:3072
    v_smfmac_f32_16x16x64_bf16 v[16:19], v[36:39], a[208:215], v2
    v_add_u32 v6, s91, v0
    s_cbranch_vccnz Lpr_79
Lpc_80:
    ds_write_b128 v6, v[44:47] offset:22528
    v_smfmac_f32_16x16x64_bf16 v[20:23], v[36:39], a[216:223], v2
    s_waitcnt lgkmcnt(5)
    v_smfmac_f32_16x16x64_bf16 v[28:31], v[36:39], v[248:255], v2
    ds_read_b128 v[248:251], v1 offset:16384
    ds_read_b128 v[252:255], v1 offset:17408
    v_smfmac_f32_16x16x64_bf16 v[8:11], v[40:43], a[80:87], v2
    s_mov_b32 m0, s97
    v_smfmac_f32_16x16x64_bf16 v[12:15], v[40:43], a[88:95], v2
    s_waitcnt lgkmcnt(2)
    s_waitcnt vmcnt(0)
    s_barrier
    ds_read_b128 v[32:35], v0 offset:28672
    ds_read_b128 v[36:39], v0 offset:29696
    v_smfmac_f32_16x16x64_bf16 v[24:27], v[40:43], v[48:55], v2
    ds_read_b128 v[48:51], v1 offset:18432
    ds_read_b128 v[52:55], v1 offset:19456
    s_cmp_eq_u32 s66, 30
    s_cbranch_scc1 Lkv_81
Lkvc_82:
    v_smfmac_f32_16x16x64_bf16 v[16:19], v[40:43], a[224:231], v2
    ds_read_b128 v[44:47], v0 offset:30720
    buffer_load_dwordx4 v0, s[60:63], s95 offen sc1 lds
    v_smfmac_f32_16x16x64_bf16 v[20:23], v[40:43], a[232:239], v2
    buffer_load_dwordx4 v0, s[60:63], s95 offen offset:1024 sc1 lds
    v_smfmac_f32_16x16x64_bf16 v[28:31], v[40:43], v[56:63], v2
    ds_read_b128 v[56:59], v1 offset:32768
    ds_read_b128 v[60:63], v1 offset:33792
    s_waitcnt lgkmcnt(6)
    v_smfmac_f32_16x16x64_bf16 v[8:11], v[32:35], a[96:103], v2
    s_mov_b32 m0, 0x7d00
    v_lshlrev_b32 v6, 2, v0
    v_smfmac_f32_16x16x64_bf16 v[12:15], v[32:35], a[104:111], v2
    v_smfmac_f32_16x16x64_bf16 v[16:19], v[32:35], a[240:247], v2
    s_waitcnt lgkmcnt(3)
    v_smfmac_f32_16x16x64_bf16 v[8:11], v[36:39], a[112:119], v2
    buffer_load_dword v6, s[60:63], s101 offen sc1 lds
    v_smfmac_f32_16x16x64_bf16 v[12:15], v[36:39], a[120:127], v2
    v_smfmac_f32_16x16x64_bf16 v[20:23], v[32:35], a[248:255], v2
    s_waitcnt lgkmcnt(0)
    v_smfmac_f32_16x16x64_bf16 v[8:11], v[44:47], a[128:135], v2
    v_smfmac_f32_16x16x64_bf16 v[12:15], v[44:47], a[136:143], v2
    v_and_b32 v6, 0xffff, v3
    v_smfmac_f32_16x16x64_bf16 v[24:27], v[32:35], v[248:255], v2
    ds_read_b128 v[248:251], v1 offset:34816
    ds_read_b128 v[252:255], v1 offset:35840
    v_smfmac_f32_16x16x64_bf16 v[16:19], v[36:39], v[64:71], v2
    v_add_f32 v8, v8, v10
    v_add_f32 v9, v9, v11
    v_smfmac_f32_16x16x64_bf16 v[20:23], v[36:39], v[72:79], v2
    v_add_f32 v12, v12, v14
    v_add_f32 v13, v13, v15
    v_smfmac_f32_16x16x64_bf16 v[28:31], v[32:35], v[48:55], v2
    ds_read_b128 v[48:51], v1 offset:49152
    ds_read_b128 v[52:55], v1 offset:50176
    v_cvt_pk_bf16_f32 v8, v8, v9
    v_smfmac_f32_16x16x64_bf16 v[16:19], v[44:47], v[80:87], v2
    v_cvt_pk_bf16_f32 v9, v12, v13
    ds_write2_b32 v6, v8, v9 offset0:0 offset1:64
    v_smfmac_f32_16x16x64_bf16 v[20:23], v[44:47], v[88:95], v2
    ds_read_b128 v[8:11], v1 offset:51200
    ds_read_b128 v[12:15], v1 offset:52224
    v_smfmac_f32_16x16x64_bf16 v[24:27], v[36:39], v[56:63], v2
    ds_read_b128 v[56:59], v0 offset:4096
    ds_read_b128 v[60:63], v0 offset:8192
    s_waitcnt lgkmcnt(7)
    v_smfmac_f32_16x16x64_bf16 v[28:31], v[36:39], v[248:255], v2
    v_add_f32 v16, v16, v18
    v_add_f32 v17, v17, v19
    v_add_f32 v20, v20, v22
    v_add_f32 v21, v21, v23
    v_cvt_pk_bf16_f32 v16, v16, v17
    v_cvt_pk_bf16_f32 v17, v20, v21
    v_add_u32 v18, 2048, v6
    ds_write2_b32 v18, v16, v17 offset0:0 offset1:64
    s_waitcnt lgkmcnt(6)
    v_smfmac_f32_16x16x64_bf16 v[24:27], v[44:47], v[48:55], v2
    ds_read_b128 v[248:251], v0 offset:5120
    ds_read_b128 v[252:255], v0 offset:9216
    v_lshrrev_b32 v3, 16, v3
    s_waitcnt lgkmcnt(5)
    v_smfmac_f32_16x16x64_bf16 v[28:31], v[44:47], v[8:15], v2
    v_lshrrev_b32 v18, 1, v0
    buffer_store_dwordx2 v[16:17], v18, s[60:63], s83 offen sc1
    s_nop 0
    v_add_f32 v24, v24, v26
    v_add_f32 v25, v25, v27
    s_waitcnt lgkmcnt(2)
    s_barrier
    ds_read_b64_tr_b16 v[32:33], v3 offset:0
    ds_read_b64_tr_b16 v[34:35], v3 offset:256
    ds_read_b64_tr_b16 v[40:41], v3 offset:512
    ds_read_b64_tr_b16 v[42:43], v3 offset:768
    v_add_f32 v28, v28, v30
    ds_read_b128 v[48:51], v0 offset:6144
    ds_read_b128 v[52:55], v0 offset:10240
    v_add_f32 v29, v29, v31
    ds_read_b64_tr_b16 v[36:37], v3 offset:1024
    ds_read_b64_tr_b16 v[38:39], v3 offset:1280
    v_cvt_pk_bf16_f32 v24, v24, v25
    s_waitcnt lgkmcnt(6)
    v_mfma_f32_16x16x32_bf16 v[16:19], v[56:59], v[32:35], 0
    ds_read_b64_tr_b16 v[44:45], v3 offset:1536
    ds_read_b64_tr_b16 v[46:47], v3 offset:1792
    v_mfma_f32_16x16x32_bf16 v[20:23], v[60:63], v[32:35], 0
    ds_read_b128 v[8:11], v0 offset:7168
    ds_read_b128 v[12:15], v0 offset:11264
    s_waitcnt lgkmcnt(8)
    v_mfma_f32_16x16x32_bf16 v[16:19], v[248:251], v[40:43], v[16:19]
    ds_read_b64_tr_b16 v[56:57], v7 offset:0
    ds_read_b64_tr_b16 v[58:59], v7 offset:256
    v_mfma_f32_16x16x32_bf16 v[20:23], v[252:255], v[40:43], v[20:23]
    ds_read_b64_tr_b16 v[60:61], v7 offset:512
    ds_read_b64_tr_b16 v[62:63], v7 offset:768
    s_waitcnt lgkmcnt(8)
    v_mfma_f32_16x16x32_bf16 v[16:19], v[48:51], v[36:39], v[16:19]
    ds_read_b64_tr_b16 v[248:249], v7 offset:1024
    ds_read_b64_tr_b16 v[250:251], v7 offset:1280
    v_mfma_f32_16x16x32_bf16 v[20:23], v[52:55], v[36:39], v[20:23]
    ds_read_b64_tr_b16 v[252:253], v7 offset:1536
    ds_read_b64_tr_b16 v[254:255], v7 offset:1792
    s_waitcnt lgkmcnt(8)
    v_mfma_f32_16x16x32_bf16 v[16:19], v[8:11], v[44:47], v[16:19]
    v_cvt_pk_bf16_f32 v25, v28, v29
    v_lshl_or_b32 v3, v3, 16, v6
    v_mfma_f32_16x16x32_bf16 v[20:23], v[12:15], v[44:47], v[20:23]
    v_add_u32 v6, s98, v0
    v_lshrrev_b32 v26, 1, v0
    s_waitcnt lgkmcnt(6)
    v_mfma_f32_16x16x32_bf16 v[28:31], v[56:59], v[32:35], 0
    buffer_store_dwordx2 v[24:25], v26, s[60:63], s84 offen sc1
    s_cmp_eq_u32 s66, 63
    s_waitcnt lgkmcnt(4)
    v_mfma_f32_16x16x32_bf16 v[28:31], v[60:63], v[40:43], v[28:31]
    s_cbranch_scc1 Llast_83
    s_waitcnt vmcnt(3)
    s_waitcnt lgkmcnt(2)
    v_mfma_f32_16x16x32_bf16 v[28:31], v[248:251], v[36:39], v[28:31]
    ds_read_b128 v[48:51], v6 offset:20480
    ds_read_b128 v[52:55], v6 offset:21504
    s_waitcnt lgkmcnt(2)
    v_mfma_f32_16x16x32_bf16 v[28:31], v[252:255], v[44:47], v[28:31]
    v_cndmask_b32 v8, v20, v16, s[92:93]
    v_cndmask_b32 v9, v21, v17, s[92:93]
    v_cndmask_b32 v10, v22, v18, s[92:93]
    v_cndmask_b32 v11, v23, v19, s[92:93]
    v_max3_f32 v12, v8, v9, v10
    v_mov_b64 v[20:21], -1
    v_max_f32 v12, v12, v11
    v_mov_b64 v[22:23], -1
    v_cndmask_b32 v16, v28, v30, s[78:79]
    v_cndmask_b32 v17, v29, v31, s[78:79]
    v_max3_f32 v12, v12, v16, v17
    s_xor_b32 s67, s70, 0x80000
    buffer_store_dwordx4 v[20:23], v0, s[60:63], s67 offen sc1
    v_max_f32_dpp v13, v12, v12 row_ror:8 row_mask:0xf bank_mask:0xf
    v_max_f32_dpp v12, v12, v12 row_ror:8 row_mask:0xf bank_mask:0xf
    v_mov_b32 v40, 0x3f803f80
    v_mov_b32 v41, 0x3f803f80
    v_permlane16_swap_b32 v12, v13
    v_max_f32 v14, v12, v13
    v_max_f32 v12, v12, v13
    v_mov_b64 v[42:43], v[40:41]
    v_mov_b32 v37, 0
    v_permlane32_swap_b32 v12, v14
    v_max_f32 v12, v12, v14
    v_mul_f32 v12, s80, v12
    v_fma_f32 v8, v8, s80, -v12
    v_fma_f32 v9, v9, s80, -v12
    v_exp_f32 v8, v8
    v_exp_f32 v9, v9
    v_fma_f32 v10, v10, s80, -v12
    v_fma_f32 v11, v11, s80, -v12
    v_cvt_pk_bf16_f32 v32, v8, v9
    v_exp_f32 v10, v10
    v_exp_f32 v11, v11
    v_mov_b32_dpp v34, v32 row_ror:8 row_mask:0xf bank_mask:0xf
    v_cvt_pk_bf16_f32 v33, v10, v11
    v_fma_f32 v16, v16, s80, -v12
    v_fma_f32 v17, v17, s80, -v12
    v_mov_b32_dpp v35, v33 row_ror:8 row_mask:0xf bank_mask:0xf
    v_exp_f32 v16, v16
    s_waitcnt lgkmcnt(0)
    v_mfma_f32_16x16x32_bf16 v[56:59], v[40:43], v[32:35], 0
    v_exp_f32 v17, v17
    v_mfma_f32_16x16x32_bf16 v[248:251], v[48:51], v[32:35], 0
    v_mov_b32 v38, 0
    v_cvt_pk_bf16_f32 v36, v16, v17
    v_mfma_f32_16x16x32_bf16 v[252:255], v[52:55], v[32:35], 0
    v_cvt_pk_bf16_f32 v39, v16, v17
    v_lshrrev_b32 v6, 16, v2
    v_mfma_f32_16x16x16_bf16 v[56:59], v[40:41], v[36:37], v[56:59]
    v_mov_b64 v[8:9], 0
    v_mov_b64 v[10:11], 0
    v_mfma_f32_16x16x16_bf16 v[248:251], v[24:25], v[36:37], v[248:251]
    v_mov_b64 v[12:13], 0
    v_mov_b64 v[14:15], 0
    v_mfma_f32_16x16x16_bf16 v[252:255], v[24:25], v[38:39], v[252:255]
    buffer_store_dwordx4 v[20:23], v0, s[60:63], s67 offen offset:1024 sc1
    v_rcp_f32 v56, v56
    v_mov_b64 v[16:17], 0
    s_nop 0
    v_mul_f32 v248, v248, v56
    v_mul_f32 v249, v249, v56
    v_cvt_pk_bf16_f32 v44, v248, v249
    v_mul_f32 v250, v250, v56
    v_mul_f32 v251, v251, v56
    v_cvt_pk_bf16_f32 v45, v250, v251
    v_mul_f32 v252, v252, v56
    v_mul_f32 v253, v253, v56
    v_cvt_pk_bf16_f32 v46, v252, v253
    v_mul_f32 v254, v254, v56
    v_mul_f32 v255, v255, v56
    v_cvt_pk_bf16_f32 v47, v254, v255
    s_mov_b64 exec, s[92:93]
    ds_write_b128 v6, v[44:47]
    s_mov_b64 exec, -1
    v_mov_b64 v[18:19], 0
    v_mov_b64 v[20:21], 0
    v_mov_b64 v[22:23], 0
    v_mov_b64 v[24:25], 0
    v_mov_b64 v[26:27], 0
    v_and_b32 v6, 0xf0, v0
    v_mov_b32 v56, -2
    v_mov_b32 v57, -2
    v_mov_b64 v[58:59], v[56:57]
    v_mov_b64 v[60:61], v[56:57]
    v_mov_b64 v[62:63], v[56:57]
    s_waitcnt lgkmcnt(0)
    s_barrier
    ds_read_b128 v[44:47], v0 offset:28672
    ds_read_b128 v[48:51], v0 offset:29696
    ds_read_b128 v[248:251], v6 offset:31744
    v_mov_b64 v[28:29], 0
    v_mov_b64 v[30:31], 0
    v_mov_b64 v[32:33], 0
    v_mov_b64 v[34:35], 0
    v_mov_b64 v[36:37], 0
    v_mov_b64 v[38:39], 0
    v_mov_b64 v[40:41], 0
    v_mov_b64 v[42:43], 0
    s_waitcnt lgkmcnt(2)
    v_smfmac_f32_16x16x64_bf16 v[8:11], v[44:47], v[96:103], v2
    s_mov_b32 s72, s75
    v_subrev_u32 v1, 0x10000, v1
    v_smfmac_f32_16x16x64_bf16 v[12:15], v[44:47], v[112:119], v2
    s_add_u32 s75, s75, 16384
    v_and_b32 v6, 0xffff, v4
    v_smfmac_f32_16x16x64_bf16 v[16:19], v[44:47], v[128:135], v2
    s_and_b32 s75, s75, 0xfffeffff
    s_waitcnt lgkmcnt(1)
    v_smfmac_f32_16x16x64_bf16 v[8:11], v[48:51], v[104:111], v2
    s_add_u32 s88, s75, s90
    v_smfmac_f32_16x16x64_bf16 v[12:15], v[48:51], v[120:127], v2
    v_smfmac_f32_16x16x64_bf16 v[20:23], v[44:47], v[144:151], v2
    v_add_f32 v8, v8, v10
    v_smfmac_f32_16x16x64_bf16 v[16:19], v[48:51], v[136:143], v2
    v_add_f32 v9, v9, v11
    v_smfmac_f32_16x16x64_bf16 v[20:23], v[48:51], v[152:159], v2
    v_add_f32 v12, v12, v14
    v_smfmac_f32_16x16x64_bf16 v[24:27], v[44:47], v[160:167], v2
    v_add_f32 v13, v13, v15
    v_smfmac_f32_16x16x64_bf16 v[28:31], v[44:47], v[176:183], v2
    v_cvt_pk_bf16_f32 v8, v8, v9
    v_smfmac_f32_16x16x64_bf16 v[32:35], v[44:47], v[192:199], v2
    v_cvt_pk_bf16_f32 v9, v12, v13
    v_smfmac_f32_16x16x64_bf16 v[24:27], v[48:51], v[168:175], v2
    buffer_store_dwordx2 v[8:9], v5, s[60:63], s3 offen sc1
    v_add_f32 v16, v16, v18
    v_smfmac_f32_16x16x64_bf16 v[28:31], v[48:51], v[184:191], v2
    v_add_f32 v17, v17, v19
    v_smfmac_f32_16x16x64_bf16 v[36:39], v[44:47], v[208:215], v2
    v_add_f32 v20, v20, v22
    v_smfmac_f32_16x16x64_bf16 v[40:43], v[44:47], v[224:231], v2
    v_add_f32 v21, v21, v23
    v_smfmac_f32_16x16x64_bf16 v[32:35], v[48:51], v[200:207], v2
    v_cvt_pk_bf16_f32 v16, v16, v17
    v_smfmac_f32_16x16x64_bf16 v[36:39], v[48:51], v[216:223], v2
    v_cvt_pk_bf16_f32 v17, v20, v21
    v_smfmac_f32_16x16x64_bf16 v[40:43], v[48:51], v[232:239], v2
    buffer_store_dwordx2 v[16:17], v5, s[60:63], s4 offen sc1
    v_add_f32 v24, v24, v26
    v_add_f32 v25, v25, v27
    v_add_f32 v28, v28, v30
    v_add_f32 v29, v29, v31
    v_cvt_pk_bf16_f32 v24, v24, v25
    v_cvt_pk_bf16_f32 v25, v28, v29
    buffer_store_dwordx2 v[24:25], v5, s[60:63], s5 offen sc1
    v_pk_add_f32 v[32:33], v[32:33], v[34:35]
    v_pk_add_f32 v[36:37], v[36:37], v[38:39]
    v_cvt_pk_bf16_f32 v32, v32, v33
    v_cvt_pk_bf16_f32 v33, v36, v37
    buffer_store_dwordx2 v[32:33], v5, s[60:63], s6 offen sc1
    v_pk_add_f32 v[40:41], v[40:41], v[42:43]
    v_mov_b64 v[28:29], -1
    v_cvt_pk_bf16_f32 v40, v40, v41
    v_mov_b64 v[30:31], -1
    v_mov_b64 v[8:9], 0
    v_mov_b32_dpp v41, v40 row_ror:8 row_mask:0xf bank_mask:0xf
    s_mov_b64 exec, s[92:93]
    buffer_store_dwordx2 v[40:41], v5, s[60:63], s7 offen sc1
    s_mov_b64 exec, -1
    s_waitcnt lgkmcnt(0)
    v_mov_b64 v[10:11], 0
    v_mov_b64 v[12:13], 0
    v_mov_b64 v[14:15], 0
    v_mov_b64 v[16:17], 0
    v_mov_b64 v[18:19], 0
    buffer_load_dwordx4 v[56:59], v0, s[60:63], s70 offen sc1
    buffer_load_dwordx4 v[60:63], v0, s[60:63], s70 offen offset:1024 sc1
Lpl_86:
    v_max3_u32 v252, v56, v57, v58
    v_max3_u32 v253, v59, v60, v61
    v_max3_u32 v252, v252, v62, v63
    v_max_u32 v252, v252, v253
    v_cmp_le_u32 vcc, -2, v252
    s_add_u32 s74, s74, 1
    s_cbranch_vccz Lrok_85
    v_max3_u32 v252, v56, v57, v58
    v_max3_u32 v253, v59, v60, v61
    v_max3_u32 v252, v252, v62, v63
    v_max_u32 v252, v252, v253
    v_cmp_le_u32 vcc, -2, v252
    s_nop 0
    s_cbranch_vccz Lrok_85
    v_max3_u32 v252, v56, v57, v58
    v_max3_u32 v253, v59, v60, v61
    v_max3_u32 v252, v252, v62, v63
    v_max_u32 v252, v252, v253
    v_cmp_le_u32 vcc, -2, v252
    s_cmp_lt_u32 s74, 0x100000
    s_cbranch_vccz Lrok_85
    buffer_load_dwordx4 v[56:59], v0, s[60:63], s70 offen sc1
    v_mov_b32 v254, 0
    buffer_load_dwordx4 v[60:63], v0, s[60:63], s70 offen offset:1024 sc1
    v_mov_b32 v254, 0
    s_cbranch_scc1 Lpl_86
    s_branch L_fail
Lrok_85:
    v_mfma_f32_16x16x32_bf16 v[252:255], v[248:251], v[56:59], 0
    v_mfma_f32_16x16x32_bf16 v[252:255], v[248:251], v[60:63], v[252:255]
    v_mov_b32 v40, -2
    v_mov_b32 v41, -2
    v_mov_b64 v[42:43], v[40:41]
    v_mov_b64 v[44:45], v[40:41]
    v_mov_b64 v[46:47], v[40:41]
    s_nop 2
    v_add_f32_dpp v254, v252, v252 row_ror:8 row_mask:0xf bank_mask:0xf
    v_add_f32_dpp v255, v253, v253 row_ror:8 row_mask:0xf bank_mask:0xf
    s_nop 0
    v_add_f32_dpp v252, v254, v254 row_ror:4 row_mask:0xf bank_mask:0xf
    v_add_f32_dpp v253, v255, v255 row_ror:4 row_mask:0xf bank_mask:0xf
    s_mov_b64 exec, s[76:77]
    v_cvt_pk_bf16_f32 v252, v252, v253
    buffer_store_dword v252, v6, s[60:63], s75 offen sc1
    buffer_store_dword v28, v6, s[60:63], s72 offen sc1
    s_mov_b64 exec, -1
    v_mov_b64 v[20:21], 0
    v_mov_b64 v[22:23], 0
    v_mov_b64 v[24:25], 0
    v_mov_b64 v[26:27], 0
    s_add_u32 s89, s75, s91
    s_add_u32 s94, s94, 0x80000
    s_add_u32 s95, s95, 0x80000
    s_add_u32 s101, s101, 0x80000
    s_add_u32 s83, s83, 0x10000
    s_add_u32 s84, s84, 0x10000
    v_xor_b32 v5, 0x80000, v5
    s_add_u32 s66, s66, 1
    s_xor_b32 s70, s70, 0x80000
    v_add_u32 v6, s98, v0
    ds_read_b128 v[48:51], v6 offset:12288
    ds_read_b128 v[52:55], v6 offset:13312
    v_mov_b64 v[28:29], 0
    v_mov_b64 v[30:31], 0
    buffer_load_dwordx4 v[40:43], v0, s[60:63], s88 offen sc1
    buffer_load_dwordx4 v[44:47], v0, s[60:63], s88 offen offset:1024 sc1
Lagp_84:
    v_add_u32 v6, s90, v0
Lpl_88:
    v_max3_u32 v252, v40, v41, v42
    v_max3_u32 v253, v43, v44, v45
    v_max3_u32 v252, v252, v46, v47
    v_max_u32 v252, v252, v253
    v_cmp_le_u32 vcc, -2, v252
    s_add_u32 s74, s74, 1
    s_cbranch_vccz LpAok_87
    v_max3_u32 v252, v40, v41, v42
    v_max3_u32 v253, v43, v44, v45
    v_max3_u32 v252, v252, v46, v47
    v_max_u32 v252, v252, v253
    v_cmp_le_u32 vcc, -2, v252
    s_nop 0
    s_cbranch_vccz LpAok_87
    v_max3_u32 v252, v40, v41, v42
    v_max3_u32 v253, v43, v44, v45
    v_max3_u32 v252, v252, v46, v47
    v_max_u32 v252, v252, v253
    v_cmp_le_u32 vcc, -2, v252
    s_cmp_lt_u32 s74, 0x100000
    s_cbranch_vccz LpAok_87
    buffer_load_dwordx4 v[40:43], v0, s[60:63], s88 offen sc1
    v_mov_b32 v254, 0
    buffer_load_dwordx4 v[44:47], v0, s[60:63], s88 offen offset:1024 sc1
    v_mov_b32 v254, 0
    s_cbranch_scc1 Lpl_88
    s_branch L_fail
LpAok_87:
    ds_write_b128 v6, v[40:43] offset:22528
    ds_write_b128 v6, v[44:47] offset:23552
    s_branch Lbar1_78
Lagtop_77:
    buffer_load_dwordx4 v[40:43], v0, s[60:63], s88 offen sc1
    buffer_load_dwordx4 v[44:47], v0, s[60:63], s88 offen offset:1024 sc1
    s_branch Lagp_84
Lpr_79:
    buffer_load_dwordx4 v[44:47], v0, s[60:63], s89 offen sc1
    s_add_u32 s74, s74, 1
    s_cmp_ge_u32 s74, 0x100000
    s_cbranch_scc1 L_fail
    s_waitcnt vmcnt(0)
    v_max3_u32 v6, v44, v45, v46
    v_max_u32 v6, v6, v47
    v_cmp_eq_u32 vcc, -1, v6
    v_add_u32 v6, s91, v0
    s_cbranch_vccnz Lpr_79
    s_branch Lpc_80
Lkv_81:
    buffer_load_dword v6, off, s[56:59], 0 offset:148 sc1
    s_add_u32 s74, s74, 1
    s_cmp_ge_u32 s74, 0x100000
    s_cbranch_scc1 L_fail
    s_waitcnt vmcnt(0)
    v_readfirstlane_b32 s67, v6
    s_cmp_lt_u32 s67, 224
    s_cbranch_scc1 Lkv_81
    s_branch Lkvc_82
Llast_83:
    s_waitcnt vmcnt(0)
    s_barrier
    s_branch L_done
Lwave_63:
    s_branch Lagtop_89
.p2align 3
Lbar1_90:
    s_waitcnt lgkmcnt(0)
    s_barrier
    ds_read_b128 v[32:35], v0 offset:22528
    ds_read_b128 v[36:39], v0 offset:23552
    ds_read_b128 v[248:251], v1 offset:2048
    ds_read_b128 v[252:255], v1 offset:3072
    ds_read_b128 v[56:59], v1 offset:0
    ds_read_b128 v[60:63], v1 offset:1024
    s_waitcnt lgkmcnt(5)
    v_smfmac_f32_16x16x64_bf16 v[8:11], v[32:35], a[0:7], v2
    v_smfmac_f32_16x16x64_bf16 v[12:15], v[32:35], a[8:15], v2
    v_smfmac_f32_16x16x64_bf16 v[24:27], v[32:35], v[240:247], v2
    v_smfmac_f32_16x16x64_bf16 v[16:19], v[32:35], a[144:151], v2
    v_smfmac_f32_16x16x64_bf16 v[20:23], v[32:35], a[152:159], v2
    v_smfmac_f32_16x16x64_bf16 v[28:31], v[32:35], v[48:55], v2
    ds_read_b128 v[48:51], v1 offset:16384
    ds_read_b128 v[52:55], v1 offset:17408
    s_waitcnt lgkmcnt(2)
    v_smfmac_f32_16x16x64_bf16 v[8:11], v[36:39], a[16:23], v2
    s_waitcnt vmcnt(0)
    ds_read_b128 v[40:43], v0 offset:24576
    v_smfmac_f32_16x16x64_bf16 v[12:15], v[36:39], a[24:31], v2
    ds_read_b128 v[32:35], v0 offset:25600
    buffer_load_dwordx4 v[44:47], v0, s[60:63], s89 offen sc1
    v_smfmac_f32_16x16x64_bf16 v[24:27], v[36:39], v[56:63], v2
    ds_read_b128 v[56:59], v1 offset:18432
    ds_read_b128 v[60:63], v1 offset:19456
    v_smfmac_f32_16x16x64_bf16 v[16:19], v[36:39], a[160:167], v2
    s_mov_b32 m0, s96
    v_smfmac_f32_16x16x64_bf16 v[20:23], v[36:39], a[168:175], v2
    buffer_load_dwordx4 v0, s[60:63], s94 offen sc1 lds
    v_smfmac_f32_16x16x64_bf16 v[28:31], v[36:39], v[248:255], v2
    ds_read_b128 v[248:251], v1 offset:32768
    ds_read_b128 v[252:255], v1 offset:33792
    s_waitcnt lgkmcnt(5)
    v_smfmac_f32_16x16x64_bf16 v[8:11], v[40:43], a[32:39], v2
    ds_read_b128 v[36:39], v0 offset:26624
    v_smfmac_f32_16x16x64_bf16 v[12:15], v[40:43], a[40:47], v2
    buffer_load_dwordx4 v0, s[60:63], s94 offen offset:1024 sc1 lds
    v_smfmac_f32_16x16x64_bf16 v[24:27], v[40:43], v[48:55], v2
    ds_read_b128 v[48:51], v1 offset:34816
    ds_read_b128 v[52:55], v1 offset:35840
    v_smfmac_f32_16x16x64_bf16 v[16:19], v[40:43], a[176:183], v2
    v_smfmac_f32_16x16x64_bf16 v[20:23], v[40:43], a[184:191], v2
    s_waitcnt lgkmcnt(5)
    v_smfmac_f32_16x16x64_bf16 v[28:31], v[40:43], v[56:63], v2
    ds_read_b128 v[56:59], v1 offset:49152
    ds_read_b128 v[60:63], v1 offset:50176
    v_smfmac_f32_16x16x64_bf16 v[8:11], v[32:35], a[48:55], v2
    ds_read_b128 v[40:43], v0 offset:27648
    v_smfmac_f32_16x16x64_bf16 v[12:15], v[32:35], a[56:63], v2
    s_waitcnt lgkmcnt(5)
    v_smfmac_f32_16x16x64_bf16 v[24:27], v[32:35], v[248:255], v2
    ds_read_b128 v[248:251], v1 offset:51200
    ds_read_b128 v[252:255], v1 offset:52224
    v_smfmac_f32_16x16x64_bf16 v[16:19], v[32:35], a[192:199], v2
    s_waitcnt vmcnt(2)
    v_max3_u32 v6, v44, v45, v46
    v_smfmac_f32_16x16x64_bf16 v[20:23], v[32:35], a[200:207], v2
    v_add_u32 v1, 0x10000, v1
    s_waitcnt lgkmcnt(5)
    v_smfmac_f32_16x16x64_bf16 v[28:31], v[32:35], v[48:55], v2
    ds_read_b128 v[48:51], v1 offset:0
    ds_read_b128 v[52:55], v1 offset:1024
    v_smfmac_f32_16x16x64_bf16 v[8:11], v[36:39], a[64:71], v2
    v_max_u32 v6, v6, v47
    v_smfmac_f32_16x16x64_bf16 v[12:15], v[36:39], a[72:79], v2
    v_cmp_eq_u32 vcc, -1, v6
    s_waitcnt lgkmcnt(4)
    v_smfmac_f32_16x16x64_bf16 v[24:27], v[36:39], v[56:63], v2
    ds_read_b128 v[56:59], v1 offset:2048
    ds_read_b128 v[60:63], v1 offset:3072
    v_smfmac_f32_16x16x64_bf16 v[16:19], v[36:39], a[208:215], v2
    v_add_u32 v6, s91, v0
    s_cbranch_vccnz Lpr_91
Lpc_92:
    ds_write_b128 v6, v[44:47] offset:22528
    v_smfmac_f32_16x16x64_bf16 v[20:23], v[36:39], a[216:223], v2
    s_waitcnt lgkmcnt(5)
    v_smfmac_f32_16x16x64_bf16 v[28:31], v[36:39], v[248:255], v2
    ds_read_b128 v[248:251], v1 offset:16384
    ds_read_b128 v[252:255], v1 offset:17408
    v_smfmac_f32_16x16x64_bf16 v[8:11], v[40:43], a[80:87], v2
    s_mov_b32 m0, s97
    v_smfmac_f32_16x16x64_bf16 v[12:15], v[40:43], a[88:95], v2
    s_waitcnt lgkmcnt(2)
    s_waitcnt vmcnt(0)
    s_barrier
    ds_read_b128 v[32:35], v0 offset:28672
    ds_read_b128 v[36:39], v0 offset:29696
    v_smfmac_f32_16x16x64_bf16 v[24:27], v[40:43], v[48:55], v2
    ds_read_b128 v[48:51], v1 offset:18432
    ds_read_b128 v[52:55], v1 offset:19456
    s_cmp_eq_u32 s66, 30
    s_cbranch_scc1 Lkv_93
Lkvc_94:
    v_smfmac_f32_16x16x64_bf16 v[16:19], v[40:43], a[224:231], v2
    ds_read_b128 v[44:47], v0 offset:30720
    buffer_load_dwordx4 v0, s[60:63], s95 offen sc1 lds
    v_smfmac_f32_16x16x64_bf16 v[20:23], v[40:43], a[232:239], v2
    buffer_load_dwordx4 v0, s[60:63], s95 offen offset:1024 sc1 lds
    v_smfmac_f32_16x16x64_bf16 v[28:31], v[40:43], v[56:63], v2
    ds_read_b128 v[56:59], v1 offset:32768
    ds_read_b128 v[60:63], v1 offset:33792
    s_waitcnt lgkmcnt(6)
    v_smfmac_f32_16x16x64_bf16 v[8:11], v[32:35], a[96:103], v2
    s_mov_b32 m0, 0x7d00
    v_lshlrev_b32 v6, 2, v0
    v_smfmac_f32_16x16x64_bf16 v[12:15], v[32:35], a[104:111], v2
    v_smfmac_f32_16x16x64_bf16 v[16:19], v[32:35], a[240:247], v2
    s_waitcnt lgkmcnt(3)
    v_smfmac_f32_16x16x64_bf16 v[8:11], v[36:39], a[112:119], v2
    buffer_load_dword v6, s[60:63], s101 offen sc1 lds
    v_smfmac_f32_16x16x64_bf16 v[12:15], v[36:39], a[120:127], v2
    v_smfmac_f32_16x16x64_bf16 v[20:23], v[32:35], a[248:255], v2
    s_waitcnt lgkmcnt(0)
    v_smfmac_f32_16x16x64_bf16 v[8:11], v[44:47], a[128:135], v2
    v_smfmac_f32_16x16x64_bf16 v[12:15], v[44:47], a[136:143], v2
    v_and_b32 v6, 0xffff, v3
    v_smfmac_f32_16x16x64_bf16 v[24:27], v[32:35], v[248:255], v2
    ds_read_b128 v[248:251], v1 offset:34816
    ds_read_b128 v[252:255], v1 offset:35840
    v_smfmac_f32_16x16x64_bf16 v[16:19], v[36:39], v[64:71], v2
    v_add_f32 v8, v8, v10
    v_add_f32 v9, v9, v11
    v_smfmac_f32_16x16x64_bf16 v[20:23], v[36:39], v[72:79], v2
    v_add_f32 v12, v12, v14
    v_add_f32 v13, v13, v15
    v_smfmac_f32_16x16x64_bf16 v[28:31], v[32:35], v[48:55], v2
    ds_read_b128 v[48:51], v1 offset:49152
    ds_read_b128 v[52:55], v1 offset:50176
    v_cvt_pk_bf16_f32 v8, v8, v9
    v_smfmac_f32_16x16x64_bf16 v[16:19], v[44:47], v[80:87], v2
    v_cvt_pk_bf16_f32 v9, v12, v13
    ds_write2_b32 v6, v8, v9 offset0:0 offset1:64
    v_smfmac_f32_16x16x64_bf16 v[20:23], v[44:47], v[88:95], v2
    ds_read_b128 v[8:11], v1 offset:51200
    ds_read_b128 v[12:15], v1 offset:52224
    v_smfmac_f32_16x16x64_bf16 v[24:27], v[36:39], v[56:63], v2
    ds_read_b128 v[56:59], v0 offset:4096
    ds_read_b128 v[60:63], v0 offset:8192
    s_waitcnt lgkmcnt(7)
    v_smfmac_f32_16x16x64_bf16 v[28:31], v[36:39], v[248:255], v2
    v_add_f32 v16, v16, v18
    v_add_f32 v17, v17, v19
    v_add_f32 v20, v20, v22
    v_add_f32 v21, v21, v23
    v_cvt_pk_bf16_f32 v16, v16, v17
    v_cvt_pk_bf16_f32 v17, v20, v21
    v_add_u32 v18, 2048, v6
    ds_write2_b32 v18, v16, v17 offset0:0 offset1:64
    s_waitcnt lgkmcnt(6)
    v_smfmac_f32_16x16x64_bf16 v[24:27], v[44:47], v[48:55], v2
    ds_read_b128 v[248:251], v0 offset:5120
    ds_read_b128 v[252:255], v0 offset:9216
    v_lshrrev_b32 v3, 16, v3
    s_waitcnt lgkmcnt(5)
    v_smfmac_f32_16x16x64_bf16 v[28:31], v[44:47], v[8:15], v2
    v_lshrrev_b32 v18, 1, v0
    buffer_store_dwordx2 v[16:17], v18, s[60:63], s83 offen sc1
    s_nop 0
    v_add_f32 v24, v24, v26
    v_add_f32 v25, v25, v27
    s_waitcnt lgkmcnt(2)
    s_barrier
    ds_read_b64_tr_b16 v[32:33], v3 offset:0
    ds_read_b64_tr_b16 v[34:35], v3 offset:256
    ds_read_b64_tr_b16 v[40:41], v3 offset:512
    ds_read_b64_tr_b16 v[42:43], v3 offset:768
    v_add_f32 v28, v28, v30
    ds_read_b128 v[48:51], v0 offset:6144
    ds_read_b128 v[52:55], v0 offset:10240
    v_add_f32 v29, v29, v31
    ds_read_b64_tr_b16 v[36:37], v3 offset:1024
    ds_read_b64_tr_b16 v[38:39], v3 offset:1280
    v_cvt_pk_bf16_f32 v24, v24, v25
    s_waitcnt lgkmcnt(6)
    v_mfma_f32_16x16x32_bf16 v[16:19], v[56:59], v[32:35], 0
    ds_read_b64_tr_b16 v[44:45], v3 offset:1536
    ds_read_b64_tr_b16 v[46:47], v3 offset:1792
    v_mfma_f32_16x16x32_bf16 v[20:23], v[60:63], v[32:35], 0
    ds_read_b128 v[8:11], v0 offset:7168
    ds_read_b128 v[12:15], v0 offset:11264
    s_waitcnt lgkmcnt(8)
    v_mfma_f32_16x16x32_bf16 v[16:19], v[248:251], v[40:43], v[16:19]
    ds_read_b64_tr_b16 v[56:57], v7 offset:0
    ds_read_b64_tr_b16 v[58:59], v7 offset:256
    v_mfma_f32_16x16x32_bf16 v[20:23], v[252:255], v[40:43], v[20:23]
    ds_read_b64_tr_b16 v[60:61], v7 offset:512
    ds_read_b64_tr_b16 v[62:63], v7 offset:768
    s_waitcnt lgkmcnt(8)
    v_mfma_f32_16x16x32_bf16 v[16:19], v[48:51], v[36:39], v[16:19]
    ds_read_b64_tr_b16 v[248:249], v7 offset:1024
    ds_read_b64_tr_b16 v[250:251], v7 offset:1280
    v_mfma_f32_16x16x32_bf16 v[20:23], v[52:55], v[36:39], v[20:23]
    ds_read_b64_tr_b16 v[252:253], v7 offset:1536
    ds_read_b64_tr_b16 v[254:255], v7 offset:1792
    s_waitcnt lgkmcnt(8)
    v_mfma_f32_16x16x32_bf16 v[16:19], v[8:11], v[44:47], v[16:19]
    v_cvt_pk_bf16_f32 v25, v28, v29
    v_lshl_or_b32 v3, v3, 16, v6
    v_mfma_f32_16x16x32_bf16 v[20:23], v[12:15], v[44:47], v[20:23]
    v_add_u32 v6, s98, v0
    v_lshrrev_b32 v26, 1, v0
    s_waitcnt lgkmcnt(6)
    v_mfma_f32_16x16x32_bf16 v[28:31], v[56:59], v[32:35], 0
    buffer_store_dwordx2 v[24:25], v26, s[60:63], s84 offen sc1
    s_cmp_eq_u32 s66, 63
    s_waitcnt lgkmcnt(4)
    v_mfma_f32_16x16x32_bf16 v[28:31], v[60:63], v[40:43], v[28:31]
    s_cbranch_scc1 Llast_95
    s_waitcnt vmcnt(3)
    s_waitcnt lgkmcnt(2)
    v_mfma_f32_16x16x32_bf16 v[28:31], v[248:251], v[36:39], v[28:31]
    ds_read_b128 v[48:51], v6 offset:20480
    ds_read_b128 v[52:55], v6 offset:21504
    s_waitcnt lgkmcnt(2)
    v_mfma_f32_16x16x32_bf16 v[28:31], v[252:255], v[44:47], v[28:31]
    v_cndmask_b32 v8, v20, v16, s[92:93]
    v_cndmask_b32 v9, v21, v17, s[92:93]
    v_cndmask_b32 v10, v22, v18, s[92:93]
    v_cndmask_b32 v11, v23, v19, s[92:93]
    v_max3_f32 v12, v8, v9, v10
    v_mov_b64 v[20:21], -1
    v_max_f32 v12, v12, v11
    v_mov_b64 v[22:23], -1
    v_cndmask_b32 v16, v28, v30, s[78:79]
    v_cndmask_b32 v17, v29, v31, s[78:79]
    v_max3_f32 v12, v12, v16, v17
    s_xor_b32 s67, s70, 0x80000
    buffer_store_dwordx4 v[20:23], v0, s[60:63], s67 offen sc1
    v_max_f32_dpp v13, v12, v12 row_ror:8 row_mask:0xf bank_mask:0xf
    v_max_f32_dpp v12, v12, v12 row_ror:8 row_mask:0xf bank_mask:0xf
    v_mov_b32 v40, 0x3f803f80
    v_mov_b32 v41, 0x3f803f80
    v_permlane16_swap_b32 v12, v13
    v_max_f32 v14, v12, v13
    v_max_f32 v12, v12, v13
    v_mov_b64 v[42:43], v[40:41]
    v_mov_b32 v37, 0
    v_permlane32_swap_b32 v12, v14
    v_max_f32 v12, v12, v14
    v_mul_f32 v12, s80, v12
    v_fma_f32 v8, v8, s80, -v12
    v_fma_f32 v9, v9, s80, -v12
    v_exp_f32 v8, v8
    v_exp_f32 v9, v9
    v_fma_f32 v10, v10, s80, -v12
    v_fma_f32 v11, v11, s80, -v12
    v_cvt_pk_bf16_f32 v32, v8, v9
    v_exp_f32 v10, v10
    v_exp_f32 v11, v11
    v_mov_b32_dpp v34, v32 row_ror:8 row_mask:0xf bank_mask:0xf
    v_cvt_pk_bf16_f32 v33, v10, v11
    v_fma_f32 v16, v16, s80, -v12
    v_fma_f32 v17, v17, s80, -v12
    v_mov_b32_dpp v35, v33 row_ror:8 row_mask:0xf bank_mask:0xf
    v_exp_f32 v16, v16
    s_waitcnt lgkmcnt(0)
    v_mfma_f32_16x16x32_bf16 v[56:59], v[40:43], v[32:35], 0
    v_exp_f32 v17, v17
    v_mfma_f32_16x16x32_bf16 v[248:251], v[48:51], v[32:35], 0
    v_mov_b32 v38, 0
    v_cvt_pk_bf16_f32 v36, v16, v17
    v_mfma_f32_16x16x32_bf16 v[252:255], v[52:55], v[32:35], 0
    v_cvt_pk_bf16_f32 v39, v16, v17
    v_lshrrev_b32 v6, 16, v2
    v_mfma_f32_16x16x16_bf16 v[56:59], v[40:41], v[36:37], v[56:59]
    v_mov_b64 v[8:9], 0
    v_mov_b64 v[10:11], 0
    v_mfma_f32_16x16x16_bf16 v[248:251], v[24:25], v[36:37], v[248:251]
    v_mov_b64 v[12:13], 0
    v_mov_b64 v[14:15], 0
    v_mfma_f32_16x16x16_bf16 v[252:255], v[24:25], v[38:39], v[252:255]
    buffer_store_dwordx4 v[20:23], v0, s[60:63], s67 offen offset:1024 sc1
    v_rcp_f32 v56, v56
    v_mov_b64 v[16:17], 0
    s_nop 0
    v_mul_f32 v248, v248, v56
    v_mul_f32 v249, v249, v56
    v_cvt_pk_bf16_f32 v44, v248, v249
    v_mul_f32 v250, v250, v56
    v_mul_f32 v251, v251, v56
    v_cvt_pk_bf16_f32 v45, v250, v251
    v_mul_f32 v252, v252, v56
    v_mul_f32 v253, v253, v56
    v_cvt_pk_bf16_f32 v46, v252, v253
    v_mul_f32 v254, v254, v56
    v_mul_f32 v255, v255, v56
    v_cvt_pk_bf16_f32 v47, v254, v255
    s_mov_b64 exec, s[92:93]
    ds_write_b128 v6, v[44:47]
    s_mov_b64 exec, -1
    v_mov_b64 v[18:19], 0
    v_mov_b64 v[20:21], 0
    v_mov_b64 v[22:23], 0
    v_mov_b64 v[24:25], 0
    v_mov_b64 v[26:27], 0
    v_and_b32 v6, 0xf0, v0
    v_mov_b32 v56, -2
    v_mov_b32 v57, -2
    v_mov_b64 v[58:59], v[56:57]
    v_mov_b64 v[60:61], v[56:57]
    v_mov_b64 v[62:63], v[56:57]
    s_waitcnt lgkmcnt(0)
    s_barrier
    ds_read_b128 v[44:47], v0 offset:28672
    ds_read_b128 v[48:51], v0 offset:29696
    ds_read_b128 v[248:251], v6 offset:31744
    v_mov_b64 v[28:29], 0
    v_mov_b64 v[30:31], 0
    v_mov_b64 v[32:33], 0
    v_mov_b64 v[34:35], 0
    v_mov_b64 v[36:37], 0
    v_mov_b64 v[38:39], 0
    v_mov_b64 v[40:41], 0
    v_mov_b64 v[42:43], 0
    s_waitcnt lgkmcnt(2)
    v_smfmac_f32_16x16x64_bf16 v[8:11], v[44:47], v[96:103], v2
    s_mov_b32 s72, s75
    v_subrev_u32 v1, 0x10000, v1
    v_smfmac_f32_16x16x64_bf16 v[12:15], v[44:47], v[112:119], v2
    s_add_u32 s75, s75, 16384
    v_and_b32 v6, 0xffff, v4
    v_smfmac_f32_16x16x64_bf16 v[16:19], v[44:47], v[128:135], v2
    s_and_b32 s75, s75, 0xfffeffff
    s_waitcnt lgkmcnt(1)
    v_smfmac_f32_16x16x64_bf16 v[8:11], v[48:51], v[104:111], v2
    s_add_u32 s88, s75, s90
    v_smfmac_f32_16x16x64_bf16 v[12:15], v[48:51], v[120:127], v2
    v_smfmac_f32_16x16x64_bf16 v[20:23], v[44:47], v[144:151], v2
    v_add_f32 v8, v8, v10
    v_smfmac_f32_16x16x64_bf16 v[16:19], v[48:51], v[136:143], v2
    v_add_f32 v9, v9, v11
    v_smfmac_f32_16x16x64_bf16 v[20:23], v[48:51], v[152:159], v2
    v_add_f32 v12, v12, v14
    v_smfmac_f32_16x16x64_bf16 v[24:27], v[44:47], v[160:167], v2
    v_add_f32 v13, v13, v15
    v_smfmac_f32_16x16x64_bf16 v[28:31], v[44:47], v[176:183], v2
    v_cvt_pk_bf16_f32 v8, v8, v9
    v_smfmac_f32_16x16x64_bf16 v[32:35], v[44:47], v[192:199], v2
    v_cvt_pk_bf16_f32 v9, v12, v13
    v_smfmac_f32_16x16x64_bf16 v[24:27], v[48:51], v[168:175], v2
    buffer_store_dwordx2 v[8:9], v5, s[60:63], s3 offen sc1
    v_add_f32 v16, v16, v18
    v_smfmac_f32_16x16x64_bf16 v[28:31], v[48:51], v[184:191], v2
    v_add_f32 v17, v17, v19
    v_smfmac_f32_16x16x64_bf16 v[36:39], v[44:47], v[208:215], v2
    v_add_f32 v20, v20, v22
    v_smfmac_f32_16x16x64_bf16 v[40:43], v[44:47], v[224:231], v2
    v_add_f32 v21, v21, v23
    v_smfmac_f32_16x16x64_bf16 v[32:35], v[48:51], v[200:207], v2
    v_cvt_pk_bf16_f32 v16, v16, v17
    v_smfmac_f32_16x16x64_bf16 v[36:39], v[48:51], v[216:223], v2
    v_cvt_pk_bf16_f32 v17, v20, v21
    v_smfmac_f32_16x16x64_bf16 v[40:43], v[48:51], v[232:239], v2
    buffer_store_dwordx2 v[16:17], v5, s[60:63], s4 offen sc1
    v_add_f32 v24, v24, v26
    v_add_f32 v25, v25, v27
    v_add_f32 v28, v28, v30
    v_add_f32 v29, v29, v31
    v_cvt_pk_bf16_f32 v24, v24, v25
    v_cvt_pk_bf16_f32 v25, v28, v29
    buffer_store_dwordx2 v[24:25], v5, s[60:63], s5 offen sc1
    v_pk_add_f32 v[32:33], v[32:33], v[34:35]
    v_pk_add_f32 v[36:37], v[36:37], v[38:39]
    v_cvt_pk_bf16_f32 v32, v32, v33
    v_cvt_pk_bf16_f32 v33, v36, v37
    buffer_store_dwordx2 v[32:33], v5, s[60:63], s6 offen sc1
    v_pk_add_f32 v[40:41], v[40:41], v[42:43]
    v_mov_b64 v[28:29], -1
    v_cvt_pk_bf16_f32 v40, v40, v41
    v_mov_b64 v[30:31], -1
    v_mov_b64 v[8:9], 0
    v_mov_b32_dpp v41, v40 row_ror:8 row_mask:0xf bank_mask:0xf
    s_mov_b64 exec, s[92:93]
    buffer_store_dwordx2 v[40:41], v5, s[60:63], s7 offen sc1
    s_mov_b64 exec, -1
    s_waitcnt lgkmcnt(0)
    v_mov_b64 v[10:11], 0
    v_mov_b64 v[12:13], 0
    v_mov_b64 v[14:15], 0
    v_mov_b64 v[16:17], 0
    v_mov_b64 v[18:19], 0
    v_mov_b64 v[20:21], 0
    v_mov_b64 v[22:23], 0
    v_mov_b64 v[24:25], 0
    v_mov_b64 v[26:27], 0
    s_add_u32 s89, s75, s91
    s_add_u32 s94, s94, 0x80000
    s_add_u32 s95, s95, 0x80000
    buffer_load_dwordx4 v[56:59], v0, s[60:63], s70 offen sc1
    buffer_load_dwordx4 v[60:63], v0, s[60:63], s70 offen offset:1024 sc1
Lpl_98:
    v_max3_u32 v252, v56, v57, v58
    v_max3_u32 v253, v59, v60, v61
    v_max3_u32 v252, v252, v62, v63
    v_max_u32 v252, v252, v253
    v_cmp_le_u32 vcc, -2, v252
    s_add_u32 s74, s74, 1
    s_cbranch_vccz Lrok_97
    v_max3_u32 v252, v56, v57, v58
    v_max3_u32 v253, v59, v60, v61
    v_max3_u32 v252, v252, v62, v63
    v_max_u32 v252, v252, v253
    v_cmp_le_u32 vcc, -2, v252
    s_nop 0
    s_cbranch_vccz Lrok_97
    v_max3_u32 v252, v56, v57, v58
    v_max3_u32 v253, v59, v60, v61
    v_max3_u32 v252, v252, v62, v63
    v_max_u32 v252, v252, v253
    v_cmp_le_u32 vcc, -2, v252
    s_cmp_lt_u32 s74, 0x100000
    s_cbranch_vccz Lrok_97
    buffer_load_dwordx4 v[56:59], v0, s[60:63], s70 offen sc1
    v_mov_b32 v254, 0
    buffer_load_dwordx4 v[60:63], v0, s[60:63], s70 offen offset:1024 sc1
    v_mov_b32 v254, 0
    s_cbranch_scc1 Lpl_98
    s_branch L_fail
Lrok_97:
    v_mfma_f32_16x16x32_bf16 v[252:255], v[248:251], v[56:59], 0
    v_mfma_f32_16x16x32_bf16 v[252:255], v[248:251], v[60:63], v[252:255]
    v_mov_b32 v40, -2
    v_mov_b32 v41, -2
    v_mov_b64 v[42:43], v[40:41]
    v_mov_b64 v[44:45], v[40:41]
    v_mov_b64 v[46:47], v[40:41]
    s_nop 2
    v_add_f32_dpp v254, v252, v252 row_ror:8 row_mask:0xf bank_mask:0xf
    v_add_f32_dpp v255, v253, v253 row_ror:8 row_mask:0xf bank_mask:0xf
    s_nop 0
    v_add_f32_dpp v252, v254, v254 row_ror:4 row_mask:0xf bank_mask:0xf
    v_add_f32_dpp v253, v255, v255 row_ror:4 row_mask:0xf bank_mask:0xf
    s_mov_b64 exec, s[76:77]
    v_cvt_pk_bf16_f32 v252, v252, v253
    buffer_store_dword v252, v6, s[60:63], s75 offen sc1
    buffer_store_dword v28, v6, s[60:63], s72 offen sc1
    s_mov_b64 exec, -1
    s_add_u32 s101, s101, 0x80000
    s_add_u32 s83, s83, 0x10000
    s_add_u32 s84, s84, 0x10000
    v_xor_b32 v5, 0x80000, v5
    s_add_u32 s66, s66, 1
    s_xor_b32 s70, s70, 0x80000
    v_add_u32 v6, s98, v0
    ds_read_b128 v[48:51], v6 offset:12288
    ds_read_b128 v[52:55], v6 offset:13312
    v_mov_b64 v[28:29], 0
    v_mov_b64 v[30:31], 0
    buffer_load_dwordx4 v[40:43], v0, s[60:63], s88 offen sc1
    buffer_load_dwordx4 v[44:47], v0, s[60:63], s88 offen offset:1024 sc1
Lagp_96:
    v_add_u32 v6, s90, v0
Lpl_100:
    v_max3_u32 v252, v40, v41, v42
    v_max3_u32 v253, v43, v44, v45
    v_max3_u32 v252, v252, v46, v47
    v_max_u32 v252, v252, v253
    v_cmp_le_u32 vcc, -2, v252
    s_add_u32 s74, s74, 1
    s_cbranch_vccz LpAok_99
    v_max3_u32 v252, v40, v41, v42
    v_max3_u32 v253, v43, v44, v45
    v_max3_u32 v252, v252, v46, v47
    v_max_u32 v252, v252, v253
    v_cmp_le_u32 vcc, -2, v252
    s_nop 0
    s_cbranch_vccz LpAok_99
    v_max3_u32 v252, v40, v41, v42
    v_max3_u32 v253, v43, v44, v45
    v_max3_u32 v252, v252, v46, v47
    v_max_u32 v252, v252, v253
    v_cmp_le_u32 vcc, -2, v252
    s_cmp_lt_u32 s74, 0x100000
    s_cbranch_vccz LpAok_99
    buffer_load_dwordx4 v[40:43], v0, s[60:63], s88 offen sc1
    v_mov_b32 v254, 0
    buffer_load_dwordx4 v[44:47], v0, s[60:63], s88 offen offset:1024 sc1
    v_mov_b32 v254, 0
    s_cbranch_scc1 Lpl_100
    s_branch L_fail
LpAok_99:
    ds_write_b128 v6, v[40:43] offset:22528
    ds_write_b128 v6, v[44:47] offset:23552
    s_branch Lbar1_90
Lagtop_89:
    buffer_load_dwordx4 v[40:43], v0, s[60:63], s88 offen sc1
    buffer_load_dwordx4 v[44:47], v0, s[60:63], s88 offen offset:1024 sc1
    s_branch Lagp_96
Lpr_91:
    buffer_load_dwordx4 v[44:47], v0, s[60:63], s89 offen sc1
    s_add_u32 s74, s74, 1
    s_cmp_ge_u32 s74, 0x100000
    s_cbranch_scc1 L_fail
    s_waitcnt vmcnt(0)
    v_max3_u32 v6, v44, v45, v46
    v_max_u32 v6, v6, v47
    v_cmp_eq_u32 vcc, -1, v6
    v_add_u32 v6, s91, v0
    s_cbranch_vccnz Lpr_91
    s_branch Lpc_92
Lkv_93:
    buffer_load_dword v6, off, s[56:59], 0 offset:148 sc1
    s_add_u32 s74, s74, 1
    s_cmp_ge_u32 s74, 0x100000
    s_cbranch_scc1 L_fail
    s_waitcnt vmcnt(0)
    v_readfirstlane_b32 s67, v6
    s_cmp_lt_u32 s67, 224
    s_cbranch_scc1 Lkv_93
    s_branch Lkvc_94
Llast_95:
    s_waitcnt vmcnt(0)
    s_barrier
    s_branch L_done
Lwave_64:
.p2align 3
Lbar1_102:
    s_waitcnt lgkmcnt(0)
    s_barrier
    ds_read_b128 v[32:35], v0 offset:22528
    ds_read_b128 v[36:39], v0 offset:23552
    ds_read_b128 v[248:251], v1 offset:2048
    ds_read_b128 v[252:255], v1 offset:3072
    ds_read_b128 v[56:59], v1 offset:0
    ds_read_b128 v[60:63], v1 offset:1024
    s_waitcnt lgkmcnt(5)
    v_smfmac_f32_16x16x64_bf16 v[8:11], v[32:35], a[0:7], v2
    v_smfmac_f32_16x16x64_bf16 v[12:15], v[32:35], a[8:15], v2
    v_smfmac_f32_16x16x64_bf16 v[24:27], v[32:35], v[240:247], v2
    v_smfmac_f32_16x16x64_bf16 v[16:19], v[32:35], a[144:151], v2
    v_smfmac_f32_16x16x64_bf16 v[20:23], v[32:35], a[152:159], v2
    v_smfmac_f32_16x16x64_bf16 v[28:31], v[32:35], v[48:55], v2
    ds_read_b128 v[48:51], v1 offset:16384
    ds_read_b128 v[52:55], v1 offset:17408
    s_waitcnt lgkmcnt(2)
    v_smfmac_f32_16x16x64_bf16 v[8:11], v[36:39], a[16:23], v2
    s_waitcnt vmcnt(0)
    ds_read_b128 v[40:43], v0 offset:24576
    v_smfmac_f32_16x16x64_bf16 v[12:15], v[36:39], a[24:31], v2
    ds_read_b128 v[32:35], v0 offset:25600
    buffer_load_dwordx4 v[44:47], v0, s[60:63], s89 offen sc1
    v_smfmac_f32_16x16x64_bf16 v[24:27], v[36:39], v[56:63], v2
    ds_read_b128 v[56:59], v1 offset:18432
    ds_read_b128 v[60:63], v1 offset:19456
    v_smfmac_f32_16x16x64_bf16 v[16:19], v[36:39], a[160:167], v2
    s_mov_b32 m0, s96
    v_smfmac_f32_16x16x64_bf16 v[20:23], v[36:39], a[168:175], v2
    buffer_load_dwordx4 v0, s[60:63], s94 offen sc1 lds
    v_smfmac_f32_16x16x64_bf16 v[28:31], v[36:39], v[248:255], v2
    ds_read_b128 v[248:251], v1 offset:32768
    ds_read_b128 v[252:255], v1 offset:33792
    s_waitcnt lgkmcnt(5)
    v_smfmac_f32_16x16x64_bf16 v[8:11], v[40:43], a[32:39], v2
    ds_read_b128 v[36:39], v0 offset:26624
    v_smfmac_f32_16x16x64_bf16 v[12:15], v[40:43], a[40:47], v2
    buffer_load_dwordx4 v0, s[60:63], s94 offen offset:1024 sc1 lds
    v_smfmac_f32_16x16x64_bf16 v[24:27], v[40:43], v[48:55], v2
    ds_read_b128 v[48:51], v1 offset:34816
    ds_read_b128 v[52:55], v1 offset:35840
    v_smfmac_f32_16x16x64_bf16 v[16:19], v[40:43], a[176:183], v2
    v_smfmac_f32_16x16x64_bf16 v[20:23], v[40:43], a[184:191], v2
    s_waitcnt lgkmcnt(5)
    v_smfmac_f32_16x16x64_bf16 v[28:31], v[40:43], v[56:63], v2
    ds_read_b128 v[56:59], v1 offset:49152
    ds_read_b128 v[60:63], v1 offset:50176
    v_smfmac_f32_16x16x64_bf16 v[8:11], v[32:35], a[48:55], v2
    ds_read_b128 v[40:43], v0 offset:27648
    v_smfmac_f32_16x16x64_bf16 v[12:15], v[32:35], a[56:63], v2
    s_waitcnt lgkmcnt(5)
    v_smfmac_f32_16x16x64_bf16 v[24:27], v[32:35], v[248:255], v2
    ds_read_b128 v[248:251], v1 offset:51200
    ds_read_b128 v[252:255], v1 offset:52224
    v_smfmac_f32_16x16x64_bf16 v[16:19], v[32:35], a[192:199], v2
    s_waitcnt vmcnt(2)
    v_max3_u32 v6, v44, v45, v46
    v_smfmac_f32_16x16x64_bf16 v[20:23], v[32:35], a[200:207], v2
    v_add_u32 v1, 0x10000, v1
    s_waitcnt lgkmcnt(5)
    v_smfmac_f32_16x16x64_bf16 v[28:31], v[32:35], v[48:55], v2
    ds_read_b128 v[48:51], v1 offset:0
    ds_read_b128 v[52:55], v1 offset:1024
    v_smfmac_f32_16x16x64_bf16 v[8:11], v[36:39], a[64:71], v2
    v_max_u32 v6, v6, v47
    v_smfmac_f32_16x16x64_bf16 v[12:15], v[36:39], a[72:79], v2
    v_cmp_eq_u32 vcc, -1, v6
    s_waitcnt lgkmcnt(4)
    v_smfmac_f32_16x16x64_bf16 v[24:27], v[36:39], v[56:63], v2
    ds_read_b128 v[56:59], v1 offset:2048
    ds_read_b128 v[60:63], v1 offset:3072
    v_smfmac_f32_16x16x64_bf16 v[16:19], v[36:39], a[208:215], v2
    v_add_u32 v6, s91, v0
    s_cbranch_vccnz Lpr_103
Lpc_104:
    ds_write_b128 v6, v[44:47] offset:22528
    v_smfmac_f32_16x16x64_bf16 v[20:23], v[36:39], a[216:223], v2
    s_waitcnt lgkmcnt(5)
    v_smfmac_f32_16x16x64_bf16 v[28:31], v[36:39], v[248:255], v2
    ds_read_b128 v[248:251], v1 offset:16384
    ds_read_b128 v[252:255], v1 offset:17408
    v_smfmac_f32_16x16x64_bf16 v[8:11], v[40:43], a[80:87], v2
    s_mov_b32 m0, s97
    v_smfmac_f32_16x16x64_bf16 v[12:15], v[40:43], a[88:95], v2
    s_waitcnt lgkmcnt(2)
    s_waitcnt vmcnt(0)
    s_barrier
    ds_read_b128 v[32:35], v0 offset:28672
    ds_read_b128 v[36:39], v0 offset:29696
    v_smfmac_f32_16x16x64_bf16 v[24:27], v[40:43], v[48:55], v2
    ds_read_b128 v[48:51], v1 offset:18432
    ds_read_b128 v[52:55], v1 offset:19456
    s_cmp_eq_u32 s66, 30
    s_cbranch_scc1 Lkv_105
Lkvc_106:
    v_smfmac_f32_16x16x64_bf16 v[16:19], v[40:43], a[224:231], v2
    ds_read_b128 v[44:47], v0 offset:30720
    buffer_load_dwordx4 v0, s[60:63], s95 offen sc1 lds
    v_smfmac_f32_16x16x64_bf16 v[20:23], v[40:43], a[232:239], v2
    buffer_load_dwordx4 v0, s[60:63], s95 offen offset:1024 sc1 lds
    v_smfmac_f32_16x16x64_bf16 v[28:31], v[40:43], v[56:63], v2
    ds_read_b128 v[56:59], v1 offset:32768
    ds_read_b128 v[60:63], v1 offset:33792
    s_waitcnt lgkmcnt(6)
    v_smfmac_f32_16x16x64_bf16 v[8:11], v[32:35], a[96:103], v2
    s_mov_b32 m0, 0x7d00
    v_lshlrev_b32 v6, 2, v0
    v_smfmac_f32_16x16x64_bf16 v[12:15], v[32:35], a[104:111], v2
    v_smfmac_f32_16x16x64_bf16 v[16:19], v[32:35], a[240:247], v2
    s_waitcnt lgkmcnt(3)
    v_smfmac_f32_16x16x64_bf16 v[8:11], v[36:39], a[112:119], v2
    buffer_load_dword v6, s[60:63], s101 offen sc1 lds
    v_smfmac_f32_16x16x64_bf16 v[12:15], v[36:39], a[120:127], v2
    v_smfmac_f32_16x16x64_bf16 v[20:23], v[32:35], a[248:255], v2
    v_mov_b32 v6, s66
    s_mov_b64 exec, 1
    buffer_store_dword v6, off, s[60:63], s100 sc1
    s_mov_b64 exec, -1
    s_waitcnt lgkmcnt(0)
    v_smfmac_f32_16x16x64_bf16 v[8:11], v[44:47], a[128:135], v2
    v_smfmac_f32_16x16x64_bf16 v[12:15], v[44:47], a[136:143], v2
    v_and_b32 v6, 0xffff, v3
    v_smfmac_f32_16x16x64_bf16 v[24:27], v[32:35], v[248:255], v2
    ds_read_b128 v[248:251], v1 offset:34816
    ds_read_b128 v[252:255], v1 offset:35840
    v_smfmac_f32_16x16x64_bf16 v[16:19], v[36:39], v[64:71], v2
    v_add_f32 v8, v8, v10
    v_add_f32 v9, v9, v11
    v_smfmac_f32_16x16x64_bf16 v[20:23], v[36:39], v[72:79], v2
    v_add_f32 v12, v12, v14
    v_add_f32 v13, v13, v15
    v_smfmac_f32_16x16x64_bf16 v[28:31], v[32:35], v[48:55], v2
    ds_read_b128 v[48:51], v1 offset:49152
    ds_read_b128 v[52:55], v1 offset:50176
    v_cvt_pk_bf16_f32 v8, v8, v9
    v_smfmac_f32_16x16x64_bf16 v[16:19], v[44:47], v[80:87], v2
    v_cvt_pk_bf16_f32 v9, v12, v13
    ds_write2_b32 v6, v8, v9 offset0:0 offset1:64
    v_smfmac_f32_16x16x64_bf16 v[20:23], v[44:47], v[88:95], v2
    ds_read_b128 v[8:11], v1 offset:51200
    ds_read_b128 v[12:15], v1 offset:52224
    v_smfmac_f32_16x16x64_bf16 v[24:27], v[36:39], v[56:63], v2
    ds_read_b128 v[56:59], v0 offset:4096
    ds_read_b128 v[60:63], v0 offset:8192
    s_waitcnt lgkmcnt(7)
    v_smfmac_f32_16x16x64_bf16 v[28:31], v[36:39], v[248:255], v2
    v_add_f32 v16, v16, v18
    v_add_f32 v17, v17, v19
    v_add_f32 v20, v20, v22
    v_add_f32 v21, v21, v23
    v_cvt_pk_bf16_f32 v16, v16, v17
    v_cvt_pk_bf16_f32 v17, v20, v21
    v_add_u32 v18, 2048, v6
    ds_write2_b32 v18, v16, v17 offset0:0 offset1:64
    s_waitcnt lgkmcnt(6)
    v_smfmac_f32_16x16x64_bf16 v[24:27], v[44:47], v[48:55], v2
    ds_read_b128 v[248:251], v0 offset:5120
    ds_read_b128 v[252:255], v0 offset:9216
    v_lshrrev_b32 v3, 16, v3
    s_waitcnt lgkmcnt(5)
    v_smfmac_f32_16x16x64_bf16 v[28:31], v[44:47], v[8:15], v2
    v_lshrrev_b32 v18, 1, v0
    buffer_store_dwordx2 v[16:17], v18, s[60:63], s83 offen sc1
    s_nop 0
    v_add_f32 v24, v24, v26
    v_add_f32 v25, v25, v27
    s_waitcnt lgkmcnt(2)
    s_barrier
    ds_read_b64_tr_b16 v[32:33], v3 offset:0
    ds_read_b64_tr_b16 v[34:35], v3 offset:256
    ds_read_b64_tr_b16 v[40:41], v3 offset:512
    ds_read_b64_tr_b16 v[42:43], v3 offset:768
    v_add_f32 v28, v28, v30
    ds_read_b128 v[48:51], v0 offset:6144
    ds_read_b128 v[52:55], v0 offset:10240
    v_add_f32 v29, v29, v31
    ds_read_b64_tr_b16 v[36:37], v3 offset:1024
    ds_read_b64_tr_b16 v[38:39], v3 offset:1280
    v_cvt_pk_bf16_f32 v24, v24, v25
    s_waitcnt lgkmcnt(6)
    v_mfma_f32_16x16x32_bf16 v[16:19], v[56:59], v[32:35], 0
    ds_read_b64_tr_b16 v[44:45], v3 offset:1536
    ds_read_b64_tr_b16 v[46:47], v3 offset:1792
    v_mfma_f32_16x16x32_bf16 v[20:23], v[60:63], v[32:35], 0
    ds_read_b128 v[8:11], v0 offset:7168
    ds_read_b128 v[12:15], v0 offset:11264
    s_waitcnt lgkmcnt(8)
    v_mfma_f32_16x16x32_bf16 v[16:19], v[248:251], v[40:43], v[16:19]
    ds_read_b64_tr_b16 v[56:57], v7 offset:0
    ds_read_b64_tr_b16 v[58:59], v7 offset:256
    v_mfma_f32_16x16x32_bf16 v[20:23], v[252:255], v[40:43], v[20:23]
    ds_read_b64_tr_b16 v[60:61], v7 offset:512
    ds_read_b64_tr_b16 v[62:63], v7 offset:768
    s_waitcnt lgkmcnt(8)
    v_mfma_f32_16x16x32_bf16 v[16:19], v[48:51], v[36:39], v[16:19]
    ds_read_b64_tr_b16 v[248:249], v7 offset:1024
    ds_read_b64_tr_b16 v[250:251], v7 offset:1280
    v_mfma_f32_16x16x32_bf16 v[20:23], v[52:55], v[36:39], v[20:23]
    ds_read_b64_tr_b16 v[252:253], v7 offset:1536
    ds_read_b64_tr_b16 v[254:255], v7 offset:1792
    s_waitcnt lgkmcnt(8)
    v_mfma_f32_16x16x32_bf16 v[16:19], v[8:11], v[44:47], v[16:19]
    v_cvt_pk_bf16_f32 v25, v28, v29
    v_lshl_or_b32 v3, v3, 16, v6
    v_mfma_f32_16x16x32_bf16 v[20:23], v[12:15], v[44:47], v[20:23]
    v_add_u32 v6, s98, v0
    v_lshrrev_b32 v26, 1, v0
    s_waitcnt lgkmcnt(6)
    v_mfma_f32_16x16x32_bf16 v[28:31], v[56:59], v[32:35], 0
    buffer_store_dwordx2 v[24:25], v26, s[60:63], s84 offen sc1
    s_cmp_eq_u32 s66, 63
    s_waitcnt lgkmcnt(4)
    v_mfma_f32_16x16x32_bf16 v[28:31], v[60:63], v[40:43], v[28:31]
    s_cbranch_scc1 Llast_107
    s_waitcnt vmcnt(4)
    s_waitcnt lgkmcnt(2)
    v_mfma_f32_16x16x32_bf16 v[28:31], v[248:251], v[36:39], v[28:31]
    ds_read_b128 v[48:51], v6 offset:20480
    ds_read_b128 v[52:55], v6 offset:21504
    s_waitcnt lgkmcnt(2)
    v_mfma_f32_16x16x32_bf16 v[28:31], v[252:255], v[44:47], v[28:31]
    v_cndmask_b32 v8, v20, v16, s[92:93]
    v_cndmask_b32 v9, v21, v17, s[92:93]
    v_cndmask_b32 v10, v22, v18, s[92:93]
    v_cndmask_b32 v11, v23, v19, s[92:93]
    v_max3_f32 v12, v8, v9, v10
    v_mov_b64 v[20:21], -1
    v_max_f32 v12, v12, v11
    v_mov_b64 v[22:23], -1
    v_cndmask_b32 v16, v28, v30, s[78:79]
    v_cndmask_b32 v17, v29, v31, s[78:79]
    v_max3_f32 v12, v12, v16, v17
    s_xor_b32 s67, s70, 0x80000
    buffer_store_dwordx4 v[20:23], v0, s[60:63], s67 offen sc1
    v_max_f32_dpp v13, v12, v12 row_ror:8 row_mask:0xf bank_mask:0xf
    v_max_f32_dpp v12, v12, v12 row_ror:8 row_mask:0xf bank_mask:0xf
    v_mov_b32 v40, 0x3f803f80
    v_mov_b32 v41, 0x3f803f80
    v_permlane16_swap_b32 v12, v13
    v_max_f32 v14, v12, v13
    v_max_f32 v12, v12, v13
    v_mov_b64 v[42:43], v[40:41]
    v_mov_b32 v37, 0
    v_permlane32_swap_b32 v12, v14
    v_max_f32 v12, v12, v14
    v_mul_f32 v12, s80, v12
    v_fma_f32 v8, v8, s80, -v12
    v_fma_f32 v9, v9, s80, -v12
    v_exp_f32 v8, v8
    v_exp_f32 v9, v9
    v_fma_f32 v10, v10, s80, -v12
    v_fma_f32 v11, v11, s80, -v12
    v_cvt_pk_bf16_f32 v32, v8, v9
    v_exp_f32 v10, v10
    v_exp_f32 v11, v11
    v_mov_b32_dpp v34, v32 row_ror:8 row_mask:0xf bank_mask:0xf
    v_cvt_pk_bf16_f32 v33, v10, v11
    v_fma_f32 v16, v16, s80, -v12
    v_fma_f32 v17, v17, s80, -v12
    v_mov_b32_dpp v35, v33 row_ror:8 row_mask:0xf bank_mask:0xf
    v_exp_f32 v16, v16
    s_waitcnt lgkmcnt(0)
    v_mfma_f32_16x16x32_bf16 v[56:59], v[40:43], v[32:35], 0
    v_exp_f32 v17, v17
    v_mfma_f32_16x16x32_bf16 v[248:251], v[48:51], v[32:35], 0
    v_mov_b32 v38, 0
    v_cvt_pk_bf16_f32 v36, v16, v17
    v_mfma_f32_16x16x32_bf16 v[252:255], v[52:55], v[32:35], 0
    v_cvt_pk_bf16_f32 v39, v16, v17
    v_lshrrev_b32 v6, 16, v2
    v_mfma_f32_16x16x16_bf16 v[56:59], v[40:41], v[36:37], v[56:59]
    v_mov_b64 v[8:9], 0
    v_mov_b64 v[10:11], 0
    v_mfma_f32_16x16x16_bf16 v[248:251], v[24:25], v[36:37], v[248:251]
    v_mov_b64 v[12:13], 0
    v_mov_b64 v[14:15], 0
    v_mfma_f32_16x16x16_bf16 v[252:255], v[24:25], v[38:39], v[252:255]
    buffer_store_dwordx4 v[20:23], v0, s[60:63], s67 offen offset:1024 sc1
    v_rcp_f32 v56, v56
    v_mov_b64 v[16:17], 0
    s_nop 0
    v_mul_f32 v248, v248, v56
    v_mul_f32 v249, v249, v56
    v_cvt_pk_bf16_f32 v44, v248, v249
    v_mul_f32 v250, v250, v56
    v_mul_f32 v251, v251, v56
    v_cvt_pk_bf16_f32 v45, v250, v251
    v_mul_f32 v252, v252, v56
    v_mul_f32 v253, v253, v56
    v_cvt_pk_bf16_f32 v46, v252, v253
    v_mul_f32 v254, v254, v56
    v_mul_f32 v255, v255, v56
    v_cvt_pk_bf16_f32 v47, v254, v255
    s_mov_b64 exec, s[92:93]
    ds_write_b128 v6, v[44:47]
    s_mov_b64 exec, -1
    v_mov_b64 v[18:19], 0
    v_mov_b64 v[20:21], 0
    v_mov_b64 v[22:23], 0
    v_mov_b64 v[24:25], 0
    v_mov_b64 v[26:27], 0
    v_and_b32 v6, 0xf0, v0
    v_mov_b32 v56, -2
    v_mov_b32 v57, -2
    v_mov_b64 v[58:59], v[56:57]
    v_mov_b64 v[60:61], v[56:57]
    v_mov_b64 v[62:63], v[56:57]
    s_waitcnt lgkmcnt(0)
    s_barrier
    ds_read_b128 v[44:47], v0 offset:28672
    ds_read_b128 v[48:51], v0 offset:29696
    ds_read_b128 v[248:251], v6 offset:31744
    v_mov_b64 v[28:29], 0
    v_mov_b64 v[30:31], 0
    v_mov_b64 v[32:33], 0
    v_mov_b64 v[34:35], 0
    v_mov_b64 v[36:37], 0
    v_mov_b64 v[38:39], 0
    v_mov_b64 v[40:41], 0
    v_mov_b64 v[42:43], 0
    s_waitcnt lgkmcnt(2)
    v_smfmac_f32_16x16x64_bf16 v[8:11], v[44:47], v[96:103], v2
    s_mov_b32 s72, s75
    v_subrev_u32 v1, 0x10000, v1
    v_smfmac_f32_16x16x64_bf16 v[12:15], v[44:47], v[112:119], v2
    s_add_u32 s75, s75, 16384
    v_and_b32 v6, 0xffff, v4
    v_smfmac_f32_16x16x64_bf16 v[16:19], v[44:47], v[128:135], v2
    s_and_b32 s75, s75, 0xfffeffff
    s_waitcnt lgkmcnt(1)
    v_smfmac_f32_16x16x64_bf16 v[8:11], v[48:51], v[104:111], v2
    s_add_u32 s88, s75, s90
    v_smfmac_f32_16x16x64_bf16 v[12:15], v[48:51], v[120:127], v2
    v_smfmac_f32_16x16x64_bf16 v[20:23], v[44:47], v[144:151], v2
    v_add_f32 v8, v8, v10
    v_smfmac_f32_16x16x64_bf16 v[16:19], v[48:51], v[136:143], v2
    v_add_f32 v9, v9, v11
    v_smfmac_f32_16x16x64_bf16 v[20:23], v[48:51], v[152:159], v2
    v_add_f32 v12, v12, v14
    v_smfmac_f32_16x16x64_bf16 v[24:27], v[44:47], v[160:167], v2
    v_add_f32 v13, v13, v15
    v_smfmac_f32_16x16x64_bf16 v[28:31], v[44:47], v[176:183], v2
    v_cvt_pk_bf16_f32 v8, v8, v9
    v_smfmac_f32_16x16x64_bf16 v[32:35], v[44:47], v[192:199], v2
    v_cvt_pk_bf16_f32 v9, v12, v13
    v_smfmac_f32_16x16x64_bf16 v[24:27], v[48:51], v[168:175], v2
    buffer_store_dwordx2 v[8:9], v5, s[60:63], s3 offen sc1
    v_add_f32 v16, v16, v18
    v_smfmac_f32_16x16x64_bf16 v[28:31], v[48:51], v[184:191], v2
    v_add_f32 v17, v17, v19
    v_smfmac_f32_16x16x64_bf16 v[36:39], v[44:47], v[208:215], v2
    v_add_f32 v20, v20, v22
    v_smfmac_f32_16x16x64_bf16 v[40:43], v[44:47], v[224:231], v2
    v_add_f32 v21, v21, v23
    v_smfmac_f32_16x16x64_bf16 v[32:35], v[48:51], v[200:207], v2
    v_cvt_pk_bf16_f32 v16, v16, v17
    v_smfmac_f32_16x16x64_bf16 v[36:39], v[48:51], v[216:223], v2
    v_cvt_pk_bf16_f32 v17, v20, v21
    v_smfmac_f32_16x16x64_bf16 v[40:43], v[48:51], v[232:239], v2
    buffer_store_dwordx2 v[16:17], v5, s[60:63], s4 offen sc1
    v_add_f32 v24, v24, v26
    v_add_f32 v25, v25, v27
    v_add_f32 v28, v28, v30
    v_add_f32 v29, v29, v31
    v_cvt_pk_bf16_f32 v24, v24, v25
    v_cvt_pk_bf16_f32 v25, v28, v29
    buffer_store_dwordx2 v[24:25], v5, s[60:63], s5 offen sc1
    v_pk_add_f32 v[32:33], v[32:33], v[34:35]
    v_pk_add_f32 v[36:37], v[36:37], v[38:39]
    v_cvt_pk_bf16_f32 v32, v32, v33
    v_cvt_pk_bf16_f32 v33, v36, v37
    buffer_store_dwordx2 v[32:33], v5, s[60:63], s6 offen sc1
    v_pk_add_f32 v[40:41], v[40:41], v[42:43]
    v_mov_b64 v[28:29], -1
    v_cvt_pk_bf16_f32 v40, v40, v41
    v_mov_b64 v[30:31], -1
    v_mov_b64 v[8:9], 0
    v_mov_b32_dpp v41, v40 row_ror:8 row_mask:0xf bank_mask:0xf
    s_mov_b64 exec, s[92:93]
    buffer_store_dwordx2 v[40:41], v5, s[60:63], s7 offen sc1
    s_mov_b64 exec, -1
    s_waitcnt lgkmcnt(0)
    v_mov_b32 v40, -2
    v_mov_b32 v41, -2
    v_mov_b64 v[42:43], v[40:41]
    v_mov_b64 v[44:45], v[40:41]
    v_mov_b64 v[46:47], v[40:41]
    v_mov_b64 v[10:11], 0
    v_mov_b64 v[12:13], 0
    v_mov_b64 v[14:15], 0
    v_mov_b64 v[16:17], 0
    v_mov_b64 v[18:19], 0
    v_mov_b64 v[20:21], 0
    v_mov_b64 v[22:23], 0
    v_mov_b64 v[24:25], 0
    v_mov_b64 v[26:27], 0
    s_add_u32 s89, s75, s91
    s_add_u32 s94, s94, 0x80000
    s_add_u32 s95, s95, 0x80000
    s_add_u32 s101, s101, 0x80000
    s_add_u32 s83, s83, 0x10000
    s_add_u32 s84, s84, 0x10000
    v_xor_b32 v5, 0x80000, v5
    s_add_u32 s66, s66, 1
    s_cmp_eq_u32 s99, 0
    s_cbranch_scc1 Lnj2_109
    s_xor_b32 s67, s71, 0x80000
    buffer_store_dwordx4 v[28:31], v0, s[60:63], s67 offen sc1
    buffer_store_dwordx4 v[28:31], v0, s[60:63], s67 offen offset:1024 sc1
    buffer_load_dwordx4 v[56:59], v0, s[60:63], s70 offen sc1
    buffer_load_dwordx4 v[60:63], v0, s[60:63], s70 offen offset:1024 sc1
    buffer_load_dwordx4 v[40:43], v0, s[60:63], s71 offen sc1
    buffer_load_dwordx4 v[44:47], v0, s[60:63], s71 offen offset:1024 sc1
Lpl_111:
    v_max3_u32 v252, v56, v57, v58
    v_max3_u32 v253, v59, v60, v61
    v_max3_u32 v252, v252, v62, v63
    v_max_u32 v252, v252, v253
    v_cmp_le_u32 vcc, -2, v252
    s_add_u32 s74, s74, 1
    s_cbranch_vccz Lrok_110
    v_max3_u32 v252, v56, v57, v58
    v_max3_u32 v253, v59, v60, v61
    v_max3_u32 v252, v252, v62, v63
    v_max_u32 v252, v252, v253
    v_cmp_le_u32 vcc, -2, v252
    s_nop 0
    s_cbranch_vccz Lrok_110
    v_max3_u32 v252, v56, v57, v58
    v_max3_u32 v253, v59, v60, v61
    v_max3_u32 v252, v252, v62, v63
    v_max_u32 v252, v252, v253
    v_cmp_le_u32 vcc, -2, v252
    s_cmp_lt_u32 s74, 0x100000
    s_cbranch_vccz Lrok_110
    buffer_load_dwordx4 v[56:59], v0, s[60:63], s70 offen sc1
    v_mov_b32 v254, 0
    buffer_load_dwordx4 v[60:63], v0, s[60:63], s70 offen offset:1024 sc1
    v_mov_b32 v254, 0
    s_cbranch_scc1 Lpl_111
    s_branch L_fail
Lrok_110:
    v_mfma_f32_16x16x32_bf16 v[252:255], v[248:251], v[56:59], 0
    v_mfma_f32_16x16x32_bf16 v[252:255], v[248:251], v[60:63], v[252:255]
    s_nop 7
    v_add_f32_dpp v254, v252, v252 row_ror:8 row_mask:0xf bank_mask:0xf
    v_add_f32_dpp v255, v253, v253 row_ror:8 row_mask:0xf bank_mask:0xf
    s_nop 0
    v_add_f32_dpp v252, v254, v254 row_ror:4 row_mask:0xf bank_mask:0xf
    v_add_f32_dpp v253, v255, v255 row_ror:4 row_mask:0xf bank_mask:0xf
    s_mov_b64 exec, s[76:77]
    v_cvt_pk_bf16_f32 v252, v252, v253
    buffer_store_dword v252, v6, s[60:63], s75 offen sc1
    buffer_store_dword v28, v6, s[60:63], s72 offen sc1
    s_mov_b64 exec, -1
    v_lshrrev_b32 v6, 16, v4
Lpl_113:
    v_max3_u32 v252, v40, v41, v42
    v_max3_u32 v253, v43, v44, v45
    v_max3_u32 v252, v252, v46, v47
    v_max_u32 v252, v252, v253
    v_cmp_le_u32 vcc, -2, v252
    s_add_u32 s74, s74, 1
    s_cbranch_vccz Lrok_112
    v_max3_u32 v252, v40, v41, v42
    v_max3_u32 v253, v43, v44, v45
    v_max3_u32 v252, v252, v46, v47
    v_max_u32 v252, v252, v253
    v_cmp_le_u32 vcc, -2, v252
    s_nop 0
    s_cbranch_vccz Lrok_112
    v_max3_u32 v252, v40, v41, v42
    v_max3_u32 v253, v43, v44, v45
    v_max3_u32 v252, v252, v46, v47
    v_max_u32 v252, v252, v253
    v_cmp_le_u32 vcc, -2, v252
    s_cmp_lt_u32 s74, 0x100000
    s_cbranch_vccz Lrok_112
    buffer_load_dwordx4 v[40:43], v0, s[60:63], s71 offen sc1
    v_mov_b32 v254, 0
    buffer_load_dwordx4 v[44:47], v0, s[60:63], s71 offen offset:1024 sc1
    v_mov_b32 v254, 0
    s_cbranch_scc1 Lpl_113
    s_branch L_fail
Lrok_112:
    v_mfma_f32_16x16x32_bf16 v[252:255], v[248:251], v[40:43], 0
    v_mfma_f32_16x16x32_bf16 v[252:255], v[248:251], v[44:47], v[252:255]
    s_nop 7
    v_add_f32_dpp v254, v252, v252 row_ror:8 row_mask:0xf bank_mask:0xf
    v_add_f32_dpp v255, v253, v253 row_ror:8 row_mask:0xf bank_mask:0xf
    s_nop 0
    v_add_f32_dpp v252, v254, v254 row_ror:4 row_mask:0xf bank_mask:0xf
    v_add_f32_dpp v253, v255, v255 row_ror:4 row_mask:0xf bank_mask:0xf
    s_mov_b64 exec, s[76:77]
    v_cvt_pk_bf16_f32 v252, v252, v253
    buffer_store_dword v252, v6, s[60:63], s75 offen sc1
    buffer_store_dword v28, v6, s[60:63], s72 offen sc1
    s_mov_b64 exec, -1
    s_xor_b32 s71, s71, 0x80000
    s_xor_b32 s70, s70, 0x80000
    v_add_u32 v6, s98, v0
    ds_read_b128 v[48:51], v6 offset:12288
    ds_read_b128 v[52:55], v6 offset:13312
    v_mov_b64 v[28:29], 0
    v_mov_b64 v[30:31], 0
    s_waitcnt vmcnt(2)
    s_branch Lbar1_102
Lnj2_109:
    buffer_load_dwordx4 v[56:59], v0, s[60:63], s70 offen sc1
    buffer_load_dwordx4 v[60:63], v0, s[60:63], s70 offen offset:1024 sc1
Lpl_115:
    v_max3_u32 v252, v56, v57, v58
    v_max3_u32 v253, v59, v60, v61
    v_max3_u32 v252, v252, v62, v63
    v_max_u32 v252, v252, v253
    v_cmp_le_u32 vcc, -2, v252
    s_add_u32 s74, s74, 1
    s_cbranch_vccz Lrok_114
    v_max3_u32 v252, v56, v57, v58
    v_max3_u32 v253, v59, v60, v61
    v_max3_u32 v252, v252, v62, v63
    v_max_u32 v252, v252, v253
    v_cmp_le_u32 vcc, -2, v252
    s_nop 0
    s_cbranch_vccz Lrok_114
    v_max3_u32 v252, v56, v57, v58
    v_max3_u32 v253, v59, v60, v61
    v_max3_u32 v252, v252, v62, v63
    v_max_u32 v252, v252, v253
    v_cmp_le_u32 vcc, -2, v252
    s_cmp_lt_u32 s74, 0x100000
    s_cbranch_vccz Lrok_114
    buffer_load_dwordx4 v[56:59], v0, s[60:63], s70 offen sc1
    v_mov_b32 v254, 0
    buffer_load_dwordx4 v[60:63], v0, s[60:63], s70 offen offset:1024 sc1
    v_mov_b32 v254, 0
    s_cbranch_scc1 Lpl_115
    s_branch L_fail
Lrok_114:
    v_mfma_f32_16x16x32_bf16 v[252:255], v[248:251], v[56:59], 0
    v_mfma_f32_16x16x32_bf16 v[252:255], v[248:251], v[60:63], v[252:255]
    s_nop 7
    v_add_f32_dpp v254, v252, v252 row_ror:8 row_mask:0xf bank_mask:0xf
    v_add_f32_dpp v255, v253, v253 row_ror:8 row_mask:0xf bank_mask:0xf
    s_nop 0
    v_add_f32_dpp v252, v254, v254 row_ror:4 row_mask:0xf bank_mask:0xf
    v_add_f32_dpp v253, v255, v255 row_ror:4 row_mask:0xf bank_mask:0xf
    s_mov_b64 exec, s[76:77]
    v_cvt_pk_bf16_f32 v252, v252, v253
    buffer_store_dword v252, v6, s[60:63], s75 offen sc1
    buffer_store_dword v28, v6, s[60:63], s72 offen sc1
    s_mov_b64 exec, -1
    s_xor_b32 s70, s70, 0x80000
    v_add_u32 v6, s98, v0
    ds_read_b128 v[48:51], v6 offset:12288
    ds_read_b128 v[52:55], v6 offset:13312
    v_mov_b64 v[28:29], 0
    v_mov_b64 v[30:31], 0
    s_waitcnt vmcnt(0)
    s_branch Lbar1_102
Lpr_103:
    buffer_load_dwordx4 v[44:47], v0, s[60:63], s89 offen sc1
    s_add_u32 s74, s74, 1
    s_cmp_ge_u32 s74, 0x100000
    s_cbranch_scc1 L_fail
    s_waitcnt vmcnt(0)
    v_max3_u32 v6, v44, v45, v46
    v_max_u32 v6, v6, v47
    v_cmp_eq_u32 vcc, -1, v6
    v_add_u32 v6, s91, v0
    s_cbranch_vccnz Lpr_103
    s_branch Lpc_104
Lkv_105:
    buffer_load_dword v6, off, s[56:59], 0 offset:148 sc1
    s_add_u32 s74, s74, 1
    s_cmp_ge_u32 s74, 0x100000
    s_cbranch_scc1 L_fail
    s_waitcnt vmcnt(0)
    v_readfirstlane_b32 s67, v6
    s_cmp_lt_u32 s67, 224
    s_cbranch_scc1 Lkv_105
    s_branch Lkvc_106
Llast_107:
    s_waitcnt vmcnt(0)
    s_barrier
    v_mov_b32 v60, 64
    s_mov_b64 exec, 1
    buffer_store_dword v60, off, s[60:63], s100 sc1
    s_mov_b64 exec, -1
    s_branch L_done
L_worker:
    v_and_b32 v0, 63, v0
    s_lshr_b32 s88, s64, 5
    s_sub_u32 s88, s88, 1
    s_and_b32 s89, s64, 31
    s_and_b32 s66, s89, 3
    s_lshr_b32 s67, s89, 2
    s_lshl_b32 s68, s88, 3
    s_add_u32 s67, s67, s68
L_p1pass:
    s_waitcnt vmcnt(0) lgkmcnt(0)
    s_barrier
    v_and_b32 v12, 15, v0
    v_lshrrev_b32 v13, 4, v0
    v_lshlrev_b32 v1, 4, v0
    s_lshl_b32 s68, s66, 2
    s_add_u32 s68, s68, s65
    s_mul_i32 s86, s68, 73728
    v_lshrrev_b32 v2, 3, v0
    v_and_b32 v3, 7, v0
    v_bfe_u32 v15, v0, 4, 1
    v_lshlrev_b32 v15, 1, v15
    v_xor_b32 v3, v3, v15
    v_lshlrev_b32 v3, 4, v3
    s_mul_i32 s70, s65, 48
    v_add_u32 v2, s70, v2
    v_lshl_add_u32 v4, v2, 13, v3
    v_mul_u32_u24 v168, 9216, v2
    v_add_u32 v168, v168, v3
    s_mul_i32 s80, s65, 6144
    s_mov_b32 s76, s67
    s_mov_b32 s90, 0
    s_lshr_b32 s70, s76, 6
    s_and_b32 s71, s76, 63
    s_sub_u32 s79, s76, 192
    s_mov_b32 s72, s20
    s_mov_b32 s73, s21
    s_mov_b32 s74, s22
    s_cmp_eq_u32 s70, 1
    s_cselect_b32 s72, s24, s72
    s_cselect_b32 s73, s25, s73
    s_cmp_eq_u32 s70, 2
    s_cselect_b32 s72, s16, s72
    s_cselect_b32 s73, s17, s73
    s_mov_b32 s78, 65536
    s_cmp_ge_u32 s70, 3
    s_cselect_b32 s72, s32, s72
    s_cselect_b32 s73, s33, s73
    s_cselect_b32 s74, s34, s74
    s_mov_b32 s75, 0x20000
    s_cselect_b32 s78, 73728, s78
    s_cselect_b32 s79, s79, s71
    s_cselect_b64 vcc, -1, 0
    s_lshl_b32 s79, s79, 7
    v_cndmask_b32 v169, v4, v168, vcc
    v_xor_b32 v178, 64, v169
    v_lshrrev_b32 v2, 2, v0
    v_mul_u32_u24 v9, 1152, v2
    v_and_b32 v2, 3, v0
    v_lshl_add_u32 v9, v2, 4, v9
    s_mul_i32 s92, s65, 36864
    v_lshlrev_b32 v14, 6, v12
    v_lshl_add_u32 v14, v13, 4, v14
    v_add_u32 v14, s92, v14
    s_mul_i32 s70, s65, 144
    v_add_u32 v2, s70, v0
    v_lshlrev_b32 v2, 13, v2
    buffer_load_dword v15, v2, s[72:75], s79 offen
    s_add_u32 s70, s79, 524288
    buffer_load_dword v15, v2, s[72:75], s70 offen
    s_add_u32 s70, s79, 655360
    buffer_load_dword v15, v2, s[72:75], s70 offen
    s_add_u32 m0, s92, 2048
    s_nop 0
    buffer_load_dwordx4 v9, s[8:11], s86 offen offset:0 lds
    s_add_u32 m0, s92, 3008
    s_nop 0
    buffer_load_dwordx4 v9, s[8:11], s86 offen offset:64 lds
    s_add_u32 m0, s92, 3968
    s_nop 0
    buffer_load_dwordx4 v9, s[8:11], s86 offen offset:128 lds
    s_add_u32 m0, s92, 4928
    s_nop 0
    buffer_load_dwordx4 v9, s[8:11], s86 offen offset:192 lds
    s_add_u32 m0, s92, 5888
    s_nop 0
    buffer_load_dwordx4 v9, s[8:11], s86 offen offset:256 lds
    s_add_u32 m0, s92, 6848
    s_nop 0
    buffer_load_dwordx4 v9, s[8:11], s86 offen offset:320 lds
    s_add_u32 m0, s92, 7808
    s_nop 0
    buffer_load_dwordx4 v9, s[8:11], s86 offen offset:384 lds
    s_add_u32 m0, s92, 8768
    s_nop 0
    buffer_load_dwordx4 v9, s[8:11], s86 offen offset:448 lds
    s_add_u32 m0, s92, 9728
    s_nop 0
    buffer_load_dwordx4 v9, s[8:11], s86 offen offset:512 lds
    s_add_u32 m0, s92, 10688
    s_nop 0
    buffer_load_dwordx4 v9, s[8:11], s86 offen offset:576 lds
    s_add_u32 m0, s92, 11648
    s_nop 0
    buffer_load_dwordx4 v9, s[8:11], s86 offen offset:640 lds
    s_add_u32 m0, s92, 12608
    s_nop 0
    buffer_load_dwordx4 v9, s[8:11], s86 offen offset:704 lds
    s_add_u32 m0, s92, 13568
    s_nop 0
    buffer_load_dwordx4 v9, s[8:11], s86 offen offset:768 lds
    s_add_u32 m0, s92, 14528
    s_nop 0
    buffer_load_dwordx4 v9, s[8:11], s86 offen offset:832 lds
    s_add_u32 m0, s92, 15488
    s_nop 0
    buffer_load_dwordx4 v9, s[8:11], s86 offen offset:896 lds
    s_add_u32 m0, s92, 16448
    s_nop 0
    buffer_load_dwordx4 v9, s[8:11], s86 offen offset:960 lds
    s_add_u32 m0, s92, 17408
    s_nop 0
    buffer_load_dwordx4 v9, s[8:11], s86 offen offset:1024 lds
    s_add_u32 m0, s92, 18368
    s_nop 0
    buffer_load_dwordx4 v9, s[8:11], s86 offen offset:1088 lds
    s_add_u32 s86, s86, 18432
    s_add_u32 m0, s92, 20480
    s_nop 0
    buffer_load_dwordx4 v9, s[8:11], s86 offen offset:0 lds
    s_add_u32 m0, s92, 21440
    s_nop 0
    buffer_load_dwordx4 v9, s[8:11], s86 offen offset:64 lds
    s_add_u32 m0, s92, 22400
    s_nop 0
    buffer_load_dwordx4 v9, s[8:11], s86 offen offset:128 lds
    s_add_u32 m0, s92, 23360
    s_nop 0
    buffer_load_dwordx4 v9, s[8:11], s86 offen offset:192 lds
    s_add_u32 m0, s92, 24320
    s_nop 0
    buffer_load_dwordx4 v9, s[8:11], s86 offen offset:256 lds
    s_add_u32 m0, s92, 25280
    s_nop 0
    buffer_load_dwordx4 v9, s[8:11], s86 offen offset:320 lds
    s_add_u32 m0, s92, 26240
    s_nop 0
    buffer_load_dwordx4 v9, s[8:11], s86 offen offset:384 lds
    s_add_u32 m0, s92, 27200
    s_nop 0
    buffer_load_dwordx4 v9, s[8:11], s86 offen offset:448 lds
    s_add_u32 m0, s92, 28160
    s_nop 0
    buffer_load_dwordx4 v9, s[8:11], s86 offen offset:512 lds
    s_add_u32 m0, s92, 29120
    s_nop 0
    buffer_load_dwordx4 v9, s[8:11], s86 offen offset:576 lds
    s_add_u32 m0, s92, 30080
    s_nop 0
    buffer_load_dwordx4 v9, s[8:11], s86 offen offset:640 lds
    s_add_u32 m0, s92, 31040
    s_nop 0
    buffer_load_dwordx4 v9, s[8:11], s86 offen offset:704 lds
    s_add_u32 m0, s92, 32000
    s_nop 0
    buffer_load_dwordx4 v9, s[8:11], s86 offen offset:768 lds
    s_add_u32 m0, s92, 32960
    s_nop 0
    buffer_load_dwordx4 v9, s[8:11], s86 offen offset:832 lds
    s_add_u32 m0, s92, 33920
    s_nop 0
    buffer_load_dwordx4 v9, s[8:11], s86 offen offset:896 lds
    s_add_u32 m0, s92, 34880
    s_nop 0
    buffer_load_dwordx4 v9, s[8:11], s86 offen offset:960 lds
    s_add_u32 m0, s92, 35840
    s_nop 0
    buffer_load_dwordx4 v9, s[8:11], s86 offen offset:1024 lds
    s_add_u32 m0, s92, 36800
    s_nop 0
    buffer_load_dwordx4 v9, s[8:11], s86 offen offset:1088 lds
    s_waitcnt vmcnt(30)
    ds_read_b128 a[0:3], v14 offset:2048
    ds_read_b128 a[4:7], v14 offset:3072
    ds_read_b128 a[8:11], v14 offset:4096
    ds_read_b128 a[12:15], v14 offset:5120
    ds_read_b128 a[16:19], v14 offset:6144
    ds_read_b128 a[20:23], v14 offset:7168
    s_waitcnt vmcnt(24)
    ds_read_b128 a[24:27], v14 offset:8192
    ds_read_b128 a[28:31], v14 offset:9216
    ds_read_b128 a[32:35], v14 offset:10240
    ds_read_b128 a[36:39], v14 offset:11264
    ds_read_b128 a[40:43], v14 offset:12288
    ds_read_b128 a[44:47], v14 offset:13312
    s_waitcnt vmcnt(18)
    ds_read_b128 a[48:51], v14 offset:14336
    ds_read_b128 a[52:55], v14 offset:15360
    ds_read_b128 a[56:59], v14 offset:16384
    ds_read_b128 a[60:63], v14 offset:17408
    ds_read_b128 a[64:67], v14 offset:18432
    ds_read_b128 a[68:71], v14 offset:19456
    s_waitcnt vmcnt(12)
    ds_read_b128 a[72:75], v14 offset:20480
    ds_read_b128 a[76:79], v14 offset:21504
    ds_read_b128 a[80:83], v14 offset:22528
    ds_read_b128 a[84:87], v14 offset:23552
    ds_read_b128 a[88:91], v14 offset:24576
    ds_read_b128 a[92:95], v14 offset:25600
    s_waitcnt vmcnt(6)
    ds_read_b128 a[96:99], v14 offset:26624
    ds_read_b128 a[100:103], v14 offset:27648
    ds_read_b128 a[104:107], v14 offset:28672
    ds_read_b128 a[108:111], v14 offset:29696
    ds_read_b128 a[112:115], v14 offset:30720
    ds_read_b128 a[116:119], v14 offset:31744
    s_waitcnt vmcnt(0)
    ds_read_b128 a[120:123], v14 offset:32768
    ds_read_b128 a[124:127], v14 offset:33792
    ds_read_b128 a[128:131], v14 offset:34816
    ds_read_b128 a[132:135], v14 offset:35840
    ds_read_b128 a[136:139], v14 offset:36864
    ds_read_b128 a[140:143], v14 offset:37888
    s_waitcnt lgkmcnt(0)
    s_add_u32 s86, s86, 18432
    s_add_u32 m0, s92, 2048
    s_nop 0
    buffer_load_dwordx4 v9, s[8:11], s86 offen offset:0 lds
    s_add_u32 m0, s92, 3008
    s_nop 0
    buffer_load_dwordx4 v9, s[8:11], s86 offen offset:64 lds
    s_add_u32 m0, s92, 3968
    s_nop 0
    buffer_load_dwordx4 v9, s[8:11], s86 offen offset:128 lds
    s_add_u32 m0, s92, 4928
    s_nop 0
    buffer_load_dwordx4 v9, s[8:11], s86 offen offset:192 lds
    s_add_u32 m0, s92, 5888
    s_nop 0
    buffer_load_dwordx4 v9, s[8:11], s86 offen offset:256 lds
    s_add_u32 m0, s92, 6848
    s_nop 0
    buffer_load_dwordx4 v9, s[8:11], s86 offen offset:320 lds
    s_add_u32 m0, s92, 7808
    s_nop 0
    buffer_load_dwordx4 v9, s[8:11], s86 offen offset:384 lds
    s_add_u32 m0, s92, 8768
    s_nop 0
    buffer_load_dwordx4 v9, s[8:11], s86 offen offset:448 lds
    s_add_u32 m0, s92, 9728
    s_nop 0
    buffer_load_dwordx4 v9, s[8:11], s86 offen offset:512 lds
    s_add_u32 m0, s92, 10688
    s_nop 0
    buffer_load_dwordx4 v9, s[8:11], s86 offen offset:576 lds
    s_add_u32 m0, s92, 11648
    s_nop 0
    buffer_load_dwordx4 v9, s[8:11], s86 offen offset:640 lds
    s_add_u32 m0, s92, 12608
    s_nop 0
    buffer_load_dwordx4 v9, s[8:11], s86 offen offset:704 lds
    s_add_u32 m0, s92, 13568
    s_nop 0
    buffer_load_dwordx4 v9, s[8:11], s86 offen offset:768 lds
    s_add_u32 m0, s92, 14528
    s_nop 0
    buffer_load_dwordx4 v9, s[8:11], s86 offen offset:832 lds
    s_add_u32 m0, s92, 15488
    s_nop 0
    buffer_load_dwordx4 v9, s[8:11], s86 offen offset:896 lds
    s_add_u32 m0, s92, 16448
    s_nop 0
    buffer_load_dwordx4 v9, s[8:11], s86 offen offset:960 lds
    s_add_u32 m0, s92, 17408
    s_nop 0
    buffer_load_dwordx4 v9, s[8:11], s86 offen offset:1024 lds
    s_add_u32 m0, s92, 18368
    s_nop 0
    buffer_load_dwordx4 v9, s[8:11], s86 offen offset:1088 lds
    s_add_u32 s86, s86, 18432
    s_add_u32 m0, s92, 20480
    s_nop 0
    buffer_load_dwordx4 v9, s[8:11], s86 offen offset:0 lds
    s_add_u32 m0, s92, 21440
    s_nop 0
    buffer_load_dwordx4 v9, s[8:11], s86 offen offset:64 lds
    s_add_u32 m0, s92, 22400
    s_nop 0
    buffer_load_dwordx4 v9, s[8:11], s86 offen offset:128 lds
    s_add_u32 m0, s92, 23360
    s_nop 0
    buffer_load_dwordx4 v9, s[8:11], s86 offen offset:192 lds
    s_add_u32 m0, s92, 24320
    s_nop 0
    buffer_load_dwordx4 v9, s[8:11], s86 offen offset:256 lds
    s_add_u32 m0, s92, 25280
    s_nop 0
    buffer_load_dwordx4 v9, s[8:11], s86 offen offset:320 lds
    s_add_u32 m0, s92, 26240
    s_nop 0
    buffer_load_dwordx4 v9, s[8:11], s86 offen offset:384 lds
    s_add_u32 m0, s92, 27200
    s_nop 0
    buffer_load_dwordx4 v9, s[8:11], s86 offen offset:448 lds
    s_add_u32 m0, s92, 28160
    s_nop 0
    buffer_load_dwordx4 v9, s[8:11], s86 offen offset:512 lds
    s_add_u32 m0, s92, 29120
    s_nop 0
    buffer_load_dwordx4 v9, s[8:11], s86 offen offset:576 lds
    s_add_u32 m0, s92, 30080
    s_nop 0
    buffer_load_dwordx4 v9, s[8:11], s86 offen offset:640 lds
    s_add_u32 m0, s92, 31040
    s_nop 0
    buffer_load_dwordx4 v9, s[8:11], s86 offen offset:704 lds
    s_add_u32 m0, s92, 32000
    s_nop 0
    buffer_load_dwordx4 v9, s[8:11], s86 offen offset:768 lds
    s_add_u32 m0, s92, 32960
    s_nop 0
    buffer_load_dwordx4 v9, s[8:11], s86 offen offset:832 lds
    s_add_u32 m0, s92, 33920
    s_nop 0
    buffer_load_dwordx4 v9, s[8:11], s86 offen offset:896 lds
    s_add_u32 m0, s92, 34880
    s_nop 0
    buffer_load_dwordx4 v9, s[8:11], s86 offen offset:960 lds
    s_add_u32 m0, s92, 35840
    s_nop 0
    buffer_load_dwordx4 v9, s[8:11], s86 offen offset:1024 lds
    s_add_u32 m0, s92, 36800
    s_nop 0
    buffer_load_dwordx4 v9, s[8:11], s86 offen offset:1088 lds
    s_waitcnt vmcnt(30)
    ds_read_b128 a[144:147], v14 offset:2048
    ds_read_b128 a[148:151], v14 offset:3072
    ds_read_b128 a[152:155], v14 offset:4096
    ds_read_b128 a[156:159], v14 offset:5120
    ds_read_b128 a[160:163], v14 offset:6144
    ds_read_b128 a[164:167], v14 offset:7168
    s_waitcnt vmcnt(24)
    ds_read_b128 a[168:171], v14 offset:8192
    ds_read_b128 a[172:175], v14 offset:9216
    ds_read_b128 a[176:179], v14 offset:10240
    ds_read_b128 a[180:183], v14 offset:11264
    ds_read_b128 a[184:187], v14 offset:12288
    ds_read_b128 a[188:191], v14 offset:13312
    s_waitcnt vmcnt(18)
    ds_read_b128 a[192:195], v14 offset:14336
    ds_read_b128 a[196:199], v14 offset:15360
    ds_read_b128 a[200:203], v14 offset:16384
    ds_read_b128 a[204:207], v14 offset:17408
    ds_read_b128 a[208:211], v14 offset:18432
    ds_read_b128 a[212:215], v14 offset:19456
    s_waitcnt vmcnt(12)
    ds_read_b128 a[216:219], v14 offset:20480
    ds_read_b128 a[220:223], v14 offset:21504
    ds_read_b128 a[224:227], v14 offset:22528
    ds_read_b128 a[228:231], v14 offset:23552
    ds_read_b128 a[232:235], v14 offset:24576
    ds_read_b128 a[236:239], v14 offset:25600
    s_waitcnt vmcnt(6)
    ds_read_b128 a[240:243], v14 offset:26624
    ds_read_b128 a[244:247], v14 offset:27648
    ds_read_b128 a[248:251], v14 offset:28672
    ds_read_b128 a[252:255], v14 offset:29696
    ds_read_b128 v[224:227], v14 offset:30720
    ds_read_b128 v[228:231], v14 offset:31744
    s_waitcnt vmcnt(0)
    ds_read_b128 v[232:235], v14 offset:32768
    ds_read_b128 v[236:239], v14 offset:33792
    ds_read_b128 v[240:243], v14 offset:34816
    ds_read_b128 v[244:247], v14 offset:35840
    ds_read_b128 v[248:251], v14 offset:36864
    ds_read_b128 v[252:255], v14 offset:37888
    s_waitcnt lgkmcnt(0)
    s_barrier
    s_mov_b32 s91, s79
    s_add_u32 s92, s90, s80
    s_add_u32 m0, s92, 0
    s_nop 0
    buffer_load_dwordx4 v169, s[72:75], s91 offen lds
    s_add_u32 s91, s91, s78
    s_add_u32 m0, s92, 1024
    s_nop 0
    buffer_load_dwordx4 v178, s[72:75], s91 offen lds
    s_add_u32 s91, s91, s78
    s_add_u32 m0, s92, 2048
    s_nop 0
    buffer_load_dwordx4 v169, s[72:75], s91 offen lds
    s_add_u32 s91, s91, s78
    s_add_u32 m0, s92, 3072
    s_nop 0
    buffer_load_dwordx4 v178, s[72:75], s91 offen lds
    s_add_u32 s91, s91, s78
    s_add_u32 m0, s92, 4096
    s_nop 0
    buffer_load_dwordx4 v169, s[72:75], s91 offen lds
    s_add_u32 s91, s91, s78
    s_add_u32 m0, s92, 5120
    s_nop 0
    buffer_load_dwordx4 v178, s[72:75], s91 offen lds
    s_mul_i32 s68, s78, 19
    s_add_u32 s91, s91, s68
    s_add_u32 m0, s92, 24576
    s_nop 0
    buffer_load_dwordx4 v169, s[72:75], s91 offen lds
    s_add_u32 s91, s91, s78
    s_add_u32 m0, s92, 25600
    s_nop 0
    buffer_load_dwordx4 v178, s[72:75], s91 offen lds
    s_add_u32 s91, s91, s78
    s_add_u32 m0, s92, 26624
    s_nop 0
    buffer_load_dwordx4 v169, s[72:75], s91 offen lds
    s_add_u32 s91, s91, s78
    s_add_u32 m0, s92, 27648
    s_nop 0
    buffer_load_dwordx4 v178, s[72:75], s91 offen lds
    s_add_u32 s91, s91, s78
    s_add_u32 m0, s92, 28672
    s_nop 0
    buffer_load_dwordx4 v169, s[72:75], s91 offen lds
    s_add_u32 s91, s91, s78
    s_add_u32 m0, s92, 29696
    s_nop 0
    buffer_load_dwordx4 v178, s[72:75], s91 offen lds
    s_mul_i32 s68, s78, 19
    s_add_u32 s91, s91, s68
    s_add_u32 m0, s92, 49152
    s_nop 0
    buffer_load_dwordx4 v169, s[72:75], s91 offen lds
    s_add_u32 s91, s91, s78
    s_add_u32 m0, s92, 50176
    s_nop 0
    buffer_load_dwordx4 v178, s[72:75], s91 offen lds
    s_add_u32 s91, s91, s78
    s_add_u32 m0, s92, 51200
    s_nop 0
    buffer_load_dwordx4 v169, s[72:75], s91 offen lds
    s_add_u32 s91, s91, s78
    s_add_u32 m0, s92, 52224
    s_nop 0
    buffer_load_dwordx4 v178, s[72:75], s91 offen lds
    s_add_u32 s91, s91, s78
    s_add_u32 m0, s92, 53248
    s_nop 0
    buffer_load_dwordx4 v169, s[72:75], s91 offen lds
    s_add_u32 s91, s91, s78
    s_add_u32 m0, s92, 54272
    s_nop 0
    buffer_load_dwordx4 v178, s[72:75], s91 offen lds
    v_bfe_u32 v2, v0, 2, 2
    v_lshl_add_u32 v3, v13, 3, v2
    v_lshlrev_b32 v3, 7, v3
    v_and_b32 v15, 3, v0
    v_lshl_add_u32 v3, v15, 3, v3
    v_lshrrev_b32 v2, 1, v2
    v_and_b32 v15, 1, v13
    v_lshl_add_u32 v2, v15, 1, v2
    v_lshl_add_u32 v5, v2, 5, v3
    v_xor_b32 v6, 32, v5
    v_xor_b32 v7, 64, v5
    v_xor_b32 v8, 96, v5
    v_lshlrev_b32 v11, 3, v13
    s_mov_b32 s84, 0xc0135761
    s_mov_b32 s85, 0xbdd2d3e8
    v_mov_b32 v10, s84
    s_waitcnt vmcnt(0)
Lp1_116:
    s_waitcnt vmcnt(8)
    s_barrier
    s_sub_u32 s69, s76, 192
    s_max_i32 s69, s69, 0
    s_lshl_b32 s70, s69, 7
    buffer_load_dwordx2 v[128:129], v11, s[36:39], s70 offen offset:0
    buffer_load_dwordx2 v[130:131], v11, s[36:39], s70 offen offset:32
    buffer_load_dwordx2 v[132:133], v11, s[36:39], s70 offen offset:64
    buffer_load_dwordx2 v[134:135], v11, s[36:39], s70 offen offset:96
    v_add_u32 v170, s90, v5
    v_add_u32 v174, 49152, v170
    v_add_u32 v171, s90, v6
    v_add_u32 v175, 49152, v171
    v_add_u32 v172, s90, v7
    v_add_u32 v176, 49152, v172
    v_add_u32 v173, s90, v8
    v_add_u32 v177, 49152, v173
    s_add_u32 s77, s76, 56
    s_min_u32 s86, s77, 263
    s_lshr_b32 s83, s76, 6
    s_cmp_eq_u32 s83, 1
    s_cbranch_scc1 Lp1v_117
    ds_read_b64_tr_b16 v[80:81], v170 offset:0
    ds_read_b64_tr_b16 v[82:83], v170 offset:512
    ds_read_b64_tr_b16 v[84:85], v171 offset:0
    ds_read_b64_tr_b16 v[86:87], v171 offset:512
    ds_read_b64_tr_b16 v[88:89], v172 offset:0
    ds_read_b64_tr_b16 v[90:91], v172 offset:512
    ds_read_b64_tr_b16 v[92:93], v173 offset:0
    ds_read_b64_tr_b16 v[94:95], v173 offset:512
    ds_read_b64_tr_b16 v[96:97], v170 offset:4096
    ds_read_b64_tr_b16 v[98:99], v170 offset:4608
    ds_read_b64_tr_b16 v[100:101], v171 offset:4096
    ds_read_b64_tr_b16 v[102:103], v171 offset:4608
    ds_read_b64_tr_b16 v[104:105], v172 offset:4096
    ds_read_b64_tr_b16 v[106:107], v172 offset:4608
    ds_read_b64_tr_b16 v[108:109], v173 offset:4096
    ds_read_b64_tr_b16 v[110:111], v173 offset:4608
    s_lshr_b32 s70, s86, 6
    s_and_b32 s71, s86, 63
    s_sub_u32 s79, s86, 192
    s_mov_b32 s72, s20
    s_mov_b32 s73, s21
    s_mov_b32 s74, s22
    s_cmp_eq_u32 s70, 1
    s_cselect_b32 s72, s24, s72
    s_cselect_b32 s73, s25, s73
    s_cmp_eq_u32 s70, 2
    s_cselect_b32 s72, s16, s72
    s_cselect_b32 s73, s17, s73
    s_mov_b32 s78, 65536
    s_cmp_ge_u32 s70, 3
    s_cselect_b32 s72, s32, s72
    s_cselect_b32 s73, s33, s73
    s_cselect_b32 s74, s34, s74
    s_mov_b32 s75, 0x20000
    s_cselect_b32 s78, 73728, s78
    s_cselect_b32 s79, s79, s71
    s_cselect_b64 vcc, -1, 0
    s_lshl_b32 s79, s79, 7
    v_cndmask_b32 v169, v4, v168, vcc
    v_xor_b32 v178, 64, v169
    s_xor_b32 s86, s90, 73728
    s_mov_b32 s91, s79
    s_add_u32 s92, s86, s80
    s_waitcnt lgkmcnt(14)
    v_mfma_f32_16x16x32_bf16 v[16:19], v[80:83], a[0:3], 0
    ds_read_b64_tr_b16 v[112:113], v170 offset:8192
    ds_read_b64_tr_b16 v[114:115], v170 offset:8704
    v_mfma_f32_16x16x32_bf16 v[32:35], v[80:83], a[72:75], 0
    v_mfma_f32_16x16x32_bf16 v[48:51], v[80:83], a[144:147], 0
    v_mfma_f32_16x16x32_bf16 v[64:67], v[80:83], a[216:219], 0
    s_waitcnt lgkmcnt(14)
    v_mfma_f32_16x16x32_bf16 v[20:23], v[84:87], a[0:3], 0
    ds_read_b64_tr_b16 v[116:117], v171 offset:8192
    ds_read_b64_tr_b16 v[118:119], v171 offset:8704
    v_mfma_f32_16x16x32_bf16 v[36:39], v[84:87], a[72:75], 0
    v_mfma_f32_16x16x32_bf16 v[52:55], v[84:87], a[144:147], 0
    s_add_u32 m0, s92, 0
    s_nop 0
    buffer_load_dwordx4 v169, s[72:75], s91 offen lds
    s_add_u32 s91, s91, s78
    v_mfma_f32_16x16x32_bf16 v[68:71], v[84:87], a[216:219], 0
    s_waitcnt lgkmcnt(14)
    v_mfma_f32_16x16x32_bf16 v[24:27], v[88:91], a[0:3], 0
    ds_read_b64_tr_b16 v[120:121], v172 offset:8192
    ds_read_b64_tr_b16 v[122:123], v172 offset:8704
    v_mfma_f32_16x16x32_bf16 v[40:43], v[88:91], a[72:75], 0
    v_mfma_f32_16x16x32_bf16 v[56:59], v[88:91], a[144:147], 0
    v_mfma_f32_16x16x32_bf16 v[72:75], v[88:91], a[216:219], 0
    s_waitcnt lgkmcnt(14)
    v_mfma_f32_16x16x32_bf16 v[28:31], v[92:95], a[0:3], 0
    ds_read_b64_tr_b16 v[124:125], v173 offset:8192
    ds_read_b64_tr_b16 v[126:127], v173 offset:8704
    v_mfma_f32_16x16x32_bf16 v[44:47], v[92:95], a[72:75], 0
    v_mfma_f32_16x16x32_bf16 v[60:63], v[92:95], a[144:147], 0
    s_add_u32 m0, s92, 1024
    s_nop 0
    buffer_load_dwordx4 v178, s[72:75], s91 offen lds
    s_add_u32 s91, s91, s78
    v_mfma_f32_16x16x32_bf16 v[76:79], v[92:95], a[216:219], 0
    s_waitcnt lgkmcnt(14)
    v_mfma_f32_16x16x32_bf16 v[16:19], v[96:99], a[4:7], v[16:19]
    ds_read_b64_tr_b16 v[80:81], v170 offset:12288
    ds_read_b64_tr_b16 v[82:83], v170 offset:12800
    v_mfma_f32_16x16x32_bf16 v[32:35], v[96:99], a[76:79], v[32:35]
    v_mfma_f32_16x16x32_bf16 v[48:51], v[96:99], a[148:151], v[48:51]
    v_mfma_f32_16x16x32_bf16 v[64:67], v[96:99], a[220:223], v[64:67]
    s_waitcnt lgkmcnt(14)
    v_mfma_f32_16x16x32_bf16 v[20:23], v[100:103], a[4:7], v[20:23]
    ds_read_b64_tr_b16 v[84:85], v171 offset:12288
    ds_read_b64_tr_b16 v[86:87], v171 offset:12800
    v_mfma_f32_16x16x32_bf16 v[36:39], v[100:103], a[76:79], v[36:39]
    v_mfma_f32_16x16x32_bf16 v[52:55], v[100:103], a[148:151], v[52:55]
    s_add_u32 m0, s92, 2048
    s_nop 0
    buffer_load_dwordx4 v169, s[72:75], s91 offen lds
    s_add_u32 s91, s91, s78
    v_mfma_f32_16x16x32_bf16 v[68:71], v[100:103], a[220:223], v[68:71]
    s_waitcnt lgkmcnt(14)
    v_mfma_f32_16x16x32_bf16 v[24:27], v[104:107], a[4:7], v[24:27]
    ds_read_b64_tr_b16 v[88:89], v172 offset:12288
    ds_read_b64_tr_b16 v[90:91], v172 offset:12800
    v_mfma_f32_16x16x32_bf16 v[40:43], v[104:107], a[76:79], v[40:43]
    v_mfma_f32_16x16x32_bf16 v[56:59], v[104:107], a[148:151], v[56:59]
    v_mfma_f32_16x16x32_bf16 v[72:75], v[104:107], a[220:223], v[72:75]
    s_waitcnt lgkmcnt(14)
    v_mfma_f32_16x16x32_bf16 v[28:31], v[108:111], a[4:7], v[28:31]
    ds_read_b64_tr_b16 v[92:93], v173 offset:12288
    ds_read_b64_tr_b16 v[94:95], v173 offset:12800
    v_mfma_f32_16x16x32_bf16 v[44:47], v[108:111], a[76:79], v[44:47]
    v_mfma_f32_16x16x32_bf16 v[60:63], v[108:111], a[148:151], v[60:63]
    s_add_u32 m0, s92, 3072
    s_nop 0
    buffer_load_dwordx4 v178, s[72:75], s91 offen lds
    s_add_u32 s91, s91, s78
    v_mfma_f32_16x16x32_bf16 v[76:79], v[108:111], a[220:223], v[76:79]
    s_waitcnt lgkmcnt(14)
    v_mfma_f32_16x16x32_bf16 v[16:19], v[112:115], a[8:11], v[16:19]
    ds_read_b64_tr_b16 v[96:97], v170 offset:16384
    ds_read_b64_tr_b16 v[98:99], v170 offset:16896
    v_mfma_f32_16x16x32_bf16 v[32:35], v[112:115], a[80:83], v[32:35]
    v_mfma_f32_16x16x32_bf16 v[48:51], v[112:115], a[152:155], v[48:51]
    v_mfma_f32_16x16x32_bf16 v[64:67], v[112:115], a[224:227], v[64:67]
    s_waitcnt lgkmcnt(14)
    v_mfma_f32_16x16x32_bf16 v[20:23], v[116:119], a[8:11], v[20:23]
    ds_read_b64_tr_b16 v[100:101], v171 offset:16384
    ds_read_b64_tr_b16 v[102:103], v171 offset:16896
    v_mfma_f32_16x16x32_bf16 v[36:39], v[116:119], a[80:83], v[36:39]
    v_mfma_f32_16x16x32_bf16 v[52:55], v[116:119], a[152:155], v[52:55]
    s_add_u32 m0, s92, 4096
    s_nop 0
    buffer_load_dwordx4 v169, s[72:75], s91 offen lds
    s_add_u32 s91, s91, s78
    v_mfma_f32_16x16x32_bf16 v[68:71], v[116:119], a[224:227], v[68:71]
    s_waitcnt lgkmcnt(14)
    v_mfma_f32_16x16x32_bf16 v[24:27], v[120:123], a[8:11], v[24:27]
    ds_read_b64_tr_b16 v[104:105], v172 offset:16384
    ds_read_b64_tr_b16 v[106:107], v172 offset:16896
    v_mfma_f32_16x16x32_bf16 v[40:43], v[120:123], a[80:83], v[40:43]
    v_mfma_f32_16x16x32_bf16 v[56:59], v[120:123], a[152:155], v[56:59]
    v_mfma_f32_16x16x32_bf16 v[72:75], v[120:123], a[224:227], v[72:75]
    s_waitcnt lgkmcnt(14)
    v_mfma_f32_16x16x32_bf16 v[28:31], v[124:127], a[8:11], v[28:31]
    ds_read_b64_tr_b16 v[108:109], v173 offset:16384
    ds_read_b64_tr_b16 v[110:111], v173 offset:16896
    v_mfma_f32_16x16x32_bf16 v[44:47], v[124:127], a[80:83], v[44:47]
    v_mfma_f32_16x16x32_bf16 v[60:63], v[124:127], a[152:155], v[60:63]
    s_add_u32 m0, s92, 5120
    s_nop 0
    buffer_load_dwordx4 v178, s[72:75], s91 offen lds
    s_mul_i32 s68, s78, 19
    s_add_u32 s91, s91, s68
    v_mfma_f32_16x16x32_bf16 v[76:79], v[124:127], a[224:227], v[76:79]
    s_waitcnt lgkmcnt(14)
    v_mfma_f32_16x16x32_bf16 v[16:19], v[80:83], a[12:15], v[16:19]
    ds_read_b64_tr_b16 v[112:113], v170 offset:20480
    ds_read_b64_tr_b16 v[114:115], v170 offset:20992
    v_mfma_f32_16x16x32_bf16 v[32:35], v[80:83], a[84:87], v[32:35]
    v_mfma_f32_16x16x32_bf16 v[48:51], v[80:83], a[156:159], v[48:51]
    v_mfma_f32_16x16x32_bf16 v[64:67], v[80:83], a[228:231], v[64:67]
    s_waitcnt lgkmcnt(14)
    v_mfma_f32_16x16x32_bf16 v[20:23], v[84:87], a[12:15], v[20:23]
    ds_read_b64_tr_b16 v[116:117], v171 offset:20480
    ds_read_b64_tr_b16 v[118:119], v171 offset:20992
    v_mfma_f32_16x16x32_bf16 v[36:39], v[84:87], a[84:87], v[36:39]
    v_mfma_f32_16x16x32_bf16 v[52:55], v[84:87], a[156:159], v[52:55]
    s_add_u32 m0, s92, 24576
    s_nop 0
    buffer_load_dwordx4 v169, s[72:75], s91 offen lds
    s_add_u32 s91, s91, s78
    v_mfma_f32_16x16x32_bf16 v[68:71], v[84:87], a[228:231], v[68:71]
    s_waitcnt lgkmcnt(14)
    v_mfma_f32_16x16x32_bf16 v[24:27], v[88:91], a[12:15], v[24:27]
    ds_read_b64_tr_b16 v[120:121], v172 offset:20480
    ds_read_b64_tr_b16 v[122:123], v172 offset:20992
    v_mfma_f32_16x16x32_bf16 v[40:43], v[88:91], a[84:87], v[40:43]
    v_mfma_f32_16x16x32_bf16 v[56:59], v[88:91], a[156:159], v[56:59]
    v_mfma_f32_16x16x32_bf16 v[72:75], v[88:91], a[228:231], v[72:75]
    s_waitcnt lgkmcnt(14)
    v_mfma_f32_16x16x32_bf16 v[28:31], v[92:95], a[12:15], v[28:31]
    ds_read_b64_tr_b16 v[124:125], v173 offset:20480
    ds_read_b64_tr_b16 v[126:127], v173 offset:20992
    v_mfma_f32_16x16x32_bf16 v[44:47], v[92:95], a[84:87], v[44:47]
    v_mfma_f32_16x16x32_bf16 v[60:63], v[92:95], a[156:159], v[60:63]
    s_add_u32 m0, s92, 25600
    s_nop 0
    buffer_load_dwordx4 v178, s[72:75], s91 offen lds
    s_add_u32 s91, s91, s78
    v_mfma_f32_16x16x32_bf16 v[76:79], v[92:95], a[228:231], v[76:79]
    s_waitcnt lgkmcnt(14)
    v_mfma_f32_16x16x32_bf16 v[16:19], v[96:99], a[16:19], v[16:19]
    ds_read_b64_tr_b16 v[80:81], v170 offset:24576
    ds_read_b64_tr_b16 v[82:83], v170 offset:25088
    v_mfma_f32_16x16x32_bf16 v[32:35], v[96:99], a[88:91], v[32:35]
    v_mfma_f32_16x16x32_bf16 v[48:51], v[96:99], a[160:163], v[48:51]
    v_mfma_f32_16x16x32_bf16 v[64:67], v[96:99], a[232:235], v[64:67]
    s_waitcnt lgkmcnt(14)
    v_mfma_f32_16x16x32_bf16 v[20:23], v[100:103], a[16:19], v[20:23]
    ds_read_b64_tr_b16 v[84:85], v171 offset:24576
    ds_read_b64_tr_b16 v[86:87], v171 offset:25088
    v_mfma_f32_16x16x32_bf16 v[36:39], v[100:103], a[88:91], v[36:39]
    v_mfma_f32_16x16x32_bf16 v[52:55], v[100:103], a[160:163], v[52:55]
    s_add_u32 m0, s92, 26624
    s_nop 0
    buffer_load_dwordx4 v169, s[72:75], s91 offen lds
    s_add_u32 s91, s91, s78
    v_mfma_f32_16x16x32_bf16 v[68:71], v[100:103], a[232:235], v[68:71]
    s_waitcnt lgkmcnt(14)
    v_mfma_f32_16x16x32_bf16 v[24:27], v[104:107], a[16:19], v[24:27]
    ds_read_b64_tr_b16 v[88:89], v172 offset:24576
    ds_read_b64_tr_b16 v[90:91], v172 offset:25088
    v_mfma_f32_16x16x32_bf16 v[40:43], v[104:107], a[88:91], v[40:43]
    v_mfma_f32_16x16x32_bf16 v[56:59], v[104:107], a[160:163], v[56:59]
    v_mfma_f32_16x16x32_bf16 v[72:75], v[104:107], a[232:235], v[72:75]
    s_waitcnt lgkmcnt(14)
    v_mfma_f32_16x16x32_bf16 v[28:31], v[108:111], a[16:19], v[28:31]
    ds_read_b64_tr_b16 v[92:93], v173 offset:24576
    ds_read_b64_tr_b16 v[94:95], v173 offset:25088
    v_mfma_f32_16x16x32_bf16 v[44:47], v[108:111], a[88:91], v[44:47]
    v_mfma_f32_16x16x32_bf16 v[60:63], v[108:111], a[160:163], v[60:63]
    s_add_u32 m0, s92, 27648
    s_nop 0
    buffer_load_dwordx4 v178, s[72:75], s91 offen lds
    s_add_u32 s91, s91, s78
    v_mfma_f32_16x16x32_bf16 v[76:79], v[108:111], a[232:235], v[76:79]
    s_waitcnt lgkmcnt(14)
    v_mfma_f32_16x16x32_bf16 v[16:19], v[112:115], a[20:23], v[16:19]
    ds_read_b64_tr_b16 v[96:97], v170 offset:28672
    ds_read_b64_tr_b16 v[98:99], v170 offset:29184
    v_mfma_f32_16x16x32_bf16 v[32:35], v[112:115], a[92:95], v[32:35]
    v_mfma_f32_16x16x32_bf16 v[48:51], v[112:115], a[164:167], v[48:51]
    v_mfma_f32_16x16x32_bf16 v[64:67], v[112:115], a[236:239], v[64:67]
    s_waitcnt lgkmcnt(14)
    v_mfma_f32_16x16x32_bf16 v[20:23], v[116:119], a[20:23], v[20:23]
    ds_read_b64_tr_b16 v[100:101], v171 offset:28672
    ds_read_b64_tr_b16 v[102:103], v171 offset:29184
    v_mfma_f32_16x16x32_bf16 v[36:39], v[116:119], a[92:95], v[36:39]
    v_mfma_f32_16x16x32_bf16 v[52:55], v[116:119], a[164:167], v[52:55]
    s_add_u32 m0, s92, 28672
    s_nop 0
    buffer_load_dwordx4 v169, s[72:75], s91 offen lds
    s_add_u32 s91, s91, s78
    v_mfma_f32_16x16x32_bf16 v[68:71], v[116:119], a[236:239], v[68:71]
    s_waitcnt lgkmcnt(14)
    v_mfma_f32_16x16x32_bf16 v[24:27], v[120:123], a[20:23], v[24:27]
    ds_read_b64_tr_b16 v[104:105], v172 offset:28672
    ds_read_b64_tr_b16 v[106:107], v172 offset:29184
    v_mfma_f32_16x16x32_bf16 v[40:43], v[120:123], a[92:95], v[40:43]
    v_mfma_f32_16x16x32_bf16 v[56:59], v[120:123], a[164:167], v[56:59]
    v_mfma_f32_16x16x32_bf16 v[72:75], v[120:123], a[236:239], v[72:75]
    s_waitcnt lgkmcnt(14)
    v_mfma_f32_16x16x32_bf16 v[28:31], v[124:127], a[20:23], v[28:31]
    ds_read_b64_tr_b16 v[108:109], v173 offset:28672
    ds_read_b64_tr_b16 v[110:111], v173 offset:29184
    v_mfma_f32_16x16x32_bf16 v[44:47], v[124:127], a[92:95], v[44:47]
    v_mfma_f32_16x16x32_bf16 v[60:63], v[124:127], a[164:167], v[60:63]
    s_add_u32 m0, s92, 29696
    s_nop 0
    buffer_load_dwordx4 v178, s[72:75], s91 offen lds
    s_mul_i32 s68, s78, 19
    s_add_u32 s91, s91, s68
    v_mfma_f32_16x16x32_bf16 v[76:79], v[124:127], a[236:239], v[76:79]
    s_waitcnt lgkmcnt(14)
    v_mfma_f32_16x16x32_bf16 v[16:19], v[80:83], a[24:27], v[16:19]
    ds_read_b64_tr_b16 v[112:113], v170 offset:32768
    ds_read_b64_tr_b16 v[114:115], v170 offset:33280
    v_mfma_f32_16x16x32_bf16 v[32:35], v[80:83], a[96:99], v[32:35]
    v_mfma_f32_16x16x32_bf16 v[48:51], v[80:83], a[168:171], v[48:51]
    v_mfma_f32_16x16x32_bf16 v[64:67], v[80:83], a[240:243], v[64:67]
    s_waitcnt lgkmcnt(14)
    v_mfma_f32_16x16x32_bf16 v[20:23], v[84:87], a[24:27], v[20:23]
    ds_read_b64_tr_b16 v[116:117], v171 offset:32768
    ds_read_b64_tr_b16 v[118:119], v171 offset:33280
    v_mfma_f32_16x16x32_bf16 v[36:39], v[84:87], a[96:99], v[36:39]
    v_mfma_f32_16x16x32_bf16 v[52:55], v[84:87], a[168:171], v[52:55]
    s_add_u32 m0, s92, 49152
    s_nop 0
    buffer_load_dwordx4 v169, s[72:75], s91 offen lds
    s_add_u32 s91, s91, s78
    v_mfma_f32_16x16x32_bf16 v[68:71], v[84:87], a[240:243], v[68:71]
    s_waitcnt lgkmcnt(14)
    v_mfma_f32_16x16x32_bf16 v[24:27], v[88:91], a[24:27], v[24:27]
    ds_read_b64_tr_b16 v[120:121], v172 offset:32768
    ds_read_b64_tr_b16 v[122:123], v172 offset:33280
    v_mfma_f32_16x16x32_bf16 v[40:43], v[88:91], a[96:99], v[40:43]
    v_mfma_f32_16x16x32_bf16 v[56:59], v[88:91], a[168:171], v[56:59]
    v_mfma_f32_16x16x32_bf16 v[72:75], v[88:91], a[240:243], v[72:75]
    s_waitcnt lgkmcnt(14)
    v_mfma_f32_16x16x32_bf16 v[28:31], v[92:95], a[24:27], v[28:31]
    ds_read_b64_tr_b16 v[124:125], v173 offset:32768
    ds_read_b64_tr_b16 v[126:127], v173 offset:33280
    v_mfma_f32_16x16x32_bf16 v[44:47], v[92:95], a[96:99], v[44:47]
    v_mfma_f32_16x16x32_bf16 v[60:63], v[92:95], a[168:171], v[60:63]
    s_add_u32 m0, s92, 50176
    s_nop 0
    buffer_load_dwordx4 v178, s[72:75], s91 offen lds
    s_add_u32 s91, s91, s78
    v_mfma_f32_16x16x32_bf16 v[76:79], v[92:95], a[240:243], v[76:79]
    s_waitcnt lgkmcnt(14)
    v_mfma_f32_16x16x32_bf16 v[16:19], v[96:99], a[28:31], v[16:19]
    ds_read_b64_tr_b16 v[80:81], v170 offset:36864
    ds_read_b64_tr_b16 v[82:83], v170 offset:37376
    v_mfma_f32_16x16x32_bf16 v[32:35], v[96:99], a[100:103], v[32:35]
    v_mfma_f32_16x16x32_bf16 v[48:51], v[96:99], a[172:175], v[48:51]
    v_mfma_f32_16x16x32_bf16 v[64:67], v[96:99], a[244:247], v[64:67]
    s_waitcnt lgkmcnt(14)
    v_mfma_f32_16x16x32_bf16 v[20:23], v[100:103], a[28:31], v[20:23]
    ds_read_b64_tr_b16 v[84:85], v171 offset:36864
    ds_read_b64_tr_b16 v[86:87], v171 offset:37376
    v_mfma_f32_16x16x32_bf16 v[36:39], v[100:103], a[100:103], v[36:39]
    v_mfma_f32_16x16x32_bf16 v[52:55], v[100:103], a[172:175], v[52:55]
    s_add_u32 m0, s92, 51200
    s_nop 0
    buffer_load_dwordx4 v169, s[72:75], s91 offen lds
    s_add_u32 s91, s91, s78
    v_mfma_f32_16x16x32_bf16 v[68:71], v[100:103], a[244:247], v[68:71]
    s_waitcnt lgkmcnt(14)
    v_mfma_f32_16x16x32_bf16 v[24:27], v[104:107], a[28:31], v[24:27]
    ds_read_b64_tr_b16 v[88:89], v172 offset:36864
    ds_read_b64_tr_b16 v[90:91], v172 offset:37376
    v_mfma_f32_16x16x32_bf16 v[40:43], v[104:107], a[100:103], v[40:43]
    v_mfma_f32_16x16x32_bf16 v[56:59], v[104:107], a[172:175], v[56:59]
    v_mfma_f32_16x16x32_bf16 v[72:75], v[104:107], a[244:247], v[72:75]
    s_waitcnt lgkmcnt(14)
    v_mfma_f32_16x16x32_bf16 v[28:31], v[108:111], a[28:31], v[28:31]
    ds_read_b64_tr_b16 v[92:93], v173 offset:36864
    ds_read_b64_tr_b16 v[94:95], v173 offset:37376
    v_mfma_f32_16x16x32_bf16 v[44:47], v[108:111], a[100:103], v[44:47]
    v_mfma_f32_16x16x32_bf16 v[60:63], v[108:111], a[172:175], v[60:63]
    s_add_u32 m0, s92, 52224
    s_nop 0
    buffer_load_dwordx4 v178, s[72:75], s91 offen lds
    s_add_u32 s91, s91, s78
    v_mfma_f32_16x16x32_bf16 v[76:79], v[108:111], a[244:247], v[76:79]
    s_waitcnt lgkmcnt(14)
    v_mfma_f32_16x16x32_bf16 v[16:19], v[112:115], a[32:35], v[16:19]
    ds_read_b64_tr_b16 v[96:97], v170 offset:40960
    ds_read_b64_tr_b16 v[98:99], v170 offset:41472
    v_mfma_f32_16x16x32_bf16 v[32:35], v[112:115], a[104:107], v[32:35]
    v_mfma_f32_16x16x32_bf16 v[48:51], v[112:115], a[176:179], v[48:51]
    v_mfma_f32_16x16x32_bf16 v[64:67], v[112:115], a[248:251], v[64:67]
    s_waitcnt lgkmcnt(14)
    v_mfma_f32_16x16x32_bf16 v[20:23], v[116:119], a[32:35], v[20:23]
    ds_read_b64_tr_b16 v[100:101], v171 offset:40960
    ds_read_b64_tr_b16 v[102:103], v171 offset:41472
    v_mfma_f32_16x16x32_bf16 v[36:39], v[116:119], a[104:107], v[36:39]
    v_mfma_f32_16x16x32_bf16 v[52:55], v[116:119], a[176:179], v[52:55]
    s_add_u32 m0, s92, 53248
    s_nop 0
    buffer_load_dwordx4 v169, s[72:75], s91 offen lds
    s_add_u32 s91, s91, s78
    v_mfma_f32_16x16x32_bf16 v[68:71], v[116:119], a[248:251], v[68:71]
    s_waitcnt lgkmcnt(14)
    v_mfma_f32_16x16x32_bf16 v[24:27], v[120:123], a[32:35], v[24:27]
    ds_read_b64_tr_b16 v[104:105], v172 offset:40960
    ds_read_b64_tr_b16 v[106:107], v172 offset:41472
    v_mfma_f32_16x16x32_bf16 v[40:43], v[120:123], a[104:107], v[40:43]
    v_mfma_f32_16x16x32_bf16 v[56:59], v[120:123], a[176:179], v[56:59]
    v_mfma_f32_16x16x32_bf16 v[72:75], v[120:123], a[248:251], v[72:75]
    s_waitcnt lgkmcnt(14)
    v_mfma_f32_16x16x32_bf16 v[28:31], v[124:127], a[32:35], v[28:31]
    ds_read_b64_tr_b16 v[108:109], v173 offset:40960
    ds_read_b64_tr_b16 v[110:111], v173 offset:41472
    v_mfma_f32_16x16x32_bf16 v[44:47], v[124:127], a[104:107], v[44:47]
    v_mfma_f32_16x16x32_bf16 v[60:63], v[124:127], a[176:179], v[60:63]
    s_add_u32 m0, s92, 54272
    s_nop 0
    buffer_load_dwordx4 v178, s[72:75], s91 offen lds
    v_mfma_f32_16x16x32_bf16 v[76:79], v[124:127], a[248:251], v[76:79]
    s_waitcnt lgkmcnt(14)
    v_mfma_f32_16x16x32_bf16 v[16:19], v[80:83], a[36:39], v[16:19]
    ds_read_b64_tr_b16 v[112:113], v170 offset:45056
    ds_read_b64_tr_b16 v[114:115], v170 offset:45568
    v_mfma_f32_16x16x32_bf16 v[32:35], v[80:83], a[108:111], v[32:35]
    v_mfma_f32_16x16x32_bf16 v[48:51], v[80:83], a[180:183], v[48:51]
    v_mfma_f32_16x16x32_bf16 v[64:67], v[80:83], a[252:255], v[64:67]
    s_waitcnt lgkmcnt(14)
    v_mfma_f32_16x16x32_bf16 v[20:23], v[84:87], a[36:39], v[20:23]
    ds_read_b64_tr_b16 v[116:117], v171 offset:45056
    ds_read_b64_tr_b16 v[118:119], v171 offset:45568
    v_mfma_f32_16x16x32_bf16 v[36:39], v[84:87], a[108:111], v[36:39]
    v_mfma_f32_16x16x32_bf16 v[52:55], v[84:87], a[180:183], v[52:55]
    v_mfma_f32_16x16x32_bf16 v[68:71], v[84:87], a[252:255], v[68:71]
    s_waitcnt lgkmcnt(14)
    v_mfma_f32_16x16x32_bf16 v[24:27], v[88:91], a[36:39], v[24:27]
    ds_read_b64_tr_b16 v[120:121], v172 offset:45056
    ds_read_b64_tr_b16 v[122:123], v172 offset:45568
    v_mfma_f32_16x16x32_bf16 v[40:43], v[88:91], a[108:111], v[40:43]
    v_mfma_f32_16x16x32_bf16 v[56:59], v[88:91], a[180:183], v[56:59]
    v_mfma_f32_16x16x32_bf16 v[72:75], v[88:91], a[252:255], v[72:75]
    s_waitcnt lgkmcnt(14)
    v_mfma_f32_16x16x32_bf16 v[28:31], v[92:95], a[36:39], v[28:31]
    ds_read_b64_tr_b16 v[124:125], v173 offset:45056
    ds_read_b64_tr_b16 v[126:127], v173 offset:45568
    v_mfma_f32_16x16x32_bf16 v[44:47], v[92:95], a[108:111], v[44:47]
    v_mfma_f32_16x16x32_bf16 v[60:63], v[92:95], a[180:183], v[60:63]
    v_mfma_f32_16x16x32_bf16 v[76:79], v[92:95], a[252:255], v[76:79]
    s_waitcnt lgkmcnt(14)
    v_mfma_f32_16x16x32_bf16 v[16:19], v[96:99], a[40:43], v[16:19]
    ds_read_b64_tr_b16 v[80:81], v170 offset:49152
    ds_read_b64_tr_b16 v[82:83], v170 offset:49664
    v_mfma_f32_16x16x32_bf16 v[32:35], v[96:99], a[112:115], v[32:35]
    v_mfma_f32_16x16x32_bf16 v[48:51], v[96:99], a[184:187], v[48:51]
    v_mfma_f32_16x16x32_bf16 v[64:67], v[96:99], v[224:227], v[64:67]
    s_waitcnt lgkmcnt(14)
    v_mfma_f32_16x16x32_bf16 v[20:23], v[100:103], a[40:43], v[20:23]
    ds_read_b64_tr_b16 v[84:85], v171 offset:49152
    ds_read_b64_tr_b16 v[86:87], v171 offset:49664
    v_mfma_f32_16x16x32_bf16 v[36:39], v[100:103], a[112:115], v[36:39]
    v_mfma_f32_16x16x32_bf16 v[52:55], v[100:103], a[184:187], v[52:55]
    v_mfma_f32_16x16x32_bf16 v[68:71], v[100:103], v[224:227], v[68:71]
    s_waitcnt lgkmcnt(14)
    v_mfma_f32_16x16x32_bf16 v[24:27], v[104:107], a[40:43], v[24:27]
    ds_read_b64_tr_b16 v[88:89], v172 offset:49152
    ds_read_b64_tr_b16 v[90:91], v172 offset:49664
    v_mfma_f32_16x16x32_bf16 v[40:43], v[104:107], a[112:115], v[40:43]
    v_mfma_f32_16x16x32_bf16 v[56:59], v[104:107], a[184:187], v[56:59]
    v_mfma_f32_16x16x32_bf16 v[72:75], v[104:107], v[224:227], v[72:75]
    s_waitcnt lgkmcnt(14)
    v_mfma_f32_16x16x32_bf16 v[28:31], v[108:111], a[40:43], v[28:31]
    ds_read_b64_tr_b16 v[92:93], v173 offset:49152
    ds_read_b64_tr_b16 v[94:95], v173 offset:49664
    v_mfma_f32_16x16x32_bf16 v[44:47], v[108:111], a[112:115], v[44:47]
    v_mfma_f32_16x16x32_bf16 v[60:63], v[108:111], a[184:187], v[60:63]
    v_mfma_f32_16x16x32_bf16 v[76:79], v[108:111], v[224:227], v[76:79]
    s_waitcnt lgkmcnt(14)
    v_mfma_f32_16x16x32_bf16 v[16:19], v[112:115], a[44:47], v[16:19]
    ds_read_b64_tr_b16 v[96:97], v170 offset:53248
    ds_read_b64_tr_b16 v[98:99], v170 offset:53760
    v_mfma_f32_16x16x32_bf16 v[32:35], v[112:115], a[116:119], v[32:35]
    v_mfma_f32_16x16x32_bf16 v[48:51], v[112:115], a[188:191], v[48:51]
    v_mfma_f32_16x16x32_bf16 v[64:67], v[112:115], v[228:231], v[64:67]
    s_waitcnt lgkmcnt(14)
    v_mfma_f32_16x16x32_bf16 v[20:23], v[116:119], a[44:47], v[20:23]
    ds_read_b64_tr_b16 v[100:101], v171 offset:53248
    ds_read_b64_tr_b16 v[102:103], v171 offset:53760
    v_mfma_f32_16x16x32_bf16 v[36:39], v[116:119], a[116:119], v[36:39]
    v_mfma_f32_16x16x32_bf16 v[52:55], v[116:119], a[188:191], v[52:55]
    v_mfma_f32_16x16x32_bf16 v[68:71], v[116:119], v[228:231], v[68:71]
    s_waitcnt lgkmcnt(14)
    v_mfma_f32_16x16x32_bf16 v[24:27], v[120:123], a[44:47], v[24:27]
    ds_read_b64_tr_b16 v[104:105], v172 offset:53248
    ds_read_b64_tr_b16 v[106:107], v172 offset:53760
    v_mfma_f32_16x16x32_bf16 v[40:43], v[120:123], a[116:119], v[40:43]
    v_mfma_f32_16x16x32_bf16 v[56:59], v[120:123], a[188:191], v[56:59]
    v_mfma_f32_16x16x32_bf16 v[72:75], v[120:123], v[228:231], v[72:75]
    s_waitcnt lgkmcnt(14)
    v_mfma_f32_16x16x32_bf16 v[28:31], v[124:127], a[44:47], v[28:31]
    ds_read_b64_tr_b16 v[108:109], v173 offset:53248
    ds_read_b64_tr_b16 v[110:111], v173 offset:53760
    v_mfma_f32_16x16x32_bf16 v[44:47], v[124:127], a[116:119], v[44:47]
    v_mfma_f32_16x16x32_bf16 v[60:63], v[124:127], a[188:191], v[60:63]
    v_mfma_f32_16x16x32_bf16 v[76:79], v[124:127], v[228:231], v[76:79]
    s_waitcnt lgkmcnt(14)
    v_mfma_f32_16x16x32_bf16 v[16:19], v[80:83], a[48:51], v[16:19]
    ds_read_b64_tr_b16 v[112:113], v170 offset:57344
    ds_read_b64_tr_b16 v[114:115], v170 offset:57856
    v_mfma_f32_16x16x32_bf16 v[32:35], v[80:83], a[120:123], v[32:35]
    v_mfma_f32_16x16x32_bf16 v[48:51], v[80:83], a[192:195], v[48:51]
    v_mfma_f32_16x16x32_bf16 v[64:67], v[80:83], v[232:235], v[64:67]
    s_waitcnt lgkmcnt(14)
    v_mfma_f32_16x16x32_bf16 v[20:23], v[84:87], a[48:51], v[20:23]
    ds_read_b64_tr_b16 v[116:117], v171 offset:57344
    ds_read_b64_tr_b16 v[118:119], v171 offset:57856
    v_mfma_f32_16x16x32_bf16 v[36:39], v[84:87], a[120:123], v[36:39]
    v_mfma_f32_16x16x32_bf16 v[52:55], v[84:87], a[192:195], v[52:55]
    v_mfma_f32_16x16x32_bf16 v[68:71], v[84:87], v[232:235], v[68:71]
    s_waitcnt lgkmcnt(14)
    v_mfma_f32_16x16x32_bf16 v[24:27], v[88:91], a[48:51], v[24:27]
    ds_read_b64_tr_b16 v[120:121], v172 offset:57344
    ds_read_b64_tr_b16 v[122:123], v172 offset:57856
    v_mfma_f32_16x16x32_bf16 v[40:43], v[88:91], a[120:123], v[40:43]
    v_mfma_f32_16x16x32_bf16 v[56:59], v[88:91], a[192:195], v[56:59]
    v_mfma_f32_16x16x32_bf16 v[72:75], v[88:91], v[232:235], v[72:75]
    s_waitcnt lgkmcnt(14)
    v_mfma_f32_16x16x32_bf16 v[28:31], v[92:95], a[48:51], v[28:31]
    ds_read_b64_tr_b16 v[124:125], v173 offset:57344
    ds_read_b64_tr_b16 v[126:127], v173 offset:57856
    v_mfma_f32_16x16x32_bf16 v[44:47], v[92:95], a[120:123], v[44:47]
    v_mfma_f32_16x16x32_bf16 v[60:63], v[92:95], a[192:195], v[60:63]
    v_mfma_f32_16x16x32_bf16 v[76:79], v[92:95], v[232:235], v[76:79]
    s_waitcnt lgkmcnt(14)
    v_mfma_f32_16x16x32_bf16 v[16:19], v[96:99], a[52:55], v[16:19]
    ds_read_b64_tr_b16 v[80:81], v170 offset:61440
    ds_read_b64_tr_b16 v[82:83], v170 offset:61952
    v_mfma_f32_16x16x32_bf16 v[32:35], v[96:99], a[124:127], v[32:35]
    v_mfma_f32_16x16x32_bf16 v[48:51], v[96:99], a[196:199], v[48:51]
    v_mfma_f32_16x16x32_bf16 v[64:67], v[96:99], v[236:239], v[64:67]
    s_waitcnt lgkmcnt(14)
    v_mfma_f32_16x16x32_bf16 v[20:23], v[100:103], a[52:55], v[20:23]
    ds_read_b64_tr_b16 v[84:85], v171 offset:61440
    ds_read_b64_tr_b16 v[86:87], v171 offset:61952
    v_mfma_f32_16x16x32_bf16 v[36:39], v[100:103], a[124:127], v[36:39]
    v_mfma_f32_16x16x32_bf16 v[52:55], v[100:103], a[196:199], v[52:55]
    v_mfma_f32_16x16x32_bf16 v[68:71], v[100:103], v[236:239], v[68:71]
    s_waitcnt lgkmcnt(14)
    v_mfma_f32_16x16x32_bf16 v[24:27], v[104:107], a[52:55], v[24:27]
    ds_read_b64_tr_b16 v[88:89], v172 offset:61440
    ds_read_b64_tr_b16 v[90:91], v172 offset:61952
    v_mfma_f32_16x16x32_bf16 v[40:43], v[104:107], a[124:127], v[40:43]
    v_mfma_f32_16x16x32_bf16 v[56:59], v[104:107], a[196:199], v[56:59]
    v_mfma_f32_16x16x32_bf16 v[72:75], v[104:107], v[236:239], v[72:75]
    s_waitcnt lgkmcnt(14)
    v_mfma_f32_16x16x32_bf16 v[28:31], v[108:111], a[52:55], v[28:31]
    ds_read_b64_tr_b16 v[92:93], v173 offset:61440
    ds_read_b64_tr_b16 v[94:95], v173 offset:61952
    v_mfma_f32_16x16x32_bf16 v[44:47], v[108:111], a[124:127], v[44:47]
    v_mfma_f32_16x16x32_bf16 v[60:63], v[108:111], a[196:199], v[60:63]
    v_mfma_f32_16x16x32_bf16 v[76:79], v[108:111], v[236:239], v[76:79]
    s_waitcnt lgkmcnt(14)
    v_mfma_f32_16x16x32_bf16 v[16:19], v[112:115], a[56:59], v[16:19]
    ds_read_b64_tr_b16 v[96:97], v174 offset:16384
    ds_read_b64_tr_b16 v[98:99], v174 offset:16896
    v_mfma_f32_16x16x32_bf16 v[32:35], v[112:115], a[128:131], v[32:35]
    v_mfma_f32_16x16x32_bf16 v[48:51], v[112:115], a[200:203], v[48:51]
    v_mfma_f32_16x16x32_bf16 v[64:67], v[112:115], v[240:243], v[64:67]
    s_waitcnt lgkmcnt(14)
    v_mfma_f32_16x16x32_bf16 v[20:23], v[116:119], a[56:59], v[20:23]
    ds_read_b64_tr_b16 v[100:101], v175 offset:16384
    ds_read_b64_tr_b16 v[102:103], v175 offset:16896
    v_mfma_f32_16x16x32_bf16 v[36:39], v[116:119], a[128:131], v[36:39]
    v_mfma_f32_16x16x32_bf16 v[52:55], v[116:119], a[200:203], v[52:55]
    v_mfma_f32_16x16x32_bf16 v[68:71], v[116:119], v[240:243], v[68:71]
    s_waitcnt lgkmcnt(14)
    v_mfma_f32_16x16x32_bf16 v[24:27], v[120:123], a[56:59], v[24:27]
    ds_read_b64_tr_b16 v[104:105], v176 offset:16384
    ds_read_b64_tr_b16 v[106:107], v176 offset:16896
    v_mfma_f32_16x16x32_bf16 v[40:43], v[120:123], a[128:131], v[40:43]
    v_mfma_f32_16x16x32_bf16 v[56:59], v[120:123], a[200:203], v[56:59]
    v_mfma_f32_16x16x32_bf16 v[72:75], v[120:123], v[240:243], v[72:75]
    s_waitcnt lgkmcnt(14)
    v_mfma_f32_16x16x32_bf16 v[28:31], v[124:127], a[56:59], v[28:31]
    ds_read_b64_tr_b16 v[108:109], v177 offset:16384
    ds_read_b64_tr_b16 v[110:111], v177 offset:16896
    v_mfma_f32_16x16x32_bf16 v[44:47], v[124:127], a[128:131], v[44:47]
    v_mfma_f32_16x16x32_bf16 v[60:63], v[124:127], a[200:203], v[60:63]
    v_mfma_f32_16x16x32_bf16 v[76:79], v[124:127], v[240:243], v[76:79]
    s_waitcnt lgkmcnt(14)
    v_mfma_f32_16x16x32_bf16 v[16:19], v[80:83], a[60:63], v[16:19]
    ds_read_b64_tr_b16 v[112:113], v174 offset:20480
    ds_read_b64_tr_b16 v[114:115], v174 offset:20992
    v_mfma_f32_16x16x32_bf16 v[32:35], v[80:83], a[132:135], v[32:35]
    v_mfma_f32_16x16x32_bf16 v[48:51], v[80:83], a[204:207], v[48:51]
    v_mfma_f32_16x16x32_bf16 v[64:67], v[80:83], v[244:247], v[64:67]
    s_waitcnt lgkmcnt(14)
    v_mfma_f32_16x16x32_bf16 v[20:23], v[84:87], a[60:63], v[20:23]
    ds_read_b64_tr_b16 v[116:117], v175 offset:20480
    ds_read_b64_tr_b16 v[118:119], v175 offset:20992
    v_mfma_f32_16x16x32_bf16 v[36:39], v[84:87], a[132:135], v[36:39]
    v_mfma_f32_16x16x32_bf16 v[52:55], v[84:87], a[204:207], v[52:55]
    v_mfma_f32_16x16x32_bf16 v[68:71], v[84:87], v[244:247], v[68:71]
    s_waitcnt lgkmcnt(14)
    v_mfma_f32_16x16x32_bf16 v[24:27], v[88:91], a[60:63], v[24:27]
    ds_read_b64_tr_b16 v[120:121], v176 offset:20480
    ds_read_b64_tr_b16 v[122:123], v176 offset:20992
    v_mfma_f32_16x16x32_bf16 v[40:43], v[88:91], a[132:135], v[40:43]
    v_mfma_f32_16x16x32_bf16 v[56:59], v[88:91], a[204:207], v[56:59]
    v_mfma_f32_16x16x32_bf16 v[72:75], v[88:91], v[244:247], v[72:75]
    s_waitcnt lgkmcnt(14)
    v_mfma_f32_16x16x32_bf16 v[28:31], v[92:95], a[60:63], v[28:31]
    ds_read_b64_tr_b16 v[124:125], v177 offset:20480
    ds_read_b64_tr_b16 v[126:127], v177 offset:20992
    v_mfma_f32_16x16x32_bf16 v[44:47], v[92:95], a[132:135], v[44:47]
    v_mfma_f32_16x16x32_bf16 v[60:63], v[92:95], a[204:207], v[60:63]
    v_mfma_f32_16x16x32_bf16 v[76:79], v[92:95], v[244:247], v[76:79]
    s_waitcnt lgkmcnt(14)
    v_mfma_f32_16x16x32_bf16 v[16:19], v[96:99], a[64:67], v[16:19]
    v_mfma_f32_16x16x32_bf16 v[32:35], v[96:99], a[136:139], v[32:35]
    v_mfma_f32_16x16x32_bf16 v[48:51], v[96:99], a[208:211], v[48:51]
    v_mfma_f32_16x16x32_bf16 v[64:67], v[96:99], v[248:251], v[64:67]
    s_waitcnt lgkmcnt(12)
    v_mfma_f32_16x16x32_bf16 v[20:23], v[100:103], a[64:67], v[20:23]
    v_mfma_f32_16x16x32_bf16 v[36:39], v[100:103], a[136:139], v[36:39]
    v_mfma_f32_16x16x32_bf16 v[52:55], v[100:103], a[208:211], v[52:55]
    v_mfma_f32_16x16x32_bf16 v[68:71], v[100:103], v[248:251], v[68:71]
    s_waitcnt lgkmcnt(10)
    v_mfma_f32_16x16x32_bf16 v[24:27], v[104:107], a[64:67], v[24:27]
    v_mfma_f32_16x16x32_bf16 v[40:43], v[104:107], a[136:139], v[40:43]
    v_mfma_f32_16x16x32_bf16 v[56:59], v[104:107], a[208:211], v[56:59]
    v_mfma_f32_16x16x32_bf16 v[72:75], v[104:107], v[248:251], v[72:75]
    s_waitcnt lgkmcnt(8)
    v_mfma_f32_16x16x32_bf16 v[28:31], v[108:111], a[64:67], v[28:31]
    v_mfma_f32_16x16x32_bf16 v[44:47], v[108:111], a[136:139], v[44:47]
    v_mfma_f32_16x16x32_bf16 v[60:63], v[108:111], a[208:211], v[60:63]
    v_mfma_f32_16x16x32_bf16 v[76:79], v[108:111], v[248:251], v[76:79]
    s_waitcnt lgkmcnt(6)
    v_mfma_f32_16x16x32_bf16 v[16:19], v[112:115], a[68:71], v[16:19]
    v_mfma_f32_16x16x32_bf16 v[32:35], v[112:115], a[140:143], v[32:35]
    v_mfma_f32_16x16x32_bf16 v[48:51], v[112:115], a[212:215], v[48:51]
    v_mfma_f32_16x16x32_bf16 v[64:67], v[112:115], v[252:255], v[64:67]
    s_waitcnt lgkmcnt(4)
    v_mfma_f32_16x16x32_bf16 v[20:23], v[116:119], a[68:71], v[20:23]
    v_mfma_f32_16x16x32_bf16 v[36:39], v[116:119], a[140:143], v[36:39]
    v_mfma_f32_16x16x32_bf16 v[52:55], v[116:119], a[212:215], v[52:55]
    v_mfma_f32_16x16x32_bf16 v[68:71], v[116:119], v[252:255], v[68:71]
    s_waitcnt lgkmcnt(2)
    v_mfma_f32_16x16x32_bf16 v[24:27], v[120:123], a[68:71], v[24:27]
    v_mfma_f32_16x16x32_bf16 v[40:43], v[120:123], a[140:143], v[40:43]
    v_mfma_f32_16x16x32_bf16 v[56:59], v[120:123], a[212:215], v[56:59]
    v_mfma_f32_16x16x32_bf16 v[72:75], v[120:123], v[252:255], v[72:75]
    s_waitcnt lgkmcnt(0)
    v_mfma_f32_16x16x32_bf16 v[28:31], v[124:127], a[68:71], v[28:31]
    v_mfma_f32_16x16x32_bf16 v[44:47], v[124:127], a[140:143], v[44:47]
    v_mfma_f32_16x16x32_bf16 v[60:63], v[124:127], a[212:215], v[60:63]
    v_mfma_f32_16x16x32_bf16 v[76:79], v[124:127], v[252:255], v[76:79]
    s_branch Lp1e_118
Lp1v_117:
    ds_read_b64_tr_b16 v[80:81], v170 offset:0
    ds_read_b64_tr_b16 v[82:83], v170 offset:512
    ds_read_b64_tr_b16 v[84:85], v171 offset:0
    ds_read_b64_tr_b16 v[86:87], v171 offset:512
    ds_read_b64_tr_b16 v[88:89], v172 offset:0
    ds_read_b64_tr_b16 v[90:91], v172 offset:512
    ds_read_b64_tr_b16 v[92:93], v173 offset:0
    ds_read_b64_tr_b16 v[94:95], v173 offset:512
    ds_read_b64_tr_b16 v[96:97], v170 offset:4096
    ds_read_b64_tr_b16 v[98:99], v170 offset:4608
    ds_read_b64_tr_b16 v[100:101], v171 offset:4096
    ds_read_b64_tr_b16 v[102:103], v171 offset:4608
    ds_read_b64_tr_b16 v[104:105], v172 offset:4096
    ds_read_b64_tr_b16 v[106:107], v172 offset:4608
    ds_read_b64_tr_b16 v[108:109], v173 offset:4096
    ds_read_b64_tr_b16 v[110:111], v173 offset:4608
    s_lshr_b32 s70, s86, 6
    s_and_b32 s71, s86, 63
    s_sub_u32 s79, s86, 192
    s_mov_b32 s72, s20
    s_mov_b32 s73, s21
    s_mov_b32 s74, s22
    s_cmp_eq_u32 s70, 1
    s_cselect_b32 s72, s24, s72
    s_cselect_b32 s73, s25, s73
    s_cmp_eq_u32 s70, 2
    s_cselect_b32 s72, s16, s72
    s_cselect_b32 s73, s17, s73
    s_mov_b32 s78, 65536
    s_cmp_ge_u32 s70, 3
    s_cselect_b32 s72, s32, s72
    s_cselect_b32 s73, s33, s73
    s_cselect_b32 s74, s34, s74
    s_mov_b32 s75, 0x20000
    s_cselect_b32 s78, 73728, s78
    s_cselect_b32 s79, s79, s71
    s_cselect_b64 vcc, -1, 0
    s_lshl_b32 s79, s79, 7
    v_cndmask_b32 v169, v4, v168, vcc
    v_xor_b32 v178, 64, v169
    s_xor_b32 s86, s90, 73728
    s_mov_b32 s91, s79
    s_add_u32 s92, s86, s80
    s_waitcnt lgkmcnt(14)
    v_mfma_f32_16x16x32_bf16 v[16:19], a[0:3], v[80:83], 0
    ds_read_b64_tr_b16 v[112:113], v170 offset:8192
    ds_read_b64_tr_b16 v[114:115], v170 offset:8704
    v_mfma_f32_16x16x32_bf16 v[32:35], a[72:75], v[80:83], 0
    v_mfma_f32_16x16x32_bf16 v[48:51], a[144:147], v[80:83], 0
    v_mfma_f32_16x16x32_bf16 v[64:67], a[216:219], v[80:83], 0
    s_waitcnt lgkmcnt(14)
    v_mfma_f32_16x16x32_bf16 v[20:23], a[0:3], v[84:87], 0
    ds_read_b64_tr_b16 v[116:117], v171 offset:8192
    ds_read_b64_tr_b16 v[118:119], v171 offset:8704
    v_mfma_f32_16x16x32_bf16 v[36:39], a[72:75], v[84:87], 0
    v_mfma_f32_16x16x32_bf16 v[52:55], a[144:147], v[84:87], 0
    s_add_u32 m0, s92, 0
    s_nop 0
    buffer_load_dwordx4 v169, s[72:75], s91 offen lds
    s_add_u32 s91, s91, s78
    v_mfma_f32_16x16x32_bf16 v[68:71], a[216:219], v[84:87], 0
    s_waitcnt lgkmcnt(14)
    v_mfma_f32_16x16x32_bf16 v[24:27], a[0:3], v[88:91], 0
    ds_read_b64_tr_b16 v[120:121], v172 offset:8192
    ds_read_b64_tr_b16 v[122:123], v172 offset:8704
    v_mfma_f32_16x16x32_bf16 v[40:43], a[72:75], v[88:91], 0
    v_mfma_f32_16x16x32_bf16 v[56:59], a[144:147], v[88:91], 0
    v_mfma_f32_16x16x32_bf16 v[72:75], a[216:219], v[88:91], 0
    s_waitcnt lgkmcnt(14)
    v_mfma_f32_16x16x32_bf16 v[28:31], a[0:3], v[92:95], 0
    ds_read_b64_tr_b16 v[124:125], v173 offset:8192
    ds_read_b64_tr_b16 v[126:127], v173 offset:8704
    v_mfma_f32_16x16x32_bf16 v[44:47], a[72:75], v[92:95], 0
    v_mfma_f32_16x16x32_bf16 v[60:63], a[144:147], v[92:95], 0
    s_add_u32 m0, s92, 1024
    s_nop 0
    buffer_load_dwordx4 v178, s[72:75], s91 offen lds
    s_add_u32 s91, s91, s78
    v_mfma_f32_16x16x32_bf16 v[76:79], a[216:219], v[92:95], 0
    s_waitcnt lgkmcnt(14)
    v_mfma_f32_16x16x32_bf16 v[16:19], a[4:7], v[96:99], v[16:19]
    ds_read_b64_tr_b16 v[80:81], v170 offset:12288
    ds_read_b64_tr_b16 v[82:83], v170 offset:12800
    v_mfma_f32_16x16x32_bf16 v[32:35], a[76:79], v[96:99], v[32:35]
    v_mfma_f32_16x16x32_bf16 v[48:51], a[148:151], v[96:99], v[48:51]
    v_mfma_f32_16x16x32_bf16 v[64:67], a[220:223], v[96:99], v[64:67]
    s_waitcnt lgkmcnt(14)
    v_mfma_f32_16x16x32_bf16 v[20:23], a[4:7], v[100:103], v[20:23]
    ds_read_b64_tr_b16 v[84:85], v171 offset:12288
    ds_read_b64_tr_b16 v[86:87], v171 offset:12800
    v_mfma_f32_16x16x32_bf16 v[36:39], a[76:79], v[100:103], v[36:39]
    v_mfma_f32_16x16x32_bf16 v[52:55], a[148:151], v[100:103], v[52:55]
    s_add_u32 m0, s92, 2048
    s_nop 0
    buffer_load_dwordx4 v169, s[72:75], s91 offen lds
    s_add_u32 s91, s91, s78
    v_mfma_f32_16x16x32_bf16 v[68:71], a[220:223], v[100:103], v[68:71]
    s_waitcnt lgkmcnt(14)
    v_mfma_f32_16x16x32_bf16 v[24:27], a[4:7], v[104:107], v[24:27]
    ds_read_b64_tr_b16 v[88:89], v172 offset:12288
    ds_read_b64_tr_b16 v[90:91], v172 offset:12800
    v_mfma_f32_16x16x32_bf16 v[40:43], a[76:79], v[104:107], v[40:43]
    v_mfma_f32_16x16x32_bf16 v[56:59], a[148:151], v[104:107], v[56:59]
    v_mfma_f32_16x16x32_bf16 v[72:75], a[220:223], v[104:107], v[72:75]
    s_waitcnt lgkmcnt(14)
    v_mfma_f32_16x16x32_bf16 v[28:31], a[4:7], v[108:111], v[28:31]
    ds_read_b64_tr_b16 v[92:93], v173 offset:12288
    ds_read_b64_tr_b16 v[94:95], v173 offset:12800
    v_mfma_f32_16x16x32_bf16 v[44:47], a[76:79], v[108:111], v[44:47]
    v_mfma_f32_16x16x32_bf16 v[60:63], a[148:151], v[108:111], v[60:63]
    s_add_u32 m0, s92, 3072
    s_nop 0
    buffer_load_dwordx4 v178, s[72:75], s91 offen lds
    s_add_u32 s91, s91, s78
    v_mfma_f32_16x16x32_bf16 v[76:79], a[220:223], v[108:111], v[76:79]
    s_waitcnt lgkmcnt(14)
    v_mfma_f32_16x16x32_bf16 v[16:19], a[8:11], v[112:115], v[16:19]
    ds_read_b64_tr_b16 v[96:97], v170 offset:16384
    ds_read_b64_tr_b16 v[98:99], v170 offset:16896
    v_mfma_f32_16x16x32_bf16 v[32:35], a[80:83], v[112:115], v[32:35]
    v_mfma_f32_16x16x32_bf16 v[48:51], a[152:155], v[112:115], v[48:51]
    v_mfma_f32_16x16x32_bf16 v[64:67], a[224:227], v[112:115], v[64:67]
    s_waitcnt lgkmcnt(14)
    v_mfma_f32_16x16x32_bf16 v[20:23], a[8:11], v[116:119], v[20:23]
    ds_read_b64_tr_b16 v[100:101], v171 offset:16384
    ds_read_b64_tr_b16 v[102:103], v171 offset:16896
    v_mfma_f32_16x16x32_bf16 v[36:39], a[80:83], v[116:119], v[36:39]
    v_mfma_f32_16x16x32_bf16 v[52:55], a[152:155], v[116:119], v[52:55]
    s_add_u32 m0, s92, 4096
    s_nop 0
    buffer_load_dwordx4 v169, s[72:75], s91 offen lds
    s_add_u32 s91, s91, s78
    v_mfma_f32_16x16x32_bf16 v[68:71], a[224:227], v[116:119], v[68:71]
    s_waitcnt lgkmcnt(14)
    v_mfma_f32_16x16x32_bf16 v[24:27], a[8:11], v[120:123], v[24:27]
    ds_read_b64_tr_b16 v[104:105], v172 offset:16384
    ds_read_b64_tr_b16 v[106:107], v172 offset:16896
    v_mfma_f32_16x16x32_bf16 v[40:43], a[80:83], v[120:123], v[40:43]
    v_mfma_f32_16x16x32_bf16 v[56:59], a[152:155], v[120:123], v[56:59]
    v_mfma_f32_16x16x32_bf16 v[72:75], a[224:227], v[120:123], v[72:75]
    s_waitcnt lgkmcnt(14)
    v_mfma_f32_16x16x32_bf16 v[28:31], a[8:11], v[124:127], v[28:31]
    ds_read_b64_tr_b16 v[108:109], v173 offset:16384
    ds_read_b64_tr_b16 v[110:111], v173 offset:16896
    v_mfma_f32_16x16x32_bf16 v[44:47], a[80:83], v[124:127], v[44:47]
    v_mfma_f32_16x16x32_bf16 v[60:63], a[152:155], v[124:127], v[60:63]
    s_add_u32 m0, s92, 5120
    s_nop 0
    buffer_load_dwordx4 v178, s[72:75], s91 offen lds
    s_mul_i32 s68, s78, 19
    s_add_u32 s91, s91, s68
    v_mfma_f32_16x16x32_bf16 v[76:79], a[224:227], v[124:127], v[76:79]
    s_waitcnt lgkmcnt(14)
    v_mfma_f32_16x16x32_bf16 v[16:19], a[12:15], v[80:83], v[16:19]
    ds_read_b64_tr_b16 v[112:113], v170 offset:20480
    ds_read_b64_tr_b16 v[114:115], v170 offset:20992
    v_mfma_f32_16x16x32_bf16 v[32:35], a[84:87], v[80:83], v[32:35]
    v_mfma_f32_16x16x32_bf16 v[48:51], a[156:159], v[80:83], v[48:51]
    v_mfma_f32_16x16x32_bf16 v[64:67], a[228:231], v[80:83], v[64:67]
    s_waitcnt lgkmcnt(14)
    v_mfma_f32_16x16x32_bf16 v[20:23], a[12:15], v[84:87], v[20:23]
    ds_read_b64_tr_b16 v[116:117], v171 offset:20480
    ds_read_b64_tr_b16 v[118:119], v171 offset:20992
    v_mfma_f32_16x16x32_bf16 v[36:39], a[84:87], v[84:87], v[36:39]
    v_mfma_f32_16x16x32_bf16 v[52:55], a[156:159], v[84:87], v[52:55]
    s_add_u32 m0, s92, 24576
    s_nop 0
    buffer_load_dwordx4 v169, s[72:75], s91 offen lds
    s_add_u32 s91, s91, s78
    v_mfma_f32_16x16x32_bf16 v[68:71], a[228:231], v[84:87], v[68:71]
    s_waitcnt lgkmcnt(14)
    v_mfma_f32_16x16x32_bf16 v[24:27], a[12:15], v[88:91], v[24:27]
    ds_read_b64_tr_b16 v[120:121], v172 offset:20480
    ds_read_b64_tr_b16 v[122:123], v172 offset:20992
    v_mfma_f32_16x16x32_bf16 v[40:43], a[84:87], v[88:91], v[40:43]
    v_mfma_f32_16x16x32_bf16 v[56:59], a[156:159], v[88:91], v[56:59]
    v_mfma_f32_16x16x32_bf16 v[72:75], a[228:231], v[88:91], v[72:75]
    s_waitcnt lgkmcnt(14)
    v_mfma_f32_16x16x32_bf16 v[28:31], a[12:15], v[92:95], v[28:31]
    ds_read_b64_tr_b16 v[124:125], v173 offset:20480
    ds_read_b64_tr_b16 v[126:127], v173 offset:20992
    v_mfma_f32_16x16x32_bf16 v[44:47], a[84:87], v[92:95], v[44:47]
    v_mfma_f32_16x16x32_bf16 v[60:63], a[156:159], v[92:95], v[60:63]
    s_add_u32 m0, s92, 25600
    s_nop 0
    buffer_load_dwordx4 v178, s[72:75], s91 offen lds
    s_add_u32 s91, s91, s78
    v_mfma_f32_16x16x32_bf16 v[76:79], a[228:231], v[92:95], v[76:79]
    s_waitcnt lgkmcnt(14)
    v_mfma_f32_16x16x32_bf16 v[16:19], a[16:19], v[96:99], v[16:19]
    ds_read_b64_tr_b16 v[80:81], v170 offset:24576
    ds_read_b64_tr_b16 v[82:83], v170 offset:25088
    v_mfma_f32_16x16x32_bf16 v[32:35], a[88:91], v[96:99], v[32:35]
    v_mfma_f32_16x16x32_bf16 v[48:51], a[160:163], v[96:99], v[48:51]
    v_mfma_f32_16x16x32_bf16 v[64:67], a[232:235], v[96:99], v[64:67]
    s_waitcnt lgkmcnt(14)
    v_mfma_f32_16x16x32_bf16 v[20:23], a[16:19], v[100:103], v[20:23]
    ds_read_b64_tr_b16 v[84:85], v171 offset:24576
    ds_read_b64_tr_b16 v[86:87], v171 offset:25088
    v_mfma_f32_16x16x32_bf16 v[36:39], a[88:91], v[100:103], v[36:39]
    v_mfma_f32_16x16x32_bf16 v[52:55], a[160:163], v[100:103], v[52:55]
    s_add_u32 m0, s92, 26624
    s_nop 0
    buffer_load_dwordx4 v169, s[72:75], s91 offen lds
    s_add_u32 s91, s91, s78
    v_mfma_f32_16x16x32_bf16 v[68:71], a[232:235], v[100:103], v[68:71]
    s_waitcnt lgkmcnt(14)
    v_mfma_f32_16x16x32_bf16 v[24:27], a[16:19], v[104:107], v[24:27]
    ds_read_b64_tr_b16 v[88:89], v172 offset:24576
    ds_read_b64_tr_b16 v[90:91], v172 offset:25088
    v_mfma_f32_16x16x32_bf16 v[40:43], a[88:91], v[104:107], v[40:43]
    v_mfma_f32_16x16x32_bf16 v[56:59], a[160:163], v[104:107], v[56:59]
    v_mfma_f32_16x16x32_bf16 v[72:75], a[232:235], v[104:107], v[72:75]
    s_waitcnt lgkmcnt(14)
    v_mfma_f32_16x16x32_bf16 v[28:31], a[16:19], v[108:111], v[28:31]
    ds_read_b64_tr_b16 v[92:93], v173 offset:24576
    ds_read_b64_tr_b16 v[94:95], v173 offset:25088
    v_mfma_f32_16x16x32_bf16 v[44:47], a[88:91], v[108:111], v[44:47]
    v_mfma_f32_16x16x32_bf16 v[60:63], a[160:163], v[108:111], v[60:63]
    s_add_u32 m0, s92, 27648
    s_nop 0
    buffer_load_dwordx4 v178, s[72:75], s91 offen lds
    s_add_u32 s91, s91, s78
    v_mfma_f32_16x16x32_bf16 v[76:79], a[232:235], v[108:111], v[76:79]
    s_waitcnt lgkmcnt(14)
    v_mfma_f32_16x16x32_bf16 v[16:19], a[20:23], v[112:115], v[16:19]
    ds_read_b64_tr_b16 v[96:97], v170 offset:28672
    ds_read_b64_tr_b16 v[98:99], v170 offset:29184
    v_mfma_f32_16x16x32_bf16 v[32:35], a[92:95], v[112:115], v[32:35]
    v_mfma_f32_16x16x32_bf16 v[48:51], a[164:167], v[112:115], v[48:51]
    v_mfma_f32_16x16x32_bf16 v[64:67], a[236:239], v[112:115], v[64:67]
    s_waitcnt lgkmcnt(14)
    v_mfma_f32_16x16x32_bf16 v[20:23], a[20:23], v[116:119], v[20:23]
    ds_read_b64_tr_b16 v[100:101], v171 offset:28672
    ds_read_b64_tr_b16 v[102:103], v171 offset:29184
    v_mfma_f32_16x16x32_bf16 v[36:39], a[92:95], v[116:119], v[36:39]
    v_mfma_f32_16x16x32_bf16 v[52:55], a[164:167], v[116:119], v[52:55]
    s_add_u32 m0, s92, 28672
    s_nop 0
    buffer_load_dwordx4 v169, s[72:75], s91 offen lds
    s_add_u32 s91, s91, s78
    v_mfma_f32_16x16x32_bf16 v[68:71], a[236:239], v[116:119], v[68:71]
    s_waitcnt lgkmcnt(14)
    v_mfma_f32_16x16x32_bf16 v[24:27], a[20:23], v[120:123], v[24:27]
    ds_read_b64_tr_b16 v[104:105], v172 offset:28672
    ds_read_b64_tr_b16 v[106:107], v172 offset:29184
    v_mfma_f32_16x16x32_bf16 v[40:43], a[92:95], v[120:123], v[40:43]
    v_mfma_f32_16x16x32_bf16 v[56:59], a[164:167], v[120:123], v[56:59]
    v_mfma_f32_16x16x32_bf16 v[72:75], a[236:239], v[120:123], v[72:75]
    s_waitcnt lgkmcnt(14)
    v_mfma_f32_16x16x32_bf16 v[28:31], a[20:23], v[124:127], v[28:31]
    ds_read_b64_tr_b16 v[108:109], v173 offset:28672
    ds_read_b64_tr_b16 v[110:111], v173 offset:29184
    v_mfma_f32_16x16x32_bf16 v[44:47], a[92:95], v[124:127], v[44:47]
    v_mfma_f32_16x16x32_bf16 v[60:63], a[164:167], v[124:127], v[60:63]
    s_add_u32 m0, s92, 29696
    s_nop 0
    buffer_load_dwordx4 v178, s[72:75], s91 offen lds
    s_mul_i32 s68, s78, 19
    s_add_u32 s91, s91, s68
    v_mfma_f32_16x16x32_bf16 v[76:79], a[236:239], v[124:127], v[76:79]
    s_waitcnt lgkmcnt(14)
    v_mfma_f32_16x16x32_bf16 v[16:19], a[24:27], v[80:83], v[16:19]
    ds_read_b64_tr_b16 v[112:113], v170 offset:32768
    ds_read_b64_tr_b16 v[114:115], v170 offset:33280
    v_mfma_f32_16x16x32_bf16 v[32:35], a[96:99], v[80:83], v[32:35]
    v_mfma_f32_16x16x32_bf16 v[48:51], a[168:171], v[80:83], v[48:51]
    v_mfma_f32_16x16x32_bf16 v[64:67], a[240:243], v[80:83], v[64:67]
    s_waitcnt lgkmcnt(14)
    v_mfma_f32_16x16x32_bf16 v[20:23], a[24:27], v[84:87], v[20:23]
    ds_read_b64_tr_b16 v[116:117], v171 offset:32768
    ds_read_b64_tr_b16 v[118:119], v171 offset:33280
    v_mfma_f32_16x16x32_bf16 v[36:39], a[96:99], v[84:87], v[36:39]
    v_mfma_f32_16x16x32_bf16 v[52:55], a[168:171], v[84:87], v[52:55]
    s_add_u32 m0, s92, 49152
    s_nop 0
    buffer_load_dwordx4 v169, s[72:75], s91 offen lds
    s_add_u32 s91, s91, s78
    v_mfma_f32_16x16x32_bf16 v[68:71], a[240:243], v[84:87], v[68:71]
    s_waitcnt lgkmcnt(14)
    v_mfma_f32_16x16x32_bf16 v[24:27], a[24:27], v[88:91], v[24:27]
    ds_read_b64_tr_b16 v[120:121], v172 offset:32768
    ds_read_b64_tr_b16 v[122:123], v172 offset:33280
    v_mfma_f32_16x16x32_bf16 v[40:43], a[96:99], v[88:91], v[40:43]
    v_mfma_f32_16x16x32_bf16 v[56:59], a[168:171], v[88:91], v[56:59]
    v_mfma_f32_16x16x32_bf16 v[72:75], a[240:243], v[88:91], v[72:75]
    s_waitcnt lgkmcnt(14)
    v_mfma_f32_16x16x32_bf16 v[28:31], a[24:27], v[92:95], v[28:31]
    ds_read_b64_tr_b16 v[124:125], v173 offset:32768
    ds_read_b64_tr_b16 v[126:127], v173 offset:33280
    v_mfma_f32_16x16x32_bf16 v[44:47], a[96:99], v[92:95], v[44:47]
    v_mfma_f32_16x16x32_bf16 v[60:63], a[168:171], v[92:95], v[60:63]
    s_add_u32 m0, s92, 50176
    s_nop 0
    buffer_load_dwordx4 v178, s[72:75], s91 offen lds
    s_add_u32 s91, s91, s78
    v_mfma_f32_16x16x32_bf16 v[76:79], a[240:243], v[92:95], v[76:79]
    s_waitcnt lgkmcnt(14)
    v_mfma_f32_16x16x32_bf16 v[16:19], a[28:31], v[96:99], v[16:19]
    ds_read_b64_tr_b16 v[80:81], v170 offset:36864
    ds_read_b64_tr_b16 v[82:83], v170 offset:37376
    v_mfma_f32_16x16x32_bf16 v[32:35], a[100:103], v[96:99], v[32:35]
    v_mfma_f32_16x16x32_bf16 v[48:51], a[172:175], v[96:99], v[48:51]
    v_mfma_f32_16x16x32_bf16 v[64:67], a[244:247], v[96:99], v[64:67]
    s_waitcnt lgkmcnt(14)
    v_mfma_f32_16x16x32_bf16 v[20:23], a[28:31], v[100:103], v[20:23]
    ds_read_b64_tr_b16 v[84:85], v171 offset:36864
    ds_read_b64_tr_b16 v[86:87], v171 offset:37376
    v_mfma_f32_16x16x32_bf16 v[36:39], a[100:103], v[100:103], v[36:39]
    v_mfma_f32_16x16x32_bf16 v[52:55], a[172:175], v[100:103], v[52:55]
    s_add_u32 m0, s92, 51200
    s_nop 0
    buffer_load_dwordx4 v169, s[72:75], s91 offen lds
    s_add_u32 s91, s91, s78
    v_mfma_f32_16x16x32_bf16 v[68:71], a[244:247], v[100:103], v[68:71]
    s_waitcnt lgkmcnt(14)
    v_mfma_f32_16x16x32_bf16 v[24:27], a[28:31], v[104:107], v[24:27]
    ds_read_b64_tr_b16 v[88:89], v172 offset:36864
    ds_read_b64_tr_b16 v[90:91], v172 offset:37376
    v_mfma_f32_16x16x32_bf16 v[40:43], a[100:103], v[104:107], v[40:43]
    v_mfma_f32_16x16x32_bf16 v[56:59], a[172:175], v[104:107], v[56:59]
    v_mfma_f32_16x16x32_bf16 v[72:75], a[244:247], v[104:107], v[72:75]
    s_waitcnt lgkmcnt(14)
    v_mfma_f32_16x16x32_bf16 v[28:31], a[28:31], v[108:111], v[28:31]
    ds_read_b64_tr_b16 v[92:93], v173 offset:36864
    ds_read_b64_tr_b16 v[94:95], v173 offset:37376
    v_mfma_f32_16x16x32_bf16 v[44:47], a[100:103], v[108:111], v[44:47]
    v_mfma_f32_16x16x32_bf16 v[60:63], a[172:175], v[108:111], v[60:63]
    s_add_u32 m0, s92, 52224
    s_nop 0
    buffer_load_dwordx4 v178, s[72:75], s91 offen lds
    s_add_u32 s91, s91, s78
    v_mfma_f32_16x16x32_bf16 v[76:79], a[244:247], v[108:111], v[76:79]
    s_waitcnt lgkmcnt(14)
    v_mfma_f32_16x16x32_bf16 v[16:19], a[32:35], v[112:115], v[16:19]
    ds_read_b64_tr_b16 v[96:97], v170 offset:40960
    ds_read_b64_tr_b16 v[98:99], v170 offset:41472
    v_mfma_f32_16x16x32_bf16 v[32:35], a[104:107], v[112:115], v[32:35]
    v_mfma_f32_16x16x32_bf16 v[48:51], a[176:179], v[112:115], v[48:51]
    v_mfma_f32_16x16x32_bf16 v[64:67], a[248:251], v[112:115], v[64:67]
    s_waitcnt lgkmcnt(14)
    v_mfma_f32_16x16x32_bf16 v[20:23], a[32:35], v[116:119], v[20:23]
    ds_read_b64_tr_b16 v[100:101], v171 offset:40960
    ds_read_b64_tr_b16 v[102:103], v171 offset:41472
    v_mfma_f32_16x16x32_bf16 v[36:39], a[104:107], v[116:119], v[36:39]
    v_mfma_f32_16x16x32_bf16 v[52:55], a[176:179], v[116:119], v[52:55]
    s_add_u32 m0, s92, 53248
    s_nop 0
    buffer_load_dwordx4 v169, s[72:75], s91 offen lds
    s_add_u32 s91, s91, s78
    v_mfma_f32_16x16x32_bf16 v[68:71], a[248:251], v[116:119], v[68:71]
    s_waitcnt lgkmcnt(14)
    v_mfma_f32_16x16x32_bf16 v[24:27], a[32:35], v[120:123], v[24:27]
    ds_read_b64_tr_b16 v[104:105], v172 offset:40960
    ds_read_b64_tr_b16 v[106:107], v172 offset:41472
    v_mfma_f32_16x16x32_bf16 v[40:43], a[104:107], v[120:123], v[40:43]
    v_mfma_f32_16x16x32_bf16 v[56:59], a[176:179], v[120:123], v[56:59]
    v_mfma_f32_16x16x32_bf16 v[72:75], a[248:251], v[120:123], v[72:75]
    s_waitcnt lgkmcnt(14)
    v_mfma_f32_16x16x32_bf16 v[28:31], a[32:35], v[124:127], v[28:31]
    ds_read_b64_tr_b16 v[108:109], v173 offset:40960
    ds_read_b64_tr_b16 v[110:111], v173 offset:41472
    v_mfma_f32_16x16x32_bf16 v[44:47], a[104:107], v[124:127], v[44:47]
    v_mfma_f32_16x16x32_bf16 v[60:63], a[176:179], v[124:127], v[60:63]
    s_add_u32 m0, s92, 54272
    s_nop 0
    buffer_load_dwordx4 v178, s[72:75], s91 offen lds
    v_mfma_f32_16x16x32_bf16 v[76:79], a[248:251], v[124:127], v[76:79]
    s_waitcnt lgkmcnt(14)
    v_mfma_f32_16x16x32_bf16 v[16:19], a[36:39], v[80:83], v[16:19]
    ds_read_b64_tr_b16 v[112:113], v170 offset:45056
    ds_read_b64_tr_b16 v[114:115], v170 offset:45568
    v_mfma_f32_16x16x32_bf16 v[32:35], a[108:111], v[80:83], v[32:35]
    v_mfma_f32_16x16x32_bf16 v[48:51], a[180:183], v[80:83], v[48:51]
    v_mfma_f32_16x16x32_bf16 v[64:67], a[252:255], v[80:83], v[64:67]
    s_waitcnt lgkmcnt(14)
    v_mfma_f32_16x16x32_bf16 v[20:23], a[36:39], v[84:87], v[20:23]
    ds_read_b64_tr_b16 v[116:117], v171 offset:45056
    ds_read_b64_tr_b16 v[118:119], v171 offset:45568
    v_mfma_f32_16x16x32_bf16 v[36:39], a[108:111], v[84:87], v[36:39]
    v_mfma_f32_16x16x32_bf16 v[52:55], a[180:183], v[84:87], v[52:55]
    v_mfma_f32_16x16x32_bf16 v[68:71], a[252:255], v[84:87], v[68:71]
    s_waitcnt lgkmcnt(14)
    v_mfma_f32_16x16x32_bf16 v[24:27], a[36:39], v[88:91], v[24:27]
    ds_read_b64_tr_b16 v[120:121], v172 offset:45056
    ds_read_b64_tr_b16 v[122:123], v172 offset:45568
    v_mfma_f32_16x16x32_bf16 v[40:43], a[108:111], v[88:91], v[40:43]
    v_mfma_f32_16x16x32_bf16 v[56:59], a[180:183], v[88:91], v[56:59]
    v_mfma_f32_16x16x32_bf16 v[72:75], a[252:255], v[88:91], v[72:75]
    s_waitcnt lgkmcnt(14)
    v_mfma_f32_16x16x32_bf16 v[28:31], a[36:39], v[92:95], v[28:31]
    ds_read_b64_tr_b16 v[124:125], v173 offset:45056
    ds_read_b64_tr_b16 v[126:127], v173 offset:45568
    v_mfma_f32_16x16x32_bf16 v[44:47], a[108:111], v[92:95], v[44:47]
    v_mfma_f32_16x16x32_bf16 v[60:63], a[180:183], v[92:95], v[60:63]
    v_mfma_f32_16x16x32_bf16 v[76:79], a[252:255], v[92:95], v[76:79]
    s_waitcnt lgkmcnt(14)
    v_mfma_f32_16x16x32_bf16 v[16:19], a[40:43], v[96:99], v[16:19]
    ds_read_b64_tr_b16 v[80:81], v170 offset:49152
    ds_read_b64_tr_b16 v[82:83], v170 offset:49664
    v_mfma_f32_16x16x32_bf16 v[32:35], a[112:115], v[96:99], v[32:35]
    v_mfma_f32_16x16x32_bf16 v[48:51], a[184:187], v[96:99], v[48:51]
    v_mfma_f32_16x16x32_bf16 v[64:67], v[224:227], v[96:99], v[64:67]
    s_waitcnt lgkmcnt(14)
    v_mfma_f32_16x16x32_bf16 v[20:23], a[40:43], v[100:103], v[20:23]
    ds_read_b64_tr_b16 v[84:85], v171 offset:49152
    ds_read_b64_tr_b16 v[86:87], v171 offset:49664
    v_mfma_f32_16x16x32_bf16 v[36:39], a[112:115], v[100:103], v[36:39]
    v_mfma_f32_16x16x32_bf16 v[52:55], a[184:187], v[100:103], v[52:55]
    v_mfma_f32_16x16x32_bf16 v[68:71], v[224:227], v[100:103], v[68:71]
    s_waitcnt lgkmcnt(14)
    v_mfma_f32_16x16x32_bf16 v[24:27], a[40:43], v[104:107], v[24:27]
    ds_read_b64_tr_b16 v[88:89], v172 offset:49152
    ds_read_b64_tr_b16 v[90:91], v172 offset:49664
    v_mfma_f32_16x16x32_bf16 v[40:43], a[112:115], v[104:107], v[40:43]
    v_mfma_f32_16x16x32_bf16 v[56:59], a[184:187], v[104:107], v[56:59]
    v_mfma_f32_16x16x32_bf16 v[72:75], v[224:227], v[104:107], v[72:75]
    s_waitcnt lgkmcnt(14)
    v_mfma_f32_16x16x32_bf16 v[28:31], a[40:43], v[108:111], v[28:31]
    ds_read_b64_tr_b16 v[92:93], v173 offset:49152
    ds_read_b64_tr_b16 v[94:95], v173 offset:49664
    v_mfma_f32_16x16x32_bf16 v[44:47], a[112:115], v[108:111], v[44:47]
    v_mfma_f32_16x16x32_bf16 v[60:63], a[184:187], v[108:111], v[60:63]
    v_mfma_f32_16x16x32_bf16 v[76:79], v[224:227], v[108:111], v[76:79]
    s_waitcnt lgkmcnt(14)
    v_mfma_f32_16x16x32_bf16 v[16:19], a[44:47], v[112:115], v[16:19]
    ds_read_b64_tr_b16 v[96:97], v170 offset:53248
    ds_read_b64_tr_b16 v[98:99], v170 offset:53760
    v_mfma_f32_16x16x32_bf16 v[32:35], a[116:119], v[112:115], v[32:35]
    v_mfma_f32_16x16x32_bf16 v[48:51], a[188:191], v[112:115], v[48:51]
    v_mfma_f32_16x16x32_bf16 v[64:67], v[228:231], v[112:115], v[64:67]
    s_waitcnt lgkmcnt(14)
    v_mfma_f32_16x16x32_bf16 v[20:23], a[44:47], v[116:119], v[20:23]
    ds_read_b64_tr_b16 v[100:101], v171 offset:53248
    ds_read_b64_tr_b16 v[102:103], v171 offset:53760
    v_mfma_f32_16x16x32_bf16 v[36:39], a[116:119], v[116:119], v[36:39]
    v_mfma_f32_16x16x32_bf16 v[52:55], a[188:191], v[116:119], v[52:55]
    v_mfma_f32_16x16x32_bf16 v[68:71], v[228:231], v[116:119], v[68:71]
    s_waitcnt lgkmcnt(14)
    v_mfma_f32_16x16x32_bf16 v[24:27], a[44:47], v[120:123], v[24:27]
    ds_read_b64_tr_b16 v[104:105], v172 offset:53248
    ds_read_b64_tr_b16 v[106:107], v172 offset:53760
    v_mfma_f32_16x16x32_bf16 v[40:43], a[116:119], v[120:123], v[40:43]
    v_mfma_f32_16x16x32_bf16 v[56:59], a[188:191], v[120:123], v[56:59]
    v_mfma_f32_16x16x32_bf16 v[72:75], v[228:231], v[120:123], v[72:75]
    s_waitcnt lgkmcnt(14)
    v_mfma_f32_16x16x32_bf16 v[28:31], a[44:47], v[124:127], v[28:31]
    ds_read_b64_tr_b16 v[108:109], v173 offset:53248
    ds_read_b64_tr_b16 v[110:111], v173 offset:53760
    v_mfma_f32_16x16x32_bf16 v[44:47], a[116:119], v[124:127], v[44:47]
    v_mfma_f32_16x16x32_bf16 v[60:63], a[188:191], v[124:127], v[60:63]
    v_mfma_f32_16x16x32_bf16 v[76:79], v[228:231], v[124:127], v[76:79]
    s_waitcnt lgkmcnt(14)
    v_mfma_f32_16x16x32_bf16 v[16:19], a[48:51], v[80:83], v[16:19]
    ds_read_b64_tr_b16 v[112:113], v170 offset:57344
    ds_read_b64_tr_b16 v[114:115], v170 offset:57856
    v_mfma_f32_16x16x32_bf16 v[32:35], a[120:123], v[80:83], v[32:35]
    v_mfma_f32_16x16x32_bf16 v[48:51], a[192:195], v[80:83], v[48:51]
    v_mfma_f32_16x16x32_bf16 v[64:67], v[232:235], v[80:83], v[64:67]
    s_waitcnt lgkmcnt(14)
    v_mfma_f32_16x16x32_bf16 v[20:23], a[48:51], v[84:87], v[20:23]
    ds_read_b64_tr_b16 v[116:117], v171 offset:57344
    ds_read_b64_tr_b16 v[118:119], v171 offset:57856
    v_mfma_f32_16x16x32_bf16 v[36:39], a[120:123], v[84:87], v[36:39]
    v_mfma_f32_16x16x32_bf16 v[52:55], a[192:195], v[84:87], v[52:55]
    v_mfma_f32_16x16x32_bf16 v[68:71], v[232:235], v[84:87], v[68:71]
    s_waitcnt lgkmcnt(14)
    v_mfma_f32_16x16x32_bf16 v[24:27], a[48:51], v[88:91], v[24:27]
    ds_read_b64_tr_b16 v[120:121], v172 offset:57344
    ds_read_b64_tr_b16 v[122:123], v172 offset:57856
    v_mfma_f32_16x16x32_bf16 v[40:43], a[120:123], v[88:91], v[40:43]
    v_mfma_f32_16x16x32_bf16 v[56:59], a[192:195], v[88:91], v[56:59]
    v_mfma_f32_16x16x32_bf16 v[72:75], v[232:235], v[88:91], v[72:75]
    s_waitcnt lgkmcnt(14)
    v_mfma_f32_16x16x32_bf16 v[28:31], a[48:51], v[92:95], v[28:31]
    ds_read_b64_tr_b16 v[124:125], v173 offset:57344
    ds_read_b64_tr_b16 v[126:127], v173 offset:57856
    v_mfma_f32_16x16x32_bf16 v[44:47], a[120:123], v[92:95], v[44:47]
    v_mfma_f32_16x16x32_bf16 v[60:63], a[192:195], v[92:95], v[60:63]
    v_mfma_f32_16x16x32_bf16 v[76:79], v[232:235], v[92:95], v[76:79]
    s_waitcnt lgkmcnt(14)
    v_mfma_f32_16x16x32_bf16 v[16:19], a[52:55], v[96:99], v[16:19]
    ds_read_b64_tr_b16 v[80:81], v170 offset:61440
    ds_read_b64_tr_b16 v[82:83], v170 offset:61952
    v_mfma_f32_16x16x32_bf16 v[32:35], a[124:127], v[96:99], v[32:35]
    v_mfma_f32_16x16x32_bf16 v[48:51], a[196:199], v[96:99], v[48:51]
    v_mfma_f32_16x16x32_bf16 v[64:67], v[236:239], v[96:99], v[64:67]
    s_waitcnt lgkmcnt(14)
    v_mfma_f32_16x16x32_bf16 v[20:23], a[52:55], v[100:103], v[20:23]
    ds_read_b64_tr_b16 v[84:85], v171 offset:61440
    ds_read_b64_tr_b16 v[86:87], v171 offset:61952
    v_mfma_f32_16x16x32_bf16 v[36:39], a[124:127], v[100:103], v[36:39]
    v_mfma_f32_16x16x32_bf16 v[52:55], a[196:199], v[100:103], v[52:55]
    v_mfma_f32_16x16x32_bf16 v[68:71], v[236:239], v[100:103], v[68:71]
    s_waitcnt lgkmcnt(14)
    v_mfma_f32_16x16x32_bf16 v[24:27], a[52:55], v[104:107], v[24:27]
    ds_read_b64_tr_b16 v[88:89], v172 offset:61440
    ds_read_b64_tr_b16 v[90:91], v172 offset:61952
    v_mfma_f32_16x16x32_bf16 v[40:43], a[124:127], v[104:107], v[40:43]
    v_mfma_f32_16x16x32_bf16 v[56:59], a[196:199], v[104:107], v[56:59]
    v_mfma_f32_16x16x32_bf16 v[72:75], v[236:239], v[104:107], v[72:75]
    s_waitcnt lgkmcnt(14)
    v_mfma_f32_16x16x32_bf16 v[28:31], a[52:55], v[108:111], v[28:31]
    ds_read_b64_tr_b16 v[92:93], v173 offset:61440
    ds_read_b64_tr_b16 v[94:95], v173 offset:61952
    v_mfma_f32_16x16x32_bf16 v[44:47], a[124:127], v[108:111], v[44:47]
    v_mfma_f32_16x16x32_bf16 v[60:63], a[196:199], v[108:111], v[60:63]
    v_mfma_f32_16x16x32_bf16 v[76:79], v[236:239], v[108:111], v[76:79]
    s_waitcnt lgkmcnt(14)
    v_mfma_f32_16x16x32_bf16 v[16:19], a[56:59], v[112:115], v[16:19]
    ds_read_b64_tr_b16 v[96:97], v174 offset:16384
    ds_read_b64_tr_b16 v[98:99], v174 offset:16896
    v_mfma_f32_16x16x32_bf16 v[32:35], a[128:131], v[112:115], v[32:35]
    v_mfma_f32_16x16x32_bf16 v[48:51], a[200:203], v[112:115], v[48:51]
    v_mfma_f32_16x16x32_bf16 v[64:67], v[240:243], v[112:115], v[64:67]
    s_waitcnt lgkmcnt(14)
    v_mfma_f32_16x16x32_bf16 v[20:23], a[56:59], v[116:119], v[20:23]
    ds_read_b64_tr_b16 v[100:101], v175 offset:16384
    ds_read_b64_tr_b16 v[102:103], v175 offset:16896
    v_mfma_f32_16x16x32_bf16 v[36:39], a[128:131], v[116:119], v[36:39]
    v_mfma_f32_16x16x32_bf16 v[52:55], a[200:203], v[116:119], v[52:55]
    v_mfma_f32_16x16x32_bf16 v[68:71], v[240:243], v[116:119], v[68:71]
    s_waitcnt lgkmcnt(14)
    v_mfma_f32_16x16x32_bf16 v[24:27], a[56:59], v[120:123], v[24:27]
    ds_read_b64_tr_b16 v[104:105], v176 offset:16384
    ds_read_b64_tr_b16 v[106:107], v176 offset:16896
    v_mfma_f32_16x16x32_bf16 v[40:43], a[128:131], v[120:123], v[40:43]
    v_mfma_f32_16x16x32_bf16 v[56:59], a[200:203], v[120:123], v[56:59]
    v_mfma_f32_16x16x32_bf16 v[72:75], v[240:243], v[120:123], v[72:75]
    s_waitcnt lgkmcnt(14)
    v_mfma_f32_16x16x32_bf16 v[28:31], a[56:59], v[124:127], v[28:31]
    ds_read_b64_tr_b16 v[108:109], v177 offset:16384
    ds_read_b64_tr_b16 v[110:111], v177 offset:16896
    v_mfma_f32_16x16x32_bf16 v[44:47], a[128:131], v[124:127], v[44:47]
    v_mfma_f32_16x16x32_bf16 v[60:63], a[200:203], v[124:127], v[60:63]
    v_mfma_f32_16x16x32_bf16 v[76:79], v[240:243], v[124:127], v[76:79]
    s_waitcnt lgkmcnt(14)
    v_mfma_f32_16x16x32_bf16 v[16:19], a[60:63], v[80:83], v[16:19]
    ds_read_b64_tr_b16 v[112:113], v174 offset:20480
    ds_read_b64_tr_b16 v[114:115], v174 offset:20992
    v_mfma_f32_16x16x32_bf16 v[32:35], a[132:135], v[80:83], v[32:35]
    v_mfma_f32_16x16x32_bf16 v[48:51], a[204:207], v[80:83], v[48:51]
    v_mfma_f32_16x16x32_bf16 v[64:67], v[244:247], v[80:83], v[64:67]
    s_waitcnt lgkmcnt(14)
    v_mfma_f32_16x16x32_bf16 v[20:23], a[60:63], v[84:87], v[20:23]
    ds_read_b64_tr_b16 v[116:117], v175 offset:20480
    ds_read_b64_tr_b16 v[118:119], v175 offset:20992
    v_mfma_f32_16x16x32_bf16 v[36:39], a[132:135], v[84:87], v[36:39]
    v_mfma_f32_16x16x32_bf16 v[52:55], a[204:207], v[84:87], v[52:55]
    v_mfma_f32_16x16x32_bf16 v[68:71], v[244:247], v[84:87], v[68:71]
    s_waitcnt lgkmcnt(14)
    v_mfma_f32_16x16x32_bf16 v[24:27], a[60:63], v[88:91], v[24:27]
    ds_read_b64_tr_b16 v[120:121], v176 offset:20480
    ds_read_b64_tr_b16 v[122:123], v176 offset:20992
    v_mfma_f32_16x16x32_bf16 v[40:43], a[132:135], v[88:91], v[40:43]
    v_mfma_f32_16x16x32_bf16 v[56:59], a[204:207], v[88:91], v[56:59]
    v_mfma_f32_16x16x32_bf16 v[72:75], v[244:247], v[88:91], v[72:75]
    s_waitcnt lgkmcnt(14)
    v_mfma_f32_16x16x32_bf16 v[28:31], a[60:63], v[92:95], v[28:31]
    ds_read_b64_tr_b16 v[124:125], v177 offset:20480
    ds_read_b64_tr_b16 v[126:127], v177 offset:20992
    v_mfma_f32_16x16x32_bf16 v[44:47], a[132:135], v[92:95], v[44:47]
    v_mfma_f32_16x16x32_bf16 v[60:63], a[204:207], v[92:95], v[60:63]
    v_mfma_f32_16x16x32_bf16 v[76:79], v[244:247], v[92:95], v[76:79]
    s_waitcnt lgkmcnt(14)
    v_mfma_f32_16x16x32_bf16 v[16:19], a[64:67], v[96:99], v[16:19]
    v_mfma_f32_16x16x32_bf16 v[32:35], a[136:139], v[96:99], v[32:35]
    v_mfma_f32_16x16x32_bf16 v[48:51], a[208:211], v[96:99], v[48:51]
    v_mfma_f32_16x16x32_bf16 v[64:67], v[248:251], v[96:99], v[64:67]
    s_waitcnt lgkmcnt(12)
    v_mfma_f32_16x16x32_bf16 v[20:23], a[64:67], v[100:103], v[20:23]
    v_mfma_f32_16x16x32_bf16 v[36:39], a[136:139], v[100:103], v[36:39]
    v_mfma_f32_16x16x32_bf16 v[52:55], a[208:211], v[100:103], v[52:55]
    v_mfma_f32_16x16x32_bf16 v[68:71], v[248:251], v[100:103], v[68:71]
    s_waitcnt lgkmcnt(10)
    v_mfma_f32_16x16x32_bf16 v[24:27], a[64:67], v[104:107], v[24:27]
    v_mfma_f32_16x16x32_bf16 v[40:43], a[136:139], v[104:107], v[40:43]
    v_mfma_f32_16x16x32_bf16 v[56:59], a[208:211], v[104:107], v[56:59]
    v_mfma_f32_16x16x32_bf16 v[72:75], v[248:251], v[104:107], v[72:75]
    s_waitcnt lgkmcnt(8)
    v_mfma_f32_16x16x32_bf16 v[28:31], a[64:67], v[108:111], v[28:31]
    v_mfma_f32_16x16x32_bf16 v[44:47], a[136:139], v[108:111], v[44:47]
    v_mfma_f32_16x16x32_bf16 v[60:63], a[208:211], v[108:111], v[60:63]
    v_mfma_f32_16x16x32_bf16 v[76:79], v[248:251], v[108:111], v[76:79]
    s_waitcnt lgkmcnt(6)
    v_mfma_f32_16x16x32_bf16 v[16:19], a[68:71], v[112:115], v[16:19]
    v_mfma_f32_16x16x32_bf16 v[32:35], a[140:143], v[112:115], v[32:35]
    v_mfma_f32_16x16x32_bf16 v[48:51], a[212:215], v[112:115], v[48:51]
    v_mfma_f32_16x16x32_bf16 v[64:67], v[252:255], v[112:115], v[64:67]
    s_waitcnt lgkmcnt(4)
    v_mfma_f32_16x16x32_bf16 v[20:23], a[68:71], v[116:119], v[20:23]
    v_mfma_f32_16x16x32_bf16 v[36:39], a[140:143], v[116:119], v[36:39]
    v_mfma_f32_16x16x32_bf16 v[52:55], a[212:215], v[116:119], v[52:55]
    v_mfma_f32_16x16x32_bf16 v[68:71], v[252:255], v[116:119], v[68:71]
    s_waitcnt lgkmcnt(2)
    v_mfma_f32_16x16x32_bf16 v[24:27], a[68:71], v[120:123], v[24:27]
    v_mfma_f32_16x16x32_bf16 v[40:43], a[140:143], v[120:123], v[40:43]
    v_mfma_f32_16x16x32_bf16 v[56:59], a[212:215], v[120:123], v[56:59]
    v_mfma_f32_16x16x32_bf16 v[72:75], v[252:255], v[120:123], v[72:75]
    s_waitcnt lgkmcnt(0)
    v_mfma_f32_16x16x32_bf16 v[28:31], a[68:71], v[124:127], v[28:31]
    v_mfma_f32_16x16x32_bf16 v[44:47], a[140:143], v[124:127], v[44:47]
    v_mfma_f32_16x16x32_bf16 v[60:63], a[212:215], v[124:127], v[60:63]
    v_mfma_f32_16x16x32_bf16 v[76:79], v[252:255], v[124:127], v[76:79]
    s_lshl_b32 s68, s66, 2
    s_add_u32 s68, s68, s65
    s_lshl_b32 s68, s68, 6
    s_bfe_u32 s69, s76, 0x50001
    s_add_u32 s68, s68, s69
    s_lshl_b32 s68, s68, 14
    s_and_b32 s69, s76, 1
    s_lshl_b32 s69, s69, 12
    s_add_u32 s68, s68, s69
    s_add_u32 s68, s68, 8192
    v_cvt_pk_bf16_f32 v16, v16, v17
    v_cvt_pk_bf16_f32 v17, v18, v19
    v_cvt_pk_bf16_f32 v18, v32, v33
    v_cvt_pk_bf16_f32 v19, v34, v35
    buffer_store_dwordx4 v[16:19], v1, s[60:63], s68 offen offset:0 sc1
    v_cvt_pk_bf16_f32 v20, v20, v21
    v_cvt_pk_bf16_f32 v21, v22, v23
    v_cvt_pk_bf16_f32 v22, v36, v37
    v_cvt_pk_bf16_f32 v23, v38, v39
    buffer_store_dwordx4 v[20:23], v1, s[60:63], s68 offen offset:1024 sc1
    v_cvt_pk_bf16_f32 v24, v24, v25
    v_cvt_pk_bf16_f32 v25, v26, v27
    v_cvt_pk_bf16_f32 v26, v40, v41
    v_cvt_pk_bf16_f32 v27, v42, v43
    buffer_store_dwordx4 v[24:27], v1, s[60:63], s68 offen offset:2048 sc1
    v_cvt_pk_bf16_f32 v28, v28, v29
    v_cvt_pk_bf16_f32 v29, v30, v31
    v_cvt_pk_bf16_f32 v30, v44, v45
    v_cvt_pk_bf16_f32 v31, v46, v47
    buffer_store_dwordx4 v[28:31], v1, s[60:63], s68 offen offset:3072 sc1
    s_add_u32 s68, s68, 524288
    v_cvt_pk_bf16_f32 v48, v48, v49
    v_cvt_pk_bf16_f32 v49, v50, v51
    v_cvt_pk_bf16_f32 v50, v64, v65
    v_cvt_pk_bf16_f32 v51, v66, v67
    buffer_store_dwordx4 v[48:51], v1, s[60:63], s68 offen offset:0 sc1
    v_cvt_pk_bf16_f32 v52, v52, v53
    v_cvt_pk_bf16_f32 v53, v54, v55
    v_cvt_pk_bf16_f32 v54, v68, v69
    v_cvt_pk_bf16_f32 v55, v70, v71
    buffer_store_dwordx4 v[52:55], v1, s[60:63], s68 offen offset:1024 sc1
    v_cvt_pk_bf16_f32 v56, v56, v57
    v_cvt_pk_bf16_f32 v57, v58, v59
    v_cvt_pk_bf16_f32 v58, v72, v73
    v_cvt_pk_bf16_f32 v59, v74, v75
    buffer_store_dwordx4 v[56:59], v1, s[60:63], s68 offen offset:2048 sc1
    v_cvt_pk_bf16_f32 v60, v60, v61
    v_cvt_pk_bf16_f32 v61, v62, v63
    v_cvt_pk_bf16_f32 v62, v76, v77
    v_cvt_pk_bf16_f32 v63, v78, v79
    buffer_store_dwordx4 v[60:63], v1, s[60:63], s68 offen offset:3072 sc1
    s_branch Lp1n_119
Lp1e_118:
    s_cmp_ge_u32 s83, 3
    s_cbranch_scc1 Lp1h_120
    s_cmp_eq_u32 s83, 2
    s_cselect_b32 s87, 13, 14
    s_lshl_b32 s68, s66, 2
    s_add_u32 s68, s68, s65
    s_lshl_b32 s68, s68, 6
    s_bfe_u32 s69, s76, 0x50001
    s_add_u32 s68, s68, s69
    s_lshl_b32 s68, s68, s87
    s_lshl_b32 s87, 32, s87
    s_cmp_eq_u32 s83, 2
    s_cselect_b32 s69, 0x2000000, 0
    s_add_u32 s68, s68, s69
    s_and_b32 s69, s76, 1
    s_lshl_b32 s69, s69, 11
    s_add_u32 s68, s68, s69
    s_add_u32 s69, s68, 0
    v_cvt_pk_bf16_f32 v16, v16, v17
    v_cvt_pk_bf16_f32 v17, v18, v19
    v_cvt_pk_bf16_f32 v18, v20, v21
    v_cvt_pk_bf16_f32 v19, v22, v23
    buffer_store_dwordx4 v[16:19], v1, s[60:63], s69 offen offset:0 sc1
    v_cvt_pk_bf16_f32 v24, v24, v25
    v_cvt_pk_bf16_f32 v25, v26, v27
    v_cvt_pk_bf16_f32 v26, v28, v29
    v_cvt_pk_bf16_f32 v27, v30, v31
    buffer_store_dwordx4 v[24:27], v1, s[60:63], s69 offen offset:1024 sc1
    s_add_u32 s69, s68, 4096
    v_cvt_pk_bf16_f32 v32, v32, v33
    v_cvt_pk_bf16_f32 v33, v34, v35
    v_cvt_pk_bf16_f32 v34, v36, v37
    v_cvt_pk_bf16_f32 v35, v38, v39
    buffer_store_dwordx4 v[32:35], v1, s[60:63], s69 offen offset:0 sc1
    v_cvt_pk_bf16_f32 v40, v40, v41
    v_cvt_pk_bf16_f32 v41, v42, v43
    v_cvt_pk_bf16_f32 v42, v44, v45
    v_cvt_pk_bf16_f32 v43, v46, v47
    buffer_store_dwordx4 v[40:43], v1, s[60:63], s69 offen offset:1024 sc1
    s_add_u32 s68, s68, s87
    s_add_u32 s69, s68, 0
    v_cvt_pk_bf16_f32 v48, v48, v49
    v_cvt_pk_bf16_f32 v49, v50, v51
    v_cvt_pk_bf16_f32 v50, v52, v53
    v_cvt_pk_bf16_f32 v51, v54, v55
    buffer_store_dwordx4 v[48:51], v1, s[60:63], s69 offen offset:0 sc1
    v_cvt_pk_bf16_f32 v56, v56, v57
    v_cvt_pk_bf16_f32 v57, v58, v59
    v_cvt_pk_bf16_f32 v58, v60, v61
    v_cvt_pk_bf16_f32 v59, v62, v63
    buffer_store_dwordx4 v[56:59], v1, s[60:63], s69 offen offset:1024 sc1
    s_add_u32 s69, s68, 4096
    v_cvt_pk_bf16_f32 v64, v64, v65
    v_cvt_pk_bf16_f32 v65, v66, v67
    v_cvt_pk_bf16_f32 v66, v68, v69
    v_cvt_pk_bf16_f32 v67, v70, v71
    buffer_store_dwordx4 v[64:67], v1, s[60:63], s69 offen offset:0 sc1
    v_cvt_pk_bf16_f32 v72, v72, v73
    v_cvt_pk_bf16_f32 v73, v74, v75
    v_cvt_pk_bf16_f32 v74, v76, v77
    v_cvt_pk_bf16_f32 v75, v78, v79
    buffer_store_dwordx4 v[72:75], v1, s[60:63], s69 offen offset:1024 sc1
    s_branch Lp1n_119
Lp1h_120:
    s_lshl_b32 s68, s66, 2
    s_add_u32 s68, s68, s65
    s_mul_i32 s68, s68, 589824
    s_sub_u32 s69, s76, 192
    s_lshl_b32 s69, s69, 11
    s_add_u32 s68, s68, s69
    s_add_u32 s68, s68, 0x3000000
    s_waitcnt vmcnt(18)
    v_lshlrev_b32 v136, 16, v128
    v_and_b32 v137, 0xffff0000, v128
    v_lshlrev_b32 v138, 16, v129
    v_and_b32 v139, 0xffff0000, v129
    v_lshlrev_b32 v140, 16, v130
    v_and_b32 v141, 0xffff0000, v130
    v_lshlrev_b32 v142, 16, v131
    v_and_b32 v143, 0xffff0000, v131
    v_lshlrev_b32 v144, 16, v132
    v_and_b32 v145, 0xffff0000, v132
    v_lshlrev_b32 v146, 16, v133
    v_and_b32 v147, 0xffff0000, v133
    v_lshlrev_b32 v148, 16, v134
    v_and_b32 v149, 0xffff0000, v134
    v_lshlrev_b32 v150, 16, v135
    v_and_b32 v151, 0xffff0000, v135
    v_cvt_pk_bf16_f32 v152, v16, v17
    v_cvt_pk_bf16_f32 v156, v18, v19
    v_lshlrev_b32 v16, 16, v152
    v_lshlrev_b32 v18, 16, v156
    v_and_b32 v17, 0xffff0000, v152
    v_and_b32 v19, 0xffff0000, v156
    v_add_f32 v16, v16, v136
    v_add_f32 v18, v18, v138
    v_add_f32 v17, v17, v137
    v_add_f32 v19, v19, v139
    v_cvt_pk_bf16_f32 v152, v16, v17
    v_cvt_pk_bf16_f32 v156, v18, v19
    v_lshlrev_b32 v16, 16, v152
    v_lshlrev_b32 v18, 16, v156
    v_and_b32 v17, 0xffff0000, v152
    v_and_b32 v19, 0xffff0000, v156
    v_mul_f32 v153, v16, v16
    v_mul_f32 v157, v18, v18
    v_mul_f32 v154, v17, v17
    v_mul_f32 v158, v19, v19
    v_fma_f32 v153, v153, s85, v10
    v_fma_f32 v157, v157, s85, v10
    v_fma_f32 v154, v154, s85, v10
    v_fma_f32 v158, v158, s85, v10
    v_mul_f32 v153, v153, v16
    v_mul_f32 v157, v157, v18
    v_mul_f32 v154, v154, v17
    v_mul_f32 v158, v158, v19
    v_exp_f32 v153, v153
    v_exp_f32 v157, v157
    v_exp_f32 v154, v154
    v_exp_f32 v158, v158
    v_add_f32 v153, 1.0, v153
    v_add_f32 v157, 1.0, v157
    v_add_f32 v154, 1.0, v154
    v_add_f32 v158, 1.0, v158
    v_rcp_f32 v153, v153
    v_rcp_f32 v157, v157
    v_rcp_f32 v154, v154
    v_rcp_f32 v158, v158
    v_mul_f32 v16, v16, v153
    v_mul_f32 v18, v18, v157
    v_mul_f32 v17, v17, v154
    v_mul_f32 v19, v19, v158
    v_cvt_pk_bf16_f32 v160, v16, v17
    v_cvt_pk_bf16_f32 v161, v18, v19
    v_cvt_pk_bf16_f32 v152, v20, v21
    v_cvt_pk_bf16_f32 v156, v22, v23
    v_lshlrev_b32 v20, 16, v152
    v_lshlrev_b32 v22, 16, v156
    v_and_b32 v21, 0xffff0000, v152
    v_and_b32 v23, 0xffff0000, v156
    v_add_f32 v20, v20, v140
    v_add_f32 v22, v22, v142
    v_add_f32 v21, v21, v141
    v_add_f32 v23, v23, v143
    v_cvt_pk_bf16_f32 v152, v20, v21
    v_cvt_pk_bf16_f32 v156, v22, v23
    v_lshlrev_b32 v20, 16, v152
    v_lshlrev_b32 v22, 16, v156
    v_and_b32 v21, 0xffff0000, v152
    v_and_b32 v23, 0xffff0000, v156
    v_mul_f32 v153, v20, v20
    v_mul_f32 v157, v22, v22
    v_mul_f32 v154, v21, v21
    v_mul_f32 v158, v23, v23
    v_fma_f32 v153, v153, s85, v10
    v_fma_f32 v157, v157, s85, v10
    v_fma_f32 v154, v154, s85, v10
    v_fma_f32 v158, v158, s85, v10
    v_mul_f32 v153, v153, v20
    v_mul_f32 v157, v157, v22
    v_mul_f32 v154, v154, v21
    v_mul_f32 v158, v158, v23
    v_exp_f32 v153, v153
    v_exp_f32 v157, v157
    v_exp_f32 v154, v154
    v_exp_f32 v158, v158
    v_add_f32 v153, 1.0, v153
    v_add_f32 v157, 1.0, v157
    v_add_f32 v154, 1.0, v154
    v_add_f32 v158, 1.0, v158
    v_rcp_f32 v153, v153
    v_rcp_f32 v157, v157
    v_rcp_f32 v154, v154
    v_rcp_f32 v158, v158
    v_mul_f32 v20, v20, v153
    v_mul_f32 v22, v22, v157
    v_mul_f32 v21, v21, v154
    v_mul_f32 v23, v23, v158
    v_cvt_pk_bf16_f32 v162, v20, v21
    v_cvt_pk_bf16_f32 v163, v22, v23
    s_add_u32 s69, s68, 0
    buffer_store_dwordx4 v[160:163], v1, s[60:63], s69 offen offset:0 sc1
    v_cvt_pk_bf16_f32 v152, v24, v25
    v_cvt_pk_bf16_f32 v156, v26, v27
    v_lshlrev_b32 v24, 16, v152
    v_lshlrev_b32 v26, 16, v156
    v_and_b32 v25, 0xffff0000, v152
    v_and_b32 v27, 0xffff0000, v156
    v_add_f32 v24, v24, v144
    v_add_f32 v26, v26, v146
    v_add_f32 v25, v25, v145
    v_add_f32 v27, v27, v147
    v_cvt_pk_bf16_f32 v152, v24, v25
    v_cvt_pk_bf16_f32 v156, v26, v27
    v_lshlrev_b32 v24, 16, v152
    v_lshlrev_b32 v26, 16, v156
    v_and_b32 v25, 0xffff0000, v152
    v_and_b32 v27, 0xffff0000, v156
    v_mul_f32 v153, v24, v24
    v_mul_f32 v157, v26, v26
    v_mul_f32 v154, v25, v25
    v_mul_f32 v158, v27, v27
    v_fma_f32 v153, v153, s85, v10
    v_fma_f32 v157, v157, s85, v10
    v_fma_f32 v154, v154, s85, v10
    v_fma_f32 v158, v158, s85, v10
    v_mul_f32 v153, v153, v24
    v_mul_f32 v157, v157, v26
    v_mul_f32 v154, v154, v25
    v_mul_f32 v158, v158, v27
    v_exp_f32 v153, v153
    v_exp_f32 v157, v157
    v_exp_f32 v154, v154
    v_exp_f32 v158, v158
    v_add_f32 v153, 1.0, v153
    v_add_f32 v157, 1.0, v157
    v_add_f32 v154, 1.0, v154
    v_add_f32 v158, 1.0, v158
    v_rcp_f32 v153, v153
    v_rcp_f32 v157, v157
    v_rcp_f32 v154, v154
    v_rcp_f32 v158, v158
    v_mul_f32 v24, v24, v153
    v_mul_f32 v26, v26, v157
    v_mul_f32 v25, v25, v154
    v_mul_f32 v27, v27, v158
    v_cvt_pk_bf16_f32 v164, v24, v25
    v_cvt_pk_bf16_f32 v165, v26, v27
    v_cvt_pk_bf16_f32 v152, v28, v29
    v_cvt_pk_bf16_f32 v156, v30, v31
    v_lshlrev_b32 v28, 16, v152
    v_lshlrev_b32 v30, 16, v156
    v_and_b32 v29, 0xffff0000, v152
    v_and_b32 v31, 0xffff0000, v156
    v_add_f32 v28, v28, v148
    v_add_f32 v30, v30, v150
    v_add_f32 v29, v29, v149
    v_add_f32 v31, v31, v151
    v_cvt_pk_bf16_f32 v152, v28, v29
    v_cvt_pk_bf16_f32 v156, v30, v31
    v_lshlrev_b32 v28, 16, v152
    v_lshlrev_b32 v30, 16, v156
    v_and_b32 v29, 0xffff0000, v152
    v_and_b32 v31, 0xffff0000, v156
    v_mul_f32 v153, v28, v28
    v_mul_f32 v157, v30, v30
    v_mul_f32 v154, v29, v29
    v_mul_f32 v158, v31, v31
    v_fma_f32 v153, v153, s85, v10
    v_fma_f32 v157, v157, s85, v10
    v_fma_f32 v154, v154, s85, v10
    v_fma_f32 v158, v158, s85, v10
    v_mul_f32 v153, v153, v28
    v_mul_f32 v157, v157, v30
    v_mul_f32 v154, v154, v29
    v_mul_f32 v158, v158, v31
    v_exp_f32 v153, v153
    v_exp_f32 v157, v157
    v_exp_f32 v154, v154
    v_exp_f32 v158, v158
    v_add_f32 v153, 1.0, v153
    v_add_f32 v157, 1.0, v157
    v_add_f32 v154, 1.0, v154
    v_add_f32 v158, 1.0, v158
    v_rcp_f32 v153, v153
    v_rcp_f32 v157, v157
    v_rcp_f32 v154, v154
    v_rcp_f32 v158, v158
    v_mul_f32 v28, v28, v153
    v_mul_f32 v30, v30, v157
    v_mul_f32 v29, v29, v154
    v_mul_f32 v31, v31, v158
    v_cvt_pk_bf16_f32 v166, v28, v29
    v_cvt_pk_bf16_f32 v167, v30, v31
    buffer_store_dwordx4 v[164:167], v1, s[60:63], s69 offen offset:1024 sc1
    v_cvt_pk_bf16_f32 v152, v32, v33
    v_cvt_pk_bf16_f32 v156, v34, v35
    v_lshlrev_b32 v32, 16, v152
    v_lshlrev_b32 v34, 16, v156
    v_and_b32 v33, 0xffff0000, v152
    v_and_b32 v35, 0xffff0000, v156
    v_add_f32 v32, v32, v136
    v_add_f32 v34, v34, v138
    v_add_f32 v33, v33, v137
    v_add_f32 v35, v35, v139
    v_cvt_pk_bf16_f32 v152, v32, v33
    v_cvt_pk_bf16_f32 v156, v34, v35
    v_lshlrev_b32 v32, 16, v152
    v_lshlrev_b32 v34, 16, v156
    v_and_b32 v33, 0xffff0000, v152
    v_and_b32 v35, 0xffff0000, v156
    v_mul_f32 v153, v32, v32
    v_mul_f32 v157, v34, v34
    v_mul_f32 v154, v33, v33
    v_mul_f32 v158, v35, v35
    v_fma_f32 v153, v153, s85, v10
    v_fma_f32 v157, v157, s85, v10
    v_fma_f32 v154, v154, s85, v10
    v_fma_f32 v158, v158, s85, v10
    v_mul_f32 v153, v153, v32
    v_mul_f32 v157, v157, v34
    v_mul_f32 v154, v154, v33
    v_mul_f32 v158, v158, v35
    v_exp_f32 v153, v153
    v_exp_f32 v157, v157
    v_exp_f32 v154, v154
    v_exp_f32 v158, v158
    v_add_f32 v153, 1.0, v153
    v_add_f32 v157, 1.0, v157
    v_add_f32 v154, 1.0, v154
    v_add_f32 v158, 1.0, v158
    v_rcp_f32 v153, v153
    v_rcp_f32 v157, v157
    v_rcp_f32 v154, v154
    v_rcp_f32 v158, v158
    v_mul_f32 v32, v32, v153
    v_mul_f32 v34, v34, v157
    v_mul_f32 v33, v33, v154
    v_mul_f32 v35, v35, v158
    v_cvt_pk_bf16_f32 v160, v32, v33
    v_cvt_pk_bf16_f32 v161, v34, v35
    v_cvt_pk_bf16_f32 v152, v36, v37
    v_cvt_pk_bf16_f32 v156, v38, v39
    v_lshlrev_b32 v36, 16, v152
    v_lshlrev_b32 v38, 16, v156
    v_and_b32 v37, 0xffff0000, v152
    v_and_b32 v39, 0xffff0000, v156
    v_add_f32 v36, v36, v140
    v_add_f32 v38, v38, v142
    v_add_f32 v37, v37, v141
    v_add_f32 v39, v39, v143
    v_cvt_pk_bf16_f32 v152, v36, v37
    v_cvt_pk_bf16_f32 v156, v38, v39
    v_lshlrev_b32 v36, 16, v152
    v_lshlrev_b32 v38, 16, v156
    v_and_b32 v37, 0xffff0000, v152
    v_and_b32 v39, 0xffff0000, v156
    v_mul_f32 v153, v36, v36
    v_mul_f32 v157, v38, v38
    v_mul_f32 v154, v37, v37
    v_mul_f32 v158, v39, v39
    v_fma_f32 v153, v153, s85, v10
    v_fma_f32 v157, v157, s85, v10
    v_fma_f32 v154, v154, s85, v10
    v_fma_f32 v158, v158, s85, v10
    v_mul_f32 v153, v153, v36
    v_mul_f32 v157, v157, v38
    v_mul_f32 v154, v154, v37
    v_mul_f32 v158, v158, v39
    v_exp_f32 v153, v153
    v_exp_f32 v157, v157
    v_exp_f32 v154, v154
    v_exp_f32 v158, v158
    v_add_f32 v153, 1.0, v153
    v_add_f32 v157, 1.0, v157
    v_add_f32 v154, 1.0, v154
    v_add_f32 v158, 1.0, v158
    v_rcp_f32 v153, v153
    v_rcp_f32 v157, v157
    v_rcp_f32 v154, v154
    v_rcp_f32 v158, v158
    v_mul_f32 v36, v36, v153
    v_mul_f32 v38, v38, v157
    v_mul_f32 v37, v37, v154
    v_mul_f32 v39, v39, v158
    v_cvt_pk_bf16_f32 v162, v36, v37
    v_cvt_pk_bf16_f32 v163, v38, v39
    s_add_u32 s69, s68, 147456
    buffer_store_dwordx4 v[160:163], v1, s[60:63], s69 offen offset:0 sc1
    v_cvt_pk_bf16_f32 v152, v40, v41
    v_cvt_pk_bf16_f32 v156, v42, v43
    v_lshlrev_b32 v40, 16, v152
    v_lshlrev_b32 v42, 16, v156
    v_and_b32 v41, 0xffff0000, v152
    v_and_b32 v43, 0xffff0000, v156
    v_add_f32 v40, v40, v144
    v_add_f32 v42, v42, v146
    v_add_f32 v41, v41, v145
    v_add_f32 v43, v43, v147
    v_cvt_pk_bf16_f32 v152, v40, v41
    v_cvt_pk_bf16_f32 v156, v42, v43
    v_lshlrev_b32 v40, 16, v152
    v_lshlrev_b32 v42, 16, v156
    v_and_b32 v41, 0xffff0000, v152
    v_and_b32 v43, 0xffff0000, v156
    v_mul_f32 v153, v40, v40
    v_mul_f32 v157, v42, v42
    v_mul_f32 v154, v41, v41
    v_mul_f32 v158, v43, v43
    v_fma_f32 v153, v153, s85, v10
    v_fma_f32 v157, v157, s85, v10
    v_fma_f32 v154, v154, s85, v10
    v_fma_f32 v158, v158, s85, v10
    v_mul_f32 v153, v153, v40
    v_mul_f32 v157, v157, v42
    v_mul_f32 v154, v154, v41
    v_mul_f32 v158, v158, v43
    v_exp_f32 v153, v153
    v_exp_f32 v157, v157
    v_exp_f32 v154, v154
    v_exp_f32 v158, v158
    v_add_f32 v153, 1.0, v153
    v_add_f32 v157, 1.0, v157
    v_add_f32 v154, 1.0, v154
    v_add_f32 v158, 1.0, v158
    v_rcp_f32 v153, v153
    v_rcp_f32 v157, v157
    v_rcp_f32 v154, v154
    v_rcp_f32 v158, v158
    v_mul_f32 v40, v40, v153
    v_mul_f32 v42, v42, v157
    v_mul_f32 v41, v41, v154
    v_mul_f32 v43, v43, v158
    v_cvt_pk_bf16_f32 v164, v40, v41
    v_cvt_pk_bf16_f32 v165, v42, v43
    v_cvt_pk_bf16_f32 v152, v44, v45
    v_cvt_pk_bf16_f32 v156, v46, v47
    v_lshlrev_b32 v44, 16, v152
    v_lshlrev_b32 v46, 16, v156
    v_and_b32 v45, 0xffff0000, v152
    v_and_b32 v47, 0xffff0000, v156
    v_add_f32 v44, v44, v148
    v_add_f32 v46, v46, v150
    v_add_f32 v45, v45, v149
    v_add_f32 v47, v47, v151
    v_cvt_pk_bf16_f32 v152, v44, v45
    v_cvt_pk_bf16_f32 v156, v46, v47
    v_lshlrev_b32 v44, 16, v152
    v_lshlrev_b32 v46, 16, v156
    v_and_b32 v45, 0xffff0000, v152
    v_and_b32 v47, 0xffff0000, v156
    v_mul_f32 v153, v44, v44
    v_mul_f32 v157, v46, v46
    v_mul_f32 v154, v45, v45
    v_mul_f32 v158, v47, v47
    v_fma_f32 v153, v153, s85, v10
    v_fma_f32 v157, v157, s85, v10
    v_fma_f32 v154, v154, s85, v10
    v_fma_f32 v158, v158, s85, v10
    v_mul_f32 v153, v153, v44
    v_mul_f32 v157, v157, v46
    v_mul_f32 v154, v154, v45
    v_mul_f32 v158, v158, v47
    v_exp_f32 v153, v153
    v_exp_f32 v157, v157
    v_exp_f32 v154, v154
    v_exp_f32 v158, v158
    v_add_f32 v153, 1.0, v153
    v_add_f32 v157, 1.0, v157
    v_add_f32 v154, 1.0, v154
    v_add_f32 v158, 1.0, v158
    v_rcp_f32 v153, v153
    v_rcp_f32 v157, v157
    v_rcp_f32 v154, v154
    v_rcp_f32 v158, v158
    v_mul_f32 v44, v44, v153
    v_mul_f32 v46, v46, v157
    v_mul_f32 v45, v45, v154
    v_mul_f32 v47, v47, v158
    v_cvt_pk_bf16_f32 v166, v44, v45
    v_cvt_pk_bf16_f32 v167, v46, v47
    buffer_store_dwordx4 v[164:167], v1, s[60:63], s69 offen offset:1024 sc1
    v_cvt_pk_bf16_f32 v152, v48, v49
    v_cvt_pk_bf16_f32 v156, v50, v51
    v_lshlrev_b32 v48, 16, v152
    v_lshlrev_b32 v50, 16, v156
    v_and_b32 v49, 0xffff0000, v152
    v_and_b32 v51, 0xffff0000, v156
    v_add_f32 v48, v48, v136
    v_add_f32 v50, v50, v138
    v_add_f32 v49, v49, v137
    v_add_f32 v51, v51, v139
    v_cvt_pk_bf16_f32 v152, v48, v49
    v_cvt_pk_bf16_f32 v156, v50, v51
    v_lshlrev_b32 v48, 16, v152
    v_lshlrev_b32 v50, 16, v156
    v_and_b32 v49, 0xffff0000, v152
    v_and_b32 v51, 0xffff0000, v156
    v_mul_f32 v153, v48, v48
    v_mul_f32 v157, v50, v50
    v_mul_f32 v154, v49, v49
    v_mul_f32 v158, v51, v51
    v_fma_f32 v153, v153, s85, v10
    v_fma_f32 v157, v157, s85, v10
    v_fma_f32 v154, v154, s85, v10
    v_fma_f32 v158, v158, s85, v10
    v_mul_f32 v153, v153, v48
    v_mul_f32 v157, v157, v50
    v_mul_f32 v154, v154, v49
    v_mul_f32 v158, v158, v51
    v_exp_f32 v153, v153
    v_exp_f32 v157, v157
    v_exp_f32 v154, v154
    v_exp_f32 v158, v158
    v_add_f32 v153, 1.0, v153
    v_add_f32 v157, 1.0, v157
    v_add_f32 v154, 1.0, v154
    v_add_f32 v158, 1.0, v158
    v_rcp_f32 v153, v153
    v_rcp_f32 v157, v157
    v_rcp_f32 v154, v154
    v_rcp_f32 v158, v158
    v_mul_f32 v48, v48, v153
    v_mul_f32 v50, v50, v157
    v_mul_f32 v49, v49, v154
    v_mul_f32 v51, v51, v158
    v_cvt_pk_bf16_f32 v160, v48, v49
    v_cvt_pk_bf16_f32 v161, v50, v51
    v_cvt_pk_bf16_f32 v152, v52, v53
    v_cvt_pk_bf16_f32 v156, v54, v55
    v_lshlrev_b32 v52, 16, v152
    v_lshlrev_b32 v54, 16, v156
    v_and_b32 v53, 0xffff0000, v152
    v_and_b32 v55, 0xffff0000, v156
    v_add_f32 v52, v52, v140
    v_add_f32 v54, v54, v142
    v_add_f32 v53, v53, v141
    v_add_f32 v55, v55, v143
    v_cvt_pk_bf16_f32 v152, v52, v53
    v_cvt_pk_bf16_f32 v156, v54, v55
    v_lshlrev_b32 v52, 16, v152
    v_lshlrev_b32 v54, 16, v156
    v_and_b32 v53, 0xffff0000, v152
    v_and_b32 v55, 0xffff0000, v156
    v_mul_f32 v153, v52, v52
    v_mul_f32 v157, v54, v54
    v_mul_f32 v154, v53, v53
    v_mul_f32 v158, v55, v55
    v_fma_f32 v153, v153, s85, v10
    v_fma_f32 v157, v157, s85, v10
    v_fma_f32 v154, v154, s85, v10
    v_fma_f32 v158, v158, s85, v10
    v_mul_f32 v153, v153, v52
    v_mul_f32 v157, v157, v54
    v_mul_f32 v154, v154, v53
    v_mul_f32 v158, v158, v55
    v_exp_f32 v153, v153
    v_exp_f32 v157, v157
    v_exp_f32 v154, v154
    v_exp_f32 v158, v158
    v_add_f32 v153, 1.0, v153
    v_add_f32 v157, 1.0, v157
    v_add_f32 v154, 1.0, v154
    v_add_f32 v158, 1.0, v158
    v_rcp_f32 v153, v153
    v_rcp_f32 v157, v157
    v_rcp_f32 v154, v154
    v_rcp_f32 v158, v158
    v_mul_f32 v52, v52, v153
    v_mul_f32 v54, v54, v157
    v_mul_f32 v53, v53, v154
    v_mul_f32 v55, v55, v158
    v_cvt_pk_bf16_f32 v162, v52, v53
    v_cvt_pk_bf16_f32 v163, v54, v55
    s_add_u32 s69, s68, 294912
    buffer_store_dwordx4 v[160:163], v1, s[60:63], s69 offen offset:0 sc1
    v_cvt_pk_bf16_f32 v152, v56, v57
    v_cvt_pk_bf16_f32 v156, v58, v59
    v_lshlrev_b32 v56, 16, v152
    v_lshlrev_b32 v58, 16, v156
    v_and_b32 v57, 0xffff0000, v152
    v_and_b32 v59, 0xffff0000, v156
    v_add_f32 v56, v56, v144
    v_add_f32 v58, v58, v146
    v_add_f32 v57, v57, v145
    v_add_f32 v59, v59, v147
    v_cvt_pk_bf16_f32 v152, v56, v57
    v_cvt_pk_bf16_f32 v156, v58, v59
    v_lshlrev_b32 v56, 16, v152
    v_lshlrev_b32 v58, 16, v156
    v_and_b32 v57, 0xffff0000, v152
    v_and_b32 v59, 0xffff0000, v156
    v_mul_f32 v153, v56, v56
    v_mul_f32 v157, v58, v58
    v_mul_f32 v154, v57, v57
    v_mul_f32 v158, v59, v59
    v_fma_f32 v153, v153, s85, v10
    v_fma_f32 v157, v157, s85, v10
    v_fma_f32 v154, v154, s85, v10
    v_fma_f32 v158, v158, s85, v10
    v_mul_f32 v153, v153, v56
    v_mul_f32 v157, v157, v58
    v_mul_f32 v154, v154, v57
    v_mul_f32 v158, v158, v59
    v_exp_f32 v153, v153
    v_exp_f32 v157, v157
    v_exp_f32 v154, v154
    v_exp_f32 v158, v158
    v_add_f32 v153, 1.0, v153
    v_add_f32 v157, 1.0, v157
    v_add_f32 v154, 1.0, v154
    v_add_f32 v158, 1.0, v158
    v_rcp_f32 v153, v153
    v_rcp_f32 v157, v157
    v_rcp_f32 v154, v154
    v_rcp_f32 v158, v158
    v_mul_f32 v56, v56, v153
    v_mul_f32 v58, v58, v157
    v_mul_f32 v57, v57, v154
    v_mul_f32 v59, v59, v158
    v_cvt_pk_bf16_f32 v164, v56, v57
    v_cvt_pk_bf16_f32 v165, v58, v59
    v_cvt_pk_bf16_f32 v152, v60, v61
    v_cvt_pk_bf16_f32 v156, v62, v63
    v_lshlrev_b32 v60, 16, v152
    v_lshlrev_b32 v62, 16, v156
    v_and_b32 v61, 0xffff0000, v152
    v_and_b32 v63, 0xffff0000, v156
    v_add_f32 v60, v60, v148
    v_add_f32 v62, v62, v150
    v_add_f32 v61, v61, v149
    v_add_f32 v63, v63, v151
    v_cvt_pk_bf16_f32 v152, v60, v61
    v_cvt_pk_bf16_f32 v156, v62, v63
    v_lshlrev_b32 v60, 16, v152
    v_lshlrev_b32 v62, 16, v156
    v_and_b32 v61, 0xffff0000, v152
    v_and_b32 v63, 0xffff0000, v156
    v_mul_f32 v153, v60, v60
    v_mul_f32 v157, v62, v62
    v_mul_f32 v154, v61, v61
    v_mul_f32 v158, v63, v63
    v_fma_f32 v153, v153, s85, v10
    v_fma_f32 v157, v157, s85, v10
    v_fma_f32 v154, v154, s85, v10
    v_fma_f32 v158, v158, s85, v10
    v_mul_f32 v153, v153, v60
    v_mul_f32 v157, v157, v62
    v_mul_f32 v154, v154, v61
    v_mul_f32 v158, v158, v63
    v_exp_f32 v153, v153
    v_exp_f32 v157, v157
    v_exp_f32 v154, v154
    v_exp_f32 v158, v158
    v_add_f32 v153, 1.0, v153
    v_add_f32 v157, 1.0, v157
    v_add_f32 v154, 1.0, v154
    v_add_f32 v158, 1.0, v158
    v_rcp_f32 v153, v153
    v_rcp_f32 v157, v157
    v_rcp_f32 v154, v154
    v_rcp_f32 v158, v158
    v_mul_f32 v60, v60, v153
    v_mul_f32 v62, v62, v157
    v_mul_f32 v61, v61, v154
    v_mul_f32 v63, v63, v158
    v_cvt_pk_bf16_f32 v166, v60, v61
    v_cvt_pk_bf16_f32 v167, v62, v63
    buffer_store_dwordx4 v[164:167], v1, s[60:63], s69 offen offset:1024 sc1
    v_cvt_pk_bf16_f32 v152, v64, v65
    v_cvt_pk_bf16_f32 v156, v66, v67
    v_lshlrev_b32 v64, 16, v152
    v_lshlrev_b32 v66, 16, v156
    v_and_b32 v65, 0xffff0000, v152
    v_and_b32 v67, 0xffff0000, v156
    v_add_f32 v64, v64, v136
    v_add_f32 v66, v66, v138
    v_add_f32 v65, v65, v137
    v_add_f32 v67, v67, v139
    v_cvt_pk_bf16_f32 v152, v64, v65
    v_cvt_pk_bf16_f32 v156, v66, v67
    v_lshlrev_b32 v64, 16, v152
    v_lshlrev_b32 v66, 16, v156
    v_and_b32 v65, 0xffff0000, v152
    v_and_b32 v67, 0xffff0000, v156
    v_mul_f32 v153, v64, v64
    v_mul_f32 v157, v66, v66
    v_mul_f32 v154, v65, v65
    v_mul_f32 v158, v67, v67
    v_fma_f32 v153, v153, s85, v10
    v_fma_f32 v157, v157, s85, v10
    v_fma_f32 v154, v154, s85, v10
    v_fma_f32 v158, v158, s85, v10
    v_mul_f32 v153, v153, v64
    v_mul_f32 v157, v157, v66
    v_mul_f32 v154, v154, v65
    v_mul_f32 v158, v158, v67
    v_exp_f32 v153, v153
    v_exp_f32 v157, v157
    v_exp_f32 v154, v154
    v_exp_f32 v158, v158
    v_add_f32 v153, 1.0, v153
    v_add_f32 v157, 1.0, v157
    v_add_f32 v154, 1.0, v154
    v_add_f32 v158, 1.0, v158
    v_rcp_f32 v153, v153
    v_rcp_f32 v157, v157
    v_rcp_f32 v154, v154
    v_rcp_f32 v158, v158
    v_mul_f32 v64, v64, v153
    v_mul_f32 v66, v66, v157
    v_mul_f32 v65, v65, v154
    v_mul_f32 v67, v67, v158
    v_cvt_pk_bf16_f32 v160, v64, v65
    v_cvt_pk_bf16_f32 v161, v66, v67
    v_cvt_pk_bf16_f32 v152, v68, v69
    v_cvt_pk_bf16_f32 v156, v70, v71
    v_lshlrev_b32 v68, 16, v152
    v_lshlrev_b32 v70, 16, v156
    v_and_b32 v69, 0xffff0000, v152
    v_and_b32 v71, 0xffff0000, v156
    v_add_f32 v68, v68, v140
    v_add_f32 v70, v70, v142
    v_add_f32 v69, v69, v141
    v_add_f32 v71, v71, v143
    v_cvt_pk_bf16_f32 v152, v68, v69
    v_cvt_pk_bf16_f32 v156, v70, v71
    v_lshlrev_b32 v68, 16, v152
    v_lshlrev_b32 v70, 16, v156
    v_and_b32 v69, 0xffff0000, v152
    v_and_b32 v71, 0xffff0000, v156
    v_mul_f32 v153, v68, v68
    v_mul_f32 v157, v70, v70
    v_mul_f32 v154, v69, v69
    v_mul_f32 v158, v71, v71
    v_fma_f32 v153, v153, s85, v10
    v_fma_f32 v157, v157, s85, v10
    v_fma_f32 v154, v154, s85, v10
    v_fma_f32 v158, v158, s85, v10
    v_mul_f32 v153, v153, v68
    v_mul_f32 v157, v157, v70
    v_mul_f32 v154, v154, v69
    v_mul_f32 v158, v158, v71
    v_exp_f32 v153, v153
    v_exp_f32 v157, v157
    v_exp_f32 v154, v154
    v_exp_f32 v158, v158
    v_add_f32 v153, 1.0, v153
    v_add_f32 v157, 1.0, v157
    v_add_f32 v154, 1.0, v154
    v_add_f32 v158, 1.0, v158
    v_rcp_f32 v153, v153
    v_rcp_f32 v157, v157
    v_rcp_f32 v154, v154
    v_rcp_f32 v158, v158
    v_mul_f32 v68, v68, v153
    v_mul_f32 v70, v70, v157
    v_mul_f32 v69, v69, v154
    v_mul_f32 v71, v71, v158
    v_cvt_pk_bf16_f32 v162, v68, v69
    v_cvt_pk_bf16_f32 v163, v70, v71
    s_add_u32 s69, s68, 442368
    buffer_store_dwordx4 v[160:163], v1, s[60:63], s69 offen offset:0 sc1
    v_cvt_pk_bf16_f32 v152, v72, v73
    v_cvt_pk_bf16_f32 v156, v74, v75
    v_lshlrev_b32 v72, 16, v152
    v_lshlrev_b32 v74, 16, v156
    v_and_b32 v73, 0xffff0000, v152
    v_and_b32 v75, 0xffff0000, v156
    v_add_f32 v72, v72, v144
    v_add_f32 v74, v74, v146
    v_add_f32 v73, v73, v145
    v_add_f32 v75, v75, v147
    v_cvt_pk_bf16_f32 v152, v72, v73
    v_cvt_pk_bf16_f32 v156, v74, v75
    v_lshlrev_b32 v72, 16, v152
    v_lshlrev_b32 v74, 16, v156
    v_and_b32 v73, 0xffff0000, v152
    v_and_b32 v75, 0xffff0000, v156
    v_mul_f32 v153, v72, v72
    v_mul_f32 v157, v74, v74
    v_mul_f32 v154, v73, v73
    v_mul_f32 v158, v75, v75
    v_fma_f32 v153, v153, s85, v10
    v_fma_f32 v157, v157, s85, v10
    v_fma_f32 v154, v154, s85, v10
    v_fma_f32 v158, v158, s85, v10
    v_mul_f32 v153, v153, v72
    v_mul_f32 v157, v157, v74
    v_mul_f32 v154, v154, v73
    v_mul_f32 v158, v158, v75
    v_exp_f32 v153, v153
    v_exp_f32 v157, v157
    v_exp_f32 v154, v154
    v_exp_f32 v158, v158
    v_add_f32 v153, 1.0, v153
    v_add_f32 v157, 1.0, v157
    v_add_f32 v154, 1.0, v154
    v_add_f32 v158, 1.0, v158
    v_rcp_f32 v153, v153
    v_rcp_f32 v157, v157
    v_rcp_f32 v154, v154
    v_rcp_f32 v158, v158
    v_mul_f32 v72, v72, v153
    v_mul_f32 v74, v74, v157
    v_mul_f32 v73, v73, v154
    v_mul_f32 v75, v75, v158
    v_cvt_pk_bf16_f32 v164, v72, v73
    v_cvt_pk_bf16_f32 v165, v74, v75
    v_cvt_pk_bf16_f32 v152, v76, v77
    v_cvt_pk_bf16_f32 v156, v78, v79
    v_lshlrev_b32 v76, 16, v152
    v_lshlrev_b32 v78, 16, v156
    v_and_b32 v77, 0xffff0000, v152
    v_and_b32 v79, 0xffff0000, v156
    v_add_f32 v76, v76, v148
    v_add_f32 v78, v78, v150
    v_add_f32 v77, v77, v149
    v_add_f32 v79, v79, v151
    v_cvt_pk_bf16_f32 v152, v76, v77
    v_cvt_pk_bf16_f32 v156, v78, v79
    v_lshlrev_b32 v76, 16, v152
    v_lshlrev_b32 v78, 16, v156
    v_and_b32 v77, 0xffff0000, v152
    v_and_b32 v79, 0xffff0000, v156
    v_mul_f32 v153, v76, v76
    v_mul_f32 v157, v78, v78
    v_mul_f32 v154, v77, v77
    v_mul_f32 v158, v79, v79
    v_fma_f32 v153, v153, s85, v10
    v_fma_f32 v157, v157, s85, v10
    v_fma_f32 v154, v154, s85, v10
    v_fma_f32 v158, v158, s85, v10
    v_mul_f32 v153, v153, v76
    v_mul_f32 v157, v157, v78
    v_mul_f32 v154, v154, v77
    v_mul_f32 v158, v158, v79
    v_exp_f32 v153, v153
    v_exp_f32 v157, v157
    v_exp_f32 v154, v154
    v_exp_f32 v158, v158
    v_add_f32 v153, 1.0, v153
    v_add_f32 v157, 1.0, v157
    v_add_f32 v154, 1.0, v154
    v_add_f32 v158, 1.0, v158
    v_rcp_f32 v153, v153
    v_rcp_f32 v157, v157
    v_rcp_f32 v154, v154
    v_rcp_f32 v158, v158
    v_mul_f32 v76, v76, v153
    v_mul_f32 v78, v78, v157
    v_mul_f32 v77, v77, v154
    v_mul_f32 v79, v79, v158
    v_cvt_pk_bf16_f32 v166, v76, v77
    v_cvt_pk_bf16_f32 v167, v78, v79
    buffer_store_dwordx4 v[164:167], v1, s[60:63], s69 offen offset:1024 sc1
Lp1n_119:
    s_cmp_ge_u32 s76, 128
    s_cbranch_scc1 Lnokv_121
    s_cmp_lt_u32 s77, 128
    s_cbranch_scc1 Lnokv_121
    s_cmp_ge_u32 s66, 4
    s_cselect_b32 s69, 20, 4
    s_add_u32 s69, s69, 128
    s_mov_b32 s70, 1
    s_waitcnt vmcnt(0)
    s_barrier
    s_cmp_lg_u32 s65, 0
    s_cbranch_scc1 Lsig_122
    v_mov_b32 v2, s70
    v_mov_b32 v3, s69
    s_mov_b64 exec, 1
    buffer_atomic_add v2, v3, s[56:59], 0 offen
    s_mov_b64 exec, -1
Lsig_122:
Lnokv_121:
    s_mov_b32 s76, s77
    s_xor_b32 s90, s90, 73728
    s_cmp_lt_u32 s76, 264
    s_cbranch_scc1 Lp1_116
    s_sub_u32 s69, s67, 40
    s_cmp_ge_u32 s69, 4
    s_cbranch_scc1 L_nogate
    s_lshl_b32 s86, s66, 4
    s_lshl_b32 s69, s69, 2
    s_add_u32 s86, s86, s69
    s_add_u32 s86, s86, s65
    v_lshrrev_b32 v2, 2, v0
    v_and_b32 v3, 3, v0
    v_mul_u32_u24 v3, 288, v3
    v_mul_u32_u24 v4, 1152, v2
    v_add_u32 v4, v4, v3
    s_mul_i32 s68, s86, 18432
    buffer_load_dwordx4 v[16:19], v4, s[8:11], s68 offen offset:0
    buffer_load_dwordx4 v[96:99], v3, s[48:51], 0 offen offset:0
    buffer_load_dwordx4 v[20:23], v4, s[8:11], s68 offen offset:16
    buffer_load_dwordx4 v[100:103], v3, s[48:51], 0 offen offset:16
    buffer_load_dwordx4 v[24:27], v4, s[8:11], s68 offen offset:32
    buffer_load_dwordx4 v[104:107], v3, s[48:51], 0 offen offset:32
    buffer_load_dwordx4 v[28:31], v4, s[8:11], s68 offen offset:48
    buffer_load_dwordx4 v[108:111], v3, s[48:51], 0 offen offset:48
    buffer_load_dwordx4 v[32:35], v4, s[8:11], s68 offen offset:64
    buffer_load_dwordx4 v[112:115], v3, s[48:51], 0 offen offset:64
    buffer_load_dwordx4 v[36:39], v4, s[8:11], s68 offen offset:80
    buffer_load_dwordx4 v[116:119], v3, s[48:51], 0 offen offset:80
    buffer_load_dwordx4 v[40:43], v4, s[8:11], s68 offen offset:96
    buffer_load_dwordx4 v[120:123], v3, s[48:51], 0 offen offset:96
    buffer_load_dwordx4 v[44:47], v4, s[8:11], s68 offen offset:112
    buffer_load_dwordx4 v[124:127], v3, s[48:51], 0 offen offset:112
    buffer_load_dwordx4 v[48:51], v4, s[8:11], s68 offen offset:128
    buffer_load_dwordx4 v[128:131], v3, s[48:51], 0 offen offset:128
    buffer_load_dwordx4 v[52:55], v4, s[8:11], s68 offen offset:144
    buffer_load_dwordx4 v[132:135], v3, s[48:51], 0 offen offset:144
    buffer_load_dwordx4 v[56:59], v4, s[8:11], s68 offen offset:160
    buffer_load_dwordx4 v[136:139], v3, s[48:51], 0 offen offset:160
    buffer_load_dwordx4 v[60:63], v4, s[8:11], s68 offen offset:176
    buffer_load_dwordx4 v[140:143], v3, s[48:51], 0 offen offset:176
    buffer_load_dwordx4 v[64:67], v4, s[8:11], s68 offen offset:192
    buffer_load_dwordx4 v[144:147], v3, s[48:51], 0 offen offset:192
    buffer_load_dwordx4 v[68:71], v4, s[8:11], s68 offen offset:208
    buffer_load_dwordx4 v[148:151], v3, s[48:51], 0 offen offset:208
    buffer_load_dwordx4 v[72:75], v4, s[8:11], s68 offen offset:224
    buffer_load_dwordx4 v[152:155], v3, s[48:51], 0 offen offset:224
    buffer_load_dwordx4 v[76:79], v4, s[8:11], s68 offen offset:240
    buffer_load_dwordx4 v[156:159], v3, s[48:51], 0 offen offset:240
    buffer_load_dwordx4 v[80:83], v4, s[8:11], s68 offen offset:256
    buffer_load_dwordx4 v[160:163], v3, s[48:51], 0 offen offset:256
    buffer_load_dwordx4 v[84:87], v4, s[8:11], s68 offen offset:272
    buffer_load_dwordx4 v[164:167], v3, s[48:51], 0 offen offset:272
    v_mov_b32 v5, 0
    v_mov_b32 v6, 0
    s_waitcnt vmcnt(0)
    v_lshlrev_b32 v8, 16, v16
    v_lshlrev_b32 v9, 16, v96
    v_and_b32 v10, 0xffff0000, v16
    v_and_b32 v11, 0xffff0000, v96
    v_mul_f32 v8, v8, v9
    v_mul_f32 v10, v10, v11
    v_cvt_pk_bf16_f32 v8, v8, v10
    v_lshlrev_b32 v9, 16, v8
    v_and_b32 v10, 0xffff0000, v8
    v_add_f32 v5, v5, v9
    v_add_f32 v6, v6, v10
    v_lshlrev_b32 v8, 16, v17
    v_lshlrev_b32 v9, 16, v97
    v_and_b32 v10, 0xffff0000, v17
    v_and_b32 v11, 0xffff0000, v97
    v_mul_f32 v8, v8, v9
    v_mul_f32 v10, v10, v11
    v_cvt_pk_bf16_f32 v8, v8, v10
    v_lshlrev_b32 v9, 16, v8
    v_and_b32 v10, 0xffff0000, v8
    v_add_f32 v5, v5, v9
    v_add_f32 v6, v6, v10
    v_lshlrev_b32 v8, 16, v18
    v_lshlrev_b32 v9, 16, v98
    v_and_b32 v10, 0xffff0000, v18
    v_and_b32 v11, 0xffff0000, v98
    v_mul_f32 v8, v8, v9
    v_mul_f32 v10, v10, v11
    v_cvt_pk_bf16_f32 v8, v8, v10
    v_lshlrev_b32 v9, 16, v8
    v_and_b32 v10, 0xffff0000, v8
    v_add_f32 v5, v5, v9
    v_add_f32 v6, v6, v10
    v_lshlrev_b32 v8, 16, v19
    v_lshlrev_b32 v9, 16, v99
    v_and_b32 v10, 0xffff0000, v19
    v_and_b32 v11, 0xffff0000, v99
    v_mul_f32 v8, v8, v9
    v_mul_f32 v10, v10, v11
    v_cvt_pk_bf16_f32 v8, v8, v10
    v_lshlrev_b32 v9, 16, v8
    v_and_b32 v10, 0xffff0000, v8
    v_add_f32 v5, v5, v9
    v_add_f32 v6, v6, v10
    v_lshlrev_b32 v8, 16, v20
    v_lshlrev_b32 v9, 16, v100
    v_and_b32 v10, 0xffff0000, v20
    v_and_b32 v11, 0xffff0000, v100
    v_mul_f32 v8, v8, v9
    v_mul_f32 v10, v10, v11
    v_cvt_pk_bf16_f32 v8, v8, v10
    v_lshlrev_b32 v9, 16, v8
    v_and_b32 v10, 0xffff0000, v8
    v_add_f32 v5, v5, v9
    v_add_f32 v6, v6, v10
    v_lshlrev_b32 v8, 16, v21
    v_lshlrev_b32 v9, 16, v101
    v_and_b32 v10, 0xffff0000, v21
    v_and_b32 v11, 0xffff0000, v101
    v_mul_f32 v8, v8, v9
    v_mul_f32 v10, v10, v11
    v_cvt_pk_bf16_f32 v8, v8, v10
    v_lshlrev_b32 v9, 16, v8
    v_and_b32 v10, 0xffff0000, v8
    v_add_f32 v5, v5, v9
    v_add_f32 v6, v6, v10
    v_lshlrev_b32 v8, 16, v22
    v_lshlrev_b32 v9, 16, v102
    v_and_b32 v10, 0xffff0000, v22
    v_and_b32 v11, 0xffff0000, v102
    v_mul_f32 v8, v8, v9
    v_mul_f32 v10, v10, v11
    v_cvt_pk_bf16_f32 v8, v8, v10
    v_lshlrev_b32 v9, 16, v8
    v_and_b32 v10, 0xffff0000, v8
    v_add_f32 v5, v5, v9
    v_add_f32 v6, v6, v10
    v_lshlrev_b32 v8, 16, v23
    v_lshlrev_b32 v9, 16, v103
    v_and_b32 v10, 0xffff0000, v23
    v_and_b32 v11, 0xffff0000, v103
    v_mul_f32 v8, v8, v9
    v_mul_f32 v10, v10, v11
    v_cvt_pk_bf16_f32 v8, v8, v10
    v_lshlrev_b32 v9, 16, v8
    v_and_b32 v10, 0xffff0000, v8
    v_add_f32 v5, v5, v9
    v_add_f32 v6, v6, v10
    v_lshlrev_b32 v8, 16, v24
    v_lshlrev_b32 v9, 16, v104
    v_and_b32 v10, 0xffff0000, v24
    v_and_b32 v11, 0xffff0000, v104
    v_mul_f32 v8, v8, v9
    v_mul_f32 v10, v10, v11
    v_cvt_pk_bf16_f32 v8, v8, v10
    v_lshlrev_b32 v9, 16, v8
    v_and_b32 v10, 0xffff0000, v8
    v_add_f32 v5, v5, v9
    v_add_f32 v6, v6, v10
    v_lshlrev_b32 v8, 16, v25
    v_lshlrev_b32 v9, 16, v105
    v_and_b32 v10, 0xffff0000, v25
    v_and_b32 v11, 0xffff0000, v105
    v_mul_f32 v8, v8, v9
    v_mul_f32 v10, v10, v11
    v_cvt_pk_bf16_f32 v8, v8, v10
    v_lshlrev_b32 v9, 16, v8
    v_and_b32 v10, 0xffff0000, v8
    v_add_f32 v5, v5, v9
    v_add_f32 v6, v6, v10
    v_lshlrev_b32 v8, 16, v26
    v_lshlrev_b32 v9, 16, v106
    v_and_b32 v10, 0xffff0000, v26
    v_and_b32 v11, 0xffff0000, v106
    v_mul_f32 v8, v8, v9
    v_mul_f32 v10, v10, v11
    v_cvt_pk_bf16_f32 v8, v8, v10
    v_lshlrev_b32 v9, 16, v8
    v_and_b32 v10, 0xffff0000, v8
    v_add_f32 v5, v5, v9
    v_add_f32 v6, v6, v10
    v_lshlrev_b32 v8, 16, v27
    v_lshlrev_b32 v9, 16, v107
    v_and_b32 v10, 0xffff0000, v27
    v_and_b32 v11, 0xffff0000, v107
    v_mul_f32 v8, v8, v9
    v_mul_f32 v10, v10, v11
    v_cvt_pk_bf16_f32 v8, v8, v10
    v_lshlrev_b32 v9, 16, v8
    v_and_b32 v10, 0xffff0000, v8
    v_add_f32 v5, v5, v9
    v_add_f32 v6, v6, v10
    v_lshlrev_b32 v8, 16, v28
    v_lshlrev_b32 v9, 16, v108
    v_and_b32 v10, 0xffff0000, v28
    v_and_b32 v11, 0xffff0000, v108
    v_mul_f32 v8, v8, v9
    v_mul_f32 v10, v10, v11
    v_cvt_pk_bf16_f32 v8, v8, v10
    v_lshlrev_b32 v9, 16, v8
    v_and_b32 v10, 0xffff0000, v8
    v_add_f32 v5, v5, v9
    v_add_f32 v6, v6, v10
    v_lshlrev_b32 v8, 16, v29
    v_lshlrev_b32 v9, 16, v109
    v_and_b32 v10, 0xffff0000, v29
    v_and_b32 v11, 0xffff0000, v109
    v_mul_f32 v8, v8, v9
    v_mul_f32 v10, v10, v11
    v_cvt_pk_bf16_f32 v8, v8, v10
    v_lshlrev_b32 v9, 16, v8
    v_and_b32 v10, 0xffff0000, v8
    v_add_f32 v5, v5, v9
    v_add_f32 v6, v6, v10
    v_lshlrev_b32 v8, 16, v30
    v_lshlrev_b32 v9, 16, v110
    v_and_b32 v10, 0xffff0000, v30
    v_and_b32 v11, 0xffff0000, v110
    v_mul_f32 v8, v8, v9
    v_mul_f32 v10, v10, v11
    v_cvt_pk_bf16_f32 v8, v8, v10
    v_lshlrev_b32 v9, 16, v8
    v_and_b32 v10, 0xffff0000, v8
    v_add_f32 v5, v5, v9
    v_add_f32 v6, v6, v10
    v_lshlrev_b32 v8, 16, v31
    v_lshlrev_b32 v9, 16, v111
    v_and_b32 v10, 0xffff0000, v31
    v_and_b32 v11, 0xffff0000, v111
    v_mul_f32 v8, v8, v9
    v_mul_f32 v10, v10, v11
    v_cvt_pk_bf16_f32 v8, v8, v10
    v_lshlrev_b32 v9, 16, v8
    v_and_b32 v10, 0xffff0000, v8
    v_add_f32 v5, v5, v9
    v_add_f32 v6, v6, v10
    v_lshlrev_b32 v8, 16, v32
    v_lshlrev_b32 v9, 16, v112
    v_and_b32 v10, 0xffff0000, v32
    v_and_b32 v11, 0xffff0000, v112
    v_mul_f32 v8, v8, v9
    v_mul_f32 v10, v10, v11
    v_cvt_pk_bf16_f32 v8, v8, v10
    v_lshlrev_b32 v9, 16, v8
    v_and_b32 v10, 0xffff0000, v8
    v_add_f32 v5, v5, v9
    v_add_f32 v6, v6, v10
    v_lshlrev_b32 v8, 16, v33
    v_lshlrev_b32 v9, 16, v113
    v_and_b32 v10, 0xffff0000, v33
    v_and_b32 v11, 0xffff0000, v113
    v_mul_f32 v8, v8, v9
    v_mul_f32 v10, v10, v11
    v_cvt_pk_bf16_f32 v8, v8, v10
    v_lshlrev_b32 v9, 16, v8
    v_and_b32 v10, 0xffff0000, v8
    v_add_f32 v5, v5, v9
    v_add_f32 v6, v6, v10
    v_lshlrev_b32 v8, 16, v34
    v_lshlrev_b32 v9, 16, v114
    v_and_b32 v10, 0xffff0000, v34
    v_and_b32 v11, 0xffff0000, v114
    v_mul_f32 v8, v8, v9
    v_mul_f32 v10, v10, v11
    v_cvt_pk_bf16_f32 v8, v8, v10
    v_lshlrev_b32 v9, 16, v8
    v_and_b32 v10, 0xffff0000, v8
    v_add_f32 v5, v5, v9
    v_add_f32 v6, v6, v10
    v_lshlrev_b32 v8, 16, v35
    v_lshlrev_b32 v9, 16, v115
    v_and_b32 v10, 0xffff0000, v35
    v_and_b32 v11, 0xffff0000, v115
    v_mul_f32 v8, v8, v9
    v_mul_f32 v10, v10, v11
    v_cvt_pk_bf16_f32 v8, v8, v10
    v_lshlrev_b32 v9, 16, v8
    v_and_b32 v10, 0xffff0000, v8
    v_add_f32 v5, v5, v9
    v_add_f32 v6, v6, v10
    v_lshlrev_b32 v8, 16, v36
    v_lshlrev_b32 v9, 16, v116
    v_and_b32 v10, 0xffff0000, v36
    v_and_b32 v11, 0xffff0000, v116
    v_mul_f32 v8, v8, v9
    v_mul_f32 v10, v10, v11
    v_cvt_pk_bf16_f32 v8, v8, v10
    v_lshlrev_b32 v9, 16, v8
    v_and_b32 v10, 0xffff0000, v8
    v_add_f32 v5, v5, v9
    v_add_f32 v6, v6, v10
    v_lshlrev_b32 v8, 16, v37
    v_lshlrev_b32 v9, 16, v117
    v_and_b32 v10, 0xffff0000, v37
    v_and_b32 v11, 0xffff0000, v117
    v_mul_f32 v8, v8, v9
    v_mul_f32 v10, v10, v11
    v_cvt_pk_bf16_f32 v8, v8, v10
    v_lshlrev_b32 v9, 16, v8
    v_and_b32 v10, 0xffff0000, v8
    v_add_f32 v5, v5, v9
    v_add_f32 v6, v6, v10
    v_lshlrev_b32 v8, 16, v38
    v_lshlrev_b32 v9, 16, v118
    v_and_b32 v10, 0xffff0000, v38
    v_and_b32 v11, 0xffff0000, v118
    v_mul_f32 v8, v8, v9
    v_mul_f32 v10, v10, v11
    v_cvt_pk_bf16_f32 v8, v8, v10
    v_lshlrev_b32 v9, 16, v8
    v_and_b32 v10, 0xffff0000, v8
    v_add_f32 v5, v5, v9
    v_add_f32 v6, v6, v10
    v_lshlrev_b32 v8, 16, v39
    v_lshlrev_b32 v9, 16, v119
    v_and_b32 v10, 0xffff0000, v39
    v_and_b32 v11, 0xffff0000, v119
    v_mul_f32 v8, v8, v9
    v_mul_f32 v10, v10, v11
    v_cvt_pk_bf16_f32 v8, v8, v10
    v_lshlrev_b32 v9, 16, v8
    v_and_b32 v10, 0xffff0000, v8
    v_add_f32 v5, v5, v9
    v_add_f32 v6, v6, v10
    v_lshlrev_b32 v8, 16, v40
    v_lshlrev_b32 v9, 16, v120
    v_and_b32 v10, 0xffff0000, v40
    v_and_b32 v11, 0xffff0000, v120
    v_mul_f32 v8, v8, v9
    v_mul_f32 v10, v10, v11
    v_cvt_pk_bf16_f32 v8, v8, v10
    v_lshlrev_b32 v9, 16, v8
    v_and_b32 v10, 0xffff0000, v8
    v_add_f32 v5, v5, v9
    v_add_f32 v6, v6, v10
    v_lshlrev_b32 v8, 16, v41
    v_lshlrev_b32 v9, 16, v121
    v_and_b32 v10, 0xffff0000, v41
    v_and_b32 v11, 0xffff0000, v121
    v_mul_f32 v8, v8, v9
    v_mul_f32 v10, v10, v11
    v_cvt_pk_bf16_f32 v8, v8, v10
    v_lshlrev_b32 v9, 16, v8
    v_and_b32 v10, 0xffff0000, v8
    v_add_f32 v5, v5, v9
    v_add_f32 v6, v6, v10
    v_lshlrev_b32 v8, 16, v42
    v_lshlrev_b32 v9, 16, v122
    v_and_b32 v10, 0xffff0000, v42
    v_and_b32 v11, 0xffff0000, v122
    v_mul_f32 v8, v8, v9
    v_mul_f32 v10, v10, v11
    v_cvt_pk_bf16_f32 v8, v8, v10
    v_lshlrev_b32 v9, 16, v8
    v_and_b32 v10, 0xffff0000, v8
    v_add_f32 v5, v5, v9
    v_add_f32 v6, v6, v10
    v_lshlrev_b32 v8, 16, v43
    v_lshlrev_b32 v9, 16, v123
    v_and_b32 v10, 0xffff0000, v43
    v_and_b32 v11, 0xffff0000, v123
    v_mul_f32 v8, v8, v9
    v_mul_f32 v10, v10, v11
    v_cvt_pk_bf16_f32 v8, v8, v10
    v_lshlrev_b32 v9, 16, v8
    v_and_b32 v10, 0xffff0000, v8
    v_add_f32 v5, v5, v9
    v_add_f32 v6, v6, v10
    v_lshlrev_b32 v8, 16, v44
    v_lshlrev_b32 v9, 16, v124
    v_and_b32 v10, 0xffff0000, v44
    v_and_b32 v11, 0xffff0000, v124
    v_mul_f32 v8, v8, v9
    v_mul_f32 v10, v10, v11
    v_cvt_pk_bf16_f32 v8, v8, v10
    v_lshlrev_b32 v9, 16, v8
    v_and_b32 v10, 0xffff0000, v8
    v_add_f32 v5, v5, v9
    v_add_f32 v6, v6, v10
    v_lshlrev_b32 v8, 16, v45
    v_lshlrev_b32 v9, 16, v125
    v_and_b32 v10, 0xffff0000, v45
    v_and_b32 v11, 0xffff0000, v125
    v_mul_f32 v8, v8, v9
    v_mul_f32 v10, v10, v11
    v_cvt_pk_bf16_f32 v8, v8, v10
    v_lshlrev_b32 v9, 16, v8
    v_and_b32 v10, 0xffff0000, v8
    v_add_f32 v5, v5, v9
    v_add_f32 v6, v6, v10
    v_lshlrev_b32 v8, 16, v46
    v_lshlrev_b32 v9, 16, v126
    v_and_b32 v10, 0xffff0000, v46
    v_and_b32 v11, 0xffff0000, v126
    v_mul_f32 v8, v8, v9
    v_mul_f32 v10, v10, v11
    v_cvt_pk_bf16_f32 v8, v8, v10
    v_lshlrev_b32 v9, 16, v8
    v_and_b32 v10, 0xffff0000, v8
    v_add_f32 v5, v5, v9
    v_add_f32 v6, v6, v10
    v_lshlrev_b32 v8, 16, v47
    v_lshlrev_b32 v9, 16, v127
    v_and_b32 v10, 0xffff0000, v47
    v_and_b32 v11, 0xffff0000, v127
    v_mul_f32 v8, v8, v9
    v_mul_f32 v10, v10, v11
    v_cvt_pk_bf16_f32 v8, v8, v10
    v_lshlrev_b32 v9, 16, v8
    v_and_b32 v10, 0xffff0000, v8
    v_add_f32 v5, v5, v9
    v_add_f32 v6, v6, v10
    v_lshlrev_b32 v8, 16, v48
    v_lshlrev_b32 v9, 16, v128
    v_and_b32 v10, 0xffff0000, v48
    v_and_b32 v11, 0xffff0000, v128
    v_mul_f32 v8, v8, v9
    v_mul_f32 v10, v10, v11
    v_cvt_pk_bf16_f32 v8, v8, v10
    v_lshlrev_b32 v9, 16, v8
    v_and_b32 v10, 0xffff0000, v8
    v_add_f32 v5, v5, v9
    v_add_f32 v6, v6, v10
    v_lshlrev_b32 v8, 16, v49
    v_lshlrev_b32 v9, 16, v129
    v_and_b32 v10, 0xffff0000, v49
    v_and_b32 v11, 0xffff0000, v129
    v_mul_f32 v8, v8, v9
    v_mul_f32 v10, v10, v11
    v_cvt_pk_bf16_f32 v8, v8, v10
    v_lshlrev_b32 v9, 16, v8
    v_and_b32 v10, 0xffff0000, v8
    v_add_f32 v5, v5, v9
    v_add_f32 v6, v6, v10
    v_lshlrev_b32 v8, 16, v50
    v_lshlrev_b32 v9, 16, v130
    v_and_b32 v10, 0xffff0000, v50
    v_and_b32 v11, 0xffff0000, v130
    v_mul_f32 v8, v8, v9
    v_mul_f32 v10, v10, v11
    v_cvt_pk_bf16_f32 v8, v8, v10
    v_lshlrev_b32 v9, 16, v8
    v_and_b32 v10, 0xffff0000, v8
    v_add_f32 v5, v5, v9
    v_add_f32 v6, v6, v10
    v_lshlrev_b32 v8, 16, v51
    v_lshlrev_b32 v9, 16, v131
    v_and_b32 v10, 0xffff0000, v51
    v_and_b32 v11, 0xffff0000, v131
    v_mul_f32 v8, v8, v9
    v_mul_f32 v10, v10, v11
    v_cvt_pk_bf16_f32 v8, v8, v10
    v_lshlrev_b32 v9, 16, v8
    v_and_b32 v10, 0xffff0000, v8
    v_add_f32 v5, v5, v9
    v_add_f32 v6, v6, v10
    v_lshlrev_b32 v8, 16, v52
    v_lshlrev_b32 v9, 16, v132
    v_and_b32 v10, 0xffff0000, v52
    v_and_b32 v11, 0xffff0000, v132
    v_mul_f32 v8, v8, v9
    v_mul_f32 v10, v10, v11
    v_cvt_pk_bf16_f32 v8, v8, v10
    v_lshlrev_b32 v9, 16, v8
    v_and_b32 v10, 0xffff0000, v8
    v_add_f32 v5, v5, v9
    v_add_f32 v6, v6, v10
    v_lshlrev_b32 v8, 16, v53
    v_lshlrev_b32 v9, 16, v133
    v_and_b32 v10, 0xffff0000, v53
    v_and_b32 v11, 0xffff0000, v133
    v_mul_f32 v8, v8, v9
    v_mul_f32 v10, v10, v11
    v_cvt_pk_bf16_f32 v8, v8, v10
    v_lshlrev_b32 v9, 16, v8
    v_and_b32 v10, 0xffff0000, v8
    v_add_f32 v5, v5, v9
    v_add_f32 v6, v6, v10
    v_lshlrev_b32 v8, 16, v54
    v_lshlrev_b32 v9, 16, v134
    v_and_b32 v10, 0xffff0000, v54
    v_and_b32 v11, 0xffff0000, v134
    v_mul_f32 v8, v8, v9
    v_mul_f32 v10, v10, v11
    v_cvt_pk_bf16_f32 v8, v8, v10
    v_lshlrev_b32 v9, 16, v8
    v_and_b32 v10, 0xffff0000, v8
    v_add_f32 v5, v5, v9
    v_add_f32 v6, v6, v10
    v_lshlrev_b32 v8, 16, v55
    v_lshlrev_b32 v9, 16, v135
    v_and_b32 v10, 0xffff0000, v55
    v_and_b32 v11, 0xffff0000, v135
    v_mul_f32 v8, v8, v9
    v_mul_f32 v10, v10, v11
    v_cvt_pk_bf16_f32 v8, v8, v10
    v_lshlrev_b32 v9, 16, v8
    v_and_b32 v10, 0xffff0000, v8
    v_add_f32 v5, v5, v9
    v_add_f32 v6, v6, v10
    v_lshlrev_b32 v8, 16, v56
    v_lshlrev_b32 v9, 16, v136
    v_and_b32 v10, 0xffff0000, v56
    v_and_b32 v11, 0xffff0000, v136
    v_mul_f32 v8, v8, v9
    v_mul_f32 v10, v10, v11
    v_cvt_pk_bf16_f32 v8, v8, v10
    v_lshlrev_b32 v9, 16, v8
    v_and_b32 v10, 0xffff0000, v8
    v_add_f32 v5, v5, v9
    v_add_f32 v6, v6, v10
    v_lshlrev_b32 v8, 16, v57
    v_lshlrev_b32 v9, 16, v137
    v_and_b32 v10, 0xffff0000, v57
    v_and_b32 v11, 0xffff0000, v137
    v_mul_f32 v8, v8, v9
    v_mul_f32 v10, v10, v11
    v_cvt_pk_bf16_f32 v8, v8, v10
    v_lshlrev_b32 v9, 16, v8
    v_and_b32 v10, 0xffff0000, v8
    v_add_f32 v5, v5, v9
    v_add_f32 v6, v6, v10
    v_lshlrev_b32 v8, 16, v58
    v_lshlrev_b32 v9, 16, v138
    v_and_b32 v10, 0xffff0000, v58
    v_and_b32 v11, 0xffff0000, v138
    v_mul_f32 v8, v8, v9
    v_mul_f32 v10, v10, v11
    v_cvt_pk_bf16_f32 v8, v8, v10
    v_lshlrev_b32 v9, 16, v8
    v_and_b32 v10, 0xffff0000, v8
    v_add_f32 v5, v5, v9
    v_add_f32 v6, v6, v10
    v_lshlrev_b32 v8, 16, v59
    v_lshlrev_b32 v9, 16, v139
    v_and_b32 v10, 0xffff0000, v59
    v_and_b32 v11, 0xffff0000, v139
    v_mul_f32 v8, v8, v9
    v_mul_f32 v10, v10, v11
    v_cvt_pk_bf16_f32 v8, v8, v10
    v_lshlrev_b32 v9, 16, v8
    v_and_b32 v10, 0xffff0000, v8
    v_add_f32 v5, v5, v9
    v_add_f32 v6, v6, v10
    v_lshlrev_b32 v8, 16, v60
    v_lshlrev_b32 v9, 16, v140
    v_and_b32 v10, 0xffff0000, v60
    v_and_b32 v11, 0xffff0000, v140
    v_mul_f32 v8, v8, v9
    v_mul_f32 v10, v10, v11
    v_cvt_pk_bf16_f32 v8, v8, v10
    v_lshlrev_b32 v9, 16, v8
    v_and_b32 v10, 0xffff0000, v8
    v_add_f32 v5, v5, v9
    v_add_f32 v6, v6, v10
    v_lshlrev_b32 v8, 16, v61
    v_lshlrev_b32 v9, 16, v141
    v_and_b32 v10, 0xffff0000, v61
    v_and_b32 v11, 0xffff0000, v141
    v_mul_f32 v8, v8, v9
    v_mul_f32 v10, v10, v11
    v_cvt_pk_bf16_f32 v8, v8, v10
    v_lshlrev_b32 v9, 16, v8
    v_and_b32 v10, 0xffff0000, v8
    v_add_f32 v5, v5, v9
    v_add_f32 v6, v6, v10
    v_lshlrev_b32 v8, 16, v62
    v_lshlrev_b32 v9, 16, v142
    v_and_b32 v10, 0xffff0000, v62
    v_and_b32 v11, 0xffff0000, v142
    v_mul_f32 v8, v8, v9
    v_mul_f32 v10, v10, v11
    v_cvt_pk_bf16_f32 v8, v8, v10
    v_lshlrev_b32 v9, 16, v8
    v_and_b32 v10, 0xffff0000, v8
    v_add_f32 v5, v5, v9
    v_add_f32 v6, v6, v10
    v_lshlrev_b32 v8, 16, v63
    v_lshlrev_b32 v9, 16, v143
    v_and_b32 v10, 0xffff0000, v63
    v_and_b32 v11, 0xffff0000, v143
    v_mul_f32 v8, v8, v9
    v_mul_f32 v10, v10, v11
    v_cvt_pk_bf16_f32 v8, v8, v10
    v_lshlrev_b32 v9, 16, v8
    v_and_b32 v10, 0xffff0000, v8
    v_add_f32 v5, v5, v9
    v_add_f32 v6, v6, v10
    v_lshlrev_b32 v8, 16, v64
    v_lshlrev_b32 v9, 16, v144
    v_and_b32 v10, 0xffff0000, v64
    v_and_b32 v11, 0xffff0000, v144
    v_mul_f32 v8, v8, v9
    v_mul_f32 v10, v10, v11
    v_cvt_pk_bf16_f32 v8, v8, v10
    v_lshlrev_b32 v9, 16, v8
    v_and_b32 v10, 0xffff0000, v8
    v_add_f32 v5, v5, v9
    v_add_f32 v6, v6, v10
    v_lshlrev_b32 v8, 16, v65
    v_lshlrev_b32 v9, 16, v145
    v_and_b32 v10, 0xffff0000, v65
    v_and_b32 v11, 0xffff0000, v145
    v_mul_f32 v8, v8, v9
    v_mul_f32 v10, v10, v11
    v_cvt_pk_bf16_f32 v8, v8, v10
    v_lshlrev_b32 v9, 16, v8
    v_and_b32 v10, 0xffff0000, v8
    v_add_f32 v5, v5, v9
    v_add_f32 v6, v6, v10
    v_lshlrev_b32 v8, 16, v66
    v_lshlrev_b32 v9, 16, v146
    v_and_b32 v10, 0xffff0000, v66
    v_and_b32 v11, 0xffff0000, v146
    v_mul_f32 v8, v8, v9
    v_mul_f32 v10, v10, v11
    v_cvt_pk_bf16_f32 v8, v8, v10
    v_lshlrev_b32 v9, 16, v8
    v_and_b32 v10, 0xffff0000, v8
    v_add_f32 v5, v5, v9
    v_add_f32 v6, v6, v10
    v_lshlrev_b32 v8, 16, v67
    v_lshlrev_b32 v9, 16, v147
    v_and_b32 v10, 0xffff0000, v67
    v_and_b32 v11, 0xffff0000, v147
    v_mul_f32 v8, v8, v9
    v_mul_f32 v10, v10, v11
    v_cvt_pk_bf16_f32 v8, v8, v10
    v_lshlrev_b32 v9, 16, v8
    v_and_b32 v10, 0xffff0000, v8
    v_add_f32 v5, v5, v9
    v_add_f32 v6, v6, v10
    v_lshlrev_b32 v8, 16, v68
    v_lshlrev_b32 v9, 16, v148
    v_and_b32 v10, 0xffff0000, v68
    v_and_b32 v11, 0xffff0000, v148
    v_mul_f32 v8, v8, v9
    v_mul_f32 v10, v10, v11
    v_cvt_pk_bf16_f32 v8, v8, v10
    v_lshlrev_b32 v9, 16, v8
    v_and_b32 v10, 0xffff0000, v8
    v_add_f32 v5, v5, v9
    v_add_f32 v6, v6, v10
    v_lshlrev_b32 v8, 16, v69
    v_lshlrev_b32 v9, 16, v149
    v_and_b32 v10, 0xffff0000, v69
    v_and_b32 v11, 0xffff0000, v149
    v_mul_f32 v8, v8, v9
    v_mul_f32 v10, v10, v11
    v_cvt_pk_bf16_f32 v8, v8, v10
    v_lshlrev_b32 v9, 16, v8
    v_and_b32 v10, 0xffff0000, v8
    v_add_f32 v5, v5, v9
    v_add_f32 v6, v6, v10
    v_lshlrev_b32 v8, 16, v70
    v_lshlrev_b32 v9, 16, v150
    v_and_b32 v10, 0xffff0000, v70
    v_and_b32 v11, 0xffff0000, v150
    v_mul_f32 v8, v8, v9
    v_mul_f32 v10, v10, v11
    v_cvt_pk_bf16_f32 v8, v8, v10
    v_lshlrev_b32 v9, 16, v8
    v_and_b32 v10, 0xffff0000, v8
    v_add_f32 v5, v5, v9
    v_add_f32 v6, v6, v10
    v_lshlrev_b32 v8, 16, v71
    v_lshlrev_b32 v9, 16, v151
    v_and_b32 v10, 0xffff0000, v71
    v_and_b32 v11, 0xffff0000, v151
    v_mul_f32 v8, v8, v9
    v_mul_f32 v10, v10, v11
    v_cvt_pk_bf16_f32 v8, v8, v10
    v_lshlrev_b32 v9, 16, v8
    v_and_b32 v10, 0xffff0000, v8
    v_add_f32 v5, v5, v9
    v_add_f32 v6, v6, v10
    v_lshlrev_b32 v8, 16, v72
    v_lshlrev_b32 v9, 16, v152
    v_and_b32 v10, 0xffff0000, v72
    v_and_b32 v11, 0xffff0000, v152
    v_mul_f32 v8, v8, v9
    v_mul_f32 v10, v10, v11
    v_cvt_pk_bf16_f32 v8, v8, v10
    v_lshlrev_b32 v9, 16, v8
    v_and_b32 v10, 0xffff0000, v8
    v_add_f32 v5, v5, v9
    v_add_f32 v6, v6, v10
    v_lshlrev_b32 v8, 16, v73
    v_lshlrev_b32 v9, 16, v153
    v_and_b32 v10, 0xffff0000, v73
    v_and_b32 v11, 0xffff0000, v153
    v_mul_f32 v8, v8, v9
    v_mul_f32 v10, v10, v11
    v_cvt_pk_bf16_f32 v8, v8, v10
    v_lshlrev_b32 v9, 16, v8
    v_and_b32 v10, 0xffff0000, v8
    v_add_f32 v5, v5, v9
    v_add_f32 v6, v6, v10
    v_lshlrev_b32 v8, 16, v74
    v_lshlrev_b32 v9, 16, v154
    v_and_b32 v10, 0xffff0000, v74
    v_and_b32 v11, 0xffff0000, v154
    v_mul_f32 v8, v8, v9
    v_mul_f32 v10, v10, v11
    v_cvt_pk_bf16_f32 v8, v8, v10
    v_lshlrev_b32 v9, 16, v8
    v_and_b32 v10, 0xffff0000, v8
    v_add_f32 v5, v5, v9
    v_add_f32 v6, v6, v10
    v_lshlrev_b32 v8, 16, v75
    v_lshlrev_b32 v9, 16, v155
    v_and_b32 v10, 0xffff0000, v75
    v_and_b32 v11, 0xffff0000, v155
    v_mul_f32 v8, v8, v9
    v_mul_f32 v10, v10, v11
    v_cvt_pk_bf16_f32 v8, v8, v10
    v_lshlrev_b32 v9, 16, v8
    v_and_b32 v10, 0xffff0000, v8
    v_add_f32 v5, v5, v9
    v_add_f32 v6, v6, v10
    v_lshlrev_b32 v8, 16, v76
    v_lshlrev_b32 v9, 16, v156
    v_and_b32 v10, 0xffff0000, v76
    v_and_b32 v11, 0xffff0000, v156
    v_mul_f32 v8, v8, v9
    v_mul_f32 v10, v10, v11
    v_cvt_pk_bf16_f32 v8, v8, v10
    v_lshlrev_b32 v9, 16, v8
    v_and_b32 v10, 0xffff0000, v8
    v_add_f32 v5, v5, v9
    v_add_f32 v6, v6, v10
    v_lshlrev_b32 v8, 16, v77
    v_lshlrev_b32 v9, 16, v157
    v_and_b32 v10, 0xffff0000, v77
    v_and_b32 v11, 0xffff0000, v157
    v_mul_f32 v8, v8, v9
    v_mul_f32 v10, v10, v11
    v_cvt_pk_bf16_f32 v8, v8, v10
    v_lshlrev_b32 v9, 16, v8
    v_and_b32 v10, 0xffff0000, v8
    v_add_f32 v5, v5, v9
    v_add_f32 v6, v6, v10
    v_lshlrev_b32 v8, 16, v78
    v_lshlrev_b32 v9, 16, v158
    v_and_b32 v10, 0xffff0000, v78
    v_and_b32 v11, 0xffff0000, v158
    v_mul_f32 v8, v8, v9
    v_mul_f32 v10, v10, v11
    v_cvt_pk_bf16_f32 v8, v8, v10
    v_lshlrev_b32 v9, 16, v8
    v_and_b32 v10, 0xffff0000, v8
    v_add_f32 v5, v5, v9
    v_add_f32 v6, v6, v10
    v_lshlrev_b32 v8, 16, v79
    v_lshlrev_b32 v9, 16, v159
    v_and_b32 v10, 0xffff0000, v79
    v_and_b32 v11, 0xffff0000, v159
    v_mul_f32 v8, v8, v9
    v_mul_f32 v10, v10, v11
    v_cvt_pk_bf16_f32 v8, v8, v10
    v_lshlrev_b32 v9, 16, v8
    v_and_b32 v10, 0xffff0000, v8
    v_add_f32 v5, v5, v9
    v_add_f32 v6, v6, v10
    v_lshlrev_b32 v8, 16, v80
    v_lshlrev_b32 v9, 16, v160
    v_and_b32 v10, 0xffff0000, v80
    v_and_b32 v11, 0xffff0000, v160
    v_mul_f32 v8, v8, v9
    v_mul_f32 v10, v10, v11
    v_cvt_pk_bf16_f32 v8, v8, v10
    v_lshlrev_b32 v9, 16, v8
    v_and_b32 v10, 0xffff0000, v8
    v_add_f32 v5, v5, v9
    v_add_f32 v6, v6, v10
    v_lshlrev_b32 v8, 16, v81
    v_lshlrev_b32 v9, 16, v161
    v_and_b32 v10, 0xffff0000, v81
    v_and_b32 v11, 0xffff0000, v161
    v_mul_f32 v8, v8, v9
    v_mul_f32 v10, v10, v11
    v_cvt_pk_bf16_f32 v8, v8, v10
    v_lshlrev_b32 v9, 16, v8
    v_and_b32 v10, 0xffff0000, v8
    v_add_f32 v5, v5, v9
    v_add_f32 v6, v6, v10
    v_lshlrev_b32 v8, 16, v82
    v_lshlrev_b32 v9, 16, v162
    v_and_b32 v10, 0xffff0000, v82
    v_and_b32 v11, 0xffff0000, v162
    v_mul_f32 v8, v8, v9
    v_mul_f32 v10, v10, v11
    v_cvt_pk_bf16_f32 v8, v8, v10
    v_lshlrev_b32 v9, 16, v8
    v_and_b32 v10, 0xffff0000, v8
    v_add_f32 v5, v5, v9
    v_add_f32 v6, v6, v10
    v_lshlrev_b32 v8, 16, v83
    v_lshlrev_b32 v9, 16, v163
    v_and_b32 v10, 0xffff0000, v83
    v_and_b32 v11, 0xffff0000, v163
    v_mul_f32 v8, v8, v9
    v_mul_f32 v10, v10, v11
    v_cvt_pk_bf16_f32 v8, v8, v10
    v_lshlrev_b32 v9, 16, v8
    v_and_b32 v10, 0xffff0000, v8
    v_add_f32 v5, v5, v9
    v_add_f32 v6, v6, v10
    v_lshlrev_b32 v8, 16, v84
    v_lshlrev_b32 v9, 16, v164
    v_and_b32 v10, 0xffff0000, v84
    v_and_b32 v11, 0xffff0000, v164
    v_mul_f32 v8, v8, v9
    v_mul_f32 v10, v10, v11
    v_cvt_pk_bf16_f32 v8, v8, v10
    v_lshlrev_b32 v9, 16, v8
    v_and_b32 v10, 0xffff0000, v8
    v_add_f32 v5, v5, v9
    v_add_f32 v6, v6, v10
    v_lshlrev_b32 v8, 16, v85
    v_lshlrev_b32 v9, 16, v165
    v_and_b32 v10, 0xffff0000, v85
    v_and_b32 v11, 0xffff0000, v165
    v_mul_f32 v8, v8, v9
    v_mul_f32 v10, v10, v11
    v_cvt_pk_bf16_f32 v8, v8, v10
    v_lshlrev_b32 v9, 16, v8
    v_and_b32 v10, 0xffff0000, v8
    v_add_f32 v5, v5, v9
    v_add_f32 v6, v6, v10
    v_lshlrev_b32 v8, 16, v86
    v_lshlrev_b32 v9, 16, v166
    v_and_b32 v10, 0xffff0000, v86
    v_and_b32 v11, 0xffff0000, v166
    v_mul_f32 v8, v8, v9
    v_mul_f32 v10, v10, v11
    v_cvt_pk_bf16_f32 v8, v8, v10
    v_lshlrev_b32 v9, 16, v8
    v_and_b32 v10, 0xffff0000, v8
    v_add_f32 v5, v5, v9
    v_add_f32 v6, v6, v10
    v_lshlrev_b32 v8, 16, v87
    v_lshlrev_b32 v9, 16, v167
    v_and_b32 v10, 0xffff0000, v87
    v_and_b32 v11, 0xffff0000, v167
    v_mul_f32 v8, v8, v9
    v_mul_f32 v10, v10, v11
    v_cvt_pk_bf16_f32 v8, v8, v10
    v_lshlrev_b32 v9, 16, v8
    v_and_b32 v10, 0xffff0000, v8
    v_add_f32 v5, v5, v9
    v_add_f32 v6, v6, v10
    v_add_f32 v5, v5, v6
    s_nop 1
    v_add_f32_dpp v6, v5, v5 quad_perm:[1,0,3,2] row_mask:0xf bank_mask:0xf
    s_nop 1
    v_add_f32_dpp v5, v6, v6 quad_perm:[2,3,0,1] row_mask:0xf bank_mask:0xf
    v_cvt_pk_bf16_f32 v5, v5, v5
    v_lshlrev_b32 v5, 16, v5
    v_mul_f32 v5, 0xbfb8aa3b, v5
    v_exp_f32 v5, v5
    s_nop 0
    v_add_f32 v5, 1.0, v5
    v_rcp_f32 v5, v5
    s_nop 0
    v_cvt_pk_bf16_f32 v5, v5, v5
    v_lshlrev_b32 v5, 16, v5
    v_lshlrev_b32 v2, 2, v2
    s_lshl_b32 s68, s86, 6
    s_add_u32 s68, s68, 0x7400000
    buffer_store_dword v5, v2, s[60:63], s68 offen sc1
L_nogate:
    s_add_u32 s66, s66, 4
    s_cmp_lt_u32 s66, 8
    s_cbranch_scc1 L_p1pass
    s_waitcnt vmcnt(0)
    s_barrier
    s_cmp_lg_u32 s65, 0
    s_cbranch_scc1 Lsig_123
    v_mov_b32 v2, 1
    v_mov_b32 v3, 136
    s_mov_b64 exec, 1
    buffer_atomic_add v2, v3, s[56:59], 0 offen
    s_mov_b64 exec, -1
Lsig_123:
    s_cmp_lt_u32 s89, 8
    s_cbranch_scc1 L_att
    s_sub_u32 s93, s89, 8
    s_cmp_ge_u32 s93, 12
    s_cselect_b32 s97, 1, 0
    s_mul_i32 s68, s97, 12
    s_sub_u32 s93, s93, s68
    s_waitcnt vmcnt(0) lgkmcnt(0)
    s_barrier
    v_add_u32 v2, 0, v0
    v_mul_u32_u24 v3, 43691, v2
    v_lshrrev_b32 v3, 18, v3
    v_mul_u32_u24 v7, 6, v3
    v_sub_u32 v2, v2, v7
    v_mul_u32_u24 v3, 1152, v3
    v_lshl_add_u32 v4, v2, 4, v3
    v_add_u32 v2, 64, v0
    v_mul_u32_u24 v3, 43691, v2
    v_lshrrev_b32 v3, 18, v3
    v_mul_u32_u24 v7, 6, v3
    v_sub_u32 v2, v2, v7
    v_mul_u32_u24 v3, 1152, v3
    v_lshl_add_u32 v5, v2, 4, v3
    v_add_u32 v2, 128, v0
    v_mul_u32_u24 v3, 43691, v2
    v_lshrrev_b32 v3, 18, v3
    v_mul_u32_u24 v7, 6, v3
    v_sub_u32 v2, v2, v7
    v_mul_u32_u24 v3, 1152, v3
    v_lshl_add_u32 v6, v2, 4, v3
    v_lshrrev_b32 v2, 4, v0
    v_bfe_u32 v3, v0, 2, 2
    v_lshl_add_u32 v3, v2, 2, v3
    v_mul_u32_u24 v3, 96, v3
    v_and_b32 v2, 3, v0
    v_lshl_add_u32 v3, v2, 3, v3
    s_mul_i32 s80, s65, 36864
    v_add_u32 v7, s80, v3
    s_mul_i32 s91, s65, 1327104
    s_mul_i32 s68, s93, 96
    s_add_u32 s91, s91, s68
    s_add_u32 m0, s80, 0
    s_nop 0
    buffer_load_dwordx4 v4, s[40:43], s91 offen lds
    s_add_u32 m0, s80, 1024
    s_nop 0
    buffer_load_dwordx4 v5, s[40:43], s91 offen lds
    s_add_u32 m0, s80, 2048
    s_nop 0
    buffer_load_dwordx4 v6, s[40:43], s91 offen lds
    s_add_u32 s91, s91, 36864
    s_add_u32 m0, s80, 3072
    s_nop 0
    buffer_load_dwordx4 v4, s[40:43], s91 offen lds
    s_add_u32 m0, s80, 4096
    s_nop 0
    buffer_load_dwordx4 v5, s[40:43], s91 offen lds
    s_add_u32 m0, s80, 5120
    s_nop 0
    buffer_load_dwordx4 v6, s[40:43], s91 offen lds
    s_add_u32 s91, s91, 36864
    s_add_u32 m0, s80, 6144
    s_nop 0
    buffer_load_dwordx4 v4, s[40:43], s91 offen lds
    s_add_u32 m0, s80, 7168
    s_nop 0
    buffer_load_dwordx4 v5, s[40:43], s91 offen lds
    s_add_u32 m0, s80, 8192
    s_nop 0
    buffer_load_dwordx4 v6, s[40:43], s91 offen lds
    s_add_u32 s91, s91, 36864
    s_add_u32 m0, s80, 9216
    s_nop 0
    buffer_load_dwordx4 v4, s[40:43], s91 offen lds
    s_add_u32 m0, s80, 10240
    s_nop 0
    buffer_load_dwordx4 v5, s[40:43], s91 offen lds
    s_add_u32 m0, s80, 11264
    s_nop 0
    buffer_load_dwordx4 v6, s[40:43], s91 offen lds
    s_add_u32 s91, s91, 36864
    s_add_u32 m0, s80, 12288
    s_nop 0
    buffer_load_dwordx4 v4, s[40:43], s91 offen lds
    s_add_u32 m0, s80, 13312
    s_nop 0
    buffer_load_dwordx4 v5, s[40:43], s91 offen lds
    s_add_u32 m0, s80, 14336
    s_nop 0
    buffer_load_dwordx4 v6, s[40:43], s91 offen lds
    s_add_u32 s91, s91, 36864
    s_add_u32 m0, s80, 15360
    s_nop 0
    buffer_load_dwordx4 v4, s[40:43], s91 offen lds
    s_add_u32 m0, s80, 16384
    s_nop 0
    buffer_load_dwordx4 v5, s[40:43], s91 offen lds
    s_add_u32 m0, s80, 17408
    s_nop 0
    buffer_load_dwordx4 v6, s[40:43], s91 offen lds
    s_add_u32 s91, s91, 36864
    s_add_u32 m0, s80, 18432
    s_nop 0
    buffer_load_dwordx4 v4, s[40:43], s91 offen lds
    s_add_u32 m0, s80, 19456
    s_nop 0
    buffer_load_dwordx4 v5, s[40:43], s91 offen lds
    s_add_u32 m0, s80, 20480
    s_nop 0
    buffer_load_dwordx4 v6, s[40:43], s91 offen lds
    s_add_u32 s91, s91, 36864
    s_add_u32 m0, s80, 21504
    s_nop 0
    buffer_load_dwordx4 v4, s[40:43], s91 offen lds
    s_add_u32 m0, s80, 22528
    s_nop 0
    buffer_load_dwordx4 v5, s[40:43], s91 offen lds
    s_add_u32 m0, s80, 23552
    s_nop 0
    buffer_load_dwordx4 v6, s[40:43], s91 offen lds
    s_add_u32 s91, s91, 36864
    s_add_u32 m0, s80, 24576
    s_nop 0
    buffer_load_dwordx4 v4, s[40:43], s91 offen lds
    s_add_u32 m0, s80, 25600
    s_nop 0
    buffer_load_dwordx4 v5, s[40:43], s91 offen lds
    s_add_u32 m0, s80, 26624
    s_nop 0
    buffer_load_dwordx4 v6, s[40:43], s91 offen lds
    s_add_u32 s91, s91, 36864
    s_add_u32 m0, s80, 27648
    s_nop 0
    buffer_load_dwordx4 v4, s[40:43], s91 offen lds
    s_add_u32 m0, s80, 28672
    s_nop 0
    buffer_load_dwordx4 v5, s[40:43], s91 offen lds
    s_add_u32 m0, s80, 29696
    s_nop 0
    buffer_load_dwordx4 v6, s[40:43], s91 offen lds
    s_add_u32 s91, s91, 36864
    s_add_u32 m0, s80, 30720
    s_nop 0
    buffer_load_dwordx4 v4, s[40:43], s91 offen lds
    s_add_u32 m0, s80, 31744
    s_nop 0
    buffer_load_dwordx4 v5, s[40:43], s91 offen lds
    s_add_u32 m0, s80, 32768
    s_nop 0
    buffer_load_dwordx4 v6, s[40:43], s91 offen lds
    s_add_u32 s91, s91, 36864
    s_add_u32 m0, s80, 33792
    s_nop 0
    buffer_load_dwordx4 v4, s[40:43], s91 offen lds
    s_add_u32 m0, s80, 34816
    s_nop 0
    buffer_load_dwordx4 v5, s[40:43], s91 offen lds
    s_add_u32 m0, s80, 35840
    s_nop 0
    buffer_load_dwordx4 v6, s[40:43], s91 offen lds
    s_add_u32 s91, s91, 36864
    s_waitcnt vmcnt(33)
    ds_read_b64_tr_b16 a[0:1], v7 offset:0
    ds_read_b64_tr_b16 a[2:3], v7 offset:1536
    ds_read_b64_tr_b16 a[4:5], v7 offset:32
    ds_read_b64_tr_b16 a[6:7], v7 offset:1568
    ds_read_b64_tr_b16 a[8:9], v7 offset:64
    ds_read_b64_tr_b16 a[10:11], v7 offset:1600
    s_waitcnt lgkmcnt(0)
    s_add_u32 m0, s80, 0
    s_nop 0
    buffer_load_dwordx4 v4, s[40:43], s91 offen lds
    s_add_u32 m0, s80, 1024
    s_nop 0
    buffer_load_dwordx4 v5, s[40:43], s91 offen lds
    s_add_u32 m0, s80, 2048
    s_nop 0
    buffer_load_dwordx4 v6, s[40:43], s91 offen lds
    s_add_u32 s91, s91, 36864
    s_waitcnt vmcnt(33)
    ds_read_b64_tr_b16 a[12:13], v7 offset:3072
    ds_read_b64_tr_b16 a[14:15], v7 offset:4608
    ds_read_b64_tr_b16 a[16:17], v7 offset:3104
    ds_read_b64_tr_b16 a[18:19], v7 offset:4640
    ds_read_b64_tr_b16 a[20:21], v7 offset:3136
    ds_read_b64_tr_b16 a[22:23], v7 offset:4672
    s_waitcnt lgkmcnt(0)
    s_add_u32 m0, s80, 3072
    s_nop 0
    buffer_load_dwordx4 v4, s[40:43], s91 offen lds
    s_add_u32 m0, s80, 4096
    s_nop 0
    buffer_load_dwordx4 v5, s[40:43], s91 offen lds
    s_add_u32 m0, s80, 5120
    s_nop 0
    buffer_load_dwordx4 v6, s[40:43], s91 offen lds
    s_add_u32 s91, s91, 36864
    s_waitcnt vmcnt(33)
    ds_read_b64_tr_b16 a[24:25], v7 offset:6144
    ds_read_b64_tr_b16 a[26:27], v7 offset:7680
    ds_read_b64_tr_b16 a[28:29], v7 offset:6176
    ds_read_b64_tr_b16 a[30:31], v7 offset:7712
    ds_read_b64_tr_b16 a[32:33], v7 offset:6208
    ds_read_b64_tr_b16 a[34:35], v7 offset:7744
    s_waitcnt lgkmcnt(0)
    s_add_u32 m0, s80, 6144
    s_nop 0
    buffer_load_dwordx4 v4, s[40:43], s91 offen lds
    s_add_u32 m0, s80, 7168
    s_nop 0
    buffer_load_dwordx4 v5, s[40:43], s91 offen lds
    s_add_u32 m0, s80, 8192
    s_nop 0
    buffer_load_dwordx4 v6, s[40:43], s91 offen lds
    s_add_u32 s91, s91, 36864
    s_waitcnt vmcnt(33)
    ds_read_b64_tr_b16 a[36:37], v7 offset:9216
    ds_read_b64_tr_b16 a[38:39], v7 offset:10752
    ds_read_b64_tr_b16 a[40:41], v7 offset:9248
    ds_read_b64_tr_b16 a[42:43], v7 offset:10784
    ds_read_b64_tr_b16 a[44:45], v7 offset:9280
    ds_read_b64_tr_b16 a[46:47], v7 offset:10816
    s_waitcnt lgkmcnt(0)
    s_add_u32 m0, s80, 9216
    s_nop 0
    buffer_load_dwordx4 v4, s[40:43], s91 offen lds
    s_add_u32 m0, s80, 10240
    s_nop 0
    buffer_load_dwordx4 v5, s[40:43], s91 offen lds
    s_add_u32 m0, s80, 11264
    s_nop 0
    buffer_load_dwordx4 v6, s[40:43], s91 offen lds
    s_add_u32 s91, s91, 36864
    s_waitcnt vmcnt(33)
    ds_read_b64_tr_b16 a[48:49], v7 offset:12288
    ds_read_b64_tr_b16 a[50:51], v7 offset:13824
    ds_read_b64_tr_b16 a[52:53], v7 offset:12320
    ds_read_b64_tr_b16 a[54:55], v7 offset:13856
    ds_read_b64_tr_b16 a[56:57], v7 offset:12352
    ds_read_b64_tr_b16 a[58:59], v7 offset:13888
    s_waitcnt lgkmcnt(0)
    s_add_u32 m0, s80, 12288
    s_nop 0
    buffer_load_dwordx4 v4, s[40:43], s91 offen lds
    s_add_u32 m0, s80, 13312
    s_nop 0
    buffer_load_dwordx4 v5, s[40:43], s91 offen lds
    s_add_u32 m0, s80, 14336
    s_nop 0
    buffer_load_dwordx4 v6, s[40:43], s91 offen lds
    s_add_u32 s91, s91, 36864
    s_waitcnt vmcnt(33)
    ds_read_b64_tr_b16 a[60:61], v7 offset:15360
    ds_read_b64_tr_b16 a[62:63], v7 offset:16896
    ds_read_b64_tr_b16 a[64:65], v7 offset:15392
    ds_read_b64_tr_b16 a[66:67], v7 offset:16928
    ds_read_b64_tr_b16 a[68:69], v7 offset:15424
    ds_read_b64_tr_b16 a[70:71], v7 offset:16960
    s_waitcnt lgkmcnt(0)
    s_add_u32 m0, s80, 15360
    s_nop 0
    buffer_load_dwordx4 v4, s[40:43], s91 offen lds
    s_add_u32 m0, s80, 16384
    s_nop 0
    buffer_load_dwordx4 v5, s[40:43], s91 offen lds
    s_add_u32 m0, s80, 17408
    s_nop 0
    buffer_load_dwordx4 v6, s[40:43], s91 offen lds
    s_add_u32 s91, s91, 36864
    s_waitcnt vmcnt(33)
    ds_read_b64_tr_b16 a[72:73], v7 offset:18432
    ds_read_b64_tr_b16 a[74:75], v7 offset:19968
    ds_read_b64_tr_b16 a[76:77], v7 offset:18464
    ds_read_b64_tr_b16 a[78:79], v7 offset:20000
    ds_read_b64_tr_b16 a[80:81], v7 offset:18496
    ds_read_b64_tr_b16 a[82:83], v7 offset:20032
    s_waitcnt lgkmcnt(0)
    s_add_u32 m0, s80, 18432
    s_nop 0
    buffer_load_dwordx4 v4, s[40:43], s91 offen lds
    s_add_u32 m0, s80, 19456
    s_nop 0
    buffer_load_dwordx4 v5, s[40:43], s91 offen lds
    s_add_u32 m0, s80, 20480
    s_nop 0
    buffer_load_dwordx4 v6, s[40:43], s91 offen lds
    s_add_u32 s91, s91, 36864
    s_waitcnt vmcnt(33)
    ds_read_b64_tr_b16 a[84:85], v7 offset:21504
    ds_read_b64_tr_b16 a[86:87], v7 offset:23040
    ds_read_b64_tr_b16 a[88:89], v7 offset:21536
    ds_read_b64_tr_b16 a[90:91], v7 offset:23072
    ds_read_b64_tr_b16 a[92:93], v7 offset:21568
    ds_read_b64_tr_b16 a[94:95], v7 offset:23104
    s_waitcnt lgkmcnt(0)
    s_add_u32 m0, s80, 21504
    s_nop 0
    buffer_load_dwordx4 v4, s[40:43], s91 offen lds
    s_add_u32 m0, s80, 22528
    s_nop 0
    buffer_load_dwordx4 v5, s[40:43], s91 offen lds
    s_add_u32 m0, s80, 23552
    s_nop 0
    buffer_load_dwordx4 v6, s[40:43], s91 offen lds
    s_add_u32 s91, s91, 36864
    s_waitcnt vmcnt(33)
    ds_read_b64_tr_b16 a[96:97], v7 offset:24576
    ds_read_b64_tr_b16 a[98:99], v7 offset:26112
    ds_read_b64_tr_b16 a[100:101], v7 offset:24608
    ds_read_b64_tr_b16 a[102:103], v7 offset:26144
    ds_read_b64_tr_b16 a[104:105], v7 offset:24640
    ds_read_b64_tr_b16 a[106:107], v7 offset:26176
    s_waitcnt lgkmcnt(0)
    s_add_u32 m0, s80, 24576
    s_nop 0
    buffer_load_dwordx4 v4, s[40:43], s91 offen lds
    s_add_u32 m0, s80, 25600
    s_nop 0
    buffer_load_dwordx4 v5, s[40:43], s91 offen lds
    s_add_u32 m0, s80, 26624
    s_nop 0
    buffer_load_dwordx4 v6, s[40:43], s91 offen lds
    s_add_u32 s91, s91, 36864
    s_waitcnt vmcnt(33)
    ds_read_b64_tr_b16 a[108:109], v7 offset:27648
    ds_read_b64_tr_b16 a[110:111], v7 offset:29184
    ds_read_b64_tr_b16 a[112:113], v7 offset:27680
    ds_read_b64_tr_b16 a[114:115], v7 offset:29216
    ds_read_b64_tr_b16 a[116:117], v7 offset:27712
    ds_read_b64_tr_b16 a[118:119], v7 offset:29248
    s_waitcnt lgkmcnt(0)
    s_add_u32 m0, s80, 27648
    s_nop 0
    buffer_load_dwordx4 v4, s[40:43], s91 offen lds
    s_add_u32 m0, s80, 28672
    s_nop 0
    buffer_load_dwordx4 v5, s[40:43], s91 offen lds
    s_add_u32 m0, s80, 29696
    s_nop 0
    buffer_load_dwordx4 v6, s[40:43], s91 offen lds
    s_add_u32 s91, s91, 36864
    s_waitcnt vmcnt(33)
    ds_read_b64_tr_b16 a[120:121], v7 offset:30720
    ds_read_b64_tr_b16 a[122:123], v7 offset:32256
    ds_read_b64_tr_b16 a[124:125], v7 offset:30752
    ds_read_b64_tr_b16 a[126:127], v7 offset:32288
    ds_read_b64_tr_b16 a[128:129], v7 offset:30784
    ds_read_b64_tr_b16 a[130:131], v7 offset:32320
    s_waitcnt lgkmcnt(0)
    s_add_u32 m0, s80, 30720
    s_nop 0
    buffer_load_dwordx4 v4, s[40:43], s91 offen lds
    s_add_u32 m0, s80, 31744
    s_nop 0
    buffer_load_dwordx4 v5, s[40:43], s91 offen lds
    s_add_u32 m0, s80, 32768
    s_nop 0
    buffer_load_dwordx4 v6, s[40:43], s91 offen lds
    s_add_u32 s91, s91, 36864
    s_waitcnt vmcnt(33)
    ds_read_b64_tr_b16 a[132:133], v7 offset:33792
    ds_read_b64_tr_b16 a[134:135], v7 offset:35328
    ds_read_b64_tr_b16 a[136:137], v7 offset:33824
    ds_read_b64_tr_b16 a[138:139], v7 offset:35360
    ds_read_b64_tr_b16 a[140:141], v7 offset:33856
    ds_read_b64_tr_b16 a[142:143], v7 offset:35392
    s_waitcnt lgkmcnt(0)
    s_add_u32 m0, s80, 33792
    s_nop 0
    buffer_load_dwordx4 v4, s[40:43], s91 offen lds
    s_add_u32 m0, s80, 34816
    s_nop 0
    buffer_load_dwordx4 v5, s[40:43], s91 offen lds
    s_add_u32 m0, s80, 35840
    s_nop 0
    buffer_load_dwordx4 v6, s[40:43], s91 offen lds
    s_add_u32 s91, s91, 36864
    s_waitcnt vmcnt(33)
    ds_read_b64_tr_b16 a[144:145], v7 offset:0
    ds_read_b64_tr_b16 a[146:147], v7 offset:1536
    ds_read_b64_tr_b16 a[148:149], v7 offset:32
    ds_read_b64_tr_b16 a[150:151], v7 offset:1568
    ds_read_b64_tr_b16 a[152:153], v7 offset:64
    ds_read_b64_tr_b16 a[154:155], v7 offset:1600
    s_waitcnt lgkmcnt(0)
    s_add_u32 m0, s80, 0
    s_nop 0
    buffer_load_dwordx4 v4, s[40:43], s91 offen lds
    s_add_u32 m0, s80, 1024
    s_nop 0
    buffer_load_dwordx4 v5, s[40:43], s91 offen lds
    s_add_u32 m0, s80, 2048
    s_nop 0
    buffer_load_dwordx4 v6, s[40:43], s91 offen lds
    s_add_u32 s91, s91, 36864
    s_waitcnt vmcnt(33)
    ds_read_b64_tr_b16 a[156:157], v7 offset:3072
    ds_read_b64_tr_b16 a[158:159], v7 offset:4608
    ds_read_b64_tr_b16 a[160:161], v7 offset:3104
    ds_read_b64_tr_b16 a[162:163], v7 offset:4640
    ds_read_b64_tr_b16 a[164:165], v7 offset:3136
    ds_read_b64_tr_b16 a[166:167], v7 offset:4672
    s_waitcnt lgkmcnt(0)
    s_add_u32 m0, s80, 3072
    s_nop 0
    buffer_load_dwordx4 v4, s[40:43], s91 offen lds
    s_add_u32 m0, s80, 4096
    s_nop 0
    buffer_load_dwordx4 v5, s[40:43], s91 offen lds
    s_add_u32 m0, s80, 5120
    s_nop 0
    buffer_load_dwordx4 v6, s[40:43], s91 offen lds
    s_add_u32 s91, s91, 36864
    s_waitcnt vmcnt(33)
    ds_read_b64_tr_b16 a[168:169], v7 offset:6144
    ds_read_b64_tr_b16 a[170:171], v7 offset:7680
    ds_read_b64_tr_b16 a[172:173], v7 offset:6176
    ds_read_b64_tr_b16 a[174:175], v7 offset:7712
    ds_read_b64_tr_b16 a[176:177], v7 offset:6208
    ds_read_b64_tr_b16 a[178:179], v7 offset:7744
    s_waitcnt lgkmcnt(0)
    s_add_u32 m0, s80, 6144
    s_nop 0
    buffer_load_dwordx4 v4, s[40:43], s91 offen lds
    s_add_u32 m0, s80, 7168
    s_nop 0
    buffer_load_dwordx4 v5, s[40:43], s91 offen lds
    s_add_u32 m0, s80, 8192
    s_nop 0
    buffer_load_dwordx4 v6, s[40:43], s91 offen lds
    s_add_u32 s91, s91, 36864
    s_waitcnt vmcnt(33)
    ds_read_b64_tr_b16 a[180:181], v7 offset:9216
    ds_read_b64_tr_b16 a[182:183], v7 offset:10752
    ds_read_b64_tr_b16 a[184:185], v7 offset:9248
    ds_read_b64_tr_b16 a[186:187], v7 offset:10784
    ds_read_b64_tr_b16 a[188:189], v7 offset:9280
    ds_read_b64_tr_b16 a[190:191], v7 offset:10816
    s_waitcnt lgkmcnt(0)
    s_add_u32 m0, s80, 9216
    s_nop 0
    buffer_load_dwordx4 v4, s[40:43], s91 offen lds
    s_add_u32 m0, s80, 10240
    s_nop 0
    buffer_load_dwordx4 v5, s[40:43], s91 offen lds
    s_add_u32 m0, s80, 11264
    s_nop 0
    buffer_load_dwordx4 v6, s[40:43], s91 offen lds
    s_add_u32 s91, s91, 36864
    s_waitcnt vmcnt(33)
    ds_read_b64_tr_b16 a[192:193], v7 offset:12288
    ds_read_b64_tr_b16 a[194:195], v7 offset:13824
    ds_read_b64_tr_b16 a[196:197], v7 offset:12320
    ds_read_b64_tr_b16 a[198:199], v7 offset:13856
    ds_read_b64_tr_b16 a[200:201], v7 offset:12352
    ds_read_b64_tr_b16 a[202:203], v7 offset:13888
    s_waitcnt lgkmcnt(0)
    s_add_u32 m0, s80, 12288
    s_nop 0
    buffer_load_dwordx4 v4, s[40:43], s91 offen lds
    s_add_u32 m0, s80, 13312
    s_nop 0
    buffer_load_dwordx4 v5, s[40:43], s91 offen lds
    s_add_u32 m0, s80, 14336
    s_nop 0
    buffer_load_dwordx4 v6, s[40:43], s91 offen lds
    s_add_u32 s91, s91, 36864
    s_waitcnt vmcnt(33)
    ds_read_b64_tr_b16 a[204:205], v7 offset:15360
    ds_read_b64_tr_b16 a[206:207], v7 offset:16896
    ds_read_b64_tr_b16 a[208:209], v7 offset:15392
    ds_read_b64_tr_b16 a[210:211], v7 offset:16928
    ds_read_b64_tr_b16 a[212:213], v7 offset:15424
    ds_read_b64_tr_b16 a[214:215], v7 offset:16960
    s_waitcnt lgkmcnt(0)
    s_add_u32 m0, s80, 15360
    s_nop 0
    buffer_load_dwordx4 v4, s[40:43], s91 offen lds
    s_add_u32 m0, s80, 16384
    s_nop 0
    buffer_load_dwordx4 v5, s[40:43], s91 offen lds
    s_add_u32 m0, s80, 17408
    s_nop 0
    buffer_load_dwordx4 v6, s[40:43], s91 offen lds
    s_add_u32 s91, s91, 36864
    s_waitcnt vmcnt(33)
    ds_read_b64_tr_b16 a[216:217], v7 offset:18432
    ds_read_b64_tr_b16 a[218:219], v7 offset:19968
    ds_read_b64_tr_b16 a[220:221], v7 offset:18464
    ds_read_b64_tr_b16 a[222:223], v7 offset:20000
    ds_read_b64_tr_b16 a[224:225], v7 offset:18496
    ds_read_b64_tr_b16 a[226:227], v7 offset:20032
    s_waitcnt lgkmcnt(0)
    s_add_u32 m0, s80, 18432
    s_nop 0
    buffer_load_dwordx4 v4, s[40:43], s91 offen lds
    s_add_u32 m0, s80, 19456
    s_nop 0
    buffer_load_dwordx4 v5, s[40:43], s91 offen lds
    s_add_u32 m0, s80, 20480
    s_nop 0
    buffer_load_dwordx4 v6, s[40:43], s91 offen lds
    s_add_u32 s91, s91, 36864
    s_waitcnt vmcnt(33)
    ds_read_b64_tr_b16 a[228:229], v7 offset:21504
    ds_read_b64_tr_b16 a[230:231], v7 offset:23040
    ds_read_b64_tr_b16 a[232:233], v7 offset:21536
    ds_read_b64_tr_b16 a[234:235], v7 offset:23072
    ds_read_b64_tr_b16 a[236:237], v7 offset:21568
    ds_read_b64_tr_b16 a[238:239], v7 offset:23104
    s_waitcnt lgkmcnt(0)
    s_add_u32 m0, s80, 21504
    s_nop 0
    buffer_load_dwordx4 v4, s[40:43], s91 offen lds
    s_add_u32 m0, s80, 22528
    s_nop 0
    buffer_load_dwordx4 v5, s[40:43], s91 offen lds
    s_add_u32 m0, s80, 23552
    s_nop 0
    buffer_load_dwordx4 v6, s[40:43], s91 offen lds
    s_add_u32 s91, s91, 36864
    s_waitcnt vmcnt(33)
    ds_read_b64_tr_b16 a[240:241], v7 offset:24576
    ds_read_b64_tr_b16 a[242:243], v7 offset:26112
    ds_read_b64_tr_b16 a[244:245], v7 offset:24608
    ds_read_b64_tr_b16 a[246:247], v7 offset:26144
    ds_read_b64_tr_b16 a[248:249], v7 offset:24640
    ds_read_b64_tr_b16 a[250:251], v7 offset:26176
    s_waitcnt lgkmcnt(0)
    s_add_u32 m0, s80, 24576
    s_nop 0
    buffer_load_dwordx4 v4, s[40:43], s91 offen lds
    s_add_u32 m0, s80, 25600
    s_nop 0
    buffer_load_dwordx4 v5, s[40:43], s91 offen lds
    s_add_u32 m0, s80, 26624
    s_nop 0
    buffer_load_dwordx4 v6, s[40:43], s91 offen lds
    s_add_u32 s91, s91, 36864
    s_waitcnt vmcnt(33)
    ds_read_b64_tr_b16 a[252:253], v7 offset:27648
    ds_read_b64_tr_b16 a[254:255], v7 offset:29184
    ds_read_b64_tr_b16 v[80:81], v7 offset:27680
    ds_read_b64_tr_b16 v[82:83], v7 offset:29216
    ds_read_b64_tr_b16 v[84:85], v7 offset:27712
    ds_read_b64_tr_b16 v[86:87], v7 offset:29248
    s_waitcnt lgkmcnt(0)
    s_add_u32 m0, s80, 27648
    s_nop 0
    buffer_load_dwordx4 v4, s[40:43], s91 offen lds
    s_add_u32 m0, s80, 28672
    s_nop 0
    buffer_load_dwordx4 v5, s[40:43], s91 offen lds
    s_add_u32 m0, s80, 29696
    s_nop 0
    buffer_load_dwordx4 v6, s[40:43], s91 offen lds
    s_add_u32 s91, s91, 36864
    s_waitcnt vmcnt(33)
    ds_read_b64_tr_b16 v[88:89], v7 offset:30720
    ds_read_b64_tr_b16 v[90:91], v7 offset:32256
    ds_read_b64_tr_b16 v[92:93], v7 offset:30752
    ds_read_b64_tr_b16 v[94:95], v7 offset:32288
    ds_read_b64_tr_b16 v[96:97], v7 offset:30784
    ds_read_b64_tr_b16 v[98:99], v7 offset:32320
    s_waitcnt lgkmcnt(0)
    s_add_u32 m0, s80, 30720
    s_nop 0
    buffer_load_dwordx4 v4, s[40:43], s91 offen lds
    s_add_u32 m0, s80, 31744
    s_nop 0
    buffer_load_dwordx4 v5, s[40:43], s91 offen lds
    s_add_u32 m0, s80, 32768
    s_nop 0
    buffer_load_dwordx4 v6, s[40:43], s91 offen lds
    s_add_u32 s91, s91, 36864
    s_waitcnt vmcnt(33)
    ds_read_b64_tr_b16 v[100:101], v7 offset:33792
    ds_read_b64_tr_b16 v[102:103], v7 offset:35328
    ds_read_b64_tr_b16 v[104:105], v7 offset:33824
    ds_read_b64_tr_b16 v[106:107], v7 offset:35360
    ds_read_b64_tr_b16 v[108:109], v7 offset:33856
    ds_read_b64_tr_b16 v[110:111], v7 offset:35392
    s_waitcnt lgkmcnt(0)
    s_add_u32 m0, s80, 33792
    s_nop 0
    buffer_load_dwordx4 v4, s[40:43], s91 offen lds
    s_add_u32 m0, s80, 34816
    s_nop 0
    buffer_load_dwordx4 v5, s[40:43], s91 offen lds
    s_add_u32 m0, s80, 35840
    s_nop 0
    buffer_load_dwordx4 v6, s[40:43], s91 offen lds
    s_add_u32 s91, s91, 36864
    s_waitcnt vmcnt(33)
    ds_read_b64_tr_b16 v[112:113], v7 offset:0
    ds_read_b64_tr_b16 v[114:115], v7 offset:1536
    ds_read_b64_tr_b16 v[116:117], v7 offset:32
    ds_read_b64_tr_b16 v[118:119], v7 offset:1568
    ds_read_b64_tr_b16 v[120:121], v7 offset:64
    ds_read_b64_tr_b16 v[122:123], v7 offset:1600
    s_waitcnt vmcnt(30)
    ds_read_b64_tr_b16 v[124:125], v7 offset:3072
    ds_read_b64_tr_b16 v[126:127], v7 offset:4608
    ds_read_b64_tr_b16 v[128:129], v7 offset:3104
    ds_read_b64_tr_b16 v[130:131], v7 offset:4640
    ds_read_b64_tr_b16 v[132:133], v7 offset:3136
    ds_read_b64_tr_b16 v[134:135], v7 offset:4672
    s_waitcnt vmcnt(27)
    ds_read_b64_tr_b16 v[136:137], v7 offset:6144
    ds_read_b64_tr_b16 v[138:139], v7 offset:7680
    ds_read_b64_tr_b16 v[140:141], v7 offset:6176
    ds_read_b64_tr_b16 v[142:143], v7 offset:7712
    ds_read_b64_tr_b16 v[144:145], v7 offset:6208
    ds_read_b64_tr_b16 v[146:147], v7 offset:7744
    s_waitcnt vmcnt(24)
    ds_read_b64_tr_b16 v[148:149], v7 offset:9216
    ds_read_b64_tr_b16 v[150:151], v7 offset:10752
    ds_read_b64_tr_b16 v[152:153], v7 offset:9248
    ds_read_b64_tr_b16 v[154:155], v7 offset:10784
    ds_read_b64_tr_b16 v[156:157], v7 offset:9280
    ds_read_b64_tr_b16 v[158:159], v7 offset:10816
    s_waitcnt vmcnt(21)
    ds_read_b64_tr_b16 v[160:161], v7 offset:12288
    ds_read_b64_tr_b16 v[162:163], v7 offset:13824
    ds_read_b64_tr_b16 v[164:165], v7 offset:12320
    ds_read_b64_tr_b16 v[166:167], v7 offset:13856
    ds_read_b64_tr_b16 v[168:169], v7 offset:12352
    ds_read_b64_tr_b16 v[170:171], v7 offset:13888
    s_waitcnt vmcnt(18)
    ds_read_b64_tr_b16 v[172:173], v7 offset:15360
    ds_read_b64_tr_b16 v[174:175], v7 offset:16896
    ds_read_b64_tr_b16 v[176:177], v7 offset:15392
    ds_read_b64_tr_b16 v[178:179], v7 offset:16928
    ds_read_b64_tr_b16 v[180:181], v7 offset:15424
    ds_read_b64_tr_b16 v[182:183], v7 offset:16960
    s_waitcnt vmcnt(15)
    ds_read_b64_tr_b16 v[184:185], v7 offset:18432
    ds_read_b64_tr_b16 v[186:187], v7 offset:19968
    ds_read_b64_tr_b16 v[188:189], v7 offset:18464
    ds_read_b64_tr_b16 v[190:191], v7 offset:20000
    ds_read_b64_tr_b16 v[192:193], v7 offset:18496
    ds_read_b64_tr_b16 v[194:195], v7 offset:20032
    s_waitcnt vmcnt(12)
    ds_read_b64_tr_b16 v[196:197], v7 offset:21504
    ds_read_b64_tr_b16 v[198:199], v7 offset:23040
    ds_read_b64_tr_b16 v[200:201], v7 offset:21536
    ds_read_b64_tr_b16 v[202:203], v7 offset:23072
    ds_read_b64_tr_b16 v[204:205], v7 offset:21568
    ds_read_b64_tr_b16 v[206:207], v7 offset:23104
    s_waitcnt vmcnt(9)
    ds_read_b64_tr_b16 v[208:209], v7 offset:24576
    ds_read_b64_tr_b16 v[210:211], v7 offset:26112
    ds_read_b64_tr_b16 v[212:213], v7 offset:24608
    ds_read_b64_tr_b16 v[214:215], v7 offset:26144
    ds_read_b64_tr_b16 v[216:217], v7 offset:24640
    ds_read_b64_tr_b16 v[218:219], v7 offset:26176
    s_waitcnt vmcnt(6)
    ds_read_b64_tr_b16 v[220:221], v7 offset:27648
    ds_read_b64_tr_b16 v[222:223], v7 offset:29184
    ds_read_b64_tr_b16 v[224:225], v7 offset:27680
    ds_read_b64_tr_b16 v[226:227], v7 offset:29216
    ds_read_b64_tr_b16 v[228:229], v7 offset:27712
    ds_read_b64_tr_b16 v[230:231], v7 offset:29248
    s_waitcnt vmcnt(3)
    ds_read_b64_tr_b16 v[232:233], v7 offset:30720
    ds_read_b64_tr_b16 v[234:235], v7 offset:32256
    ds_read_b64_tr_b16 v[236:237], v7 offset:30752
    ds_read_b64_tr_b16 v[238:239], v7 offset:32288
    ds_read_b64_tr_b16 v[240:241], v7 offset:30784
    ds_read_b64_tr_b16 v[242:243], v7 offset:32320
    s_waitcnt vmcnt(0)
    ds_read_b64_tr_b16 v[244:245], v7 offset:33792
    ds_read_b64_tr_b16 v[246:247], v7 offset:35328
    ds_read_b64_tr_b16 v[248:249], v7 offset:33824
    ds_read_b64_tr_b16 v[250:251], v7 offset:35360
    ds_read_b64_tr_b16 v[252:253], v7 offset:33856
    ds_read_b64_tr_b16 v[254:255], v7 offset:35392
    s_waitcnt lgkmcnt(0)
    s_barrier
    v_lshlrev_b32 v1, 4, v0
    s_mov_b32 s96, 0
    s_cmp_lg_u32 s65, 0
    s_cbranch_scc1 Lwt_124
    v_mov_b32 v3, 136
    s_mov_b32 s81, 0
Lwp_125:
    buffer_load_dword v2, v3, s[56:59], 0 offen sc1
    s_waitcnt vmcnt(0)
    v_readfirstlane_b32 s68, v2
    s_cmp_ge_u32 s68, 224
    s_cbranch_scc1 Lwt_124
    s_sleep 16
    s_add_u32 s81, s81, 1
    s_cmp_lt_u32 s81, 0x20000
    s_cbranch_scc1 Lwp_125
    s_branch L_fail
Lwt_124:
    s_barrier
    s_lshl_b32 s94, s88, 1
    s_add_u32 s94, s94, s97
L_g4:
    s_mul_i32 s95, s94, 147456
    s_mul_i32 s68, s65, 36864
    s_add_u32 s95, s95, s68
    s_add_u32 s95, s95, 0x3000000
    v_and_b32 v2, 15, v0
    v_lshlrev_b32 v2, 2, v2
    s_lshl_b32 s68, s94, 6
    s_add_u32 s68, s68, 0x7400000
    buffer_load_dword v8, v2, s[60:63], s68 offen sc1
    s_min_u32 s69, s65, 2
    s_mul_i32 s70, s93, 3
    s_add_u32 s70, s70, s69
    s_mul_i32 s71, s94, 36
    s_add_u32 s71, s71, s70
    s_lshl_b32 s71, s71, 9
    s_add_u32 s71, s71, 0x6000000
    v_lshlrev_b32 v9, 3, v0
    v_lshrrev_b32 v2, 4, v0
    v_lshlrev_b32 v2, 3, v2
    s_lshl_b32 s68, s70, 5
    buffer_load_dwordx2 v[10:11], v2, s[44:47], s68 offen
    buffer_load_dwordx4 v[16:19], v1, s[60:63], s95 offen offset:0 sc1
    buffer_load_dwordx4 v[20:23], v1, s[60:63], s95 offen offset:1024 sc1
    buffer_load_dwordx4 v[24:27], v1, s[60:63], s95 offen offset:2048 sc1
    buffer_load_dwordx4 v[28:31], v1, s[60:63], s95 offen offset:3072 sc1
    s_add_u32 s95, s95, 4096
    buffer_load_dwordx4 v[32:35], v1, s[60:63], s95 offen offset:0 sc1
    buffer_load_dwordx4 v[36:39], v1, s[60:63], s95 offen offset:1024 sc1
    buffer_load_dwordx4 v[40:43], v1, s[60:63], s95 offen offset:2048 sc1
    buffer_load_dwordx4 v[44:47], v1, s[60:63], s95 offen offset:3072 sc1
    s_add_u32 s95, s95, 4096
    buffer_load_dwordx4 v[48:51], v1, s[60:63], s95 offen offset:0 sc1
    buffer_load_dwordx4 v[52:55], v1, s[60:63], s95 offen offset:1024 sc1
    buffer_load_dwordx4 v[56:59], v1, s[60:63], s95 offen offset:2048 sc1
    buffer_load_dwordx4 v[60:63], v1, s[60:63], s95 offen offset:3072 sc1
    s_waitcnt vmcnt(11)
    v_mfma_f32_16x16x32_bf16 v[64:67], a[0:3], v[16:19], 0
    v_mfma_f32_16x16x32_bf16 v[68:71], a[4:7], v[16:19], 0
    v_mfma_f32_16x16x32_bf16 v[72:75], a[8:11], v[16:19], 0
    s_add_u32 s95, s95, 4096
    buffer_load_dwordx4 v[16:19], v1, s[60:63], s95 offen offset:0 sc1
    s_waitcnt vmcnt(11)
    v_mfma_f32_16x16x32_bf16 v[64:67], a[12:15], v[20:23], v[64:67]
    v_mfma_f32_16x16x32_bf16 v[68:71], a[16:19], v[20:23], v[68:71]
    v_mfma_f32_16x16x32_bf16 v[72:75], a[20:23], v[20:23], v[72:75]
    buffer_load_dwordx4 v[20:23], v1, s[60:63], s95 offen offset:1024 sc1
    s_waitcnt vmcnt(11)
    v_mfma_f32_16x16x32_bf16 v[64:67], a[24:27], v[24:27], v[64:67]
    v_mfma_f32_16x16x32_bf16 v[68:71], a[28:31], v[24:27], v[68:71]
    v_mfma_f32_16x16x32_bf16 v[72:75], a[32:35], v[24:27], v[72:75]
    buffer_load_dwordx4 v[24:27], v1, s[60:63], s95 offen offset:2048 sc1
    s_waitcnt vmcnt(11)
    v_mfma_f32_16x16x32_bf16 v[64:67], a[36:39], v[28:31], v[64:67]
    v_mfma_f32_16x16x32_bf16 v[68:71], a[40:43], v[28:31], v[68:71]
    v_mfma_f32_16x16x32_bf16 v[72:75], a[44:47], v[28:31], v[72:75]
    buffer_load_dwordx4 v[28:31], v1, s[60:63], s95 offen offset:3072 sc1
    s_waitcnt vmcnt(11)
    v_mfma_f32_16x16x32_bf16 v[64:67], a[48:51], v[32:35], v[64:67]
    v_mfma_f32_16x16x32_bf16 v[68:71], a[52:55], v[32:35], v[68:71]
    v_mfma_f32_16x16x32_bf16 v[72:75], a[56:59], v[32:35], v[72:75]
    s_add_u32 s95, s95, 4096
    buffer_load_dwordx4 v[32:35], v1, s[60:63], s95 offen offset:0 sc1
    s_waitcnt vmcnt(11)
    v_mfma_f32_16x16x32_bf16 v[64:67], a[60:63], v[36:39], v[64:67]
    v_mfma_f32_16x16x32_bf16 v[68:71], a[64:67], v[36:39], v[68:71]
    v_mfma_f32_16x16x32_bf16 v[72:75], a[68:71], v[36:39], v[72:75]
    buffer_load_dwordx4 v[36:39], v1, s[60:63], s95 offen offset:1024 sc1
    s_waitcnt vmcnt(11)
    v_mfma_f32_16x16x32_bf16 v[64:67], a[72:75], v[40:43], v[64:67]
    v_mfma_f32_16x16x32_bf16 v[68:71], a[76:79], v[40:43], v[68:71]
    v_mfma_f32_16x16x32_bf16 v[72:75], a[80:83], v[40:43], v[72:75]
    buffer_load_dwordx4 v[40:43], v1, s[60:63], s95 offen offset:2048 sc1
    s_waitcnt vmcnt(11)
    v_mfma_f32_16x16x32_bf16 v[64:67], a[84:87], v[44:47], v[64:67]
    v_mfma_f32_16x16x32_bf16 v[68:71], a[88:91], v[44:47], v[68:71]
    v_mfma_f32_16x16x32_bf16 v[72:75], a[92:95], v[44:47], v[72:75]
    buffer_load_dwordx4 v[44:47], v1, s[60:63], s95 offen offset:3072 sc1
    s_waitcnt vmcnt(11)
    v_mfma_f32_16x16x32_bf16 v[64:67], a[96:99], v[48:51], v[64:67]
    v_mfma_f32_16x16x32_bf16 v[68:71], a[100:103], v[48:51], v[68:71]
    v_mfma_f32_16x16x32_bf16 v[72:75], a[104:107], v[48:51], v[72:75]
    s_add_u32 s95, s95, 4096
    buffer_load_dwordx4 v[48:51], v1, s[60:63], s95 offen offset:0 sc1
    s_waitcnt vmcnt(11)
    v_mfma_f32_16x16x32_bf16 v[64:67], a[108:111], v[52:55], v[64:67]
    v_mfma_f32_16x16x32_bf16 v[68:71], a[112:115], v[52:55], v[68:71]
    v_mfma_f32_16x16x32_bf16 v[72:75], a[116:119], v[52:55], v[72:75]
    buffer_load_dwordx4 v[52:55], v1, s[60:63], s95 offen offset:1024 sc1
    s_waitcnt vmcnt(11)
    v_mfma_f32_16x16x32_bf16 v[64:67], a[120:123], v[56:59], v[64:67]
    v_mfma_f32_16x16x32_bf16 v[68:71], a[124:127], v[56:59], v[68:71]
    v_mfma_f32_16x16x32_bf16 v[72:75], a[128:131], v[56:59], v[72:75]
    buffer_load_dwordx4 v[56:59], v1, s[60:63], s95 offen offset:2048 sc1
    s_waitcnt vmcnt(11)
    v_mfma_f32_16x16x32_bf16 v[64:67], a[132:135], v[60:63], v[64:67]
    v_mfma_f32_16x16x32_bf16 v[68:71], a[136:139], v[60:63], v[68:71]
    v_mfma_f32_16x16x32_bf16 v[72:75], a[140:143], v[60:63], v[72:75]
    buffer_load_dwordx4 v[60:63], v1, s[60:63], s95 offen offset:3072 sc1
    s_waitcnt vmcnt(11)
    v_mfma_f32_16x16x32_bf16 v[64:67], a[144:147], v[16:19], v[64:67]
    v_mfma_f32_16x16x32_bf16 v[68:71], a[148:151], v[16:19], v[68:71]
    v_mfma_f32_16x16x32_bf16 v[72:75], a[152:155], v[16:19], v[72:75]
    s_add_u32 s95, s95, 4096
    buffer_load_dwordx4 v[16:19], v1, s[60:63], s95 offen offset:0 sc1
    s_waitcnt vmcnt(11)
    v_mfma_f32_16x16x32_bf16 v[64:67], a[156:159], v[20:23], v[64:67]
    v_mfma_f32_16x16x32_bf16 v[68:71], a[160:163], v[20:23], v[68:71]
    v_mfma_f32_16x16x32_bf16 v[72:75], a[164:167], v[20:23], v[72:75]
    buffer_load_dwordx4 v[20:23], v1, s[60:63], s95 offen offset:1024 sc1
    s_waitcnt vmcnt(11)
    v_mfma_f32_16x16x32_bf16 v[64:67], a[168:171], v[24:27], v[64:67]
    v_mfma_f32_16x16x32_bf16 v[68:71], a[172:175], v[24:27], v[68:71]
    v_mfma_f32_16x16x32_bf16 v[72:75], a[176:179], v[24:27], v[72:75]
    buffer_load_dwordx4 v[24:27], v1, s[60:63], s95 offen offset:2048 sc1
    s_waitcnt vmcnt(11)
    v_mfma_f32_16x16x32_bf16 v[64:67], a[180:183], v[28:31], v[64:67]
    v_mfma_f32_16x16x32_bf16 v[68:71], a[184:187], v[28:31], v[68:71]
    v_mfma_f32_16x16x32_bf16 v[72:75], a[188:191], v[28:31], v[72:75]
    buffer_load_dwordx4 v[28:31], v1, s[60:63], s95 offen offset:3072 sc1
    s_waitcnt vmcnt(11)
    v_mfma_f32_16x16x32_bf16 v[64:67], a[192:195], v[32:35], v[64:67]
    v_mfma_f32_16x16x32_bf16 v[68:71], a[196:199], v[32:35], v[68:71]
    v_mfma_f32_16x16x32_bf16 v[72:75], a[200:203], v[32:35], v[72:75]
    s_add_u32 s95, s95, 4096
    buffer_load_dwordx4 v[32:35], v1, s[60:63], s95 offen offset:0 sc1
    s_waitcnt vmcnt(11)
    v_mfma_f32_16x16x32_bf16 v[64:67], a[204:207], v[36:39], v[64:67]
    v_mfma_f32_16x16x32_bf16 v[68:71], a[208:211], v[36:39], v[68:71]
    v_mfma_f32_16x16x32_bf16 v[72:75], a[212:215], v[36:39], v[72:75]
    buffer_load_dwordx4 v[36:39], v1, s[60:63], s95 offen offset:1024 sc1
    s_waitcnt vmcnt(11)
    v_mfma_f32_16x16x32_bf16 v[64:67], a[216:219], v[40:43], v[64:67]
    v_mfma_f32_16x16x32_bf16 v[68:71], a[220:223], v[40:43], v[68:71]
    v_mfma_f32_16x16x32_bf16 v[72:75], a[224:227], v[40:43], v[72:75]
    buffer_load_dwordx4 v[40:43], v1, s[60:63], s95 offen offset:2048 sc1
    s_waitcnt vmcnt(11)
    v_mfma_f32_16x16x32_bf16 v[64:67], a[228:231], v[44:47], v[64:67]
    v_mfma_f32_16x16x32_bf16 v[68:71], a[232:235], v[44:47], v[68:71]
    v_mfma_f32_16x16x32_bf16 v[72:75], a[236:239], v[44:47], v[72:75]
    buffer_load_dwordx4 v[44:47], v1, s[60:63], s95 offen offset:3072 sc1
    s_waitcnt vmcnt(11)
    v_mfma_f32_16x16x32_bf16 v[64:67], a[240:243], v[48:51], v[64:67]
    v_mfma_f32_16x16x32_bf16 v[68:71], a[244:247], v[48:51], v[68:71]
    v_mfma_f32_16x16x32_bf16 v[72:75], a[248:251], v[48:51], v[72:75]
    s_add_u32 s95, s95, 4096
    buffer_load_dwordx4 v[48:51], v1, s[60:63], s95 offen offset:0 sc1
    s_waitcnt vmcnt(11)
    v_mfma_f32_16x16x32_bf16 v[64:67], a[252:255], v[52:55], v[64:67]
    v_mfma_f32_16x16x32_bf16 v[68:71], v[80:83], v[52:55], v[68:71]
    v_mfma_f32_16x16x32_bf16 v[72:75], v[84:87], v[52:55], v[72:75]
    buffer_load_dwordx4 v[52:55], v1, s[60:63], s95 offen offset:1024 sc1
    s_waitcnt vmcnt(11)
    v_mfma_f32_16x16x32_bf16 v[64:67], v[88:91], v[56:59], v[64:67]
    v_mfma_f32_16x16x32_bf16 v[68:71], v[92:95], v[56:59], v[68:71]
    v_mfma_f32_16x16x32_bf16 v[72:75], v[96:99], v[56:59], v[72:75]
    buffer_load_dwordx4 v[56:59], v1, s[60:63], s95 offen offset:2048 sc1
    s_waitcnt vmcnt(11)
    v_mfma_f32_16x16x32_bf16 v[64:67], v[100:103], v[60:63], v[64:67]
    v_mfma_f32_16x16x32_bf16 v[68:71], v[104:107], v[60:63], v[68:71]
    v_mfma_f32_16x16x32_bf16 v[72:75], v[108:111], v[60:63], v[72:75]
    buffer_load_dwordx4 v[60:63], v1, s[60:63], s95 offen offset:3072 sc1
    s_waitcnt vmcnt(11)
    v_mfma_f32_16x16x32_bf16 v[64:67], v[112:115], v[16:19], v[64:67]
    v_mfma_f32_16x16x32_bf16 v[68:71], v[116:119], v[16:19], v[68:71]
    v_mfma_f32_16x16x32_bf16 v[72:75], v[120:123], v[16:19], v[72:75]
    s_waitcnt vmcnt(10)
    v_mfma_f32_16x16x32_bf16 v[64:67], v[124:127], v[20:23], v[64:67]
    v_mfma_f32_16x16x32_bf16 v[68:71], v[128:131], v[20:23], v[68:71]
    v_mfma_f32_16x16x32_bf16 v[72:75], v[132:135], v[20:23], v[72:75]
    s_waitcnt vmcnt(9)
    v_mfma_f32_16x16x32_bf16 v[64:67], v[136:139], v[24:27], v[64:67]
    v_mfma_f32_16x16x32_bf16 v[68:71], v[140:143], v[24:27], v[68:71]
    v_mfma_f32_16x16x32_bf16 v[72:75], v[144:147], v[24:27], v[72:75]
    s_waitcnt vmcnt(8)
    v_mfma_f32_16x16x32_bf16 v[64:67], v[148:151], v[28:31], v[64:67]
    v_mfma_f32_16x16x32_bf16 v[68:71], v[152:155], v[28:31], v[68:71]
    v_mfma_f32_16x16x32_bf16 v[72:75], v[156:159], v[28:31], v[72:75]
    s_waitcnt vmcnt(7)
    v_mfma_f32_16x16x32_bf16 v[64:67], v[160:163], v[32:35], v[64:67]
    v_mfma_f32_16x16x32_bf16 v[68:71], v[164:167], v[32:35], v[68:71]
    v_mfma_f32_16x16x32_bf16 v[72:75], v[168:171], v[32:35], v[72:75]
    s_waitcnt vmcnt(6)
    v_mfma_f32_16x16x32_bf16 v[64:67], v[172:175], v[36:39], v[64:67]
    v_mfma_f32_16x16x32_bf16 v[68:71], v[176:179], v[36:39], v[68:71]
    v_mfma_f32_16x16x32_bf16 v[72:75], v[180:183], v[36:39], v[72:75]
    s_waitcnt vmcnt(5)
    v_mfma_f32_16x16x32_bf16 v[64:67], v[184:187], v[40:43], v[64:67]
    v_mfma_f32_16x16x32_bf16 v[68:71], v[188:191], v[40:43], v[68:71]
    v_mfma_f32_16x16x32_bf16 v[72:75], v[192:195], v[40:43], v[72:75]
    s_waitcnt vmcnt(4)
    v_mfma_f32_16x16x32_bf16 v[64:67], v[196:199], v[44:47], v[64:67]
    v_mfma_f32_16x16x32_bf16 v[68:71], v[200:203], v[44:47], v[68:71]
    v_mfma_f32_16x16x32_bf16 v[72:75], v[204:207], v[44:47], v[72:75]
    s_waitcnt vmcnt(3)
    v_mfma_f32_16x16x32_bf16 v[64:67], v[208:211], v[48:51], v[64:67]
    v_mfma_f32_16x16x32_bf16 v[68:71], v[212:215], v[48:51], v[68:71]
    v_mfma_f32_16x16x32_bf16 v[72:75], v[216:219], v[48:51], v[72:75]
    s_waitcnt vmcnt(2)
    v_mfma_f32_16x16x32_bf16 v[64:67], v[220:223], v[52:55], v[64:67]
    v_mfma_f32_16x16x32_bf16 v[68:71], v[224:227], v[52:55], v[68:71]
    v_mfma_f32_16x16x32_bf16 v[72:75], v[228:231], v[52:55], v[72:75]
    s_waitcnt vmcnt(1)
    v_mfma_f32_16x16x32_bf16 v[64:67], v[232:235], v[56:59], v[64:67]
    v_mfma_f32_16x16x32_bf16 v[68:71], v[236:239], v[56:59], v[68:71]
    v_mfma_f32_16x16x32_bf16 v[72:75], v[240:243], v[56:59], v[72:75]
    s_waitcnt vmcnt(0)
    v_mfma_f32_16x16x32_bf16 v[64:67], v[244:247], v[60:63], v[64:67]
    v_mfma_f32_16x16x32_bf16 v[68:71], v[248:251], v[60:63], v[68:71]
    v_mfma_f32_16x16x32_bf16 v[72:75], v[252:255], v[60:63], v[72:75]
    s_mul_i32 s68, s65, 3072
    s_add_u32 s68, s68, s96
    v_add_u32 v2, s68, v1
    ds_write_b128 v2, v[64:67] offset:0
    ds_write_b128 v2, v[68:71] offset:1024
    s_nop 2
    ds_write_b128 v2, v[72:75] offset:2048
    s_lshl_b32 s68, s69, 10
    s_add_u32 s68, s68, s96
    v_add_u32 v2, s68, v1
    s_xor_b32 s96, s96, 0x4000
    s_waitcnt lgkmcnt(0)
    s_barrier
    s_cmp_eq_u32 s65, 3
    s_cbranch_scc1 Lwsk_126
    ds_read_b128 v[16:19], v2 offset:0
    ds_read_b128 v[20:23], v2 offset:3072
    ds_read_b128 v[24:27], v2 offset:6144
    ds_read_b128 v[28:31], v2 offset:9216
    s_waitcnt lgkmcnt(0)
    v_add_f32 v16, v16, v20
    v_add_f32 v24, v24, v28
    v_add_f32 v17, v17, v21
    v_add_f32 v25, v25, v29
    v_add_f32 v18, v18, v22
    v_add_f32 v26, v26, v30
    v_add_f32 v19, v19, v23
    v_add_f32 v27, v27, v31
    v_add_f32 v16, v16, v24
    v_add_f32 v17, v17, v25
    v_add_f32 v18, v18, v26
    v_add_f32 v19, v19, v27
    v_lshlrev_b32 v20, 16, v10
    v_and_b32 v21, 0xffff0000, v10
    v_lshlrev_b32 v22, 16, v11
    v_and_b32 v23, 0xffff0000, v11
    v_cvt_pk_bf16_f32 v12, v16, v17
    v_cvt_pk_bf16_f32 v13, v18, v19
    v_lshlrev_b32 v16, 16, v12
    v_and_b32 v17, 0xffff0000, v12
    v_lshlrev_b32 v18, 16, v13
    v_and_b32 v19, 0xffff0000, v13
    v_add_f32 v16, v16, v20
    v_add_f32 v17, v17, v21
    v_add_f32 v18, v18, v22
    v_add_f32 v19, v19, v23
    v_cvt_pk_bf16_f32 v12, v16, v17
    v_cvt_pk_bf16_f32 v13, v18, v19
    v_lshlrev_b32 v16, 16, v12
    v_and_b32 v17, 0xffff0000, v12
    v_lshlrev_b32 v18, 16, v13
    v_and_b32 v19, 0xffff0000, v13
    v_sub_f32 v8, 1.0, v8
    v_cvt_pk_bf16_f32 v8, v8, v8
    v_lshlrev_b32 v8, 16, v8
    v_mul_f32 v16, v8, v16
    v_mul_f32 v17, v8, v17
    v_mul_f32 v18, v8, v18
    v_mul_f32 v19, v8, v19
    v_cvt_pk_bf16_f32 v12, v16, v17
    v_cvt_pk_bf16_f32 v13, v18, v19
    buffer_store_dwordx2 v[12:13], v9, s[60:63], s71 offen sc1
Lwsk_126:
    s_add_u32 s94, s94, 14
    s_cmp_lt_u32 s94, 128
    s_cbranch_scc1 L_g4
    s_waitcnt vmcnt(0)
    s_barrier
    s_cmp_lg_u32 s65, 0
    s_cbranch_scc1 Lsig_127
    v_mov_b32 v2, 1
    v_mov_b32 v3, 140
    s_mov_b64 exec, 1
    buffer_atomic_add v2, v3, s[56:59], 0 offen
    s_mov_b64 exec, -1
Lsig_127:
    s_waitcnt vmcnt(0) lgkmcnt(0)
    s_barrier
    v_add_u32 v2, 0, v0
    v_mul_u32_u24 v3, 43691, v2
    v_lshrrev_b32 v3, 18, v3
    v_mul_u32_u24 v7, 6, v3
    v_sub_u32 v2, v2, v7
    v_mul_u32_u24 v3, 1152, v3
    v_lshl_add_u32 v4, v2, 4, v3
    v_add_u32 v2, 64, v0
    v_mul_u32_u24 v3, 43691, v2
    v_lshrrev_b32 v3, 18, v3
    v_mul_u32_u24 v7, 6, v3
    v_sub_u32 v2, v2, v7
    v_mul_u32_u24 v3, 1152, v3
    v_lshl_add_u32 v5, v2, 4, v3
    v_add_u32 v2, 128, v0
    v_mul_u32_u24 v3, 43691, v2
    v_lshrrev_b32 v3, 18, v3
    v_mul_u32_u24 v7, 6, v3
    v_sub_u32 v2, v2, v7
    v_mul_u32_u24 v3, 1152, v3
    v_lshl_add_u32 v6, v2, 4, v3
    v_lshrrev_b32 v2, 4, v0
    v_bfe_u32 v3, v0, 2, 2
    v_lshl_add_u32 v3, v2, 2, v3
    v_mul_u32_u24 v3, 96, v3
    v_and_b32 v2, 3, v0
    v_lshl_add_u32 v3, v2, 3, v3
    s_mul_i32 s80, s65, 36864
    v_add_u32 v7, s80, v3
    s_mul_i32 s91, s65, 1179648
    s_mul_i32 s68, s93, 96
    s_add_u32 s91, s91, s68
    s_add_u32 m0, s80, 0
    s_nop 0
    buffer_load_dwordx4 v4, s[28:31], s91 offen lds
    s_add_u32 m0, s80, 1024
    s_nop 0
    buffer_load_dwordx4 v5, s[28:31], s91 offen lds
    s_add_u32 m0, s80, 2048
    s_nop 0
    buffer_load_dwordx4 v6, s[28:31], s91 offen lds
    s_add_u32 s91, s91, 36864
    s_add_u32 m0, s80, 3072
    s_nop 0
    buffer_load_dwordx4 v4, s[28:31], s91 offen lds
    s_add_u32 m0, s80, 4096
    s_nop 0
    buffer_load_dwordx4 v5, s[28:31], s91 offen lds
    s_add_u32 m0, s80, 5120
    s_nop 0
    buffer_load_dwordx4 v6, s[28:31], s91 offen lds
    s_add_u32 s91, s91, 36864
    s_add_u32 m0, s80, 6144
    s_nop 0
    buffer_load_dwordx4 v4, s[28:31], s91 offen lds
    s_add_u32 m0, s80, 7168
    s_nop 0
    buffer_load_dwordx4 v5, s[28:31], s91 offen lds
    s_add_u32 m0, s80, 8192
    s_nop 0
    buffer_load_dwordx4 v6, s[28:31], s91 offen lds
    s_add_u32 s91, s91, 36864
    s_add_u32 m0, s80, 9216
    s_nop 0
    buffer_load_dwordx4 v4, s[28:31], s91 offen lds
    s_add_u32 m0, s80, 10240
    s_nop 0
    buffer_load_dwordx4 v5, s[28:31], s91 offen lds
    s_add_u32 m0, s80, 11264
    s_nop 0
    buffer_load_dwordx4 v6, s[28:31], s91 offen lds
    s_add_u32 s91, s91, 36864
    s_add_u32 m0, s80, 12288
    s_nop 0
    buffer_load_dwordx4 v4, s[28:31], s91 offen lds
    s_add_u32 m0, s80, 13312
    s_nop 0
    buffer_load_dwordx4 v5, s[28:31], s91 offen lds
    s_add_u32 m0, s80, 14336
    s_nop 0
    buffer_load_dwordx4 v6, s[28:31], s91 offen lds
    s_add_u32 s91, s91, 36864
    s_add_u32 m0, s80, 15360
    s_nop 0
    buffer_load_dwordx4 v4, s[28:31], s91 offen lds
    s_add_u32 m0, s80, 16384
    s_nop 0
    buffer_load_dwordx4 v5, s[28:31], s91 offen lds
    s_add_u32 m0, s80, 17408
    s_nop 0
    buffer_load_dwordx4 v6, s[28:31], s91 offen lds
    s_add_u32 s91, s91, 36864
    s_add_u32 m0, s80, 18432
    s_nop 0
    buffer_load_dwordx4 v4, s[28:31], s91 offen lds
    s_add_u32 m0, s80, 19456
    s_nop 0
    buffer_load_dwordx4 v5, s[28:31], s91 offen lds
    s_add_u32 m0, s80, 20480
    s_nop 0
    buffer_load_dwordx4 v6, s[28:31], s91 offen lds
    s_add_u32 s91, s91, 36864
    s_add_u32 m0, s80, 21504
    s_nop 0
    buffer_load_dwordx4 v4, s[28:31], s91 offen lds
    s_add_u32 m0, s80, 22528
    s_nop 0
    buffer_load_dwordx4 v5, s[28:31], s91 offen lds
    s_add_u32 m0, s80, 23552
    s_nop 0
    buffer_load_dwordx4 v6, s[28:31], s91 offen lds
    s_add_u32 s91, s91, 36864
    s_add_u32 m0, s80, 24576
    s_nop 0
    buffer_load_dwordx4 v4, s[28:31], s91 offen lds
    s_add_u32 m0, s80, 25600
    s_nop 0
    buffer_load_dwordx4 v5, s[28:31], s91 offen lds
    s_add_u32 m0, s80, 26624
    s_nop 0
    buffer_load_dwordx4 v6, s[28:31], s91 offen lds
    s_add_u32 s91, s91, 36864
    s_add_u32 m0, s80, 27648
    s_nop 0
    buffer_load_dwordx4 v4, s[28:31], s91 offen lds
    s_add_u32 m0, s80, 28672
    s_nop 0
    buffer_load_dwordx4 v5, s[28:31], s91 offen lds
    s_add_u32 m0, s80, 29696
    s_nop 0
    buffer_load_dwordx4 v6, s[28:31], s91 offen lds
    s_add_u32 s91, s91, 36864
    s_add_u32 m0, s80, 30720
    s_nop 0
    buffer_load_dwordx4 v4, s[28:31], s91 offen lds
    s_add_u32 m0, s80, 31744
    s_nop 0
    buffer_load_dwordx4 v5, s[28:31], s91 offen lds
    s_add_u32 m0, s80, 32768
    s_nop 0
    buffer_load_dwordx4 v6, s[28:31], s91 offen lds
    s_add_u32 s91, s91, 36864
    s_add_u32 m0, s80, 33792
    s_nop 0
    buffer_load_dwordx4 v4, s[28:31], s91 offen lds
    s_add_u32 m0, s80, 34816
    s_nop 0
    buffer_load_dwordx4 v5, s[28:31], s91 offen lds
    s_add_u32 m0, s80, 35840
    s_nop 0
    buffer_load_dwordx4 v6, s[28:31], s91 offen lds
    s_add_u32 s91, s91, 36864
    s_waitcnt vmcnt(33)
    ds_read_b64_tr_b16 a[0:1], v7 offset:0
    ds_read_b64_tr_b16 a[2:3], v7 offset:1536
    ds_read_b64_tr_b16 a[4:5], v7 offset:32
    ds_read_b64_tr_b16 a[6:7], v7 offset:1568
    ds_read_b64_tr_b16 a[8:9], v7 offset:64
    ds_read_b64_tr_b16 a[10:11], v7 offset:1600
    s_waitcnt lgkmcnt(0)
    s_add_u32 m0, s80, 0
    s_nop 0
    buffer_load_dwordx4 v4, s[28:31], s91 offen lds
    s_add_u32 m0, s80, 1024
    s_nop 0
    buffer_load_dwordx4 v5, s[28:31], s91 offen lds
    s_add_u32 m0, s80, 2048
    s_nop 0
    buffer_load_dwordx4 v6, s[28:31], s91 offen lds
    s_add_u32 s91, s91, 36864
    s_waitcnt vmcnt(33)
    ds_read_b64_tr_b16 a[12:13], v7 offset:3072
    ds_read_b64_tr_b16 a[14:15], v7 offset:4608
    ds_read_b64_tr_b16 a[16:17], v7 offset:3104
    ds_read_b64_tr_b16 a[18:19], v7 offset:4640
    ds_read_b64_tr_b16 a[20:21], v7 offset:3136
    ds_read_b64_tr_b16 a[22:23], v7 offset:4672
    s_waitcnt lgkmcnt(0)
    s_add_u32 m0, s80, 3072
    s_nop 0
    buffer_load_dwordx4 v4, s[28:31], s91 offen lds
    s_add_u32 m0, s80, 4096
    s_nop 0
    buffer_load_dwordx4 v5, s[28:31], s91 offen lds
    s_add_u32 m0, s80, 5120
    s_nop 0
    buffer_load_dwordx4 v6, s[28:31], s91 offen lds
    s_add_u32 s91, s91, 36864
    s_waitcnt vmcnt(33)
    ds_read_b64_tr_b16 a[24:25], v7 offset:6144
    ds_read_b64_tr_b16 a[26:27], v7 offset:7680
    ds_read_b64_tr_b16 a[28:29], v7 offset:6176
    ds_read_b64_tr_b16 a[30:31], v7 offset:7712
    ds_read_b64_tr_b16 a[32:33], v7 offset:6208
    ds_read_b64_tr_b16 a[34:35], v7 offset:7744
    s_waitcnt lgkmcnt(0)
    s_add_u32 m0, s80, 6144
    s_nop 0
    buffer_load_dwordx4 v4, s[28:31], s91 offen lds
    s_add_u32 m0, s80, 7168
    s_nop 0
    buffer_load_dwordx4 v5, s[28:31], s91 offen lds
    s_add_u32 m0, s80, 8192
    s_nop 0
    buffer_load_dwordx4 v6, s[28:31], s91 offen lds
    s_add_u32 s91, s91, 36864
    s_waitcnt vmcnt(33)
    ds_read_b64_tr_b16 a[36:37], v7 offset:9216
    ds_read_b64_tr_b16 a[38:39], v7 offset:10752
    ds_read_b64_tr_b16 a[40:41], v7 offset:9248
    ds_read_b64_tr_b16 a[42:43], v7 offset:10784
    ds_read_b64_tr_b16 a[44:45], v7 offset:9280
    ds_read_b64_tr_b16 a[46:47], v7 offset:10816
    s_waitcnt lgkmcnt(0)
    s_add_u32 m0, s80, 9216
    s_nop 0
    buffer_load_dwordx4 v4, s[28:31], s91 offen lds
    s_add_u32 m0, s80, 10240
    s_nop 0
    buffer_load_dwordx4 v5, s[28:31], s91 offen lds
    s_add_u32 m0, s80, 11264
    s_nop 0
    buffer_load_dwordx4 v6, s[28:31], s91 offen lds
    s_add_u32 s91, s91, 36864
    s_waitcnt vmcnt(33)
    ds_read_b64_tr_b16 a[48:49], v7 offset:12288
    ds_read_b64_tr_b16 a[50:51], v7 offset:13824
    ds_read_b64_tr_b16 a[52:53], v7 offset:12320
    ds_read_b64_tr_b16 a[54:55], v7 offset:13856
    ds_read_b64_tr_b16 a[56:57], v7 offset:12352
    ds_read_b64_tr_b16 a[58:59], v7 offset:13888
    s_waitcnt lgkmcnt(0)
    s_add_u32 m0, s80, 12288
    s_nop 0
    buffer_load_dwordx4 v4, s[28:31], s91 offen lds
    s_add_u32 m0, s80, 13312
    s_nop 0
    buffer_load_dwordx4 v5, s[28:31], s91 offen lds
    s_add_u32 m0, s80, 14336
    s_nop 0
    buffer_load_dwordx4 v6, s[28:31], s91 offen lds
    s_add_u32 s91, s91, 36864
    s_waitcnt vmcnt(33)
    ds_read_b64_tr_b16 a[60:61], v7 offset:15360
    ds_read_b64_tr_b16 a[62:63], v7 offset:16896
    ds_read_b64_tr_b16 a[64:65], v7 offset:15392
    ds_read_b64_tr_b16 a[66:67], v7 offset:16928
    ds_read_b64_tr_b16 a[68:69], v7 offset:15424
    ds_read_b64_tr_b16 a[70:71], v7 offset:16960
    s_waitcnt lgkmcnt(0)
    s_add_u32 m0, s80, 15360
    s_nop 0
    buffer_load_dwordx4 v4, s[28:31], s91 offen lds
    s_add_u32 m0, s80, 16384
    s_nop 0
    buffer_load_dwordx4 v5, s[28:31], s91 offen lds
    s_add_u32 m0, s80, 17408
    s_nop 0
    buffer_load_dwordx4 v6, s[28:31], s91 offen lds
    s_add_u32 s91, s91, 36864
    s_waitcnt vmcnt(33)
    ds_read_b64_tr_b16 a[72:73], v7 offset:18432
    ds_read_b64_tr_b16 a[74:75], v7 offset:19968
    ds_read_b64_tr_b16 a[76:77], v7 offset:18464
    ds_read_b64_tr_b16 a[78:79], v7 offset:20000
    ds_read_b64_tr_b16 a[80:81], v7 offset:18496
    ds_read_b64_tr_b16 a[82:83], v7 offset:20032
    s_waitcnt lgkmcnt(0)
    s_add_u32 m0, s80, 18432
    s_nop 0
    buffer_load_dwordx4 v4, s[28:31], s91 offen lds
    s_add_u32 m0, s80, 19456
    s_nop 0
    buffer_load_dwordx4 v5, s[28:31], s91 offen lds
    s_add_u32 m0, s80, 20480
    s_nop 0
    buffer_load_dwordx4 v6, s[28:31], s91 offen lds
    s_add_u32 s91, s91, 36864
    s_waitcnt vmcnt(33)
    ds_read_b64_tr_b16 a[84:85], v7 offset:21504
    ds_read_b64_tr_b16 a[86:87], v7 offset:23040
    ds_read_b64_tr_b16 a[88:89], v7 offset:21536
    ds_read_b64_tr_b16 a[90:91], v7 offset:23072
    ds_read_b64_tr_b16 a[92:93], v7 offset:21568
    ds_read_b64_tr_b16 a[94:95], v7 offset:23104
    s_waitcnt lgkmcnt(0)
    s_add_u32 m0, s80, 21504
    s_nop 0
    buffer_load_dwordx4 v4, s[28:31], s91 offen lds
    s_add_u32 m0, s80, 22528
    s_nop 0
    buffer_load_dwordx4 v5, s[28:31], s91 offen lds
    s_add_u32 m0, s80, 23552
    s_nop 0
    buffer_load_dwordx4 v6, s[28:31], s91 offen lds
    s_add_u32 s91, s91, 36864
    s_waitcnt vmcnt(33)
    ds_read_b64_tr_b16 a[96:97], v7 offset:24576
    ds_read_b64_tr_b16 a[98:99], v7 offset:26112
    ds_read_b64_tr_b16 a[100:101], v7 offset:24608
    ds_read_b64_tr_b16 a[102:103], v7 offset:26144
    ds_read_b64_tr_b16 a[104:105], v7 offset:24640
    ds_read_b64_tr_b16 a[106:107], v7 offset:26176
    s_waitcnt lgkmcnt(0)
    s_add_u32 m0, s80, 24576
    s_nop 0
    buffer_load_dwordx4 v4, s[28:31], s91 offen lds
    s_add_u32 m0, s80, 25600
    s_nop 0
    buffer_load_dwordx4 v5, s[28:31], s91 offen lds
    s_add_u32 m0, s80, 26624
    s_nop 0
    buffer_load_dwordx4 v6, s[28:31], s91 offen lds
    s_add_u32 s91, s91, 36864
    s_waitcnt vmcnt(33)
    ds_read_b64_tr_b16 a[108:109], v7 offset:27648
    ds_read_b64_tr_b16 a[110:111], v7 offset:29184
    ds_read_b64_tr_b16 a[112:113], v7 offset:27680
    ds_read_b64_tr_b16 a[114:115], v7 offset:29216
    ds_read_b64_tr_b16 a[116:117], v7 offset:27712
    ds_read_b64_tr_b16 a[118:119], v7 offset:29248
    s_waitcnt lgkmcnt(0)
    s_add_u32 m0, s80, 27648
    s_nop 0
    buffer_load_dwordx4 v4, s[28:31], s91 offen lds
    s_add_u32 m0, s80, 28672
    s_nop 0
    buffer_load_dwordx4 v5, s[28:31], s91 offen lds
    s_add_u32 m0, s80, 29696
    s_nop 0
    buffer_load_dwordx4 v6, s[28:31], s91 offen lds
    s_add_u32 s91, s91, 36864
    s_waitcnt vmcnt(33)
    ds_read_b64_tr_b16 a[120:121], v7 offset:30720
    ds_read_b64_tr_b16 a[122:123], v7 offset:32256
    ds_read_b64_tr_b16 a[124:125], v7 offset:30752
    ds_read_b64_tr_b16 a[126:127], v7 offset:32288
    ds_read_b64_tr_b16 a[128:129], v7 offset:30784
    ds_read_b64_tr_b16 a[130:131], v7 offset:32320
    s_waitcnt lgkmcnt(0)
    s_add_u32 m0, s80, 30720
    s_nop 0
    buffer_load_dwordx4 v4, s[28:31], s91 offen lds
    s_add_u32 m0, s80, 31744
    s_nop 0
    buffer_load_dwordx4 v5, s[28:31], s91 offen lds
    s_add_u32 m0, s80, 32768
    s_nop 0
    buffer_load_dwordx4 v6, s[28:31], s91 offen lds
    s_add_u32 s91, s91, 36864
    s_waitcnt vmcnt(33)
    ds_read_b64_tr_b16 a[132:133], v7 offset:33792
    ds_read_b64_tr_b16 a[134:135], v7 offset:35328
    ds_read_b64_tr_b16 a[136:137], v7 offset:33824
    ds_read_b64_tr_b16 a[138:139], v7 offset:35360
    ds_read_b64_tr_b16 a[140:141], v7 offset:33856
    ds_read_b64_tr_b16 a[142:143], v7 offset:35392
    s_waitcnt lgkmcnt(0)
    s_add_u32 m0, s80, 33792
    s_nop 0
    buffer_load_dwordx4 v4, s[28:31], s91 offen lds
    s_add_u32 m0, s80, 34816
    s_nop 0
    buffer_load_dwordx4 v5, s[28:31], s91 offen lds
    s_add_u32 m0, s80, 35840
    s_nop 0
    buffer_load_dwordx4 v6, s[28:31], s91 offen lds
    s_add_u32 s91, s91, 36864
    s_waitcnt vmcnt(33)
    ds_read_b64_tr_b16 a[144:145], v7 offset:0
    ds_read_b64_tr_b16 a[146:147], v7 offset:1536
    ds_read_b64_tr_b16 a[148:149], v7 offset:32
    ds_read_b64_tr_b16 a[150:151], v7 offset:1568
    ds_read_b64_tr_b16 a[152:153], v7 offset:64
    ds_read_b64_tr_b16 a[154:155], v7 offset:1600
    s_waitcnt lgkmcnt(0)
    s_add_u32 m0, s80, 0
    s_nop 0
    buffer_load_dwordx4 v4, s[28:31], s91 offen lds
    s_add_u32 m0, s80, 1024
    s_nop 0
    buffer_load_dwordx4 v5, s[28:31], s91 offen lds
    s_add_u32 m0, s80, 2048
    s_nop 0
    buffer_load_dwordx4 v6, s[28:31], s91 offen lds
    s_add_u32 s91, s91, 36864
    s_waitcnt vmcnt(33)
    ds_read_b64_tr_b16 a[156:157], v7 offset:3072
    ds_read_b64_tr_b16 a[158:159], v7 offset:4608
    ds_read_b64_tr_b16 a[160:161], v7 offset:3104
    ds_read_b64_tr_b16 a[162:163], v7 offset:4640
    ds_read_b64_tr_b16 a[164:165], v7 offset:3136
    ds_read_b64_tr_b16 a[166:167], v7 offset:4672
    s_waitcnt lgkmcnt(0)
    s_add_u32 m0, s80, 3072
    s_nop 0
    buffer_load_dwordx4 v4, s[28:31], s91 offen lds
    s_add_u32 m0, s80, 4096
    s_nop 0
    buffer_load_dwordx4 v5, s[28:31], s91 offen lds
    s_add_u32 m0, s80, 5120
    s_nop 0
    buffer_load_dwordx4 v6, s[28:31], s91 offen lds
    s_add_u32 s91, s91, 36864
    s_waitcnt vmcnt(33)
    ds_read_b64_tr_b16 a[168:169], v7 offset:6144
    ds_read_b64_tr_b16 a[170:171], v7 offset:7680
    ds_read_b64_tr_b16 a[172:173], v7 offset:6176
    ds_read_b64_tr_b16 a[174:175], v7 offset:7712
    ds_read_b64_tr_b16 a[176:177], v7 offset:6208
    ds_read_b64_tr_b16 a[178:179], v7 offset:7744
    s_waitcnt lgkmcnt(0)
    s_add_u32 m0, s80, 6144
    s_nop 0
    buffer_load_dwordx4 v4, s[28:31], s91 offen lds
    s_add_u32 m0, s80, 7168
    s_nop 0
    buffer_load_dwordx4 v5, s[28:31], s91 offen lds
    s_add_u32 m0, s80, 8192
    s_nop 0
    buffer_load_dwordx4 v6, s[28:31], s91 offen lds
    s_add_u32 s91, s91, 36864
    s_waitcnt vmcnt(33)
    ds_read_b64_tr_b16 a[180:181], v7 offset:9216
    ds_read_b64_tr_b16 a[182:183], v7 offset:10752
    ds_read_b64_tr_b16 a[184:185], v7 offset:9248
    ds_read_b64_tr_b16 a[186:187], v7 offset:10784
    ds_read_b64_tr_b16 a[188:189], v7 offset:9280
    ds_read_b64_tr_b16 a[190:191], v7 offset:10816
    s_waitcnt lgkmcnt(0)
    s_add_u32 m0, s80, 9216
    s_nop 0
    buffer_load_dwordx4 v4, s[28:31], s91 offen lds
    s_add_u32 m0, s80, 10240
    s_nop 0
    buffer_load_dwordx4 v5, s[28:31], s91 offen lds
    s_add_u32 m0, s80, 11264
    s_nop 0
    buffer_load_dwordx4 v6, s[28:31], s91 offen lds
    s_add_u32 s91, s91, 36864
    s_waitcnt vmcnt(33)
    ds_read_b64_tr_b16 a[192:193], v7 offset:12288
    ds_read_b64_tr_b16 a[194:195], v7 offset:13824
    ds_read_b64_tr_b16 a[196:197], v7 offset:12320
    ds_read_b64_tr_b16 a[198:199], v7 offset:13856
    ds_read_b64_tr_b16 a[200:201], v7 offset:12352
    ds_read_b64_tr_b16 a[202:203], v7 offset:13888
    s_waitcnt lgkmcnt(0)
    s_add_u32 m0, s80, 12288
    s_nop 0
    buffer_load_dwordx4 v4, s[28:31], s91 offen lds
    s_add_u32 m0, s80, 13312
    s_nop 0
    buffer_load_dwordx4 v5, s[28:31], s91 offen lds
    s_add_u32 m0, s80, 14336
    s_nop 0
    buffer_load_dwordx4 v6, s[28:31], s91 offen lds
    s_add_u32 s91, s91, 36864
    s_waitcnt vmcnt(33)
    ds_read_b64_tr_b16 a[204:205], v7 offset:15360
    ds_read_b64_tr_b16 a[206:207], v7 offset:16896
    ds_read_b64_tr_b16 a[208:209], v7 offset:15392
    ds_read_b64_tr_b16 a[210:211], v7 offset:16928
    ds_read_b64_tr_b16 a[212:213], v7 offset:15424
    ds_read_b64_tr_b16 a[214:215], v7 offset:16960
    s_waitcnt lgkmcnt(0)
    s_add_u32 m0, s80, 15360
    s_nop 0
    buffer_load_dwordx4 v4, s[28:31], s91 offen lds
    s_add_u32 m0, s80, 16384
    s_nop 0
    buffer_load_dwordx4 v5, s[28:31], s91 offen lds
    s_add_u32 m0, s80, 17408
    s_nop 0
    buffer_load_dwordx4 v6, s[28:31], s91 offen lds
    s_add_u32 s91, s91, 36864
    s_waitcnt vmcnt(33)
    ds_read_b64_tr_b16 a[216:217], v7 offset:18432
    ds_read_b64_tr_b16 a[218:219], v7 offset:19968
    ds_read_b64_tr_b16 a[220:221], v7 offset:18464
    ds_read_b64_tr_b16 a[222:223], v7 offset:20000
    ds_read_b64_tr_b16 a[224:225], v7 offset:18496
    ds_read_b64_tr_b16 a[226:227], v7 offset:20032
    s_waitcnt lgkmcnt(0)
    s_add_u32 m0, s80, 18432
    s_nop 0
    buffer_load_dwordx4 v4, s[28:31], s91 offen lds
    s_add_u32 m0, s80, 19456
    s_nop 0
    buffer_load_dwordx4 v5, s[28:31], s91 offen lds
    s_add_u32 m0, s80, 20480
    s_nop 0
    buffer_load_dwordx4 v6, s[28:31], s91 offen lds
    s_add_u32 s91, s91, 36864
    s_waitcnt vmcnt(33)
    ds_read_b64_tr_b16 a[228:229], v7 offset:21504
    ds_read_b64_tr_b16 a[230:231], v7 offset:23040
    ds_read_b64_tr_b16 a[232:233], v7 offset:21536
    ds_read_b64_tr_b16 a[234:235], v7 offset:23072
    ds_read_b64_tr_b16 a[236:237], v7 offset:21568
    ds_read_b64_tr_b16 a[238:239], v7 offset:23104
    s_waitcnt lgkmcnt(0)
    s_add_u32 m0, s80, 21504
    s_nop 0
    buffer_load_dwordx4 v4, s[28:31], s91 offen lds
    s_add_u32 m0, s80, 22528
    s_nop 0
    buffer_load_dwordx4 v5, s[28:31], s91 offen lds
    s_add_u32 m0, s80, 23552
    s_nop 0
    buffer_load_dwordx4 v6, s[28:31], s91 offen lds
    s_add_u32 s91, s91, 36864
    s_waitcnt vmcnt(33)
    ds_read_b64_tr_b16 a[240:241], v7 offset:24576
    ds_read_b64_tr_b16 a[242:243], v7 offset:26112
    ds_read_b64_tr_b16 a[244:245], v7 offset:24608
    ds_read_b64_tr_b16 a[246:247], v7 offset:26144
    ds_read_b64_tr_b16 a[248:249], v7 offset:24640
    ds_read_b64_tr_b16 a[250:251], v7 offset:26176
    s_waitcnt vmcnt(30)
    ds_read_b64_tr_b16 a[252:253], v7 offset:27648
    ds_read_b64_tr_b16 a[254:255], v7 offset:29184
    ds_read_b64_tr_b16 v[80:81], v7 offset:27680
    ds_read_b64_tr_b16 v[82:83], v7 offset:29216
    ds_read_b64_tr_b16 v[84:85], v7 offset:27712
    ds_read_b64_tr_b16 v[86:87], v7 offset:29248
    s_waitcnt vmcnt(27)
    ds_read_b64_tr_b16 v[88:89], v7 offset:30720
    ds_read_b64_tr_b16 v[90:91], v7 offset:32256
    ds_read_b64_tr_b16 v[92:93], v7 offset:30752
    ds_read_b64_tr_b16 v[94:95], v7 offset:32288
    ds_read_b64_tr_b16 v[96:97], v7 offset:30784
    ds_read_b64_tr_b16 v[98:99], v7 offset:32320
    s_waitcnt vmcnt(24)
    ds_read_b64_tr_b16 v[100:101], v7 offset:33792
    ds_read_b64_tr_b16 v[102:103], v7 offset:35328
    ds_read_b64_tr_b16 v[104:105], v7 offset:33824
    ds_read_b64_tr_b16 v[106:107], v7 offset:35360
    ds_read_b64_tr_b16 v[108:109], v7 offset:33856
    ds_read_b64_tr_b16 v[110:111], v7 offset:35392
    s_waitcnt vmcnt(21)
    ds_read_b64_tr_b16 v[112:113], v7 offset:0
    ds_read_b64_tr_b16 v[114:115], v7 offset:1536
    ds_read_b64_tr_b16 v[116:117], v7 offset:32
    ds_read_b64_tr_b16 v[118:119], v7 offset:1568
    ds_read_b64_tr_b16 v[120:121], v7 offset:64
    ds_read_b64_tr_b16 v[122:123], v7 offset:1600
    s_waitcnt vmcnt(18)
    ds_read_b64_tr_b16 v[124:125], v7 offset:3072
    ds_read_b64_tr_b16 v[126:127], v7 offset:4608
    ds_read_b64_tr_b16 v[128:129], v7 offset:3104
    ds_read_b64_tr_b16 v[130:131], v7 offset:4640
    ds_read_b64_tr_b16 v[132:133], v7 offset:3136
    ds_read_b64_tr_b16 v[134:135], v7 offset:4672
    s_waitcnt vmcnt(15)
    ds_read_b64_tr_b16 v[136:137], v7 offset:6144
    ds_read_b64_tr_b16 v[138:139], v7 offset:7680
    ds_read_b64_tr_b16 v[140:141], v7 offset:6176
    ds_read_b64_tr_b16 v[142:143], v7 offset:7712
    ds_read_b64_tr_b16 v[144:145], v7 offset:6208
    ds_read_b64_tr_b16 v[146:147], v7 offset:7744
    s_waitcnt vmcnt(12)
    ds_read_b64_tr_b16 v[148:149], v7 offset:9216
    ds_read_b64_tr_b16 v[150:151], v7 offset:10752
    ds_read_b64_tr_b16 v[152:153], v7 offset:9248
    ds_read_b64_tr_b16 v[154:155], v7 offset:10784
    ds_read_b64_tr_b16 v[156:157], v7 offset:9280
    ds_read_b64_tr_b16 v[158:159], v7 offset:10816
    s_waitcnt vmcnt(9)
    ds_read_b64_tr_b16 v[160:161], v7 offset:12288
    ds_read_b64_tr_b16 v[162:163], v7 offset:13824
    ds_read_b64_tr_b16 v[164:165], v7 offset:12320
    ds_read_b64_tr_b16 v[166:167], v7 offset:13856
    ds_read_b64_tr_b16 v[168:169], v7 offset:12352
    ds_read_b64_tr_b16 v[170:171], v7 offset:13888
    s_waitcnt vmcnt(6)
    ds_read_b64_tr_b16 v[172:173], v7 offset:15360
    ds_read_b64_tr_b16 v[174:175], v7 offset:16896
    ds_read_b64_tr_b16 v[176:177], v7 offset:15392
    ds_read_b64_tr_b16 v[178:179], v7 offset:16928
    ds_read_b64_tr_b16 v[180:181], v7 offset:15424
    ds_read_b64_tr_b16 v[182:183], v7 offset:16960
    s_waitcnt vmcnt(3)
    ds_read_b64_tr_b16 v[184:185], v7 offset:18432
    ds_read_b64_tr_b16 v[186:187], v7 offset:19968
    ds_read_b64_tr_b16 v[188:189], v7 offset:18464
    ds_read_b64_tr_b16 v[190:191], v7 offset:20000
    ds_read_b64_tr_b16 v[192:193], v7 offset:18496
    ds_read_b64_tr_b16 v[194:195], v7 offset:20032
    s_waitcnt vmcnt(0)
    ds_read_b64_tr_b16 v[196:197], v7 offset:21504
    ds_read_b64_tr_b16 v[198:199], v7 offset:23040
    ds_read_b64_tr_b16 v[200:201], v7 offset:21536
    ds_read_b64_tr_b16 v[202:203], v7 offset:23072
    ds_read_b64_tr_b16 v[204:205], v7 offset:21568
    ds_read_b64_tr_b16 v[206:207], v7 offset:23104
    s_waitcnt lgkmcnt(0)
    s_barrier
    v_lshlrev_b32 v1, 4, v0
    s_mov_b32 s96, 0
    s_cmp_lg_u32 s65, 0
    s_cbranch_scc1 Lwt_128
    v_mov_b32 v3, 140
    s_mov_b32 s81, 0
Lwp_129:
    buffer_load_dword v2, v3, s[56:59], 0 offen sc1
    s_waitcnt vmcnt(0)
    v_readfirstlane_b32 s68, v2
    s_cmp_ge_u32 s68, 168
    s_cbranch_scc1 Lwt_128
    s_sleep 16
    s_add_u32 s81, s81, 1
    s_cmp_lt_u32 s81, 0x20000
    s_cbranch_scc1 Lwp_129
    s_branch L_fail
Lwt_128:
    s_barrier
    s_cmp_lg_u32 s65, 0
    s_cbranch_scc1 Lwt_130
    v_mov_b32 v3, 128
    s_mov_b32 s81, 0
Lwp_131:
    buffer_load_dword v2, v3, s[56:59], 0 offen sc1
    s_waitcnt vmcnt(0)
    v_readfirstlane_b32 s68, v2
    s_cmp_ge_u32 s68, 32
    s_cbranch_scc1 Lwt_130
    s_sleep 16
    s_add_u32 s81, s81, 1
    s_cmp_lt_u32 s81, 0x20000
    s_cbranch_scc1 Lwp_131
    s_branch L_fail
Lwt_130:
    s_barrier
    s_mov_b32 s98, s88
L_g5:
    s_lshl_b32 s99, s98, 7
    s_add_u32 s99, s99, 0x7420000
    s_cmp_lg_u32 s65, 0
    s_cbranch_scc1 Lwt_132
    v_mov_b32 v3, s99
    s_mov_b32 s81, 0
Lwp_133:
    buffer_load_dword v2, v3, s[60:63], 0 offen sc1
    s_waitcnt vmcnt(0)
    v_readfirstlane_b32 s68, v2
    s_cmp_ge_u32 s68, 8
    s_cbranch_scc1 Lwt_132
    s_sleep 4
    s_add_u32 s81, s81, 1
    s_cmp_lt_u32 s81, 0x20000
    s_cbranch_scc1 Lwp_133
    s_branch L_fail
Lwt_132:
    s_barrier
    s_lshl_b32 s94, s98, 1
    s_add_u32 s94, s94, s97
    s_mul_i32 s95, s94, 131072
    s_mul_i32 s68, s65, 32768
    s_add_u32 s95, s95, s68
    s_add_u32 s95, s95, 0x4400000
    v_and_b32 v2, 15, v0
    v_lshlrev_b32 v2, 2, v2
    s_lshl_b32 s68, s94, 6
    s_add_u32 s68, s68, 0x7400000
    buffer_load_dword v8, v2, s[60:63], s68 offen sc1
    s_min_u32 s69, s65, 2
    s_mul_i32 s70, s93, 3
    s_add_u32 s70, s70, s69
    s_mul_i32 s71, s94, 36
    s_add_u32 s71, s71, s70
    s_lshl_b32 s71, s71, 9
    s_add_u32 s71, s71, 0x6000000
    v_lshlrev_b32 v9, 3, v0
    buffer_load_dwordx2 v[10:11], v9, s[60:63], s71 offen sc1
    buffer_load_dwordx4 v[16:19], v1, s[60:63], s95 offen offset:0 sc1
    buffer_load_dwordx4 v[20:23], v1, s[60:63], s95 offen offset:1024 sc1
    buffer_load_dwordx4 v[24:27], v1, s[60:63], s95 offen offset:2048 sc1
    buffer_load_dwordx4 v[28:31], v1, s[60:63], s95 offen offset:3072 sc1
    s_add_u32 s95, s95, 4096
    buffer_load_dwordx4 v[32:35], v1, s[60:63], s95 offen offset:0 sc1
    buffer_load_dwordx4 v[36:39], v1, s[60:63], s95 offen offset:1024 sc1
    buffer_load_dwordx4 v[40:43], v1, s[60:63], s95 offen offset:2048 sc1
    buffer_load_dwordx4 v[44:47], v1, s[60:63], s95 offen offset:3072 sc1
    s_add_u32 s95, s95, 4096
    buffer_load_dwordx4 v[48:51], v1, s[60:63], s95 offen offset:0 sc1
    buffer_load_dwordx4 v[52:55], v1, s[60:63], s95 offen offset:1024 sc1
    buffer_load_dwordx4 v[56:59], v1, s[60:63], s95 offen offset:2048 sc1
    buffer_load_dwordx4 v[60:63], v1, s[60:63], s95 offen offset:3072 sc1
    s_waitcnt vmcnt(11)
    v_mfma_f32_16x16x32_bf16 v[64:67], a[0:3], v[16:19], 0
    v_mfma_f32_16x16x32_bf16 v[68:71], a[4:7], v[16:19], 0
    v_mfma_f32_16x16x32_bf16 v[72:75], a[8:11], v[16:19], 0
    s_add_u32 s95, s95, 4096
    buffer_load_dwordx4 v[16:19], v1, s[60:63], s95 offen offset:0 sc1
    s_waitcnt vmcnt(11)
    v_mfma_f32_16x16x32_bf16 v[64:67], a[12:15], v[20:23], v[64:67]
    v_mfma_f32_16x16x32_bf16 v[68:71], a[16:19], v[20:23], v[68:71]
    v_mfma_f32_16x16x32_bf16 v[72:75], a[20:23], v[20:23], v[72:75]
    buffer_load_dwordx4 v[20:23], v1, s[60:63], s95 offen offset:1024 sc1
    s_waitcnt vmcnt(11)
    v_mfma_f32_16x16x32_bf16 v[64:67], a[24:27], v[24:27], v[64:67]
    v_mfma_f32_16x16x32_bf16 v[68:71], a[28:31], v[24:27], v[68:71]
    v_mfma_f32_16x16x32_bf16 v[72:75], a[32:35], v[24:27], v[72:75]
    buffer_load_dwordx4 v[24:27], v1, s[60:63], s95 offen offset:2048 sc1
    s_waitcnt vmcnt(11)
    v_mfma_f32_16x16x32_bf16 v[64:67], a[36:39], v[28:31], v[64:67]
    v_mfma_f32_16x16x32_bf16 v[68:71], a[40:43], v[28:31], v[68:71]
    v_mfma_f32_16x16x32_bf16 v[72:75], a[44:47], v[28:31], v[72:75]
    buffer_load_dwordx4 v[28:31], v1, s[60:63], s95 offen offset:3072 sc1
    s_waitcnt vmcnt(11)
    v_mfma_f32_16x16x32_bf16 v[64:67], a[48:51], v[32:35], v[64:67]
    v_mfma_f32_16x16x32_bf16 v[68:71], a[52:55], v[32:35], v[68:71]
    v_mfma_f32_16x16x32_bf16 v[72:75], a[56:59], v[32:35], v[72:75]
    s_add_u32 s95, s95, 4096
    buffer_load_dwordx4 v[32:35], v1, s[60:63], s95 offen offset:0 sc1
    s_waitcnt vmcnt(11)
    v_mfma_f32_16x16x32_bf16 v[64:67], a[60:63], v[36:39], v[64:67]
    v_mfma_f32_16x16x32_bf16 v[68:71], a[64:67], v[36:39], v[68:71]
    v_mfma_f32_16x16x32_bf16 v[72:75], a[68:71], v[36:39], v[72:75]
    buffer_load_dwordx4 v[36:39], v1, s[60:63], s95 offen offset:1024 sc1
    s_waitcnt vmcnt(11)
    v_mfma_f32_16x16x32_bf16 v[64:67], a[72:75], v[40:43], v[64:67]
    v_mfma_f32_16x16x32_bf16 v[68:71], a[76:79], v[40:43], v[68:71]
    v_mfma_f32_16x16x32_bf16 v[72:75], a[80:83], v[40:43], v[72:75]
    buffer_load_dwordx4 v[40:43], v1, s[60:63], s95 offen offset:2048 sc1
    s_waitcnt vmcnt(11)
    v_mfma_f32_16x16x32_bf16 v[64:67], a[84:87], v[44:47], v[64:67]
    v_mfma_f32_16x16x32_bf16 v[68:71], a[88:91], v[44:47], v[68:71]
    v_mfma_f32_16x16x32_bf16 v[72:75], a[92:95], v[44:47], v[72:75]
    buffer_load_dwordx4 v[44:47], v1, s[60:63], s95 offen offset:3072 sc1
    s_waitcnt vmcnt(11)
    v_mfma_f32_16x16x32_bf16 v[64:67], a[96:99], v[48:51], v[64:67]
    v_mfma_f32_16x16x32_bf16 v[68:71], a[100:103], v[48:51], v[68:71]
    v_mfma_f32_16x16x32_bf16 v[72:75], a[104:107], v[48:51], v[72:75]
    s_add_u32 s95, s95, 4096
    buffer_load_dwordx4 v[48:51], v1, s[60:63], s95 offen offset:0 sc1
    s_waitcnt vmcnt(11)
    v_mfma_f32_16x16x32_bf16 v[64:67], a[108:111], v[52:55], v[64:67]
    v_mfma_f32_16x16x32_bf16 v[68:71], a[112:115], v[52:55], v[68:71]
    v_mfma_f32_16x16x32_bf16 v[72:75], a[116:119], v[52:55], v[72:75]
    buffer_load_dwordx4 v[52:55], v1, s[60:63], s95 offen offset:1024 sc1
    s_waitcnt vmcnt(11)
    v_mfma_f32_16x16x32_bf16 v[64:67], a[120:123], v[56:59], v[64:67]
    v_mfma_f32_16x16x32_bf16 v[68:71], a[124:127], v[56:59], v[68:71]
    v_mfma_f32_16x16x32_bf16 v[72:75], a[128:131], v[56:59], v[72:75]
    buffer_load_dwordx4 v[56:59], v1, s[60:63], s95 offen offset:2048 sc1
    s_waitcnt vmcnt(11)
    v_mfma_f32_16x16x32_bf16 v[64:67], a[132:135], v[60:63], v[64:67]
    v_mfma_f32_16x16x32_bf16 v[68:71], a[136:139], v[60:63], v[68:71]
    v_mfma_f32_16x16x32_bf16 v[72:75], a[140:143], v[60:63], v[72:75]
    buffer_load_dwordx4 v[60:63], v1, s[60:63], s95 offen offset:3072 sc1
    s_waitcnt vmcnt(11)
    v_mfma_f32_16x16x32_bf16 v[64:67], a[144:147], v[16:19], v[64:67]
    v_mfma_f32_16x16x32_bf16 v[68:71], a[148:151], v[16:19], v[68:71]
    v_mfma_f32_16x16x32_bf16 v[72:75], a[152:155], v[16:19], v[72:75]
    s_add_u32 s95, s95, 4096
    buffer_load_dwordx4 v[16:19], v1, s[60:63], s95 offen offset:0 sc1
    s_waitcnt vmcnt(11)
    v_mfma_f32_16x16x32_bf16 v[64:67], a[156:159], v[20:23], v[64:67]
    v_mfma_f32_16x16x32_bf16 v[68:71], a[160:163], v[20:23], v[68:71]
    v_mfma_f32_16x16x32_bf16 v[72:75], a[164:167], v[20:23], v[72:75]
    buffer_load_dwordx4 v[20:23], v1, s[60:63], s95 offen offset:1024 sc1
    s_waitcnt vmcnt(11)
    v_mfma_f32_16x16x32_bf16 v[64:67], a[168:171], v[24:27], v[64:67]
    v_mfma_f32_16x16x32_bf16 v[68:71], a[172:175], v[24:27], v[68:71]
    v_mfma_f32_16x16x32_bf16 v[72:75], a[176:179], v[24:27], v[72:75]
    buffer_load_dwordx4 v[24:27], v1, s[60:63], s95 offen offset:2048 sc1
    s_waitcnt vmcnt(11)
    v_mfma_f32_16x16x32_bf16 v[64:67], a[180:183], v[28:31], v[64:67]
    v_mfma_f32_16x16x32_bf16 v[68:71], a[184:187], v[28:31], v[68:71]
    v_mfma_f32_16x16x32_bf16 v[72:75], a[188:191], v[28:31], v[72:75]
    buffer_load_dwordx4 v[28:31], v1, s[60:63], s95 offen offset:3072 sc1
    s_waitcnt vmcnt(11)
    v_mfma_f32_16x16x32_bf16 v[64:67], a[192:195], v[32:35], v[64:67]
    v_mfma_f32_16x16x32_bf16 v[68:71], a[196:199], v[32:35], v[68:71]
    v_mfma_f32_16x16x32_bf16 v[72:75], a[200:203], v[32:35], v[72:75]
    s_add_u32 s95, s95, 4096
    buffer_load_dwordx4 v[32:35], v1, s[60:63], s95 offen offset:0 sc1
    s_waitcnt vmcnt(11)
    v_mfma_f32_16x16x32_bf16 v[64:67], a[204:207], v[36:39], v[64:67]
    v_mfma_f32_16x16x32_bf16 v[68:71], a[208:211], v[36:39], v[68:71]
    v_mfma_f32_16x16x32_bf16 v[72:75], a[212:215], v[36:39], v[72:75]
    buffer_load_dwordx4 v[36:39], v1, s[60:63], s95 offen offset:1024 sc1
    s_waitcnt vmcnt(11)
    v_mfma_f32_16x16x32_bf16 v[64:67], a[216:219], v[40:43], v[64:67]
    v_mfma_f32_16x16x32_bf16 v[68:71], a[220:223], v[40:43], v[68:71]
    v_mfma_f32_16x16x32_bf16 v[72:75], a[224:227], v[40:43], v[72:75]
    buffer_load_dwordx4 v[40:43], v1, s[60:63], s95 offen offset:2048 sc1
    s_waitcnt vmcnt(11)
    v_mfma_f32_16x16x32_bf16 v[64:67], a[228:231], v[44:47], v[64:67]
    v_mfma_f32_16x16x32_bf16 v[68:71], a[232:235], v[44:47], v[68:71]
    v_mfma_f32_16x16x32_bf16 v[72:75], a[236:239], v[44:47], v[72:75]
    buffer_load_dwordx4 v[44:47], v1, s[60:63], s95 offen offset:3072 sc1
    s_waitcnt vmcnt(11)
    v_mfma_f32_16x16x32_bf16 v[64:67], a[240:243], v[48:51], v[64:67]
    v_mfma_f32_16x16x32_bf16 v[68:71], a[244:247], v[48:51], v[68:71]
    v_mfma_f32_16x16x32_bf16 v[72:75], a[248:251], v[48:51], v[72:75]
    s_waitcnt vmcnt(10)
    v_mfma_f32_16x16x32_bf16 v[64:67], a[252:255], v[52:55], v[64:67]
    v_mfma_f32_16x16x32_bf16 v[68:71], v[80:83], v[52:55], v[68:71]
    v_mfma_f32_16x16x32_bf16 v[72:75], v[84:87], v[52:55], v[72:75]
    s_waitcnt vmcnt(9)
    v_mfma_f32_16x16x32_bf16 v[64:67], v[88:91], v[56:59], v[64:67]
    v_mfma_f32_16x16x32_bf16 v[68:71], v[92:95], v[56:59], v[68:71]
    v_mfma_f32_16x16x32_bf16 v[72:75], v[96:99], v[56:59], v[72:75]
    s_waitcnt vmcnt(8)
    v_mfma_f32_16x16x32_bf16 v[64:67], v[100:103], v[60:63], v[64:67]
    v_mfma_f32_16x16x32_bf16 v[68:71], v[104:107], v[60:63], v[68:71]
    v_mfma_f32_16x16x32_bf16 v[72:75], v[108:111], v[60:63], v[72:75]
    s_waitcnt vmcnt(7)
    v_mfma_f32_16x16x32_bf16 v[64:67], v[112:115], v[16:19], v[64:67]
    v_mfma_f32_16x16x32_bf16 v[68:71], v[116:119], v[16:19], v[68:71]
    v_mfma_f32_16x16x32_bf16 v[72:75], v[120:123], v[16:19], v[72:75]
    s_waitcnt vmcnt(6)
    v_mfma_f32_16x16x32_bf16 v[64:67], v[124:127], v[20:23], v[64:67]
    v_mfma_f32_16x16x32_bf16 v[68:71], v[128:131], v[20:23], v[68:71]
    v_mfma_f32_16x16x32_bf16 v[72:75], v[132:135], v[20:23], v[72:75]
    s_waitcnt vmcnt(5)
    v_mfma_f32_16x16x32_bf16 v[64:67], v[136:139], v[24:27], v[64:67]
    v_mfma_f32_16x16x32_bf16 v[68:71], v[140:143], v[24:27], v[68:71]
    v_mfma_f32_16x16x32_bf16 v[72:75], v[144:147], v[24:27], v[72:75]
    s_waitcnt vmcnt(4)
    v_mfma_f32_16x16x32_bf16 v[64:67], v[148:151], v[28:31], v[64:67]
    v_mfma_f32_16x16x32_bf16 v[68:71], v[152:155], v[28:31], v[68:71]
    v_mfma_f32_16x16x32_bf16 v[72:75], v[156:159], v[28:31], v[72:75]
    s_waitcnt vmcnt(3)
    v_mfma_f32_16x16x32_bf16 v[64:67], v[160:163], v[32:35], v[64:67]
    v_mfma_f32_16x16x32_bf16 v[68:71], v[164:167], v[32:35], v[68:71]
    v_mfma_f32_16x16x32_bf16 v[72:75], v[168:171], v[32:35], v[72:75]
    s_waitcnt vmcnt(2)
    v_mfma_f32_16x16x32_bf16 v[64:67], v[172:175], v[36:39], v[64:67]
    v_mfma_f32_16x16x32_bf16 v[68:71], v[176:179], v[36:39], v[68:71]
    v_mfma_f32_16x16x32_bf16 v[72:75], v[180:183], v[36:39], v[72:75]
    s_waitcnt vmcnt(1)
    v_mfma_f32_16x16x32_bf16 v[64:67], v[184:187], v[40:43], v[64:67]
    v_mfma_f32_16x16x32_bf16 v[68:71], v[188:191], v[40:43], v[68:71]
    v_mfma_f32_16x16x32_bf16 v[72:75], v[192:195], v[40:43], v[72:75]
    s_waitcnt vmcnt(0)
    v_mfma_f32_16x16x32_bf16 v[64:67], v[196:199], v[44:47], v[64:67]
    v_mfma_f32_16x16x32_bf16 v[68:71], v[200:203], v[44:47], v[68:71]
    v_mfma_f32_16x16x32_bf16 v[72:75], v[204:207], v[44:47], v[72:75]
    s_mul_i32 s68, s65, 3072
    s_add_u32 s68, s68, s96
    v_add_u32 v2, s68, v1
    ds_write_b128 v2, v[64:67] offset:0
    ds_write_b128 v2, v[68:71] offset:1024
    s_nop 2
    ds_write_b128 v2, v[72:75] offset:2048
    s_lshl_b32 s68, s69, 10
    s_add_u32 s68, s68, s96
    v_add_u32 v2, s68, v1
    s_xor_b32 s96, s96, 0x4000
    s_waitcnt lgkmcnt(0)
    s_barrier
    s_cmp_eq_u32 s65, 3
    s_cbranch_scc1 Lwsk_134
    ds_read_b128 v[16:19], v2 offset:0
    ds_read_b128 v[20:23], v2 offset:3072
    ds_read_b128 v[24:27], v2 offset:6144
    ds_read_b128 v[28:31], v2 offset:9216
    s_waitcnt lgkmcnt(0)
    v_add_f32 v16, v16, v20
    v_add_f32 v24, v24, v28
    v_add_f32 v17, v17, v21
    v_add_f32 v25, v25, v29
    v_add_f32 v18, v18, v22
    v_add_f32 v26, v26, v30
    v_add_f32 v19, v19, v23
    v_add_f32 v27, v27, v31
    v_add_f32 v16, v16, v24
    v_add_f32 v17, v17, v25
    v_add_f32 v18, v18, v26
    v_add_f32 v19, v19, v27
    v_lshlrev_b32 v20, 16, v10
    v_and_b32 v21, 0xffff0000, v10
    v_lshlrev_b32 v22, 16, v11
    v_and_b32 v23, 0xffff0000, v11
    v_cvt_pk_bf16_f32 v12, v16, v17
    v_cvt_pk_bf16_f32 v13, v18, v19
    v_lshlrev_b32 v16, 16, v12
    v_and_b32 v17, 0xffff0000, v12
    v_lshlrev_b32 v18, 16, v13
    v_and_b32 v19, 0xffff0000, v13
    v_mul_f32 v16, v8, v16
    v_mul_f32 v17, v8, v17
    v_mul_f32 v18, v8, v18
    v_mul_f32 v19, v8, v19
    v_cvt_pk_bf16_f32 v12, v16, v17
    v_cvt_pk_bf16_f32 v13, v18, v19
    v_lshlrev_b32 v16, 16, v12
    v_and_b32 v17, 0xffff0000, v12
    v_lshlrev_b32 v18, 16, v13
    v_and_b32 v19, 0xffff0000, v13
    v_add_f32 v16, v16, v20
    v_add_f32 v17, v17, v21
    v_add_f32 v18, v18, v22
    v_add_f32 v19, v19, v23
    v_cvt_pk_bf16_f32 v12, v16, v17
    v_cvt_pk_bf16_f32 v13, v18, v19
    v_and_b32 v2, 15, v0
    v_mul_u32_u24 v2, 1152, v2
    v_lshrrev_b32 v3, 4, v0
    v_lshl_add_u32 v2, v3, 3, v2
    s_mul_i32 s68, s94, 18432
    s_lshl_b32 s70, s70, 5
    s_add_u32 s68, s68, s70
    buffer_store_dwordx2 v[12:13], v2, s[52:55], s68 offen
Lwsk_134:
    s_add_u32 s98, s98, 7
    s_cmp_lt_u32 s98, 64
    s_cbranch_scc1 L_g5
    s_branch L_done
L_att:
    v_lshlrev_b32 v1, 4, v0
    v_lshlrev_b32 v4, 3, v0
    v_and_b32 v2, 15, v0
    v_lshrrev_b32 v3, 4, v0
    s_lshl_b32 s68, s65, 11
    v_lshlrev_b32 v5, 4, v2
    v_lshl_add_u32 v5, v3, 2, v5
    v_add_u32 v5, s68, v5
    v_lshrrev_b32 v6, 2, v2
    v_lshl_add_u32 v6, v3, 2, v6
    v_lshlrev_b32 v6, 4, v6
    v_bfe_u32 v7, v0, 1, 1
    v_lshl_add_u32 v6, v7, 3, v6
    v_add_u32 v6, s68, v6
    v_lshlrev_b32 v7, 2, v3
    v_sub_u32 v7, v2, v7
    s_mov_b32 s96, 0xffff0000
    s_mov_b32 s97, 0xffff0000
    s_mov_b32 s84, 0x3db504f3
    s_mov_b32 s85, 0x3fb8aa3b
    v_mov_b32 v8, 0xce6e6b28
    s_cmp_lg_u32 s65, 0
    s_cbranch_scc1 Lwt_135
    v_mov_b32 v3, 136
    s_mov_b32 s81, 0
Lwp_136:
    buffer_load_dword v2, v3, s[56:59], 0 offen sc1
    s_waitcnt vmcnt(0)
    v_readfirstlane_b32 s68, v2
    s_cmp_ge_u32 s68, 224
    s_cbranch_scc1 Lwt_135
    s_sleep 16
    s_add_u32 s81, s81, 1
    s_cmp_lt_u32 s81, 0x20000
    s_cbranch_scc1 Lwp_136
    s_branch L_fail
Lwt_135:
    s_barrier
    s_cmp_lg_u32 s65, 0
    s_cbranch_scc1 Lwt_137
    v_mov_b32 v3, 128
    s_mov_b32 s81, 0
Lwp_138:
    buffer_load_dword v2, v3, s[56:59], 0 offen sc1
    s_waitcnt vmcnt(0)
    v_readfirstlane_b32 s68, v2
    s_cmp_ge_u32 s68, 32
    s_cbranch_scc1 Lwt_137
    s_sleep 16
    s_add_u32 s81, s81, 1
    s_cmp_lt_u32 s81, 0x20000
    s_cbranch_scc1 Lwp_138
    s_branch L_fail
Lwt_137:
    s_barrier
    s_lshl_b32 s94, s89, 2
    s_add_u32 s94, s94, s65
    s_mov_b32 s93, s88
    s_lshl_b32 s101, s94, 7
    s_add_u32 s101, s101, 0x7410000
L_att_loop:
    s_add_u32 s98, s93, 1
    s_lshl_b32 s68, s93, 5
    s_add_u32 s86, s68, s94
    s_lshl_b32 s68, s86, 14
    s_add_u32 s69, s68, 0x0
    s_add_u32 s70, s69, 4096
    buffer_load_dwordx4 v[48:51], v1, s[60:63], s69 offen offset:0 sc1
    buffer_load_dwordx4 v[52:55], v1, s[60:63], s69 offen offset:1024 sc1
    buffer_load_dwordx4 v[56:59], v1, s[60:63], s69 offen offset:2048 sc1
    buffer_load_dwordx4 v[60:63], v1, s[60:63], s69 offen offset:3072 sc1
    buffer_load_dwordx4 v[64:67], v1, s[60:63], s70 offen offset:0 sc1
    buffer_load_dwordx4 v[68:71], v1, s[60:63], s70 offen offset:1024 sc1
    buffer_load_dwordx4 v[72:75], v1, s[60:63], s70 offen offset:2048 sc1
    buffer_load_dwordx4 v[76:79], v1, s[60:63], s70 offen offset:3072 sc1
    s_lshl_b32 s68, s86, 13
    s_add_u32 s69, s68, 0x2000000
    s_add_u32 s70, s69, 4096
    buffer_load_dwordx4 v[16:19], v1, s[60:63], s69 offen offset:0 sc1
    buffer_load_dwordx4 v[20:23], v1, s[60:63], s69 offen offset:1024 sc1
    buffer_load_dwordx4 v[24:27], v1, s[60:63], s69 offen offset:2048 sc1
    buffer_load_dwordx4 v[28:31], v1, s[60:63], s69 offen offset:3072 sc1
    buffer_load_dwordx4 v[32:35], v1, s[60:63], s70 offen offset:0 sc1
    buffer_load_dwordx4 v[36:39], v1, s[60:63], s70 offen offset:1024 sc1
    buffer_load_dwordx4 v[40:43], v1, s[60:63], s70 offen offset:2048 sc1
    buffer_load_dwordx4 v[44:47], v1, s[60:63], s70 offen offset:3072 sc1
    s_lshl_b32 s68, s86, 14
    s_add_u32 s69, s68, 0x2000
    s_add_u32 s70, s69, 4096
    buffer_load_dwordx4 v[80:83], v1, s[60:63], s69 offen offset:0 sc1
    buffer_load_dwordx4 v[84:87], v1, s[60:63], s69 offen offset:1024 sc1
    buffer_load_dwordx4 v[88:91], v1, s[60:63], s69 offen offset:2048 sc1
    buffer_load_dwordx4 v[92:95], v1, s[60:63], s69 offen offset:3072 sc1
    buffer_load_dwordx4 v[96:99], v1, s[60:63], s70 offen offset:0 sc1
    buffer_load_dwordx4 v[100:103], v1, s[60:63], s70 offen offset:1024 sc1
    buffer_load_dwordx4 v[104:107], v1, s[60:63], s70 offen offset:2048 sc1
    buffer_load_dwordx4 v[108:111], v1, s[60:63], s70 offen offset:3072 sc1
    s_waitcnt vmcnt(8)
    v_mfma_f32_16x16x32_bf16 v[144:147], v[48:51], v[16:19], 0
    v_mfma_f32_16x16x32_bf16 v[148:151], v[64:67], v[16:19], 0
    v_mfma_f32_16x16x32_bf16 v[152:155], v[48:51], v[32:35], 0
    v_mfma_f32_16x16x32_bf16 v[156:159], v[64:67], v[32:35], 0
    v_mfma_f32_16x16x32_bf16 v[144:147], v[52:55], v[20:23], v[144:147]
    v_mfma_f32_16x16x32_bf16 v[148:151], v[68:71], v[20:23], v[148:151]
    v_mfma_f32_16x16x32_bf16 v[152:155], v[52:55], v[36:39], v[152:155]
    v_mfma_f32_16x16x32_bf16 v[156:159], v[68:71], v[36:39], v[156:159]
    v_mfma_f32_16x16x32_bf16 v[144:147], v[56:59], v[24:27], v[144:147]
    v_mfma_f32_16x16x32_bf16 v[148:151], v[72:75], v[24:27], v[148:151]
    v_mfma_f32_16x16x32_bf16 v[152:155], v[56:59], v[40:43], v[152:155]
    v_mfma_f32_16x16x32_bf16 v[156:159], v[72:75], v[40:43], v[156:159]
    v_mfma_f32_16x16x32_bf16 v[144:147], v[60:63], v[28:31], v[144:147]
    v_mfma_f32_16x16x32_bf16 v[148:151], v[76:79], v[28:31], v[148:151]
    v_mfma_f32_16x16x32_bf16 v[152:155], v[60:63], v[44:47], v[152:155]
    v_mfma_f32_16x16x32_bf16 v[156:159], v[76:79], v[44:47], v[156:159]
    v_cvt_pk_bf16_f32 v200, v144, v145
    v_lshlrev_b32 v144, 16, v200
    v_and_b32 v145, 0xffff0000, v200
    v_mul_f32 v144, s84, v144
    v_mul_f32 v145, s84, v145
    v_cvt_pk_bf16_f32 v200, v144, v145
    v_lshlrev_b32 v144, 16, v200
    v_and_b32 v145, 0xffff0000, v200
    v_cvt_pk_bf16_f32 v200, v146, v147
    v_lshlrev_b32 v146, 16, v200
    v_and_b32 v147, 0xffff0000, v200
    v_mul_f32 v146, s84, v146
    v_mul_f32 v147, s84, v147
    v_cvt_pk_bf16_f32 v200, v146, v147
    v_lshlrev_b32 v146, 16, v200
    v_and_b32 v147, 0xffff0000, v200
    v_cvt_pk_bf16_f32 v200, v148, v149
    v_lshlrev_b32 v148, 16, v200
    v_and_b32 v149, 0xffff0000, v200
    v_mul_f32 v148, s84, v148
    v_mul_f32 v149, s84, v149
    v_cvt_pk_bf16_f32 v200, v148, v149
    v_lshlrev_b32 v148, 16, v200
    v_and_b32 v149, 0xffff0000, v200
    v_cvt_pk_bf16_f32 v200, v150, v151
    v_lshlrev_b32 v150, 16, v200
    v_and_b32 v151, 0xffff0000, v200
    v_mul_f32 v150, s84, v150
    v_mul_f32 v151, s84, v151
    v_cvt_pk_bf16_f32 v200, v150, v151
    v_lshlrev_b32 v150, 16, v200
    v_and_b32 v151, 0xffff0000, v200
    v_cvt_pk_bf16_f32 v200, v152, v153
    v_lshlrev_b32 v152, 16, v200
    v_and_b32 v153, 0xffff0000, v200
    v_mul_f32 v152, s84, v152
    v_mul_f32 v153, s84, v153
    v_cvt_pk_bf16_f32 v200, v152, v153
    v_lshlrev_b32 v152, 16, v200
    v_and_b32 v153, 0xffff0000, v200
    v_cvt_pk_bf16_f32 v200, v154, v155
    v_lshlrev_b32 v154, 16, v200
    v_and_b32 v155, 0xffff0000, v200
    v_mul_f32 v154, s84, v154
    v_mul_f32 v155, s84, v155
    v_cvt_pk_bf16_f32 v200, v154, v155
    v_lshlrev_b32 v154, 16, v200
    v_and_b32 v155, 0xffff0000, v200
    v_cvt_pk_bf16_f32 v200, v156, v157
    v_lshlrev_b32 v156, 16, v200
    v_and_b32 v157, 0xffff0000, v200
    v_mul_f32 v156, s84, v156
    v_mul_f32 v157, s84, v157
    v_cvt_pk_bf16_f32 v200, v156, v157
    v_lshlrev_b32 v156, 16, v200
    v_and_b32 v157, 0xffff0000, v200
    v_cvt_pk_bf16_f32 v200, v158, v159
    v_lshlrev_b32 v158, 16, v200
    v_and_b32 v159, 0xffff0000, v200
    v_mul_f32 v158, s84, v158
    v_mul_f32 v159, s84, v159
    v_cvt_pk_bf16_f32 v200, v158, v159
    v_lshlrev_b32 v158, 16, v200
    v_and_b32 v159, 0xffff0000, v200
    v_cmp_le_i32 vcc, 0, v7
    s_nop 1
    v_cndmask_b32 v144, v8, v144, vcc
    v_cmp_le_i32 vcc, 1, v7
    s_nop 1
    v_cndmask_b32 v145, v8, v145, vcc
    v_cmp_le_i32 vcc, 2, v7
    s_nop 1
    v_cndmask_b32 v146, v8, v146, vcc
    v_cmp_le_i32 vcc, 3, v7
    s_nop 1
    v_cndmask_b32 v147, v8, v147, vcc
    v_cmp_le_i32 vcc, 16, v7
    s_nop 1
    v_cndmask_b32 v148, v8, v148, vcc
    v_cmp_le_i32 vcc, 17, v7
    s_nop 1
    v_cndmask_b32 v149, v8, v149, vcc
    v_cmp_le_i32 vcc, 18, v7
    s_nop 1
    v_cndmask_b32 v150, v8, v150, vcc
    v_cmp_le_i32 vcc, 19, v7
    s_nop 1
    v_cndmask_b32 v151, v8, v151, vcc
    v_cmp_le_i32 vcc, -16, v7
    s_nop 1
    v_cndmask_b32 v152, v8, v152, vcc
    v_cmp_le_i32 vcc, -15, v7
    s_nop 1
    v_cndmask_b32 v153, v8, v153, vcc
    v_cmp_le_i32 vcc, -14, v7
    s_nop 1
    v_cndmask_b32 v154, v8, v154, vcc
    v_cmp_le_i32 vcc, -13, v7
    s_nop 1
    v_cndmask_b32 v155, v8, v155, vcc
    v_cmp_le_i32 vcc, 0, v7
    s_nop 1
    v_cndmask_b32 v156, v8, v156, vcc
    v_cmp_le_i32 vcc, 1, v7
    s_nop 1
    v_cndmask_b32 v157, v8, v157, vcc
    v_cmp_le_i32 vcc, 2, v7
    s_nop 1
    v_cndmask_b32 v158, v8, v158, vcc
    v_cmp_le_i32 vcc, 3, v7
    s_nop 1
    v_cndmask_b32 v159, v8, v159, vcc
    v_mov_b32 v3, s101
    s_mov_b32 s81, 0
Lwp_140:
    buffer_load_dword v2, v3, s[60:63], 0 offen sc1
    s_waitcnt vmcnt(0)
    v_readfirstlane_b32 s68, v2
    s_cmp_ge_u32 s68, s98
    s_cbranch_scc1 Lwt_139
    s_sleep 4
    s_add_u32 s81, s81, 1
    s_cmp_lt_u32 s81, 0x20000
    s_cbranch_scc1 Lwp_140
    s_branch L_fail
Lwt_139:
    s_lshl_b32 s68, s86, 11
    s_add_u32 s69, s68, 0x6400000
    s_add_u32 s70, s68, 0x6c00000
    buffer_load_dwordx2 v[112:113], v4, s[60:63], s69 offen offset:0 sc1
    buffer_load_dwordx2 v[114:115], v4, s[60:63], s69 offen offset:512 sc1
    buffer_load_dwordx2 v[116:117], v4, s[60:63], s69 offen offset:1024 sc1
    buffer_load_dwordx2 v[118:119], v4, s[60:63], s69 offen offset:1536 sc1
    buffer_load_dwordx2 v[120:121], v4, s[60:63], s70 offen offset:0 sc1
    buffer_load_dwordx2 v[122:123], v4, s[60:63], s70 offen offset:512 sc1
    buffer_load_dwordx2 v[124:125], v4, s[60:63], s70 offen offset:1024 sc1
    buffer_load_dwordx2 v[126:127], v4, s[60:63], s70 offen offset:1536 sc1
    s_waitcnt vmcnt(4)
    ds_write2_b32 v5, v112, v113 offset0:0 offset1:64
    ds_write2_b32 v5, v114, v115 offset0:128 offset1:192
    v_add_u32 v9, 1024, v5
    ds_write2_b32 v9, v116, v117 offset0:0 offset1:64
    ds_write2_b32 v9, v118, v119 offset0:128 offset1:192
    s_waitcnt lgkmcnt(0)
    ds_read_b64_tr_b16 v[128:129], v6 offset:0
    ds_read_b64_tr_b16 v[130:131], v6 offset:256
    ds_read_b64_tr_b16 v[132:133], v6 offset:512
    ds_read_b64_tr_b16 v[134:135], v6 offset:768
    ds_read_b64_tr_b16 v[136:137], v6 offset:1024
    ds_read_b64_tr_b16 v[138:139], v6 offset:1280
    ds_read_b64_tr_b16 v[140:141], v6 offset:1536
    ds_read_b64_tr_b16 v[142:143], v6 offset:1792
    s_waitcnt lgkmcnt(0)
    v_mfma_f32_16x16x32_bf16 v[160:163], v[128:131], v[16:19], 0
    v_mfma_f32_16x16x32_bf16 v[164:167], v[128:131], v[32:35], 0
    v_mfma_f32_16x16x32_bf16 v[160:163], v[132:135], v[20:23], v[160:163]
    v_mfma_f32_16x16x32_bf16 v[164:167], v[132:135], v[36:39], v[164:167]
    v_mfma_f32_16x16x32_bf16 v[160:163], v[136:139], v[24:27], v[160:163]
    v_mfma_f32_16x16x32_bf16 v[164:167], v[136:139], v[40:43], v[164:167]
    v_mfma_f32_16x16x32_bf16 v[160:163], v[140:143], v[28:31], v[160:163]
    v_mfma_f32_16x16x32_bf16 v[164:167], v[140:143], v[44:47], v[164:167]
    s_nop 3
    v_cndmask_b32 v160, v160, v162, s[96:97]
    v_cndmask_b32 v161, v161, v163, s[96:97]
    v_cvt_pk_bf16_f32 v200, v160, v161
    v_lshlrev_b32 v160, 16, v200
    v_and_b32 v161, 0xffff0000, v200
    v_mul_f32 v160, s84, v160
    v_mul_f32 v161, s84, v161
    v_cvt_pk_bf16_f32 v200, v160, v161
    v_lshlrev_b32 v160, 16, v200
    v_and_b32 v161, 0xffff0000, v200
    v_cndmask_b32 v164, v164, v166, s[96:97]
    v_cndmask_b32 v165, v165, v167, s[96:97]
    v_cvt_pk_bf16_f32 v200, v164, v165
    v_lshlrev_b32 v164, 16, v200
    v_and_b32 v165, 0xffff0000, v200
    v_mul_f32 v164, s84, v164
    v_mul_f32 v165, s84, v165
    v_cvt_pk_bf16_f32 v200, v164, v165
    v_lshlrev_b32 v164, 16, v200
    v_and_b32 v165, 0xffff0000, v200
    v_max3_f32 v200, v144, v145, v146
    v_max3_f32 v200, v200, v147, v148
    v_max3_f32 v200, v200, v149, v150
    v_max3_f32 v200, v200, v151, v160
    v_max_f32 v200, v200, v161
    v_mov_b32 v201, v200
    s_nop 1
    v_permlane16_swap_b32 v200, v201
    v_max_f32 v200, v200, v201
    v_mov_b32 v201, v200
    s_nop 1
    v_permlane32_swap_b32 v200, v201
    v_max_f32 v200, v200, v201
    v_sub_f32 v144, v144, v200
    v_sub_f32 v145, v145, v200
    v_sub_f32 v146, v146, v200
    v_sub_f32 v147, v147, v200
    v_sub_f32 v148, v148, v200
    v_sub_f32 v149, v149, v200
    v_sub_f32 v150, v150, v200
    v_sub_f32 v151, v151, v200
    v_sub_f32 v160, v160, v200
    v_sub_f32 v161, v161, v200
    v_mul_f32 v144, s85, v144
    v_mul_f32 v145, s85, v145
    v_mul_f32 v146, s85, v146
    v_mul_f32 v147, s85, v147
    v_mul_f32 v148, s85, v148
    v_mul_f32 v149, s85, v149
    v_mul_f32 v150, s85, v150
    v_mul_f32 v151, s85, v151
    v_mul_f32 v160, s85, v160
    v_mul_f32 v161, s85, v161
    v_exp_f32 v144, v144
    v_exp_f32 v145, v145
    v_exp_f32 v146, v146
    v_exp_f32 v147, v147
    v_exp_f32 v148, v148
    v_exp_f32 v149, v149
    v_exp_f32 v150, v150
    v_exp_f32 v151, v151
    v_exp_f32 v160, v160
    v_exp_f32 v161, v161
    v_add_f32 v202, v144, v145
    v_add_f32 v202, v202, v146
    v_add_f32 v202, v202, v147
    v_add_f32 v202, v202, v148
    v_add_f32 v202, v202, v149
    v_add_f32 v202, v202, v150
    v_add_f32 v202, v202, v151
    v_add_f32 v202, v202, v160
    v_add_f32 v202, v202, v161
    v_mov_b32 v201, v202
    s_nop 1
    v_permlane16_swap_b32 v202, v201
    v_add_f32 v202, v202, v201
    v_mov_b32 v201, v202
    s_nop 1
    v_permlane32_swap_b32 v202, v201
    v_add_f32 v202, v202, v201
    v_rcp_f32 v202, v202
    s_nop 0
    v_mul_f32 v144, v144, v202
    v_mul_f32 v145, v145, v202
    v_mul_f32 v146, v146, v202
    v_mul_f32 v147, v147, v202
    v_mul_f32 v148, v148, v202
    v_mul_f32 v149, v149, v202
    v_mul_f32 v150, v150, v202
    v_mul_f32 v151, v151, v202
    v_mul_f32 v160, v160, v202
    v_mul_f32 v161, v161, v202
    v_cvt_pk_bf16_f32 v168, v144, v145
    v_cvt_pk_bf16_f32 v169, v146, v147
    v_cvt_pk_bf16_f32 v170, v148, v149
    v_cvt_pk_bf16_f32 v171, v150, v151
    v_cvt_pk_bf16_f32 v176, v160, v161
    v_mov_b32 v177, 0
    v_mov_b32 v178, 0
    v_mov_b32 v179, v176
    v_max3_f32 v204, v152, v153, v154
    v_max3_f32 v204, v204, v155, v156
    v_max3_f32 v204, v204, v157, v158
    v_max3_f32 v204, v204, v159, v164
    v_max_f32 v204, v204, v165
    v_mov_b32 v205, v204
    s_nop 1
    v_permlane16_swap_b32 v204, v205
    v_max_f32 v204, v204, v205
    v_mov_b32 v205, v204
    s_nop 1
    v_permlane32_swap_b32 v204, v205
    v_max_f32 v204, v204, v205
    v_sub_f32 v152, v152, v204
    v_sub_f32 v153, v153, v204
    v_sub_f32 v154, v154, v204
    v_sub_f32 v155, v155, v204
    v_sub_f32 v156, v156, v204
    v_sub_f32 v157, v157, v204
    v_sub_f32 v158, v158, v204
    v_sub_f32 v159, v159, v204
    v_sub_f32 v164, v164, v204
    v_sub_f32 v165, v165, v204
    v_mul_f32 v152, s85, v152
    v_mul_f32 v153, s85, v153
    v_mul_f32 v154, s85, v154
    v_mul_f32 v155, s85, v155
    v_mul_f32 v156, s85, v156
    v_mul_f32 v157, s85, v157
    v_mul_f32 v158, s85, v158
    v_mul_f32 v159, s85, v159
    v_mul_f32 v164, s85, v164
    v_mul_f32 v165, s85, v165
    v_exp_f32 v152, v152
    v_exp_f32 v153, v153
    v_exp_f32 v154, v154
    v_exp_f32 v155, v155
    v_exp_f32 v156, v156
    v_exp_f32 v157, v157
    v_exp_f32 v158, v158
    v_exp_f32 v159, v159
    v_exp_f32 v164, v164
    v_exp_f32 v165, v165
    v_add_f32 v206, v152, v153
    v_add_f32 v206, v206, v154
    v_add_f32 v206, v206, v155
    v_add_f32 v206, v206, v156
    v_add_f32 v206, v206, v157
    v_add_f32 v206, v206, v158
    v_add_f32 v206, v206, v159
    v_add_f32 v206, v206, v164
    v_add_f32 v206, v206, v165
    v_mov_b32 v205, v206
    s_nop 1
    v_permlane16_swap_b32 v206, v205
    v_add_f32 v206, v206, v205
    v_mov_b32 v205, v206
    s_nop 1
    v_permlane32_swap_b32 v206, v205
    v_add_f32 v206, v206, v205
    v_rcp_f32 v206, v206
    s_nop 0
    v_mul_f32 v152, v152, v206
    v_mul_f32 v153, v153, v206
    v_mul_f32 v154, v154, v206
    v_mul_f32 v155, v155, v206
    v_mul_f32 v156, v156, v206
    v_mul_f32 v157, v157, v206
    v_mul_f32 v158, v158, v206
    v_mul_f32 v159, v159, v206
    v_mul_f32 v164, v164, v206
    v_mul_f32 v165, v165, v206
    v_cvt_pk_bf16_f32 v172, v152, v153
    v_cvt_pk_bf16_f32 v173, v154, v155
    v_cvt_pk_bf16_f32 v174, v156, v157
    v_cvt_pk_bf16_f32 v175, v158, v159
    v_cvt_pk_bf16_f32 v180, v164, v165
    v_mov_b32 v181, 0
    v_mov_b32 v182, 0
    v_mov_b32 v183, v180
    s_waitcnt vmcnt(0)
    v_mfma_f32_16x16x32_bf16 v[16:19], v[80:83], v[168:171], 0
    v_mfma_f32_16x16x32_bf16 v[20:23], v[84:87], v[168:171], 0
    v_mfma_f32_16x16x32_bf16 v[24:27], v[88:91], v[168:171], 0
    v_mfma_f32_16x16x32_bf16 v[28:31], v[92:95], v[168:171], 0
    v_mfma_f32_16x16x32_bf16 v[32:35], v[96:99], v[168:171], 0
    v_mfma_f32_16x16x32_bf16 v[36:39], v[100:103], v[168:171], 0
    v_mfma_f32_16x16x32_bf16 v[40:43], v[104:107], v[168:171], 0
    v_mfma_f32_16x16x32_bf16 v[44:47], v[108:111], v[168:171], 0
    v_mfma_f32_16x16x32_bf16 v[48:51], v[80:83], v[172:175], 0
    v_mfma_f32_16x16x32_bf16 v[52:55], v[84:87], v[172:175], 0
    v_mfma_f32_16x16x32_bf16 v[56:59], v[88:91], v[172:175], 0
    v_mfma_f32_16x16x32_bf16 v[60:63], v[92:95], v[172:175], 0
    v_mfma_f32_16x16x32_bf16 v[64:67], v[96:99], v[172:175], 0
    v_mfma_f32_16x16x32_bf16 v[68:71], v[100:103], v[172:175], 0
    v_mfma_f32_16x16x32_bf16 v[72:75], v[104:107], v[172:175], 0
    v_mfma_f32_16x16x32_bf16 v[76:79], v[108:111], v[172:175], 0
    v_mfma_f32_16x16x16_bf16 v[16:19], v[120:121], v[176:177], v[16:19]
    v_mfma_f32_16x16x16_bf16 v[20:23], v[120:121], v[178:179], v[20:23]
    v_mfma_f32_16x16x16_bf16 v[24:27], v[122:123], v[176:177], v[24:27]
    v_mfma_f32_16x16x16_bf16 v[28:31], v[122:123], v[178:179], v[28:31]
    v_mfma_f32_16x16x16_bf16 v[32:35], v[124:125], v[176:177], v[32:35]
    v_mfma_f32_16x16x16_bf16 v[36:39], v[124:125], v[178:179], v[36:39]
    v_mfma_f32_16x16x16_bf16 v[40:43], v[126:127], v[176:177], v[40:43]
    v_mfma_f32_16x16x16_bf16 v[44:47], v[126:127], v[178:179], v[44:47]
    v_mfma_f32_16x16x16_bf16 v[48:51], v[120:121], v[180:181], v[48:51]
    v_mfma_f32_16x16x16_bf16 v[52:55], v[120:121], v[182:183], v[52:55]
    v_mfma_f32_16x16x16_bf16 v[56:59], v[122:123], v[180:181], v[56:59]
    v_mfma_f32_16x16x16_bf16 v[60:63], v[122:123], v[182:183], v[60:63]
    v_mfma_f32_16x16x16_bf16 v[64:67], v[124:125], v[180:181], v[64:67]
    v_mfma_f32_16x16x16_bf16 v[68:71], v[124:125], v[182:183], v[68:71]
    v_mfma_f32_16x16x16_bf16 v[72:75], v[126:127], v[180:181], v[72:75]
    v_mfma_f32_16x16x16_bf16 v[76:79], v[126:127], v[182:183], v[76:79]
    s_lshl_b32 s68, s93, 18
    s_lshl_b32 s69, s94, 12
    s_add_u32 s68, s68, s69
    s_add_u32 s68, s68, 0x4400000
    s_add_u32 s69, s68, 0x20000
    v_cvt_pk_bf16_f32 v16, v16, v17
    v_cvt_pk_bf16_f32 v17, v18, v19
    v_cvt_pk_bf16_f32 v18, v20, v21
    v_cvt_pk_bf16_f32 v19, v22, v23
    buffer_store_dwordx4 v[16:19], v1, s[60:63], s68 offen offset:0 sc1
    v_cvt_pk_bf16_f32 v24, v24, v25
    v_cvt_pk_bf16_f32 v25, v26, v27
    v_cvt_pk_bf16_f32 v26, v28, v29
    v_cvt_pk_bf16_f32 v27, v30, v31
    buffer_store_dwordx4 v[24:27], v1, s[60:63], s68 offen offset:1024 sc1
    v_cvt_pk_bf16_f32 v32, v32, v33
    v_cvt_pk_bf16_f32 v33, v34, v35
    v_cvt_pk_bf16_f32 v34, v36, v37
    v_cvt_pk_bf16_f32 v35, v38, v39
    buffer_store_dwordx4 v[32:35], v1, s[60:63], s68 offen offset:2048 sc1
    v_cvt_pk_bf16_f32 v40, v40, v41
    v_cvt_pk_bf16_f32 v41, v42, v43
    v_cvt_pk_bf16_f32 v42, v44, v45
    v_cvt_pk_bf16_f32 v43, v46, v47
    buffer_store_dwordx4 v[40:43], v1, s[60:63], s68 offen offset:3072 sc1
    v_cvt_pk_bf16_f32 v48, v48, v49
    v_cvt_pk_bf16_f32 v49, v50, v51
    v_cvt_pk_bf16_f32 v50, v52, v53
    v_cvt_pk_bf16_f32 v51, v54, v55
    buffer_store_dwordx4 v[48:51], v1, s[60:63], s69 offen offset:0 sc1
    v_cvt_pk_bf16_f32 v56, v56, v57
    v_cvt_pk_bf16_f32 v57, v58, v59
    v_cvt_pk_bf16_f32 v58, v60, v61
    v_cvt_pk_bf16_f32 v59, v62, v63
    buffer_store_dwordx4 v[56:59], v1, s[60:63], s69 offen offset:1024 sc1
    v_cvt_pk_bf16_f32 v64, v64, v65
    v_cvt_pk_bf16_f32 v65, v66, v67
    v_cvt_pk_bf16_f32 v66, v68, v69
    v_cvt_pk_bf16_f32 v67, v70, v71
    buffer_store_dwordx4 v[64:67], v1, s[60:63], s69 offen offset:2048 sc1
    v_cvt_pk_bf16_f32 v72, v72, v73
    v_cvt_pk_bf16_f32 v73, v74, v75
    v_cvt_pk_bf16_f32 v74, v76, v77
    v_cvt_pk_bf16_f32 v75, v78, v79
    buffer_store_dwordx4 v[72:75], v1, s[60:63], s69 offen offset:3072 sc1
    s_lshl_b32 s99, s93, 7
    s_add_u32 s99, s99, 0x7420000
    s_mov_b32 s100, 1
    s_waitcnt vmcnt(0)
    s_barrier
    s_cmp_lg_u32 s65, 0
    s_cbranch_scc1 Lsig_141
    v_mov_b32 v2, s100
    v_mov_b32 v3, s99
    s_mov_b64 exec, 1
    buffer_atomic_add v2, v3, s[60:63], 0 offen
    s_mov_b64 exec, -1
Lsig_141:
    s_add_u32 s93, s93, 7
    s_cmp_lt_u32 s93, 64
    s_cbranch_scc1 L_att_loop
    s_branch L_done
L_fail:
    s_mov_b64 exec, -1
    v_mov_b32 v8, 0xdead
    v_mov_b32 v9, 68
    buffer_store_dword v8, v9, s[56:59], 0 offen
L_done:
    s_endpgm
.section .rodata,"a"
.p2align 6
.amdhsa_kernel gated_mix__memory_aug_recurrent_mem_tr__dense_activation_gelu__prompt_kernel
  .amdhsa_next_free_vgpr 512
  .amdhsa_next_free_sgpr 102
  .amdhsa_accum_offset 256
  .amdhsa_group_segment_fixed_size 0
  .amdhsa_kernarg_size 128
  .amdhsa_user_sgpr_count 2
  .amdhsa_user_sgpr_kernarg_segment_ptr 1
  .amdhsa_system_sgpr_workgroup_id_x 1
  .amdhsa_float_denorm_mode_32 3
  .amdhsa_float_denorm_mode_16_64 3
.end_amdhsa_kernel
```
